```python
import torch

def _softmax(x, axis=-1):
    return torch.softmax(x, dim=axis)
def _gelu(x):
    return torch.nn.functional.gelu(x, approximate="tanh")
def _silu(x):
    return torch.nn.functional.silu(x)
def _sigmoid(x):
    return torch.sigmoid(x)
def _layernorm(x, axis=-1, eps=1e-5):
    m = x.mean(dim=axis, keepdim=True)
    v = x.var(dim=axis, keepdim=True, unbiased=False)
    return (x - m) / torch.sqrt(v + eps)
def _scatter_add(tgt, idx, src, axis=0):
    return tgt.clone().index_add_(axis, idx, src)
def _segment_sum(src, seg, n):
    out = torch.zeros((n,) + src.shape[1:], dtype=src.dtype)
    return out.index_add_(0, seg, src)
def _pad(x, pw):
    flat = tuple(v for pair in reversed(pw) for v in pair)
    return torch.nn.functional.pad(x, flat)

kernel_name = 'parallel_sum__spectral_gfnet__glu_gated_swiglu__prompt'

def setup_inputs():

    _w = (lambda a: (lambda t: t.to(torch.bfloat16) if t.is_floating_point() else t)(torch.as_tensor(a)))
    def _A_setup():
        B, S, D = 1, 2048, 640
        Df = D // 2 + 1
        return {
            "x": _w((lambda *s: torch.randn(*s, dtype=torch.bfloat16) * 0.05)(B, S, D)),
            "w_r": _w((lambda *s: torch.randn(*s, dtype=torch.bfloat16) * 0.4)(S, Df) * 0.02),
            "w_i": _w((lambda *s: torch.randn(*s, dtype=torch.bfloat16) * 0.4)(S, Df) * 0.02),
        }
    _A_in = _A_setup()

    def _B_setup():
        B, S, D, F = 1, 2048, 640, 1536
        return {
            "x": _w((lambda *s: torch.randn(*s, dtype=torch.bfloat16) * 0.05)(B, S, D)),
            "w1": _w((lambda *s: torch.randn(*s, dtype=torch.bfloat16) * 0.2)(D, F) * (2.0 / D) ** 0.5),
            "w3": _w((lambda *s: torch.randn(*s, dtype=torch.bfloat16) * 0.2)(D, F) * (2.0 / D) ** 0.5),
            "w2": _w((lambda *s: torch.randn(*s, dtype=torch.bfloat16) * 0.2)(F, D) * (2.0 / F) ** 0.5),
        }
    _B_in = _B_setup()

    return {
        "A_x": _A_in["x"],
        "A_w_r": _A_in["w_r"],
        "A_w_i": _A_in["w_i"],
        "B_x": _B_in["x"],
        "B_w1": _B_in["w1"],
        "B_w3": _B_in["w3"],
        "B_w2": _B_in["w2"],
    }

def reference(A_x, A_w_r, A_w_i, B_x, B_w1, B_w3, B_w2):
    def _A_ref(x, w_r, w_i):
        B, S, D = x.shape
        X = (lambda x, axes=(-2,-1): torch.fft.rfft2(x.float(), dim=axes))(x, axes=(-2, -1))
        W = w_r + 1j * w_i
        X = X * W
        y = (lambda x, s, axes=(-2,-1): torch.fft.irfft2(x, s=s, dim=axes).to(torch.bfloat16))(X, (S, D), axes=(-2, -1))
        return y

    def _B_ref(x, w1, w3, w2):
        gate = torch.einsum("bsd,df->bsf", x, w1)
        up = torch.einsum("bsd,df->bsf", x, w3)
        h = _silu(gate) * up
        out = torch.einsum("bsf,fd->bsd", h, w2)
        return out

    x = A_x
    xn = _layernorm(x, axis=-1)
    return x + _A_ref(xn, A_w_r, A_w_i) + _B_ref(xn, B_w1, B_w3, B_w2)
```

```asm
; @launch grid=(256,1,1) block=(256,1,1) lds=163840
.amdgcn_target "amdgcn-amd-amdhsa--gfx950"
.text
.globl parallel_sum__spectral_gfnet__glu_gated_swiglu__prompt_kernel
.p2align 8
.type parallel_sum__spectral_gfnet__glu_gated_swiglu__prompt_kernel,@function
parallel_sum__spectral_gfnet__glu_gated_swiglu__prompt_kernel:
    s_cmp_ge_u32 s2, 256
    s_cbranch_scc1 L_end
    s_load_dwordx4 s[72:75], s[0:1], 0
    s_load_dwordx4 s[80:83], s[0:1], 32
    s_load_dwordx2 s[88:89], s[0:1], 72
    s_load_dwordx2 s[76:77], s[0:1], 16
    s_load_dwordx4 s[84:87], s[0:1], 48
    s_getpc_b64 s[36:37]
L_pc:
    s_sub_u32 s12, s36, L_pc-parallel_sum__spectral_gfnet__glu_gated_swiglu__prompt_kernel
    s_subb_u32 s13, s37, 0
    s_mov_b32 s14, tab_data-parallel_sum__spectral_gfnet__glu_gated_swiglu__prompt_kernel+31744
    s_mov_b32 s15, 0x20000
    v_lshlrev_b32 v250, 7, v0
    s_lshr_b32 s55, s2, 3
    s_xor_b32 s55, s55, 0
    s_lshl_b32 s55, s55, 15
    buffer_load_dword v248, v250, s[12:15], s55 offen
    v_lshrrev_b32 v1, 6, v0
    v_and_b32 v255, 63, v0
    v_readfirstlane_b32 s40, v1
    v_lshlrev_b32 v253, 4, v255
    s_lshr_b32 s54, s2, 3
    s_and_b32 s52, s2, 1
    s_bfe_u32 s53, s2, 0x20001
    s_lshl_b32 s41, s52, 7
    s_lshl_b32 s55, s53, 5
    s_add_u32 s41, s41, s55
    s_add_u32 s41, s41, s54
    v_lshrrev_b32 v1, 5, v255
    v_and_b32 v251, 31, v255
    v_lshlrev_b32 v251, 3, v251
    v_mul_u32_u24 v252, 1310720, v1
    v_add_u32 v252, v252, v251
    s_lshl_b32 s55, s40, 8
    s_add_u32 s55, s55, s41
    s_mul_i32 s44, s55, 1280
    s_add_u32 s36, s36, tab_data-L_pc
    s_addc_u32 s37, s37, 0
    s_mov_b32 s38, 31744
    s_mov_b32 s39, 0x20000
    s_lshl_b32 s47, s40, 12
    s_add_u32 m0, s47, 0x0
    s_nop 0
    buffer_load_dwordx4 v253, s[36:39], s47 offen offset:0 lds
    buffer_load_dwordx4 v253, s[36:39], s47 offen offset:1024 lds
    buffer_load_dwordx4 v253, s[36:39], s47 offen offset:2048 lds
    buffer_load_dwordx4 v253, s[36:39], s47 offen offset:3072 lds
    v_mul_u32_u24 v1, 1280, v1
    s_mul_i32 s55, s40, 2560
    v_add3_u32 v247, v1, v251, s55
    s_mov_b32 s6, 2621440
    s_mov_b32 s7, 0x20000
    s_mov_b32 s10, 1314816
    s_mov_b32 s11, 0x20000
    s_mov_b32 s18, 1966080
    s_mov_b32 s19, 0x20000
    s_mov_b32 s22, 1966080
    s_mov_b32 s23, 0x20000
    s_mov_b32 s26, 1966080
    s_mov_b32 s27, 0x20000
    s_mov_b32 s30, 2621440
    s_mov_b32 s31, 0x20000
    s_mov_b32 s34, 268435456
    s_mov_b32 s35, 0x20000
    s_and_b32 s55, s54, 7
    s_lshr_b32 s56, s54, 3
    s_lshl_b32 s52, s52, 3
    s_add_u32 s52, s52, s55
    s_lshl_b32 s53, s53, 2
    s_add_u32 s53, s53, s56
    s_lshl_b32 s55, s40, 5
    s_add_u32 s55, s55, s52
    s_mul_i32 s45, s55, 20480
    s_and_b32 s55, s53, 1
    s_lshl_b32 s55, s55, 6
    s_mul_i32 s46, s53, 192
    s_add_u32 s46, s46, s55
    s_mul_i32 s55, s40, 49152
    s_add_u32 s46, s46, s55
    s_mul_i32 s55, s52, 5
    s_lshr_b32 s55, s55, 3
    s_sub_u32 s56, s55, 10
    s_cselect_b32 s55, s55, s56
    s_lshl_b32 s56, s55, 7
    s_add_u32 s98, s45, s56
    s_mul_i32 s56, s55, 196608
    s_add_u32 s51, s46, s56
    s_add_u32 s55, s55, 1
    s_sub_u32 s56, s55, 10
    s_cselect_b32 s55, s55, s56
    s_lshl_b32 s56, s55, 7
    s_add_u32 s99, s45, s56
    s_mul_i32 s56, s55, 196608
    s_add_u32 s50, s46, s56
    s_add_u32 s55, s55, 1
    s_sub_u32 s56, s55, 10
    s_cselect_b32 s55, s55, s56
    s_lshl_b32 s56, s55, 7
    s_add_u32 s45, s45, s56
    s_mul_i32 s56, s55, 196608
    s_add_u32 s46, s46, s56
    s_mul_i32 s43, s40, 12288
    s_add_u32 s43, s43, 65536
    s_lshl_b32 s55, s2, 2
    s_add_u32 s55, s55, s40
    s_mul_i32 s55, s55, 176
    s_add_u32 s55, s55, 31744
    s_add_u32 s96, s36, s55
    s_addc_u32 s97, s37, 0
    v_lshrrev_b32 v1, 3, v255
    v_mul_u32_u24 v250, 1280, v1
    v_and_b32 v251, 7, v255
    v_lshrrev_b32 v249, 4, v255
    v_xor_b32 v249, v249, v251
    v_lshl_add_u32 v244, v249, 4, v250
    v_xor_b32 v249, 4, v249
    v_lshl_add_u32 v245, v249, 4, v250
    v_add_u32 v245, 9216, v245
    v_mul_u32_u24 v250, 3072, v1
    v_bfe_u32 v249, v255, 4, 1
    v_lshlrev_b32 v249, 2, v249
    v_xor_b32 v249, v249, v251
    v_lshl_add_u32 v242, v249, 4, v250
    v_add_u32 v243, 23552, v242
    s_waitcnt lgkmcnt(0)
    s_mov_b32 s4, s72
    s_mov_b32 s5, s73
    buffer_load_dwordx2 v[2:3], v252, s[4:7], s44 offen offset:0
    buffer_load_dwordx2 v[4:5], v252, s[4:7], s44 offen offset:256
    buffer_load_dwordx2 v[6:7], v252, s[4:7], s44 offen offset:512
    buffer_load_dwordx2 v[8:9], v252, s[4:7], s44 offen offset:768
    buffer_load_dwordx2 v[10:11], v252, s[4:7], s44 offen offset:1024
    s_lshl_b32 s47, s40, 11
    s_min_u32 s49, s47, 5120
    s_add_u32 m0, s49, 0x6000
    s_add_u32 s48, s49, 0x6000
    buffer_load_dwordx4 v253, s[36:39], s48 offen offset:0 lds
    buffer_load_dwordx4 v253, s[36:39], s48 offen offset:1024 lds
    s_cmp_lt_u32 s40, 2
    s_cselect_b32 s8, s74, s76
    s_cselect_b32 s9, s75, s77
    s_mov_b64 s[16:17], s[80:81]
    s_mov_b64 s[20:21], s[82:83]
    s_mov_b64 s[24:25], s[84:85]
    s_mov_b64 s[28:29], s[86:87]
    s_add_u32 s32, s88, 0
    s_addc_u32 s33, s89, 0
    v_mov_b32 v254, 0
    buffer_load_dword v246, v254, s[32:35], 0 offen sc1
    s_load_dwordx16 s[52:67], s[96:97], 0
    s_load_dwordx16 s[68:83], s[96:97], 64
    s_load_dwordx8 s[84:91], s[96:97], 128
    s_load_dwordx4 s[92:95], s[96:97], 160
    s_mov_b32 s0, 0x88888888
    s_mov_b32 s1, 0x88888888
    s_mov_b32 s3, 0x07060302
    v_bfe_u32 v218, v255, 2, 2
    v_lshrrev_b32 v229, 5, v255
    v_lshl_add_u32 v218, v229, 2, v218
    v_mul_u32_u24 v225, 40, v218
    v_and_b32 v218, 3, v255
    v_lshlrev_b32 v218, 3, v218
    v_bfe_u32 v219, v255, 4, 1
    v_cmp_eq_u32 vcc, 1, v219
    s_mul_i32 s49, s40, 2560
    v_lshlrev_b32 v250, 6, v229
    v_cndmask_b32_e64 v233, v218, 32, vcc
    v_add3_u32 v225, v225, v233, s49
    v_lshl_add_u32 v233, v229, 12, v218
    v_bfe_u32 v229, v255, 2, 3
    s_add_u32 m0, s43, 0x0
    s_add_u32 s48, s98, 0x0
    buffer_load_dwordx4 v244, s[4:7], s48 offen offset:0 lds
    buffer_load_dwordx4 v245, s[4:7], s48 offen offset:1024 lds
    v_lshl_add_u32 v233, v229, 8, v233
    v_lshl_add_u32 v233, s40, 6, v233
    v_lshrrev_b32 v218, 4, v255
    v_mul_u32_u24 v218, 1280, v218
    v_and_b32 v229, 15, v255
    v_lshl_add_u32 v216, v229, 4, v218
    v_add_u32 v217, 4096, v216
    v_mov_b32 v116, s40
    v_add_u32 v117, 1, v116
    v_and_b32 v117, 3, v117
    v_add_u32 v118, 2, v116
    v_and_b32 v118, 3, v118
    v_add_u32 v119, 3, v116
    v_and_b32 v119, 3, v119
    v_and_b32 v249, 31, v255
    v_lshlrev_b32 v214, 7, v249
    v_add_u32 v214, s43, v214
    v_bfe_u32 v249, v255, 1, 3
    v_lshrrev_b32 v215, 5, v255
    v_xor_b32 v249, v249, v215
    v_lshlrev_b32 v213, 1, v116
    v_xor_b32 v213, v213, v249
    v_lshl_add_u32 v76, v213, 4, v214
    v_lshlrev_b32 v213, 1, v117
    s_add_u32 m0, s43, 0x800
    s_add_u32 s48, s98, 0x50000
    buffer_load_dwordx4 v244, s[4:7], s48 offen offset:0 lds
    buffer_load_dwordx4 v245, s[4:7], s48 offen offset:1024 lds
    v_xor_b32 v213, v213, v249
    v_lshl_add_u32 v77, v213, 4, v214
    v_lshlrev_b32 v213, 1, v118
    v_xor_b32 v213, v213, v249
    v_lshl_add_u32 v78, v213, 4, v214
    v_lshlrev_b32 v213, 1, v119
    v_xor_b32 v213, v213, v249
    v_lshl_add_u32 v79, v213, 4, v214
    v_bfe_u32 v249, v255, 2, 2
    v_lshl_add_u32 v249, v215, 3, v249
    v_bfe_u32 v214, v255, 4, 1
    v_lshlrev_b32 v214, 5, v214
    v_and_b32 v213, 3, v255
    v_lshl_add_u32 v214, v213, 3, v214
    v_lshl_add_u32 v214, v249, 7, v214
    v_bfe_u32 v249, v255, 3, 1
    v_lshl_add_u32 v214, v249, 6, v214
    v_mov_b32 v220, 3072
    v_mad_u32_u24 v220, v220, s40, v214
    v_xor_b32 v221, 64, v220
    v_add_u32 v214, 114688, v214
    v_add_u32 v213, 65536, v253
    v_lshl_add_u32 v80, v116, 11, v214
    v_xor_b32 v81, 64, v80
    s_add_u32 m0, s47, 0x1c000
    s_nop 0
    buffer_load_dwordx4 v242, s[16:19], s51 offen offset:0 lds
    buffer_load_dwordx4 v243, s[16:19], s51 offen offset:1024 lds
    v_lshl_add_u32 v88, v116, 11, v213
    v_lshl_add_u32 v82, v117, 11, v214
    v_xor_b32 v83, 64, v82
    v_lshl_add_u32 v89, v117, 11, v213
    v_lshl_add_u32 v84, v118, 11, v214
    v_xor_b32 v85, 64, v84
    v_lshl_add_u32 v90, v118, 11, v213
    v_lshl_add_u32 v86, v119, 11, v214
    v_xor_b32 v87, 64, v86
    v_lshl_add_u32 v91, v119, 11, v213
    v_bfe_u32 v249, v255, 2, 2
    v_xor_b32 v249, v249, v215
    v_min_u32 v249, 1, v249
    v_sub_u32 v249, 1, v249
    v_mul_u32_u24 v249, 0x3f80, v249
    v_lshl_or_b32 v249, v249, 16, v249
    v_bfe_i32 v215, v255, 1, 1
    v_and_b32 v94, v249, v215
    v_xor_b32 v92, v249, v94
    s_waitcnt vmcnt(13)
    v_lshlrev_b32 v12, 16, v2
    v_and_b32 v13, 0xffff0000, v2
    v_lshlrev_b32 v14, 16, v3
    v_and_b32 v15, 0xffff0000, v3
    s_waitcnt vmcnt(12)
    v_lshlrev_b32 v16, 16, v4
    s_add_u32 m0, s47, 0x1e000
    s_nop 0
    buffer_load_dwordx4 v242, s[20:23], s51 offen offset:0 lds
    buffer_load_dwordx4 v243, s[20:23], s51 offen offset:1024 lds
    v_and_b32 v17, 0xffff0000, v4
    v_lshlrev_b32 v18, 16, v5
    v_and_b32 v19, 0xffff0000, v5
    s_waitcnt vmcnt(13)
    v_lshlrev_b32 v20, 16, v6
    v_and_b32 v21, 0xffff0000, v6
    v_lshlrev_b32 v22, 16, v7
    v_and_b32 v23, 0xffff0000, v7
    s_waitcnt vmcnt(12)
    v_lshlrev_b32 v24, 16, v8
    v_and_b32 v25, 0xffff0000, v8
    v_lshlrev_b32 v26, 16, v9
    v_and_b32 v27, 0xffff0000, v9
    s_waitcnt vmcnt(11)
    v_lshlrev_b32 v28, 16, v10
    v_and_b32 v29, 0xffff0000, v10
    v_lshlrev_b32 v30, 16, v11
    v_and_b32 v31, 0xffff0000, v11
    v_pk_add_f32 v[200:201], v[12:13], v[14:15]
    v_pk_add_f32 v[202:203], v[16:17], v[18:19]
    v_pk_add_f32 v[200:201], v[200:201], v[20:21]
    v_pk_add_f32 v[202:203], v[202:203], v[22:23]
    v_pk_add_f32 v[200:201], v[200:201], v[24:25]
    v_pk_add_f32 v[202:203], v[202:203], v[26:27]
    v_pk_add_f32 v[200:201], v[200:201], v[28:29]
    v_pk_add_f32 v[202:203], v[202:203], v[30:31]
    v_pk_add_f32 v[200:201], v[200:201], v[202:203]
    s_add_u32 m0, s43, 0x1000
    s_add_u32 s48, s99, 0x0
    buffer_load_dwordx4 v244, s[4:7], s48 offen offset:0 lds
    buffer_load_dwordx4 v245, s[4:7], s48 offen offset:1024 lds
    v_add_f32 v202, v200, v201
    v_mov_b32 v93, v92
    v_mov_b32 v95, v94
    v_add_f32_dpp v202, v202, v202 row_ror:8 row_mask:0xf bank_mask:0xf
    v_and_b32 v249, 1, v255
    v_mul_u32_u24 v249, 0xaaaa, v249
    v_add_f32_dpp v202, v202, v202 row_ror:4 row_mask:0xf bank_mask:0xf
    v_or_b32 v237, 0x4444, v249
    v_lshrrev_b32 v211, 5, v255
    v_add_f32_dpp v202, v202, v202 row_ror:2 row_mask:0xf bank_mask:0xf
    v_and_b32 v212, 31, v255
    v_lshl_add_u32 v210, v211, 7, v212
    v_add_f32_dpp v202, v202, v202 row_ror:1 row_mask:0xf bank_mask:0xf
    v_mov_b32 v218, v202
    v_lshlrev_b32 v210, 2, v210
    v_mov_b32 v241, 3072
    v_permlane16_swap_b32 v202, v218
    v_add_f32 v202, v202, v218
    v_mul_f32 v202, 0x3acccccd, v202
    v_mov_b32 v203, v202
    v_pk_add_f32 v[12:13], v[12:13], v[202:203] neg_lo:[0,1] neg_hi:[0,1]
    v_pk_add_f32 v[14:15], v[14:15], v[202:203] neg_lo:[0,1] neg_hi:[0,1]
    v_pk_add_f32 v[16:17], v[16:17], v[202:203] neg_lo:[0,1] neg_hi:[0,1]
    v_pk_add_f32 v[18:19], v[18:19], v[202:203] neg_lo:[0,1] neg_hi:[0,1]
    s_add_u32 m0, s43, 0x1800
    s_add_u32 s48, s99, 0x50000
    buffer_load_dwordx4 v244, s[4:7], s48 offen offset:0 lds
    buffer_load_dwordx4 v245, s[4:7], s48 offen offset:1024 lds
    v_pk_add_f32 v[20:21], v[20:21], v[202:203] neg_lo:[0,1] neg_hi:[0,1]
    v_pk_add_f32 v[22:23], v[22:23], v[202:203] neg_lo:[0,1] neg_hi:[0,1]
    v_pk_add_f32 v[24:25], v[24:25], v[202:203] neg_lo:[0,1] neg_hi:[0,1]
    v_pk_add_f32 v[26:27], v[26:27], v[202:203] neg_lo:[0,1] neg_hi:[0,1]
    v_pk_add_f32 v[28:29], v[28:29], v[202:203] neg_lo:[0,1] neg_hi:[0,1]
    v_pk_add_f32 v[30:31], v[30:31], v[202:203] neg_lo:[0,1] neg_hi:[0,1]
    v_pk_mul_f32 v[200:201], v[12:13], v[12:13]
    v_pk_mul_f32 v[218:219], v[14:15], v[14:15]
    v_pk_fma_f32 v[200:201], v[16:17], v[16:17], v[200:201]
    v_pk_fma_f32 v[218:219], v[18:19], v[18:19], v[218:219]
    v_pk_fma_f32 v[200:201], v[20:21], v[20:21], v[200:201]
    v_pk_fma_f32 v[218:219], v[22:23], v[22:23], v[218:219]
    v_pk_fma_f32 v[200:201], v[24:25], v[24:25], v[200:201]
    v_pk_fma_f32 v[218:219], v[26:27], v[26:27], v[218:219]
    v_pk_fma_f32 v[200:201], v[28:29], v[28:29], v[200:201]
    v_pk_fma_f32 v[218:219], v[30:31], v[30:31], v[218:219]
    v_pk_add_f32 v[200:201], v[200:201], v[218:219]
    v_add_f32 v200, v200, v201
    v_mad_u32_u24 v241, v241, s40, v210
    v_lshl_add_u32 v238, s40, 5, v212
    v_add_f32_dpp v200, v200, v200 row_ror:8 row_mask:0xf bank_mask:0xf
    v_add_u32 v239, 128, v238
    v_add_u32 v240, 256, v238
    v_add_f32_dpp v200, v200, v200 row_ror:4 row_mask:0xf bank_mask:0xf
    s_add_u32 m0, s47, 0x20000
    s_nop 0
    buffer_load_dwordx4 v242, s[16:19], s50 offen offset:0 lds
    buffer_load_dwordx4 v243, s[16:19], s50 offen offset:1024 lds
    v_min_u32 v240, 320, v240
    v_mul_u32_u24 v210, 6144, v211
    v_add_f32_dpp v200, v200, v200 row_ror:2 row_mask:0xf bank_mask:0xf
    v_add_u32 v210, 53248, v210
    v_lshl_add_u32 v230, v238, 2, v210
    v_add_f32_dpp v200, v200, v200 row_ror:1 row_mask:0xf bank_mask:0xf
    v_mov_b32 v218, v200
    v_sub_u32 v212, 640, v238
    v_min_u32 v226, 1, v238
    v_permlane16_swap_b32 v200, v218
    v_add_f32 v200, v200, v218
    v_mov_b32 v129, 0x3727c5ac
    v_fmac_f32 v129, 0x3acccccd, v200
    v_rsq_f32 v200, v129
    v_cvt_pk_bf16_f32 v128, v202, v202
    v_lshlrev_b32 v128, 16, v128
    v_sub_f32 v202, v202, v128
    v_mul_f32 v202, v202, v200
    v_mov_b32 v201, v200
    v_mov_b32 v203, v202
    v_pk_fma_f32 v[12:13], v[12:13], v[200:201], v[202:203]
    v_pk_fma_f32 v[14:15], v[14:15], v[200:201], v[202:203]
    v_pk_fma_f32 v[16:17], v[16:17], v[200:201], v[202:203]
    v_pk_fma_f32 v[18:19], v[18:19], v[200:201], v[202:203]
    s_add_u32 m0, s47, 0x22000
    s_nop 0
    buffer_load_dwordx4 v242, s[20:23], s50 offen offset:0 lds
    buffer_load_dwordx4 v243, s[20:23], s50 offen offset:1024 lds
    v_pk_fma_f32 v[20:21], v[20:21], v[200:201], v[202:203]
    v_pk_fma_f32 v[22:23], v[22:23], v[200:201], v[202:203]
    v_pk_fma_f32 v[24:25], v[24:25], v[200:201], v[202:203]
    v_pk_fma_f32 v[26:27], v[26:27], v[200:201], v[202:203]
    v_pk_fma_f32 v[28:29], v[28:29], v[200:201], v[202:203]
    v_pk_fma_f32 v[30:31], v[30:31], v[200:201], v[202:203]
    v_cvt_pk_bf16_f32 v12, v12, v13
    v_cvt_pk_bf16_f32 v13, v14, v15
    ds_write_b64 v247, v[12:13] offset:31744
    v_cvt_pk_bf16_f32 v14, v16, v17
    v_cvt_pk_bf16_f32 v15, v18, v19
    ds_write_b64 v247, v[14:15] offset:32000
    v_cvt_pk_bf16_f32 v16, v20, v21
    v_cvt_pk_bf16_f32 v17, v22, v23
    ds_write_b64 v247, v[16:17] offset:32256
    v_cvt_pk_bf16_f32 v18, v24, v25
    v_cvt_pk_bf16_f32 v19, v26, v27
    ds_write_b64 v247, v[18:19] offset:32512
    v_cvt_pk_bf16_f32 v20, v28, v29
    v_cvt_pk_bf16_f32 v21, v30, v31
    ds_write_b64 v247, v[20:21] offset:32768
    ds_read_b64_tr_b16 v[100:101], v225 offset:31744
    ds_read_b64_tr_b16 v[102:103], v225 offset:32064
    ds_read_b64_tr_b16 v[108:109], v225 offset:33024
    s_add_u32 m0, s43, 0x2000
    s_add_u32 s48, s45, 0x0
    buffer_load_dwordx4 v244, s[4:7], s48 offen offset:0 lds
    buffer_load_dwordx4 v245, s[4:7], s48 offen offset:1024 lds
    ds_read_b64_tr_b16 v[110:111], v225 offset:33344
    ds_read_b64_tr_b16 v[104:105], v225 offset:32384
    ds_read_b64_tr_b16 v[106:107], v225 offset:32704
    ds_read_b64_tr_b16 v[112:113], v225 offset:33664
    ds_read_b64_tr_b16 v[114:115], v225 offset:33984
    v_mul_u32_u24 v212, v212, v226
    v_lshl_add_u32 v226, v212, 2, v210
    v_lshl_add_u32 v231, v239, 2, v210
    v_sub_u32 v212, 640, v239
    v_lshl_add_u32 v227, v212, 2, v210
    v_lshl_add_u32 v232, v240, 2, v210
    v_sub_u32 v212, 640, v240
    v_lshl_add_u32 v228, v212, 2, v210
    v_lshrrev_b32 v209, 5, v255
    v_and_b32 v207, 1, v255
    v_lshlrev_b32 v207, 9, v207
    v_bfe_u32 v208, v255, 1, 3
    v_and_b32 v206, 1, v208
    v_lshlrev_b32 v204, 9, v206
    v_sub_u32 v204, 256, v204
    v_lshlrev_b32 v209, 9, v209
    v_add_u32 v209, s41, v209
    v_mad_u32_u24 v206, v209, v208, v207
    v_lshl_add_u32 v205, v208, 8, v206
    s_add_u32 m0, s43, 0x2800
    s_add_u32 s48, s45, 0x50000
    buffer_load_dwordx4 v244, s[4:7], s48 offen offset:0 lds
    buffer_load_dwordx4 v245, s[4:7], s48 offen offset:1024 lds
    v_add_u32 v120, v206, v204
    v_sub_u32 v124, v206, v204
    v_add_u32 v122, v205, v204
    v_sub_u32 v126, v205, v204
    v_cvt_f32_i32 v120, v120
    v_mul_f32 v120, 0x3a000000, v120
    v_cvt_f32_i32 v122, v122
    v_mul_f32 v122, 0x3a000000, v122
    v_cvt_f32_i32 v124, v124
    v_mul_f32 v124, 0x3a000000, v124
    v_cvt_f32_i32 v126, v126
    v_mul_f32 v126, 0x3a000000, v126
    v_subrev_f32 v121, 0x3e800000, v120
    v_add_f32 v125, 0x3e800000, v124
    v_subrev_f32 v123, 0x3e800000, v122
    v_add_f32 v127, 0x3e800000, v126
    v_cos_f32 v120, v120
    v_cos_f32 v121, v121
    v_cos_f32 v122, v122
    v_cos_f32 v123, v123
    v_cos_f32 v124, v124
    v_cos_f32 v125, v125
    v_cos_f32 v126, v126
    v_cos_f32 v127, v127
    s_add_u32 m0, s47, 0x24000
    s_nop 0
    buffer_load_dwordx4 v242, s[16:19], s46 offen offset:0 lds
    buffer_load_dwordx4 v243, s[16:19], s46 offen offset:1024 lds
    v_cvt_pk_bf16_f32 v96, v120, v121
    v_cvt_pk_bf16_f32 v97, v122, v123
    v_cvt_pk_bf16_f32 v98, v124, v125
    v_cvt_pk_bf16_f32 v99, v126, v127
    v_mul_u32_u24 v211, 2816, v211
    v_add_u32 v211, 26624, v211
    v_mul_u32_u24 v212, 4370, v238
    v_lshrrev_b32 v212, 16, v212
    v_add_lshl_u32 v234, v212, v238, 2
    v_add_u32 v222, v234, v211
    v_mul_u32_u24 v212, 4370, v239
    v_lshrrev_b32 v212, 16, v212
    v_add_lshl_u32 v235, v212, v239, 2
    v_add_u32 v223, v235, v211
    v_mul_u32_u24 v212, 4370, v240
    v_lshrrev_b32 v212, 16, v212
    v_add_lshl_u32 v236, v212, v240, 2
    v_add_u32 v224, v236, v211
    v_lshlrev_b32 v1, 4, v0
    v_lshrrev_b32 v212, 2, v0
    v_and_b32 v211, 3, v0
    v_lshlrev_b32 v251, 14, v212
    v_lshl_add_u32 v251, v211, 4, v251
    s_waitcnt lgkmcnt(0)
    s_add_u32 m0, s47, 0x26000
    s_nop 0
    buffer_load_dwordx4 v242, s[20:23], s46 offen offset:0 lds
    buffer_load_dwordx4 v243, s[20:23], s46 offen offset:1024 lds
    s_waitcnt vmcnt(24)
    v_readfirstlane_b32 s42, v246
    s_nop 0
    s_mul_i32 s42, s42, 1664525
    s_add_u32 s42, s42, 1013904223
    s_bitcmp1_b32 s55, 0
    s_cselect_b64 s[12:13], s[20:21], s[16:17]
    s_mov_b32 s14, 1966080
    s_mov_b32 s15, 0x20000
    s_and_b32 s49, s55, -2
    s_mul_i32 s48, s40, 3072
    s_add_u32 m0, s48, 53248
    v_mov_b32 v246, s42
    buffer_load_dwordx4 v242, s[12:15], s49 offen offset:0 nt lds
    buffer_load_dwordx4 v243, s[12:15], s49 offen offset:1024 nt lds
    s_add_u32 m0, s47, 0xa800
    s_nop 0
    buffer_load_dwordx4 v216, s[24:27], s53 offen offset:0 nt lds
    buffer_load_dwordx4 v217, s[24:27], s53 offen offset:1024 nt lds
    v_mov_b32 v130, s42
    v_mov_b32 v131, s42
    s_mov_b32 exec_lo, 1
    s_mov_b32 exec_hi, 1
    buffer_store_dwordx4 v[128:131], v250, s[32:35], s52 offen sc1
    s_mov_b64 exec, -1
    s_waitcnt vmcnt(25)
    ds_read_b128 a[0:3], v76 offset:0
    ds_read_b128 a[4:7], v77 offset:0
    ds_read_b128 a[8:11], v78 offset:0
    ds_read_b128 a[12:15], v79 offset:0
    v_mov_b32 v116, 0
    v_mov_b32 v117, 0
    v_mov_b32 v118, 0
    v_mov_b32 v119, 0
    v_mov_b32 v120, 0
    v_mov_b32 v121, 0
    v_mov_b32 v122, 0
    v_mov_b32 v123, 0
    s_waitcnt vmcnt(21)
    s_barrier
    ds_read_b64_tr_b16 v[124:125], v80 offset:0
    ds_read_b64_tr_b16 v[126:127], v80 offset:512
    ds_read_b64_tr_b16 v[128:129], v81 offset:0
    ds_read_b64_tr_b16 v[130:131], v81 offset:512
    ds_read_b64_tr_b16 v[132:133], v80 offset:8192
    ds_read_b64_tr_b16 v[134:135], v80 offset:8704
    ds_read_b64_tr_b16 v[136:137], v81 offset:8192
    ds_read_b64_tr_b16 v[138:139], v81 offset:8704
    ds_read_b64_tr_b16 v[140:141], v82 offset:0
    ds_read_b64_tr_b16 v[142:143], v82 offset:512
    ds_read_b64_tr_b16 v[144:145], v83 offset:0
    ds_read_b64_tr_b16 v[146:147], v83 offset:512
    s_waitcnt lgkmcnt(8)
    v_mfma_f32_32x32x16_bf16 v[12:27], v[124:127], a[0:3], 0
    ds_read_b128 a[160:163], v253 offset:0
    ds_read_b64_tr_b16 v[148:149], v82 offset:8192
    ds_read_b64_tr_b16 v[150:151], v82 offset:8704
    ds_read_b128 a[164:167], v253 offset:2048
    ds_read_b128 a[168:171], v253 offset:4096
    v_mfma_f32_32x32x16_bf16 v[28:43], v[128:131], a[0:3], 0
    v_smfmac_f32_16x16x64_bf16 v[116:119], v[92:95], v[124:131], v237
    ds_read_b128 a[172:175], v253 offset:1024
    ds_read_b64_tr_b16 v[152:153], v83 offset:8192
    ds_read_b64_tr_b16 v[154:155], v83 offset:8704
    ds_read_b128 a[176:179], v253 offset:3072
    ds_read_b128 a[180:183], v253 offset:5120
    s_add_u32 m0, s43, 0x0
    s_add_u32 s48, s77, 0x0
    buffer_load_dwordx4 v244, s[4:7], s48 offen offset:0 lds
    buffer_load_dwordx4 v245, s[4:7], s48 offen offset:1024 lds
    s_waitcnt lgkmcnt(14)
    v_mfma_f32_32x32x16_bf16 v[44:59], v[132:135], a[0:3], 0
    s_add_u32 m0, s43, 0x800
    s_add_u32 s48, s77, 0x50000
    buffer_load_dwordx4 v244, s[4:7], s48 offen offset:0 lds
    buffer_load_dwordx4 v245, s[4:7], s48 offen offset:1024 lds
    ds_read_b64_tr_b16 v[124:125], v84 offset:0
    ds_read_b64_tr_b16 v[126:127], v84 offset:512
    v_mfma_f32_32x32x16_bf16 v[60:75], v[136:139], a[0:3], 0
    v_smfmac_f32_16x16x64_bf16 v[120:123], v[92:95], v[132:139], v237
    ds_read_b128 v[156:159], v253 offset:6144
    ds_read_b64_tr_b16 v[128:129], v85 offset:0
    ds_read_b64_tr_b16 v[130:131], v85 offset:512
    ds_read_b128 v[168:171], v253 offset:10240
    s_waitcnt lgkmcnt(15)
    v_mfma_f32_32x32x16_bf16 v[180:195], v[100:103], a[160:163], 0
    v_mfma_f32_32x32x16_bf16 v[12:27], v[140:143], a[4:7], v[12:27]
    ds_read_b128 v[160:163], v253 offset:7168
    ds_read_b64_tr_b16 v[132:133], v84 offset:8192
    ds_read_b64_tr_b16 v[134:135], v84 offset:8704
    v_mfma_f32_32x32x16_bf16 v[196:211], v[108:111], a[160:163], 0
    s_waitcnt vmcnt(21)
    ds_read_b128 a[16:19], v76 offset:4096
    v_mfma_f32_32x32x16_bf16 v[28:43], v[144:147], a[4:7], v[28:43]
    ds_read_b128 v[172:175], v253 offset:11264
    ds_read_b64_tr_b16 v[136:137], v85 offset:8192
    ds_read_b64_tr_b16 v[138:139], v85 offset:8704
    ds_read_b128 v[164:167], v253 offset:8192
    s_waitcnt lgkmcnt(15)
    v_mfma_f32_32x32x16_bf16 v[180:195], v[108:111], a[164:167], v[180:195]
    ds_read_b128 a[20:23], v77 offset:4096
    v_mfma_f32_32x32x16_bf16 v[44:59], v[148:151], a[4:7], v[44:59]
    ds_read_b128 v[176:179], v253 offset:12288
    ds_read_b64_tr_b16 v[140:141], v86 offset:0
    ds_read_b64_tr_b16 v[142:143], v86 offset:512
    v_mfma_f32_32x32x16_bf16 v[196:211], v[100:103], a[168:171], v[196:211]
    ds_read_b128 a[24:27], v78 offset:4096
    v_mfma_f32_32x32x16_bf16 v[60:75], v[152:155], a[4:7], v[60:75]
    ds_read_b128 a[184:187], v253 offset:26624
    ds_read_b64_tr_b16 v[144:145], v87 offset:0
    ds_read_b64_tr_b16 v[146:147], v87 offset:512
    v_mfma_f32_32x32x16_bf16 v[180:195], v[104:107], a[172:175], v[180:195]
    ds_read_b128 a[28:31], v79 offset:4096
    s_waitcnt lgkmcnt(15)
    v_mfma_f32_32x32x16_bf16 v[12:27], v[124:127], a[8:11], v[12:27]
    ds_read_b128 a[188:191], v253 offset:28672
    ds_read_b64_tr_b16 v[148:149], v86 offset:8192
    ds_read_b64_tr_b16 v[150:151], v86 offset:8704
    ds_read_b128 a[192:195], v253 offset:27648
    v_mfma_f32_32x32x16_bf16 v[196:211], v[112:115], a[172:175], v[196:211]
    v_mfma_f32_32x32x16_bf16 v[28:43], v[128:131], a[8:11], v[28:43]
    ds_read_b128 a[196:199], v253 offset:29696
    ds_read_b64_tr_b16 v[152:153], v87 offset:8192
    ds_read_b64_tr_b16 v[154:155], v87 offset:8704
    v_mfma_f32_32x32x16_bf16 v[180:195], v[112:115], a[176:179], v[180:195]
    s_waitcnt lgkmcnt(15)
    v_mfma_f32_32x32x16_bf16 v[44:59], v[132:135], a[8:11], v[44:59]
    ds_read_b128 a[200:203], v253 offset:30720
    v_mfma_f32_32x32x16_bf16 v[196:211], v[104:107], a[180:183], v[196:211]
    s_waitcnt vmcnt(17)
    s_barrier
    ds_read_b64_tr_b16 v[124:125], v80 offset:16384
    ds_read_b64_tr_b16 v[126:127], v80 offset:16896
    v_mfma_f32_32x32x16_bf16 v[60:75], v[136:139], a[8:11], v[60:75]
    ds_read_b64_tr_b16 v[128:129], v81 offset:16384
    ds_read_b64_tr_b16 v[130:131], v81 offset:16896
    s_waitcnt lgkmcnt(12)
    s_add_u32 m0, s43, 0x1000
    s_add_u32 s48, s78, 0x0
    buffer_load_dwordx4 v244, s[4:7], s48 offen offset:0 lds
    buffer_load_dwordx4 v245, s[4:7], s48 offen offset:1024 lds
    v_mfma_f32_32x32x16_bf16 v[12:27], v[140:143], a[12:15], v[12:27]
    s_add_u32 m0, s43, 0x1800
    s_add_u32 s48, s78, 0x50000
    buffer_load_dwordx4 v244, s[4:7], s48 offen offset:0 lds
    buffer_load_dwordx4 v245, s[4:7], s48 offen offset:1024 lds
    ds_read_b64_tr_b16 v[132:133], v80 offset:24576
    ds_read_b64_tr_b16 v[134:135], v80 offset:25088
    v_mul_f32 v218, v180, v168
    v_mul_f32 v180, v180, v156
    v_fmac_f32 v180, v196, v168
    v_mfma_f32_32x32x16_bf16 v[28:43], v[144:147], a[12:15], v[28:43]
    ds_read_b64_tr_b16 v[136:137], v81 offset:24576
    ds_read_b64_tr_b16 v[138:139], v81 offset:25088
    v_fma_f32 v196, v196, v156, -v218
    v_mul_f32 v218, v181, v169
    v_mul_f32 v181, v181, v157
    v_fmac_f32 v181, v197, v169
    v_fma_f32 v197, v197, v157, -v218
    v_cvt_pk_bf16_f32 v100, v180, v181
    s_waitcnt lgkmcnt(9)
    v_mfma_f32_32x32x16_bf16 v[44:59], v[148:151], a[12:15], v[44:59]
    ds_read_b64_tr_b16 v[140:141], v82 offset:16384
    ds_read_b64_tr_b16 v[142:143], v82 offset:16896
    v_cvt_pk_bf16_f32 v104, v196, v197
    v_mul_f32 v218, v182, v170
    v_mul_f32 v182, v182, v158
    v_fmac_f32 v182, v198, v170
    v_mfma_f32_32x32x16_bf16 v[60:75], v[152:155], a[12:15], v[60:75]
    ds_read_b64_tr_b16 v[144:145], v83 offset:16384
    ds_read_b64_tr_b16 v[146:147], v83 offset:16896
    v_fma_f32 v198, v198, v158, -v218
    v_mul_f32 v218, v183, v171
    v_mul_f32 v183, v183, v159
    v_fmac_f32 v183, v199, v171
    v_fma_f32 v199, v199, v159, -v218
    s_waitcnt lgkmcnt(8)
    v_mfma_f32_32x32x16_bf16 v[12:27], v[124:127], a[16:19], v[12:27]
    ds_read_b64_tr_b16 v[148:149], v82 offset:24576
    ds_read_b64_tr_b16 v[150:151], v82 offset:25088
    v_cvt_pk_bf16_f32 v101, v182, v183
    v_cvt_pk_bf16_f32 v105, v198, v199
    v_mul_f32 v218, v184, v172
    v_mul_f32 v184, v184, v160
    v_mfma_f32_32x32x16_bf16 v[28:43], v[128:131], a[16:19], v[28:43]
    v_smfmac_f32_16x16x64_bf16 v[116:119], v[92:95], v[124:131], v237
    s_add_u32 m0, s47, 0x1c000
    s_nop 0
    buffer_load_dwordx4 v242, s[16:19], s84 offen offset:0 lds
    buffer_load_dwordx4 v243, s[16:19], s84 offen offset:1024 lds
    ds_read_b64_tr_b16 v[152:153], v83 offset:24576
    ds_read_b64_tr_b16 v[154:155], v83 offset:25088
    v_fmac_f32 v184, v200, v172
    v_fma_f32 v200, v200, v160, -v218
    v_mul_f32 v218, v185, v173
    v_mul_f32 v185, v185, v161
    s_waitcnt lgkmcnt(8)
    v_mfma_f32_32x32x16_bf16 v[44:59], v[132:135], a[16:19], v[44:59]
    ds_read_b64_tr_b16 v[124:125], v84 offset:16384
    ds_read_b64_tr_b16 v[126:127], v84 offset:16896
    v_fmac_f32 v185, v201, v173
    v_fma_f32 v201, v201, v161, -v218
    v_cvt_pk_bf16_f32 v102, v184, v185
    v_cvt_pk_bf16_f32 v106, v200, v201
    s_waitcnt vmcnt(19)
    ds_read_b128 a[32:35], v76 offset:8192
    v_mfma_f32_32x32x16_bf16 v[60:75], v[136:139], a[16:19], v[60:75]
    v_smfmac_f32_16x16x64_bf16 v[120:123], v[92:95], v[132:139], v237
    ds_read_b128 a[36:39], v77 offset:8192
    ds_read_b64_tr_b16 v[128:129], v85 offset:16384
    ds_read_b64_tr_b16 v[130:131], v85 offset:16896
    v_mul_f32 v218, v186, v174
    v_mul_f32 v186, v186, v162
    v_fmac_f32 v186, v202, v174
    v_fma_f32 v202, v202, v162, -v218
    v_mul_f32 v218, v187, v175
    s_waitcnt lgkmcnt(10)
    v_mfma_f32_32x32x16_bf16 v[12:27], v[140:143], a[20:23], v[12:27]
    ds_read_b64_tr_b16 v[132:133], v84 offset:24576
    ds_read_b64_tr_b16 v[134:135], v84 offset:25088
    v_mul_f32 v187, v187, v163
    v_fmac_f32 v187, v203, v175
    v_fma_f32 v203, v203, v163, -v218
    v_cvt_pk_bf16_f32 v103, v186, v187
    v_mfma_f32_32x32x16_bf16 v[28:43], v[144:147], a[20:23], v[28:43]
    s_add_u32 m0, s47, 0x1e000
    s_nop 0
    buffer_load_dwordx4 v242, s[20:23], s84 offen offset:0 lds
    buffer_load_dwordx4 v243, s[20:23], s84 offen offset:1024 lds
    ds_read_b64_tr_b16 v[136:137], v85 offset:24576
    ds_read_b64_tr_b16 v[138:139], v85 offset:25088
    v_cvt_pk_bf16_f32 v107, v202, v203
    v_mul_f32 v218, v188, v176
    s_waitcnt lgkmcnt(10)
    v_mfma_f32_32x32x16_bf16 v[44:59], v[148:151], a[20:23], v[44:59]
    ds_read_b128 a[40:43], v78 offset:8192
    ds_read_b64_tr_b16 v[140:141], v86 offset:16384
    ds_read_b64_tr_b16 v[142:143], v86 offset:16896
    v_mul_f32 v188, v188, v164
    v_fmac_f32 v188, v204, v176
    v_fma_f32 v204, v204, v164, -v218
    v_mul_f32 v218, v189, v177
    v_mul_f32 v189, v189, v165
    v_fmac_f32 v189, v205, v177
    v_mfma_f32_32x32x16_bf16 v[60:75], v[152:155], a[20:23], v[60:75]
    ds_read_b128 a[44:47], v79 offset:8192
    ds_read_b64_tr_b16 v[144:145], v87 offset:16384
    ds_read_b64_tr_b16 v[146:147], v87 offset:16896
    v_fma_f32 v205, v205, v165, -v218
    v_cvt_pk_bf16_f32 v108, v188, v189
    v_cvt_pk_bf16_f32 v110, v204, v205
    v_mul_f32 v218, v190, v178
    v_mul_f32 v190, v190, v166
    s_waitcnt lgkmcnt(10)
    v_mfma_f32_32x32x16_bf16 v[12:27], v[124:127], a[24:27], v[12:27]
    ds_read_b64_tr_b16 v[148:149], v86 offset:24576
    ds_read_b64_tr_b16 v[150:151], v86 offset:25088
    v_fmac_f32 v190, v206, v178
    v_fma_f32 v206, v206, v166, -v218
    v_mul_f32 v218, v191, v179
    v_mul_f32 v191, v191, v167
    s_waitcnt vmcnt(15)
    ds_read_b64_tr_b16 a[204:205], v220 offset:53248
    ds_read_b64_tr_b16 a[206:207], v220 offset:53760
    ds_read_b64_tr_b16 a[208:209], v221 offset:53248
    v_mfma_f32_32x32x16_bf16 v[28:43], v[128:131], a[24:27], v[28:43]
    ds_read_b64_tr_b16 a[210:211], v221 offset:53760
    ds_read_b64_tr_b16 v[152:153], v87 offset:24576
    ds_read_b64_tr_b16 v[154:155], v87 offset:25088
    v_fmac_f32 v191, v207, v179
    v_fma_f32 v207, v207, v167, -v218
    v_cvt_pk_bf16_f32 v109, v190, v191
    v_cvt_pk_bf16_f32 v111, v206, v207
    s_waitcnt lgkmcnt(14)
    v_mfma_f32_32x32x16_bf16 v[44:59], v[132:135], a[24:27], v[44:59]
    s_waitcnt vmcnt(13)
    v_mfma_f32_32x32x16_bf16 v[180:195], a[184:187], v[100:103], 0
    v_mfma_f32_32x32x16_bf16 v[196:211], a[188:191], v[100:103], 0
    s_barrier
    ds_read_b64_tr_b16 v[124:125], v80 offset:32768
    ds_read_b64_tr_b16 v[126:127], v80 offset:33280
    v_mfma_f32_32x32x16_bf16 v[60:75], v[136:139], a[24:27], v[60:75]
    ds_read_b64_tr_b16 a[212:213], v233 offset:43008
    ds_read_b64_tr_b16 v[128:129], v81 offset:32768
    ds_read_b64_tr_b16 v[130:131], v81 offset:33280
    ds_read_b64_tr_b16 a[214:215], v233 offset:45056
    s_waitcnt lgkmcnt(15)
    s_add_u32 m0, s43, 0x2000
    s_add_u32 s48, s79, 0x0
    buffer_load_dwordx4 v244, s[4:7], s48 offen offset:0 lds
    buffer_load_dwordx4 v245, s[4:7], s48 offen offset:1024 lds
    s_waitcnt lgkmcnt(14)
    v_mfma_f32_32x32x16_bf16 v[12:27], v[140:143], a[28:31], v[12:27]
    ds_read_b64_tr_b16 a[216:217], v233 offset:43040
    ds_read_b64_tr_b16 v[132:133], v80 offset:40960
    ds_read_b64_tr_b16 v[134:135], v80 offset:41472
    ds_read_b64_tr_b16 a[218:219], v233 offset:45088
    v_mfma_f32_32x32x16_bf16 v[180:195], a[192:195], v[104:107], v[180:195]
    v_mfma_f32_32x32x16_bf16 v[196:211], a[184:187], v[104:107], v[196:211]
    v_mfma_f32_32x32x16_bf16 v[28:43], v[144:147], a[28:31], v[28:43]
    s_add_u32 m0, s43, 0x2800
    s_add_u32 s48, s79, 0x50000
    buffer_load_dwordx4 v244, s[4:7], s48 offen offset:0 lds
    buffer_load_dwordx4 v245, s[4:7], s48 offen offset:1024 lds
    ds_read_b64_tr_b16 v[136:137], v81 offset:40960
    ds_read_b64_tr_b16 v[138:139], v81 offset:41472
    v_mfma_f32_32x32x16_bf16 v[180:195], a[196:199], v[108:111], v[180:195]
    s_waitcnt lgkmcnt(12)
    v_mfma_f32_32x32x16_bf16 v[44:59], v[148:151], a[28:31], v[44:59]
    s_add_u32 s49, s56, 81920
    buffer_store_dwordx4 a[204:207], v253, s[32:35], s56 offen offset:0 sc1
    buffer_store_dwordx4 a[208:211], v253, s[32:35], s49 offen offset:0 sc1
    ds_read_b64_tr_b16 v[140:141], v82 offset:32768
    ds_read_b64_tr_b16 v[142:143], v82 offset:33280
    v_mfma_f32_32x32x16_bf16 v[196:211], a[200:203], v[108:111], v[196:211]
    v_mfma_f32_32x32x16_bf16 v[60:75], v[152:155], a[28:31], v[60:75]
    ds_read_b64_tr_b16 v[144:145], v83 offset:32768
    ds_read_b64_tr_b16 v[146:147], v83 offset:33280
    s_waitcnt lgkmcnt(11)
    v_mfma_f32_32x32x16_bf16 v[12:27], v[124:127], a[32:35], v[12:27]
    ds_read_b64_tr_b16 v[148:149], v82 offset:40960
    ds_read_b64_tr_b16 v[150:151], v82 offset:41472
    s_nop 4
    v_cvt_pk_bf16_f32 v100, v180, v196
    ds_write_b32 v241, v100 offset:53248
    v_cvt_pk_bf16_f32 v101, v181, v197
    s_waitcnt vmcnt(14)
    ds_read_b128 a[48:51], v76 offset:0
    v_mfma_f32_32x32x16_bf16 v[28:43], v[128:131], a[32:35], v[28:43]
    v_smfmac_f32_16x16x64_bf16 v[116:119], v[92:95], v[124:131], v237
    s_waitcnt lgkmcnt(14)
    buffer_store_dwordx4 a[212:215], v253, s[32:35], s54 offen offset:0 sc1
    s_waitcnt lgkmcnt(10)
    buffer_store_dwordx4 a[216:219], v253, s[32:35], s54 offen offset:1024 sc1
    ds_read_b64_tr_b16 v[152:153], v83 offset:40960
    ds_read_b64_tr_b16 v[154:155], v83 offset:41472
    s_add_u32 m0, s47, 0x20000
    s_nop 0
    buffer_load_dwordx4 v242, s[16:19], s85 offen offset:0 lds
    buffer_load_dwordx4 v243, s[16:19], s85 offen offset:1024 lds
    ds_write_b32 v241, v101 offset:53376
    v_cvt_pk_bf16_f32 v102, v182, v198
    s_waitcnt lgkmcnt(11)
    v_mfma_f32_32x32x16_bf16 v[44:59], v[132:135], a[32:35], v[44:59]
    ds_write_b32 v241, v102 offset:53504
    ds_read_b64_tr_b16 v[124:125], v84 offset:32768
    ds_read_b64_tr_b16 v[126:127], v84 offset:33280
    v_cvt_pk_bf16_f32 v103, v183, v199
    ds_write_b32 v241, v103 offset:53632
    ds_read_b128 a[52:55], v77 offset:0
    v_mfma_f32_32x32x16_bf16 v[60:75], v[136:139], a[32:35], v[60:75]
    v_smfmac_f32_16x16x64_bf16 v[120:123], v[92:95], v[132:139], v237
    ds_read_b128 a[56:59], v78 offset:0
    ds_read_b64_tr_b16 v[128:129], v85 offset:32768
    ds_read_b64_tr_b16 v[130:131], v85 offset:33280
    v_cvt_pk_bf16_f32 v104, v184, v200
    ds_write_b32 v241, v104 offset:54272
    v_cvt_pk_bf16_f32 v105, v185, v201
    s_waitcnt lgkmcnt(15)
    v_mfma_f32_32x32x16_bf16 v[12:27], v[140:143], a[36:39], v[12:27]
    s_add_u32 m0, s47, 0x4000
    s_add_u32 s48, s47, 0x4000
    buffer_load_dwordx4 v253, s[36:39], s48 offen offset:0 lds
    buffer_load_dwordx4 v253, s[36:39], s48 offen offset:1024 lds
    ds_read_b64_tr_b16 v[132:133], v84 offset:40960
    ds_read_b64_tr_b16 v[134:135], v84 offset:41472
    ds_write_b32 v241, v105 offset:54400
    v_cvt_pk_bf16_f32 v106, v186, v202
    ds_write_b32 v241, v106 offset:54528
    v_mfma_f32_32x32x16_bf16 v[28:43], v[144:147], a[36:39], v[28:43]
    s_add_u32 m0, s47, 0x22000
    s_nop 0
    buffer_load_dwordx4 v242, s[20:23], s85 offen offset:0 lds
    buffer_load_dwordx4 v243, s[20:23], s85 offen offset:1024 lds
    ds_read_b64_tr_b16 v[136:137], v85 offset:40960
    ds_read_b64_tr_b16 v[138:139], v85 offset:41472
    v_cvt_pk_bf16_f32 v107, v187, v203
    ds_write_b32 v241, v107 offset:54656
    s_waitcnt lgkmcnt(15)
    v_mfma_f32_32x32x16_bf16 v[44:59], v[148:151], a[36:39], v[44:59]
    ds_read_b128 a[60:63], v79 offset:0
    ds_read_b64_tr_b16 v[140:141], v86 offset:32768
    ds_read_b64_tr_b16 v[142:143], v86 offset:33280
    v_cvt_pk_bf16_f32 v108, v188, v204
    ds_write_b32 v241, v108 offset:55296
    v_cvt_pk_bf16_f32 v109, v189, v205
    v_mfma_f32_32x32x16_bf16 v[60:75], v[152:155], a[36:39], v[60:75]
    ds_write_b32 v241, v109 offset:55424
    ds_read_b64_tr_b16 v[144:145], v87 offset:32768
    ds_read_b64_tr_b16 v[146:147], v87 offset:33280
    v_cvt_pk_bf16_f32 v110, v190, v206
    ds_write_b32 v241, v110 offset:55552
    s_waitcnt lgkmcnt(15)
    v_mfma_f32_32x32x16_bf16 v[12:27], v[124:127], a[40:43], v[12:27]
    ds_read_b64_tr_b16 v[148:149], v86 offset:40960
    ds_read_b64_tr_b16 v[150:151], v86 offset:41472
    v_cvt_pk_bf16_f32 v111, v191, v207
    ds_write_b32 v241, v111 offset:55680
    v_mfma_f32_32x32x16_bf16 v[28:43], v[128:131], a[40:43], v[28:43]
    ds_read_b64_tr_b16 v[152:153], v87 offset:40960
    ds_read_b64_tr_b16 v[154:155], v87 offset:41472
    s_waitcnt lgkmcnt(12)
    s_add_u32 m0, s43, 0x0
    s_add_u32 s48, s80, 0x0
    buffer_load_dwordx4 v244, s[4:7], s48 offen offset:0 lds
    buffer_load_dwordx4 v245, s[4:7], s48 offen offset:1024 lds
    v_mfma_f32_32x32x16_bf16 v[44:59], v[132:135], a[40:43], v[44:59]
    s_waitcnt lgkmcnt(2)
    s_waitcnt vmcnt(16)
    s_barrier
    ds_read_b64_tr_b16 v[124:125], v80 offset:0
    ds_read_b64_tr_b16 v[126:127], v80 offset:512
    v_mfma_f32_32x32x16_bf16 v[60:75], v[136:139], a[40:43], v[60:75]
    s_add_u32 m0, s43, 0x800
    s_add_u32 s48, s80, 0x50000
    buffer_load_dwordx4 v244, s[4:7], s48 offen offset:0 lds
    buffer_load_dwordx4 v245, s[4:7], s48 offen offset:1024 lds
    ds_read_b64_tr_b16 v[128:129], v81 offset:0
    ds_read_b64_tr_b16 v[130:131], v81 offset:512
    ds_read2st64_b32 v[100:101], v230 offset0:0 offset1:12
    ds_read2st64_b32 v[102:103], v226 offset0:0 offset1:12
    v_mfma_f32_32x32x16_bf16 v[12:27], v[140:143], a[44:47], v[12:27]
    ds_read2st64_b32 v[104:105], v231 offset0:0 offset1:12
    ds_read_b64_tr_b16 v[132:133], v80 offset:8192
    ds_read_b64_tr_b16 v[134:135], v80 offset:8704
    ds_read2st64_b32 v[106:107], v227 offset0:0 offset1:12
    v_mfma_f32_32x32x16_bf16 v[28:43], v[144:147], a[44:47], v[28:43]
    ds_read2st64_b32 v[108:109], v232 offset0:0 offset1:12
    ds_read_b64_tr_b16 v[136:137], v81 offset:8192
    ds_read_b64_tr_b16 v[138:139], v81 offset:8704
    ds_read2st64_b32 v[110:111], v228 offset0:0 offset1:12
    s_waitcnt lgkmcnt(14)
    v_mfma_f32_32x32x16_bf16 v[44:59], v[148:151], a[44:47], v[44:59]
    ds_read_b64_tr_b16 v[140:141], v82 offset:0
    ds_read_b64_tr_b16 v[142:143], v82 offset:512
    s_waitcnt lgkmcnt(10)
    v_mfma_f32_32x32x16_bf16 v[180:195], v[96:99], v[100:103], 0
    ds_read_b128 a[64:67], v76 offset:4096
    v_mfma_f32_32x32x16_bf16 v[60:75], v[152:155], a[44:47], v[60:75]
    ds_read_b128 a[68:71], v77 offset:4096
    ds_read_b64_tr_b16 v[144:145], v83 offset:0
    ds_read_b64_tr_b16 v[146:147], v83 offset:512
    s_waitcnt lgkmcnt(10)
    v_mfma_f32_32x32x16_bf16 v[196:211], v[96:99], v[104:107], 0
    v_mfma_f32_32x32x16_bf16 v[12:27], v[124:127], a[48:51], v[12:27]
    ds_read_b64_tr_b16 v[148:149], v82 offset:8192
    ds_read_b64_tr_b16 v[150:151], v82 offset:8704
    s_waitcnt lgkmcnt(8)
    v_mfma_f32_32x32x16_bf16 v[156:171], v[96:99], v[108:111], 0
    v_mfma_f32_32x32x16_bf16 v[28:43], v[128:131], a[48:51], v[28:43]
    v_smfmac_f32_16x16x64_bf16 v[116:119], v[92:95], v[124:131], v237
    s_add_u32 m0, s47, 0x24000
    s_nop 0
    buffer_load_dwordx4 v242, s[16:19], s86 offen offset:0 lds
    buffer_load_dwordx4 v243, s[16:19], s86 offen offset:1024 lds
    ds_read_b64_tr_b16 v[152:153], v83 offset:8192
    ds_read_b64_tr_b16 v[154:155], v83 offset:8704
    ds_read_b128 a[72:75], v78 offset:4096
    v_mfma_f32_32x32x16_bf16 v[44:59], v[132:135], a[48:51], v[44:59]
    ds_read_b128 a[76:79], v79 offset:4096
    ds_read_b64_tr_b16 v[124:125], v84 offset:0
    ds_read_b64_tr_b16 v[126:127], v84 offset:512
    v_cvt_pk_bf16_f32 v188, v180, v181
    ds_write_b32 v222, v188 offset:0
    v_cvt_pk_bf16_f32 v189, v182, v183
    ds_write_b32 v222, v189 offset:1408
    v_mfma_f32_32x32x16_bf16 v[60:75], v[136:139], a[48:51], v[60:75]
    v_smfmac_f32_16x16x64_bf16 v[120:123], v[92:95], v[132:139], v237
    ds_read_b64_tr_b16 v[128:129], v85 offset:0
    ds_read_b64_tr_b16 v[130:131], v85 offset:512
    v_cvt_pk_bf16_f32 v190, v184, v185
    ds_write_b32 v222, v190 offset:5632
    v_cvt_pk_bf16_f32 v191, v186, v187
    ds_write_b32 v222, v191 offset:7040
    s_waitcnt lgkmcnt(14)
    v_mfma_f32_32x32x16_bf16 v[12:27], v[140:143], a[52:55], v[12:27]
    ds_read_b64_tr_b16 v[132:133], v84 offset:8192
    ds_read_b64_tr_b16 v[134:135], v84 offset:8704
    v_cvt_pk_bf16_f32 v204, v196, v197
    ds_write_b32 v223, v204 offset:0
    v_cvt_pk_bf16_f32 v205, v198, v199
    v_mfma_f32_32x32x16_bf16 v[28:43], v[144:147], a[52:55], v[28:43]
    s_add_u32 m0, s47, 0x26000
    s_nop 0
    buffer_load_dwordx4 v242, s[20:23], s86 offen offset:0 lds
    buffer_load_dwordx4 v243, s[20:23], s86 offen offset:1024 lds
    ds_read_b64_tr_b16 v[136:137], v85 offset:8192
    ds_read_b64_tr_b16 v[138:139], v85 offset:8704
    ds_write_b32 v223, v205 offset:1408
    v_cvt_pk_bf16_f32 v206, v200, v201
    s_waitcnt lgkmcnt(15)
    v_mfma_f32_32x32x16_bf16 v[44:59], v[148:151], a[52:55], v[44:59]
    ds_write_b32 v223, v206 offset:5632
    ds_read_b64_tr_b16 v[140:141], v86 offset:0
    ds_read_b64_tr_b16 v[142:143], v86 offset:512
    v_cvt_pk_bf16_f32 v207, v202, v203
    ds_write_b32 v223, v207 offset:7040
    v_cvt_pk_bf16_f32 v164, v156, v157
    ds_write_b32 v224, v164 offset:0
    v_mfma_f32_32x32x16_bf16 v[60:75], v[152:155], a[52:55], v[60:75]
    ds_read_b64_tr_b16 v[144:145], v87 offset:0
    ds_read_b64_tr_b16 v[146:147], v87 offset:512
    v_cvt_pk_bf16_f32 v165, v158, v159
    ds_write_b32 v224, v165 offset:1408
    v_cvt_pk_bf16_f32 v166, v160, v161
    ds_write_b32 v224, v166 offset:5632
    s_waitcnt lgkmcnt(15)
    v_mfma_f32_32x32x16_bf16 v[12:27], v[124:127], a[56:59], v[12:27]
    ds_read_b64_tr_b16 v[148:149], v86 offset:8192
    ds_read_b64_tr_b16 v[150:151], v86 offset:8704
    v_cvt_pk_bf16_f32 v167, v162, v163
    ds_write_b32 v224, v167 offset:7040
    v_add_u32 v229, 26624, v1
    s_add_u32 m0, s43, 0x1000
    s_add_u32 s48, s81, 0x0
    buffer_load_dwordx4 v244, s[4:7], s48 offen offset:0 lds
    buffer_load_dwordx4 v245, s[4:7], s48 offen offset:1024 lds
    v_mfma_f32_32x32x16_bf16 v[28:43], v[128:131], a[56:59], v[28:43]
    s_add_u32 m0, s43, 0x1800
    s_add_u32 s48, s81, 0x50000
    buffer_load_dwordx4 v244, s[4:7], s48 offen offset:0 lds
    buffer_load_dwordx4 v245, s[4:7], s48 offen offset:1024 lds
    ds_read_b64_tr_b16 v[152:153], v87 offset:8192
    ds_read_b64_tr_b16 v[154:155], v87 offset:8704
    s_waitcnt lgkmcnt(15)
    v_mfma_f32_32x32x16_bf16 v[44:59], v[132:135], a[56:59], v[44:59]
    s_waitcnt lgkmcnt(2)
    s_waitcnt vmcnt(18)
    s_waitcnt vmcnt(12)
    s_barrier
    ds_read_b64_tr_b16 v[124:125], v80 offset:16384
    ds_read_b64_tr_b16 v[126:127], v80 offset:16896
    v_mfma_f32_32x32x16_bf16 v[60:75], v[136:139], a[56:59], v[60:75]
    s_lshl_b32 s48, s2, 2
    s_add_u32 s48, s48, 65536
    s_cmp_eq_u32 s40, 0
    s_cselect_b32 s48, s48, 0x40000000
    s_mov_b64 exec, 1
    buffer_store_dword v246, v254, s[32:35], s48 offen offset:0 sc1
    s_mov_b64 exec, -1
    ds_read_b64_tr_b16 v[128:129], v81 offset:16384
    ds_read_b64_tr_b16 v[130:131], v81 offset:16896
    v_mfma_f32_32x32x16_bf16 v[12:27], v[140:143], a[60:63], v[12:27]
    ds_read_b128 v[100:103], v229 offset:0
    ds_read_b64_tr_b16 v[132:133], v80 offset:24576
    ds_read_b64_tr_b16 v[134:135], v80 offset:25088
    ds_read_b128 v[104:107], v229 offset:4096
    ds_read_b128 v[108:111], v229 offset:8192
    ds_read_b128 a[80:83], v76 offset:8192
    v_mfma_f32_32x32x16_bf16 v[28:43], v[144:147], a[60:63], v[28:43]
    ds_read_b128 a[84:87], v77 offset:8192
    ds_read_b64_tr_b16 v[136:137], v81 offset:24576
    ds_read_b64_tr_b16 v[138:139], v81 offset:25088
    s_waitcnt lgkmcnt(13)
    v_mfma_f32_32x32x16_bf16 v[44:59], v[148:151], a[60:63], v[44:59]
    ds_read_b64_tr_b16 v[140:141], v82 offset:16384
    ds_read_b64_tr_b16 v[142:143], v82 offset:16896
    v_mfma_f32_32x32x16_bf16 v[60:75], v[152:155], a[60:63], v[60:75]
    ds_read_b128 a[88:91], v78 offset:8192
    ds_read_b64_tr_b16 v[144:145], v83 offset:16384
    ds_read_b64_tr_b16 v[146:147], v83 offset:16896
    s_waitcnt lgkmcnt(13)
    v_cndmask_b32 v103, v103, v246, s[0:1]
    buffer_store_dwordx4 v[100:103], v251, s[32:35], s57 offen sc1
    v_mfma_f32_32x32x16_bf16 v[12:27], v[124:127], a[64:67], v[12:27]
    ds_read_b128 a[92:95], v79 offset:8192
    ds_read_b64_tr_b16 v[148:149], v82 offset:24576
    ds_read_b64_tr_b16 v[150:151], v82 offset:25088
    s_waitcnt lgkmcnt(13)
    v_cndmask_b32 v107, v107, v246, s[0:1]
    s_add_u32 s48, s57, 1048576
    buffer_store_dwordx4 v[104:107], v251, s[32:35], s48 offen sc1
    v_mfma_f32_32x32x16_bf16 v[28:43], v[128:131], a[64:67], v[28:43]
    v_smfmac_f32_16x16x64_bf16 v[116:119], v[92:95], v[124:131], v237
    s_add_u32 m0, s47, 0x1c000
    s_nop 0
    buffer_load_dwordx4 v242, s[16:19], s87 offen offset:0 lds
    buffer_load_dwordx4 v243, s[16:19], s87 offen offset:1024 lds
    ds_read_b64_tr_b16 v[152:153], v83 offset:24576
    ds_read_b64_tr_b16 v[154:155], v83 offset:25088
    s_waitcnt lgkmcnt(14)
    v_cndmask_b32 v111, v111, v246, s[0:1]
    buffer_store_dwordx4 v[108:111], v251, s[32:35], s58 offen sc1
    s_waitcnt lgkmcnt(10)
    v_mfma_f32_32x32x16_bf16 v[44:59], v[132:135], a[64:67], v[44:59]
    s_lshl_b32 s15, s40, 12
    ds_read_b64_tr_b16 v[124:125], v84 offset:16384
    ds_read_b64_tr_b16 v[126:127], v84 offset:16896
    v_min_u32 v228, 23, v255
    v_and_b32 v233, 15, v255
    v_mfma_f32_32x32x16_bf16 v[60:75], v[136:139], a[64:67], v[60:75]
    v_smfmac_f32_16x16x64_bf16 v[120:123], v[92:95], v[132:139], v237
    ds_read_b64_tr_b16 v[128:129], v85 offset:16384
    ds_read_b64_tr_b16 v[130:131], v85 offset:16896
    v_mul_u32_u24 v226, 43691, v228
    v_bfe_u32 v96, v255, 4, 1
    s_waitcnt lgkmcnt(9)
    v_mfma_f32_32x32x16_bf16 v[12:27], v[140:143], a[68:71], v[12:27]
    ds_read_b64_tr_b16 v[132:133], v84 offset:24576
    ds_read_b64_tr_b16 v[134:135], v84 offset:25088
    v_lshrrev_b32 v226, 18, v226
    v_and_b32 v232, 15, v255
    v_lshl_add_u32 v250, v96, 5, v233
    v_mfma_f32_32x32x16_bf16 v[28:43], v[144:147], a[68:71], v[28:43]
    s_add_u32 m0, s47, 0x1e000
    s_nop 0
    buffer_load_dwordx4 v242, s[20:23], s87 offen offset:0 lds
    buffer_load_dwordx4 v243, s[20:23], s87 offen offset:1024 lds
    ds_read_b64_tr_b16 v[136:137], v85 offset:24576
    ds_read_b64_tr_b16 v[138:139], v85 offset:25088
    s_waitcnt lgkmcnt(8)
    v_mfma_f32_32x32x16_bf16 v[44:59], v[148:151], a[68:71], v[44:59]
    ds_read_b64_tr_b16 v[140:141], v86 offset:16384
    ds_read_b64_tr_b16 v[142:143], v86 offset:16896
    v_mul_u32_u24 v226, 4368, v226
    v_lshl_add_u32 v226, v228, 7, v226
    v_lshlrev_b32 v232, 7, v232
    v_bfe_u32 v231, v255, 4, 1
    v_mfma_f32_32x32x16_bf16 v[60:75], v[152:155], a[68:71], v[60:75]
    s_lshr_b32 s48, s2, 3
    s_lshl_b32 s48, s48, 1
    s_and_b32 s49, s40, 1
    s_add_u32 s48, s48, s49
    s_mul_i32 s48, s48, 20544
    s_and_b32 s49, s2, 7
    s_mul_i32 s49, s49, 642
    s_add_u32 s48, s48, s49
    buffer_load_dword v248, v226, s[8:11], s48 offen
    ds_read_b64_tr_b16 v[144:145], v87 offset:16384
    ds_read_b64_tr_b16 v[146:147], v87 offset:16896
    s_waitcnt lgkmcnt(8)
    v_mfma_f32_32x32x16_bf16 v[12:27], v[124:127], a[72:75], v[12:27]
    ds_read_b64_tr_b16 v[148:149], v86 offset:24576
    ds_read_b64_tr_b16 v[150:151], v86 offset:25088
    s_add_u32 m0, s43, 0x2000
    s_add_u32 s48, s82, 0x0
    buffer_load_dwordx4 v244, s[4:7], s48 offen offset:0 lds
    buffer_load_dwordx4 v245, s[4:7], s48 offen offset:1024 lds
    s_add_u32 m0, s43, 0x2800
    s_add_u32 s48, s82, 0x50000
    buffer_load_dwordx4 v244, s[4:7], s48 offen offset:0 lds
    buffer_load_dwordx4 v245, s[4:7], s48 offen offset:1024 lds
    v_mfma_f32_32x32x16_bf16 v[28:43], v[128:131], a[72:75], v[28:43]
    ds_read_b64_tr_b16 v[152:153], v87 offset:24576
    ds_read_b64_tr_b16 v[154:155], v87 offset:25088
    v_lshl_add_u32 v232, v231, 4, v232
    buffer_load_dwordx4 v[156:159], v232, s[32:35], s59 offen sc1
    v_lshlrev_b32 v250, 4, v250
    s_waitcnt lgkmcnt(8)
    v_mfma_f32_32x32x16_bf16 v[44:59], v[132:135], a[72:75], v[44:59]
    v_lshl_add_u32 v250, s40, 2, v250
    v_add_u32 v250, 59392, v250
    v_and_b32 v249, 0x1f0, v253
    v_add_u32 v98, 4096, v253
    s_waitcnt vmcnt(18)
    s_barrier
    ds_read_b64_tr_b16 v[124:125], v80 offset:32768
    ds_read_b64_tr_b16 v[126:127], v80 offset:33280
    v_mfma_f32_32x32x16_bf16 v[60:75], v[136:139], a[72:75], v[60:75]
    ds_read_b64_tr_b16 v[128:129], v81 offset:32768
    ds_read_b64_tr_b16 v[130:131], v81 offset:33280
    v_lshlrev_b32 v99, 10, v96
    v_lshrrev_b32 v96, 5, v255
    ds_read_b128 a[96:99], v76 offset:0
    s_waitcnt lgkmcnt(9)
    v_mfma_f32_32x32x16_bf16 v[12:27], v[140:143], a[76:79], v[12:27]
    ds_read_b128 a[100:103], v77 offset:0
    ds_read_b64_tr_b16 v[132:133], v80 offset:40960
    ds_read_b64_tr_b16 v[134:135], v80 offset:41472
    v_lshl_add_u32 v99, v96, 8, v99
    v_mfma_f32_32x32x16_bf16 v[28:43], v[144:147], a[76:79], v[28:43]
    ds_read_b128 a[104:107], v78 offset:0
    ds_read_b64_tr_b16 v[136:137], v81 offset:40960
    ds_read_b64_tr_b16 v[138:139], v81 offset:41472
    v_lshl_add_u32 v99, v233, 4, v99
    s_waitcnt lgkmcnt(11)
    v_mfma_f32_32x32x16_bf16 v[44:59], v[148:151], a[76:79], v[44:59]
    ds_read_b128 a[108:111], v79 offset:0
    ds_read_b64_tr_b16 v[140:141], v82 offset:32768
    ds_read_b64_tr_b16 v[142:143], v82 offset:33280
    v_bfe_u32 v96, v0, 4, 2
    v_mfma_f32_32x32x16_bf16 v[60:75], v[152:155], a[76:79], v[60:75]
    ds_read_b64_tr_b16 v[144:145], v83 offset:32768
    ds_read_b64_tr_b16 v[146:147], v83 offset:33280
    v_lshlrev_b32 v96, 4, v96
    s_waitcnt lgkmcnt(12)
    v_mfma_f32_32x32x16_bf16 v[12:27], v[124:127], a[80:83], v[12:27]
    ds_read_b64_tr_b16 v[148:149], v82 offset:40960
    ds_read_b64_tr_b16 v[150:151], v82 offset:41472
    v_xor_b32 v97, v1, v96
    v_mfma_f32_32x32x16_bf16 v[28:43], v[128:131], a[80:83], v[28:43]
    v_smfmac_f32_16x16x64_bf16 v[116:119], v[92:95], v[124:131], v237
    s_add_u32 m0, s47, 0x20000
    s_nop 0
    buffer_load_dwordx4 v242, s[16:19], s88 offen offset:0 lds
    buffer_load_dwordx4 v243, s[16:19], s88 offen offset:1024 lds
    ds_read_b64_tr_b16 v[152:153], v83 offset:40960
    ds_read_b64_tr_b16 v[154:155], v83 offset:41472
    s_waitcnt lgkmcnt(9)
    v_mfma_f32_32x32x16_bf16 v[44:59], v[132:135], a[80:83], v[44:59]
    ds_read_b64_tr_b16 v[124:125], v84 offset:32768
    ds_read_b64_tr_b16 v[126:127], v84 offset:33280
    v_bfe_u32 v96, v255, 2, 2
    v_mfma_f32_32x32x16_bf16 v[60:75], v[136:139], a[80:83], v[60:75]
    v_smfmac_f32_16x16x64_bf16 v[120:123], v[92:95], v[132:139], v237
    ds_read_b64_tr_b16 v[128:129], v85 offset:32768
    ds_read_b64_tr_b16 v[130:131], v85 offset:33280
    s_waitcnt lgkmcnt(12)
    s_add_u32 m0, s43, 0x0
    s_add_u32 s48, s83, 0x0
    buffer_load_dwordx4 v244, s[4:7], s48 offen offset:0 lds
    buffer_load_dwordx4 v245, s[4:7], s48 offen offset:1024 lds
    s_waitcnt lgkmcnt(8)
    v_mfma_f32_32x32x16_bf16 v[12:27], v[140:143], a[84:87], v[12:27]
    ds_read_b64_tr_b16 v[132:133], v84 offset:40960
    ds_read_b64_tr_b16 v[134:135], v84 offset:41472
    v_xor_b32 v96, s40, v96
    v_mfma_f32_32x32x16_bf16 v[28:43], v[144:147], a[84:87], v[28:43]
    s_add_u32 m0, s43, 0x800
    s_add_u32 s48, s83, 0x50000
    buffer_load_dwordx4 v244, s[4:7], s48 offen offset:0 lds
    buffer_load_dwordx4 v245, s[4:7], s48 offen offset:1024 lds
    ds_read_b64_tr_b16 v[136:137], v85 offset:40960
    ds_read_b64_tr_b16 v[138:139], v85 offset:41472
    s_waitcnt lgkmcnt(8)
    v_mfma_f32_32x32x16_bf16 v[44:59], v[148:151], a[84:87], v[44:59]
    s_add_u32 m0, s47, 0x22000
    s_nop 0
    buffer_load_dwordx4 v242, s[20:23], s88 offen offset:0 lds
    buffer_load_dwordx4 v243, s[20:23], s88 offen offset:1024 lds
    ds_read_b64_tr_b16 v[140:141], v86 offset:32768
    ds_read_b64_tr_b16 v[142:143], v86 offset:33280
    v_mfma_f32_32x32x16_bf16 v[60:75], v[152:155], a[84:87], v[60:75]
    ds_read_b64_tr_b16 v[144:145], v87 offset:32768
    ds_read_b64_tr_b16 v[146:147], v87 offset:33280
    v_lshlrev_b32 v96, 4, v96
    s_waitcnt lgkmcnt(8)
    v_mfma_f32_32x32x16_bf16 v[12:27], v[124:127], a[88:91], v[12:27]
    ds_read_b64_tr_b16 v[148:149], v86 offset:40960
    ds_read_b64_tr_b16 v[150:151], v86 offset:41472
    s_waitcnt vmcnt(22)
    ds_read_b128 a[112:115], v76 offset:4096
    v_lshl_add_u32 v96, v233, 6, v96
    v_mfma_f32_32x32x16_bf16 v[28:43], v[128:131], a[88:91], v[28:43]
    ds_read_b64_tr_b16 v[152:153], v87 offset:40960
    ds_read_b64_tr_b16 v[154:155], v87 offset:41472
    s_waitcnt lgkmcnt(9)
    v_mfma_f32_32x32x16_bf16 v[44:59], v[132:135], a[88:91], v[44:59]
    v_lshrrev_b32 v233, 4, v255
    s_waitcnt vmcnt(14)
    s_barrier
    ds_read_b64_tr_b16 v[124:125], v80 offset:0
    ds_read_b64_tr_b16 v[126:127], v80 offset:512
    v_mfma_f32_32x32x16_bf16 v[60:75], v[136:139], a[88:91], v[60:75]
    ds_read_b128 a[116:119], v77 offset:4096
    ds_read_b64_tr_b16 v[128:129], v81 offset:0
    ds_read_b64_tr_b16 v[130:131], v81 offset:512
    s_waitcnt lgkmcnt(10)
    v_mfma_f32_32x32x16_bf16 v[12:27], v[140:143], a[92:95], v[12:27]
    ds_read_b64_tr_b16 v[132:133], v80 offset:8192
    ds_read_b64_tr_b16 v[134:135], v80 offset:8704
    v_lshl_add_u32 v218, v233, 12, v96
    v_mfma_f32_32x32x16_bf16 v[28:43], v[144:147], a[92:95], v[28:43]
    ds_read_b64_tr_b16 v[136:137], v81 offset:8192
    ds_read_b64_tr_b16 v[138:139], v81 offset:8704
    s_waitcnt lgkmcnt(9)
    v_mfma_f32_32x32x16_bf16 v[44:59], v[148:151], a[92:95], v[44:59]
    ds_read_b128 a[120:123], v78 offset:4096
    ds_read_b64_tr_b16 v[140:141], v82 offset:0
    ds_read_b64_tr_b16 v[142:143], v82 offset:512
    ds_read_b128 a[240:243], v253 offset:20480
    v_mfma_f32_32x32x16_bf16 v[60:75], v[152:155], a[92:95], v[60:75]
    ds_read_b64_tr_b16 v[144:145], v83 offset:0
    ds_read_b64_tr_b16 v[146:147], v83 offset:512
    s_waitcnt lgkmcnt(10)
    v_mfma_f32_32x32x16_bf16 v[12:27], v[124:127], a[96:99], v[12:27]
    ds_read_b128 a[244:247], v253 offset:21504
    ds_read_b64_tr_b16 v[148:149], v82 offset:8192
    ds_read_b64_tr_b16 v[150:151], v82 offset:8704
    s_waitcnt vmcnt(8)
    v_cmp_ne_u32 vcc, s42, v159
    s_nop 0
    s_cbranch_vccnz L_sts_1
L_stb_2:
    v_lshrrev_b32 v226, 1, v255
    v_mfma_f32_32x32x16_bf16 v[28:43], v[128:131], a[96:99], v[28:43]
    v_smfmac_f32_16x16x64_bf16 v[116:119], v[92:95], v[124:131], v237
    ds_read_b128 a[124:127], v79 offset:4096
    ds_read_b64_tr_b16 v[152:153], v83 offset:8192
    ds_read_b64_tr_b16 v[154:155], v83 offset:8704
    s_add_u32 m0, s47, 0x24000
    s_nop 0
    buffer_load_dwordx4 v242, s[16:19], s89 offen offset:0 lds
    buffer_load_dwordx4 v243, s[16:19], s89 offen offset:1024 lds
    s_waitcnt lgkmcnt(12)
    v_mfma_f32_32x32x16_bf16 v[44:59], v[132:135], a[96:99], v[44:59]
    ds_read_b128 a[248:251], v253 offset:22528
    ds_read_b64_tr_b16 v[124:125], v84 offset:0
    ds_read_b64_tr_b16 v[126:127], v84 offset:512
    v_mul_u32_u24 v226, 5136, v226
    v_mfma_f32_32x32x16_bf16 v[60:75], v[136:139], a[96:99], v[60:75]
    v_smfmac_f32_16x16x64_bf16 v[120:123], v[92:95], v[132:139], v237
    ds_read_b64_tr_b16 v[128:129], v85 offset:0
    ds_read_b64_tr_b16 v[130:131], v85 offset:512
    v_cmp_gt_u32 vcc, 32, v255
    v_sub_f32 v156, 0, v156
    s_nop 0
    v_cndmask_b32 v156, 0, v156, vcc
    v_and_b32 v228, 1, v255
    s_waitcnt lgkmcnt(11)
    v_mfma_f32_32x32x16_bf16 v[12:27], v[140:143], a[100:103], v[12:27]
    ds_read_b128 a[252:255], v253 offset:23552
    ds_read_b64_tr_b16 v[132:133], v84 offset:8192
    ds_read_b64_tr_b16 v[134:135], v84 offset:8704
    v_rsq_f32 v229, v157
    v_lshl_add_u32 v226, v228, 4, v226
    v_mfma_f32_32x32x16_bf16 v[28:43], v[144:147], a[100:103], v[28:43]
    s_add_u32 m0, s47, 0x26000
    s_nop 0
    buffer_load_dwordx4 v242, s[20:23], s89 offen offset:0 lds
    buffer_load_dwordx4 v243, s[20:23], s89 offen offset:1024 lds
    ds_read_b64_tr_b16 v[136:137], v85 offset:8192
    ds_read_b64_tr_b16 v[138:139], v85 offset:8704
    s_waitcnt lgkmcnt(10)
    v_mfma_f32_32x32x16_bf16 v[44:59], v[148:151], a[100:103], v[44:59]
    ds_read_b128 v[204:207], v253 offset:24576
    ds_read_b64_tr_b16 v[140:141], v86 offset:0
    ds_read_b64_tr_b16 v[142:143], v86 offset:512
    v_perm_b32 v160, v156, v156, s3
    v_mul_f32 v229, 0xbfb8aa3b, v229
    ds_read_b128 a[128:131], v76 offset:8192
    v_mfma_f32_32x32x16_bf16 v[60:75], v[152:155], a[100:103], v[60:75]
    ds_read_b64_tr_b16 v[144:145], v87 offset:0
    ds_read_b64_tr_b16 v[146:147], v87 offset:512
    v_add_u32 v227, 163328, v226
    s_waitcnt lgkmcnt(11)
    v_mfma_f32_32x32x16_bf16 v[12:27], v[124:127], a[104:107], v[12:27]
    ds_read_b128 v[208:211], v253 offset:25600
    ds_read_b64_tr_b16 v[148:149], v86 offset:8192
    ds_read_b64_tr_b16 v[150:151], v86 offset:8704
    v_lshrrev_b32 v161, 16, v156
    v_mfma_f32_32x32x16_bf16 v[28:43], v[128:131], a[104:107], v[28:43]
    ds_read_b128 a[132:135], v77 offset:8192
    ds_read_b64_tr_b16 v[152:153], v87 offset:8192
    ds_read_b64_tr_b16 v[154:155], v87 offset:8704
    s_waitcnt lgkmcnt(12)
    v_mfma_f32_32x32x16_bf16 v[44:59], v[132:135], a[104:107], v[44:59]
    s_add_u32 m0, s15, 0xa800
    s_add_u32 s48, s60, 0x0
    buffer_load_dwordx4 v226, s[8:11], s48 offen offset:0 lds
    buffer_load_dwordx4 v227, s[8:11], s48 offen offset:1024 lds
    s_waitcnt vmcnt(6)
    s_barrier
    ds_read_b64_tr_b16 v[124:125], v80 offset:16384
    ds_read_b64_tr_b16 v[126:127], v80 offset:16896
    v_mfma_f32_32x32x16_bf16 v[60:75], v[136:139], a[104:107], v[60:75]
    s_add_u32 m0, s15, 0xb000
    s_add_u32 s48, s60, 0x50400
    buffer_load_dwordx4 v226, s[8:11], s48 offen offset:0 lds
    buffer_load_dwordx4 v227, s[8:11], s48 offen offset:1024 lds
    ds_read_b64_tr_b16 v[128:129], v81 offset:16384
    ds_read_b64_tr_b16 v[130:131], v81 offset:16896
    s_waitcnt lgkmcnt(10)
    v_mfma_f32_32x32x16_bf16 v[12:27], v[140:143], a[108:111], v[12:27]
    ds_read_b128 a[136:139], v78 offset:8192
    ds_read_b64_tr_b16 v[132:133], v80 offset:24576
    ds_read_b64_tr_b16 v[134:135], v80 offset:25088
    v_mov_b32 v162, 0
    v_mov_b32 v163, 0
    s_add_u32 s12, s61, 0x02020000
    v_mfma_f32_32x32x16_bf16 v[28:43], v[144:147], a[108:111], v[28:43]
    s_add_u32 s13, s61, 0x04040000
    ds_read_b64_tr_b16 v[136:137], v81 offset:24576
    ds_read_b64_tr_b16 v[138:139], v81 offset:25088
    v_mul_f32 v230, v229, v157
    s_waitcnt lgkmcnt(9)
    v_mfma_f32_32x32x16_bf16 v[44:59], v[148:151], a[108:111], v[44:59]
    s_mov_b32 s48, 65536
    buffer_load_dwordx4 v[188:191], v253, s[32:35], s48 offen sc1
    ds_read_b64_tr_b16 v[140:141], v82 offset:16384
    ds_read_b64_tr_b16 v[142:143], v82 offset:16896
    v_and_b32 v228, 15, v255
    v_mfma_f32_32x32x16_bf16 v[60:75], v[152:155], a[108:111], v[60:75]
    ds_read_b128 a[140:143], v79 offset:8192
    ds_read_b64_tr_b16 v[144:145], v83 offset:16384
    ds_read_b64_tr_b16 v[146:147], v83 offset:16896
    s_waitcnt lgkmcnt(10)
    v_mfma_f32_32x32x16_bf16 v[12:27], v[124:127], a[112:115], v[12:27]
    ds_read_b64_tr_b16 v[148:149], v82 offset:24576
    ds_read_b64_tr_b16 v[150:151], v82 offset:25088
    v_lshlrev_b32 v228, 5, v228
    v_lshrrev_b32 v225, 5, v255
    v_mfma_f32_32x32x16_bf16 v[28:43], v[128:131], a[112:115], v[28:43]
    v_smfmac_f32_16x16x64_bf16 v[116:119], v[92:95], v[124:131], v237
    s_add_u32 m0, s47, 0x1c000
    s_nop 0
    buffer_load_dwordx4 v242, s[16:19], s90 offen offset:0 lds
    buffer_load_dwordx4 v243, s[16:19], s90 offen offset:1024 lds
    ds_read_b64_tr_b16 v[152:153], v83 offset:24576
    ds_read_b64_tr_b16 v[154:155], v83 offset:25088
    v_and_b32 v223, 1, v255
    s_waitcnt lgkmcnt(9)
    v_mfma_f32_32x32x16_bf16 v[44:59], v[132:135], a[112:115], v[44:59]
    ds_read_b64_tr_b16 v[124:125], v84 offset:16384
    ds_read_b64_tr_b16 v[126:127], v84 offset:16896
    v_lshrrev_b32 v226, 4, v255
    v_lshlrev_b32 v223, 9, v223
    v_mfma_f32_32x32x16_bf16 v[60:75], v[136:139], a[112:115], v[60:75]
    v_smfmac_f32_16x16x64_bf16 v[120:123], v[92:95], v[132:139], v237
    ds_read_b64_tr_b16 v[128:129], v85 offset:16384
    ds_read_b64_tr_b16 v[130:131], v85 offset:16896
    v_lshl_add_u32 v228, v226, 11, v228
    v_bfe_u32 v224, v255, 2, 2
    s_waitcnt lgkmcnt(8)
    v_mfma_f32_32x32x16_bf16 v[12:27], v[140:143], a[116:119], v[12:27]
    ds_read_b64_tr_b16 v[132:133], v84 offset:24576
    ds_read_b64_tr_b16 v[134:135], v84 offset:25088
    ds_read_b128 a[144:147], v76 offset:0
    v_lshlrev_b32 v224, 8, v224
    v_mfma_f32_32x32x16_bf16 v[28:43], v[144:147], a[116:119], v[28:43]
    s_add_u32 m0, s47, 0x1e000
    s_nop 0
    buffer_load_dwordx4 v242, s[20:23], s90 offen offset:0 lds
    buffer_load_dwordx4 v243, s[20:23], s90 offen offset:1024 lds
    ds_read_b64_tr_b16 v[136:137], v85 offset:24576
    ds_read_b64_tr_b16 v[138:139], v85 offset:25088
    s_waitcnt lgkmcnt(9)
    v_mfma_f32_32x32x16_bf16 v[44:59], v[148:151], a[116:119], v[44:59]
    ds_read_b64_tr_b16 v[140:141], v86 offset:16384
    ds_read_b64_tr_b16 v[142:143], v86 offset:16896
    v_lshl_add_u32 v228, s40, 3, v228
    v_add_u32 v224, s41, v224
    v_and_b32 v222, 2, v255
    v_mfma_f32_32x32x16_bf16 v[60:75], v[152:155], a[116:119], v[60:75]
    ds_read_b128 a[148:151], v77 offset:0
    ds_read_b64_tr_b16 v[144:145], v87 offset:16384
    ds_read_b64_tr_b16 v[146:147], v87 offset:16896
    v_sub_u32 v220, 1, v222
    s_waitcnt lgkmcnt(10)
    v_mfma_f32_32x32x16_bf16 v[12:27], v[124:127], a[120:123], v[12:27]
    buffer_load_dwordx4 v[100:103], v1, s[32:35], s62 offen sc1
    ds_read_b64_tr_b16 v[148:149], v86 offset:24576
    ds_read_b64_tr_b16 v[150:151], v86 offset:25088
    v_mul_i32_i24 v224, v224, v220
    v_mfma_f32_32x32x16_bf16 v[28:43], v[128:131], a[120:123], v[28:43]
    s_add_u32 s48, s62, 4096
    buffer_load_dwordx4 v[104:107], v1, s[32:35], s48 offen sc1
    ds_read_b64_tr_b16 v[152:153], v87 offset:24576
    ds_read_b64_tr_b16 v[154:155], v87 offset:25088
    v_cvt_f32_i32 v220, v220
    s_waitcnt lgkmcnt(9)
    v_mfma_f32_32x32x16_bf16 v[44:59], v[132:135], a[120:123], v[44:59]
    ds_read_b128 a[152:155], v78 offset:0
    v_mul_f32 v220, 0x3e800000, v220
    s_waitcnt vmcnt(11)
    s_barrier
    ds_read_b64_tr_b16 v[124:125], v80 offset:32768
    ds_read_b64_tr_b16 v[126:127], v80 offset:33280
    v_mfma_f32_32x32x16_bf16 v[60:75], v[136:139], a[120:123], v[60:75]
    s_add_u32 s48, s62, 8192
    buffer_load_dwordx4 v[108:111], v1, s[32:35], s48 offen sc1
    ds_read_b64_tr_b16 v[128:129], v81 offset:32768
    ds_read_b64_tr_b16 v[130:131], v81 offset:33280
    v_lshlrev_b32 v225, 2, v225
    s_waitcnt lgkmcnt(9)
    v_mfma_f32_32x32x16_bf16 v[12:27], v[140:143], a[124:127], v[12:27]
    s_add_u32 s48, s62, 12288
    buffer_load_dwordx4 v[112:115], v1, s[32:35], s48 offen sc1
    ds_read_b64_tr_b16 v[132:133], v80 offset:40960
    ds_read_b64_tr_b16 v[134:135], v80 offset:41472
    v_mul_i32_i24 v222, v225, v224
    v_mfma_f32_32x32x16_bf16 v[28:43], v[144:147], a[124:127], v[28:43]
    ds_read_b128 a[156:159], v79 offset:0
    ds_read_b64_tr_b16 v[136:137], v81 offset:40960
    ds_read_b64_tr_b16 v[138:139], v81 offset:41472
    v_sub_u32 v222, v222, v223
    s_waitcnt lgkmcnt(10)
    v_mfma_f32_32x32x16_bf16 v[44:59], v[148:151], a[124:127], v[44:59]
    ds_read_b64_tr_b16 v[140:141], v82 offset:32768
    ds_read_b64_tr_b16 v[142:143], v82 offset:33280
    v_add_u32 v221, 0x100, v222
    v_mfma_f32_32x32x16_bf16 v[60:75], v[152:155], a[124:127], v[60:75]
    ds_read_b64_tr_b16 v[144:145], v83 offset:32768
    ds_read_b64_tr_b16 v[146:147], v83 offset:33280
    v_cvt_f32_i32 v221, v221
    s_waitcnt lgkmcnt(9)
    v_mfma_f32_32x32x16_bf16 v[12:27], v[124:127], a[128:131], v[12:27]
    ds_read_b64_tr_b16 v[148:149], v82 offset:40960
    ds_read_b64_tr_b16 v[150:151], v82 offset:41472
    v_mul_f32 v196, 0x3a000000, v221
    v_mfma_f32_32x32x16_bf16 v[28:43], v[128:131], a[128:131], v[28:43]
    v_smfmac_f32_16x16x64_bf16 v[116:119], v[92:95], v[124:131], v237
    ds_read_b64_tr_b16 v[152:153], v83 offset:40960
    ds_read_b64_tr_b16 v[154:155], v83 offset:41472
    v_add_f32 v197, v196, v220
    s_waitcnt lgkmcnt(8)
    v_mfma_f32_32x32x16_bf16 v[44:59], v[132:135], a[128:131], v[44:59]
    ds_read_b64_tr_b16 v[124:125], v84 offset:32768
    ds_read_b64_tr_b16 v[126:127], v84 offset:33280
    v_add_u32 v222, v222, v224
    v_mfma_f32_32x32x16_bf16 v[60:75], v[136:139], a[128:131], v[60:75]
    v_smfmac_f32_16x16x64_bf16 v[120:123], v[92:95], v[132:139], v237
    ds_read_b64_tr_b16 v[128:129], v85 offset:32768
    ds_read_b64_tr_b16 v[130:131], v85 offset:33280
    v_add_u32 v221, 0xffffff00, v222
    s_waitcnt lgkmcnt(8)
    v_mfma_f32_32x32x16_bf16 v[12:27], v[140:143], a[132:135], v[12:27]
    ds_read_b64_tr_b16 v[132:133], v84 offset:40960
    ds_read_b64_tr_b16 v[134:135], v84 offset:41472
    s_waitcnt vmcnt(8)
    v_xor_b32 v188, s42, v188
    v_bitop3_b32 v188, v188, v189, v246 bitop3:0xf6
    v_bitop3_b32 v188, v188, v190, v246 bitop3:0xf6
    v_bitop3_b32 v188, v188, v191, v246 bitop3:0xf6
    v_cmp_ne_u32 vcc, 0, v188
    s_nop 0
    s_cbranch_vccnz L_w2fs_4
L_w2fb_5:
    v_mfma_f32_32x32x16_bf16 v[28:43], v[144:147], a[132:135], v[28:43]
    s_add_u32 s14, s63, 0
    buffer_load_dwordx4 a[160:163], v253, s[32:35], s14 offen offset:0 sc1
    ds_read_b64_tr_b16 v[136:137], v85 offset:40960
    ds_read_b64_tr_b16 v[138:139], v85 offset:41472
    v_cvt_f32_i32 v221, v221
    s_waitcnt lgkmcnt(8)
    v_mfma_f32_32x32x16_bf16 v[44:59], v[148:151], a[132:135], v[44:59]
    ds_read_b64_tr_b16 v[140:141], v86 offset:32768
    ds_read_b64_tr_b16 v[142:143], v86 offset:33280
    v_mul_f32 v198, 0x3a000000, v221
    v_add_f32 v199, v198, v220
    v_mfma_f32_32x32x16_bf16 v[60:75], v[152:155], a[132:135], v[60:75]
    buffer_load_dwordx4 a[164:167], v253, s[32:35], s14 offen offset:1024 sc1
    ds_read_b64_tr_b16 v[144:145], v87 offset:32768
    ds_read_b64_tr_b16 v[146:147], v87 offset:33280
    v_add_u32 v222, v222, v224
    s_waitcnt lgkmcnt(8)
    v_mfma_f32_32x32x16_bf16 v[12:27], v[124:127], a[136:139], v[12:27]
    ds_read_b64_tr_b16 v[148:149], v86 offset:40960
    ds_read_b64_tr_b16 v[150:151], v86 offset:41472
    v_add_u32 v221, 0x100, v222
    v_mfma_f32_32x32x16_bf16 v[28:43], v[128:131], a[136:139], v[28:43]
    buffer_load_dwordx4 a[168:171], v253, s[32:35], s14 offen offset:2048 sc1
    ds_read_b64_tr_b16 v[152:153], v87 offset:40960
    ds_read_b64_tr_b16 v[154:155], v87 offset:41472
    v_cvt_f32_i32 v221, v221
    s_waitcnt lgkmcnt(8)
    v_mfma_f32_32x32x16_bf16 v[44:59], v[132:135], a[136:139], v[44:59]
    v_mul_f32 v200, 0x3a000000, v221
    s_waitcnt vmcnt(7)
    s_barrier
    ds_read_b64_tr_b16 v[124:125], v80 offset:0
    ds_read_b64_tr_b16 v[126:127], v80 offset:512
    v_mfma_f32_32x32x16_bf16 v[60:75], v[136:139], a[136:139], v[60:75]
    buffer_load_dwordx4 a[172:175], v253, s[32:35], s14 offen offset:3072 sc1
    ds_read_b64_tr_b16 v[128:129], v81 offset:0
    ds_read_b64_tr_b16 v[130:131], v81 offset:512
    v_add_f32 v201, v200, v220
    s_waitcnt lgkmcnt(8)
    v_mfma_f32_32x32x16_bf16 v[12:27], v[140:143], a[140:143], v[12:27]
    ds_read_b64 v[164:165], v228 offset:43008
    ds_read_b64_tr_b16 v[132:133], v80 offset:8192
    ds_read_b64_tr_b16 v[134:135], v80 offset:8704
    v_add_u32 v222, v222, v224
    v_mfma_f32_32x32x16_bf16 v[28:43], v[144:147], a[140:143], v[28:43]
    ds_read_b32 v180, v228 offset:43016
    ds_read_b64_tr_b16 v[136:137], v81 offset:8192
    ds_read_b64_tr_b16 v[138:139], v81 offset:8704
    v_add_u32 v221, 0xffffff00, v222
    buffer_load_dwordx4 a[176:179], v98, s[32:35], s14 offen offset:0 sc1
    s_waitcnt lgkmcnt(10)
    v_mfma_f32_32x32x16_bf16 v[44:59], v[148:151], a[140:143], v[44:59]
    ds_read_b64 v[166:167], v228 offset:51200
    ds_read_b64_tr_b16 v[140:141], v82 offset:0
    ds_read_b64_tr_b16 v[142:143], v82 offset:512
    v_cvt_f32_i32 v221, v221
    v_mfma_f32_32x32x16_bf16 v[60:75], v[152:155], a[140:143], v[60:75]
    ds_read_b32 v181, v228 offset:51208
    ds_read_b64_tr_b16 v[144:145], v83 offset:0
    ds_read_b64_tr_b16 v[146:147], v83 offset:512
    v_mul_f32 v202, 0x3a000000, v221
    s_waitcnt lgkmcnt(12)
    v_mfma_f32_32x32x16_bf16 v[12:27], v[124:127], a[144:147], v[12:27]
    ds_read_b64 v[168:169], v228 offset:43520
    ds_read_b64_tr_b16 v[148:149], v82 offset:8192
    ds_read_b64_tr_b16 v[150:151], v82 offset:8704
    v_add_f32 v203, v202, v220
    s_add_u32 s14, s63, 163840
    buffer_load_dwordx4 a[180:183], v253, s[32:35], s14 offen offset:0 sc1
    v_mfma_f32_32x32x16_bf16 v[28:43], v[128:131], a[144:147], v[28:43]
    v_smfmac_f32_16x16x64_bf16 v[116:119], v[92:95], v[124:131], v237
    ds_read_b32 v182, v228 offset:43528
    ds_read_b64_tr_b16 v[152:153], v83 offset:8192
    ds_read_b64_tr_b16 v[154:155], v83 offset:8704
    v_cos_f32 v196, v196
    s_waitcnt lgkmcnt(12)
    v_mfma_f32_32x32x16_bf16 v[44:59], v[132:135], a[144:147], v[44:59]
    s_add_u32 m0, s15, 0x10000
    s_nop 0
    buffer_load_dwordx4 v253, s[32:35], s91 offen offset:0 sc1 lds
    buffer_load_dwordx4 v253, s[32:35], s91 offen offset:1024 sc1 lds
    ds_read_b64_tr_b16 v[124:125], v84 offset:0
    ds_read_b64_tr_b16 v[126:127], v84 offset:512
    v_mfma_f32_32x32x16_bf16 v[60:75], v[136:139], a[144:147], v[60:75]
    v_smfmac_f32_16x16x64_bf16 v[120:123], v[92:95], v[132:139], v237
    ds_read_b64 v[170:171], v228 offset:51712
    ds_read_b64_tr_b16 v[128:129], v85 offset:0
    ds_read_b64_tr_b16 v[130:131], v85 offset:512
    v_cos_f32 v197, v197
    v_cos_f32 v198, v198
    s_waitcnt lgkmcnt(11)
    v_mfma_f32_32x32x16_bf16 v[12:27], v[140:143], a[148:151], v[12:27]
    ds_read_b32 v183, v228 offset:51720
    ds_read_b64_tr_b16 v[132:133], v84 offset:8192
    ds_read_b64_tr_b16 v[134:135], v84 offset:8704
    v_cos_f32 v199, v199
    buffer_load_dwordx4 a[184:187], v253, s[32:35], s14 offen offset:1024 sc1
    v_mfma_f32_32x32x16_bf16 v[28:43], v[144:147], a[148:151], v[28:43]
    ds_read_b64 v[172:173], v228 offset:44032
    ds_read_b64_tr_b16 v[136:137], v85 offset:8192
    ds_read_b64_tr_b16 v[138:139], v85 offset:8704
    v_cos_f32 v200, v200
    s_waitcnt lgkmcnt(11)
    v_mfma_f32_32x32x16_bf16 v[44:59], v[148:151], a[148:151], v[44:59]
    ds_read_b32 v184, v228 offset:44040
    ds_read_b64_tr_b16 v[140:141], v86 offset:0
    ds_read_b64_tr_b16 v[142:143], v86 offset:512
    v_cos_f32 v201, v201
    buffer_load_dwordx4 a[188:191], v253, s[32:35], s14 offen offset:2048 sc1
    v_mfma_f32_32x32x16_bf16 v[60:75], v[152:155], a[148:151], v[60:75]
    ds_read_b64 v[174:175], v228 offset:52224
    ds_read_b64_tr_b16 v[144:145], v87 offset:0
    ds_read_b64_tr_b16 v[146:147], v87 offset:512
    v_cos_f32 v202, v202
    s_waitcnt lgkmcnt(12)
    v_mfma_f32_32x32x16_bf16 v[12:27], v[124:127], a[152:155], v[12:27]
    s_add_u32 m0, s15, 0x10000
    s_nop 0
    buffer_load_dwordx4 v253, s[32:35], s91 offen offset:2048 sc1 lds
    buffer_load_dwordx4 v253, s[32:35], s91 offen offset:3072 sc1 lds
    v_add_f32 v116, v116, v117
    v_add_f32 v118, v118, v119
    v_add_f32 v120, v120, v121
    v_add_f32 v122, v122, v123
    s_mov_b64 exec, 0xffffffff
    ds_write2st64_b32 v250, v116, v118 offset0:0 offset1:1
    ds_write2st64_b32 v250, v120, v122 offset0:4 offset1:5
    s_mov_b64 exec, -1
    ds_read_b64_tr_b16 v[148:149], v86 offset:8192
    ds_read_b64_tr_b16 v[150:151], v86 offset:8704
    v_mfma_f32_32x32x16_bf16 v[28:43], v[128:131], a[152:155], v[28:43]
    ds_read_b32 v185, v228 offset:52232
    ds_read_b64_tr_b16 v[152:153], v87 offset:8192
    ds_read_b64_tr_b16 v[154:155], v87 offset:8704
    v_cos_f32 v203, v203
    s_waitcnt lgkmcnt(13)
    v_mfma_f32_32x32x16_bf16 v[44:59], v[132:135], a[152:155], v[44:59]
    ds_read_b64 v[176:177], v228 offset:44544
    v_cvt_pk_bf16_f32 v192, v196, v197
    v_cvt_pk_bf16_f32 v193, v198, v199
    buffer_load_dwordx4 a[192:195], v253, s[32:35], s14 offen offset:3072 sc1
    v_mfma_f32_32x32x16_bf16 v[60:75], v[136:139], a[152:155], v[60:75]
    ds_read_b32 v186, v228 offset:44552
    v_cvt_pk_bf16_f32 v194, v200, v201
    buffer_load_dwordx4 a[196:199], v98, s[32:35], s14 offen offset:0 sc1
    s_waitcnt lgkmcnt(9)
    v_mfma_f32_32x32x16_bf16 v[12:27], v[140:143], a[156:159], v[12:27]
    ds_read_b64 v[178:179], v228 offset:52736
    v_cvt_pk_bf16_f32 v195, v202, v203
    s_add_u32 s14, s63, 245760
    buffer_load_dwordx4 a[200:203], v253, s[32:35], s14 offen offset:0 sc1
    v_mfma_f32_32x32x16_bf16 v[28:43], v[144:147], a[156:159], v[28:43]
    ds_read_b32 v187, v228 offset:52744
    buffer_load_dwordx4 a[204:207], v253, s[32:35], s14 offen offset:1024 sc1
    s_waitcnt lgkmcnt(4)
    v_mfma_f32_32x32x16_bf16 v[44:59], v[148:151], a[156:159], v[44:59]
    s_waitcnt vmcnt(19)
    v_xor_b32 v219, s42, v103
    s_waitcnt vmcnt(18)
    v_bitop3_b32 v219, v219, v107, v246 bitop3:0xf6
    s_waitcnt vmcnt(17)
    v_bitop3_b32 v219, v219, v111, v246 bitop3:0xf6
    s_waitcnt vmcnt(16)
    v_bitop3_b32 v219, v219, v115, v246 bitop3:0xf6
    v_cmp_ne_u32 vcc, 0, v219
    s_nop 0
    s_and_b64 vcc, vcc, s[64:65]
    s_cbranch_vccnz L_vs_7
L_vb_8:
    v_add_u32 v219, 26624, v97
    ds_write_b128 v219, v[100:103] offset:0
    ds_write_b128 v219, v[104:107] offset:4096
    ds_write_b128 v219, v[108:111] offset:8192
    ds_write_b128 v219, v[112:115] offset:12288
    v_mfma_f32_32x32x16_bf16 v[60:75], v[152:155], a[156:159], v[60:75]
    s_waitcnt lgkmcnt(0)
    s_barrier
    ds_read_b128 v[100:103], v218 offset:26624
    ds_read_b128 v[104:107], v218 offset:27648
    ds_read_b128 v[108:111], v218 offset:28672
    ds_read_b128 v[112:115], v218 offset:29696
    s_or_b32 s49, s2, s40
    s_cmp_eq_u32 s49, 0
    s_cselect_b32 s49, 0, 0x40000000
    s_mov_b64 exec, 1
    buffer_store_dword v246, v254, s[32:35], s49 offen offset:0 sc1
    s_mov_b64 exec, -1
    s_waitcnt lgkmcnt(3)
    v_mov_b32 v188, v100
    s_waitcnt lgkmcnt(2)
    v_mov_b32 v189, v104
    s_waitcnt lgkmcnt(1)
    v_mov_b32 v190, v108
    s_waitcnt lgkmcnt(0)
    v_mov_b32 v191, v112
    s_nop 1
    v_mfma_f32_16x16x32_bf16 v[220:223], v[188:191], a[240:243], 0
    v_mfma_f32_16x16x32_bf16 v[84:87], v[188:191], a[244:247], 0
    v_mov_b32 v212, v101
    s_add_u32 m0, s15, 0x14000
    s_nop 0
    buffer_load_dwordx4 v253, s[32:35], s92 offen offset:0 sc1 lds
    buffer_load_dwordx4 v253, s[32:35], s92 offen offset:1024 sc1 lds
    v_mov_b32 v213, v105
    v_mov_b32 v214, v109
    v_mov_b32 v215, v113
    s_nop 1
    v_mfma_f32_16x16x32_bf16 v[224:227], v[212:215], a[240:243], 0
    v_mfma_f32_16x16x32_bf16 v[116:119], v[212:215], a[244:247], 0
    v_mov_b32 v196, v102
    v_mov_b32 v197, v106
    v_mov_b32 v198, v110
    v_mov_b32 v199, v114
    s_nop 1
    v_mfma_f32_16x16x32_bf16 v[76:79], v[196:199], a[240:243], 0
    v_mfma_f32_16x16x32_bf16 v[120:123], v[196:199], a[244:247], 0
    v_mov_b32 v200, v103
    v_mov_b32 v201, v107
    v_mov_b32 v202, v111
    s_add_u32 m0, s15, 0x14000
    s_nop 0
    buffer_load_dwordx4 v253, s[32:35], s92 offen offset:2048 sc1 lds
    buffer_load_dwordx4 v253, s[32:35], s92 offen offset:3072 sc1 lds
    v_mov_b32 v203, v115
    s_nop 1
    v_mfma_f32_16x16x32_bf16 v[80:83], v[200:203], a[240:243], 0
    v_mfma_f32_16x16x32_bf16 v[124:127], v[200:203], a[244:247], 0
    v_pk_mul_f32 v[244:245], v[220:221], v[208:209]
    v_pk_mul_f32 v[220:221], v[220:221], v[204:205]
    v_pk_fma_f32 v[220:221], v[84:85], v[208:209], v[220:221]
    v_pk_fma_f32 v[84:85], v[84:85], v[204:205], v[244:245] neg_lo:[0,0,1] neg_hi:[0,0,1]
    v_pk_mul_f32 v[244:245], v[222:223], v[210:211]
    v_pk_mul_f32 v[222:223], v[222:223], v[206:207]
    v_pk_fma_f32 v[222:223], v[86:87], v[210:211], v[222:223]
    v_pk_fma_f32 v[86:87], v[86:87], v[206:207], v[244:245] neg_lo:[0,0,1] neg_hi:[0,0,1]
    v_pk_mul_f32 v[244:245], v[224:225], v[208:209]
    v_pk_mul_f32 v[224:225], v[224:225], v[204:205]
    v_pk_fma_f32 v[224:225], v[116:117], v[208:209], v[224:225]
    s_add_u32 m0, s15, 0x18000
    s_nop 0
    buffer_load_dwordx4 v253, s[32:35], s93 offen offset:0 sc1 lds
    buffer_load_dwordx4 v253, s[32:35], s93 offen offset:1024 sc1 lds
    v_pk_fma_f32 v[116:117], v[116:117], v[204:205], v[244:245] neg_lo:[0,0,1] neg_hi:[0,0,1]
    v_pk_mul_f32 v[244:245], v[226:227], v[210:211]
    v_pk_mul_f32 v[226:227], v[226:227], v[206:207]
    v_pk_fma_f32 v[226:227], v[118:119], v[210:211], v[226:227]
    v_pk_fma_f32 v[118:119], v[118:119], v[206:207], v[244:245] neg_lo:[0,0,1] neg_hi:[0,0,1]
    v_pk_mul_f32 v[244:245], v[76:77], v[208:209]
    v_pk_mul_f32 v[76:77], v[76:77], v[204:205]
    v_pk_fma_f32 v[76:77], v[120:121], v[208:209], v[76:77]
    v_pk_fma_f32 v[120:121], v[120:121], v[204:205], v[244:245] neg_lo:[0,0,1] neg_hi:[0,0,1]
    v_pk_mul_f32 v[244:245], v[78:79], v[210:211]
    v_pk_mul_f32 v[78:79], v[78:79], v[206:207]
    v_pk_fma_f32 v[78:79], v[122:123], v[210:211], v[78:79]
    v_pk_fma_f32 v[122:123], v[122:123], v[206:207], v[244:245] neg_lo:[0,0,1] neg_hi:[0,0,1]
    v_pk_mul_f32 v[244:245], v[80:81], v[208:209]
    s_add_u32 m0, s15, 0x18000
    s_nop 0
    buffer_load_dwordx4 v253, s[32:35], s93 offen offset:2048 sc1 lds
    buffer_load_dwordx4 v253, s[32:35], s93 offen offset:3072 sc1 lds
    v_pk_mul_f32 v[80:81], v[80:81], v[204:205]
    v_pk_fma_f32 v[80:81], v[124:125], v[208:209], v[80:81]
    v_pk_fma_f32 v[124:125], v[124:125], v[204:205], v[244:245] neg_lo:[0,0,1] neg_hi:[0,0,1]
    v_pk_mul_f32 v[244:245], v[82:83], v[210:211]
    v_pk_mul_f32 v[82:83], v[82:83], v[206:207]
    v_pk_fma_f32 v[82:83], v[126:127], v[210:211], v[82:83]
    v_pk_fma_f32 v[126:127], v[126:127], v[206:207], v[244:245] neg_lo:[0,0,1] neg_hi:[0,0,1]
    v_cvt_pk_bf16_f32 v188, v220, v84
    v_cvt_pk_bf16_f32 v189, v221, v85
    v_cvt_pk_bf16_f32 v190, v222, v86
    v_cvt_pk_bf16_f32 v191, v223, v87
    s_nop 1
    v_mfma_f32_16x16x32_bf16 v[220:223], a[240:243], v[188:191], 0
    v_mfma_f32_16x16x32_bf16 v[84:87], a[244:247], v[188:191], 0
    v_cvt_pk_bf16_f32 v212, v224, v116
    s_add_u32 m0, s15, 0x20000
    s_nop 0
    buffer_load_dwordx4 v253, s[32:35], s94 offen offset:0 sc1 lds
    buffer_load_dwordx4 v253, s[32:35], s94 offen offset:1024 sc1 lds
    v_cvt_pk_bf16_f32 v213, v225, v117
    v_cvt_pk_bf16_f32 v214, v226, v118
    v_cvt_pk_bf16_f32 v215, v227, v119
    s_nop 1
    v_mfma_f32_16x16x32_bf16 v[224:227], a[240:243], v[212:215], 0
    v_mfma_f32_16x16x32_bf16 v[116:119], a[244:247], v[212:215], 0
    v_cvt_pk_bf16_f32 v196, v76, v120
    v_cvt_pk_bf16_f32 v197, v77, v121
    v_cvt_pk_bf16_f32 v198, v78, v122
    v_cvt_pk_bf16_f32 v199, v79, v123
    s_nop 1
    v_mfma_f32_16x16x32_bf16 v[76:79], a[240:243], v[196:199], 0
    v_mfma_f32_16x16x32_bf16 v[120:123], a[244:247], v[196:199], 0
    v_cvt_pk_bf16_f32 v200, v80, v124
    v_cvt_pk_bf16_f32 v201, v81, v125
    v_cvt_pk_bf16_f32 v202, v82, v126
    s_add_u32 m0, s15, 0x20000
    s_nop 0
    buffer_load_dwordx4 v253, s[32:35], s94 offen offset:2048 sc1 lds
    buffer_load_dwordx4 v253, s[32:35], s94 offen offset:3072 sc1 lds
    v_cvt_pk_bf16_f32 v203, v83, v127
    s_nop 1
    v_mfma_f32_16x16x32_bf16 v[80:83], a[240:243], v[200:203], 0
    v_mfma_f32_16x16x32_bf16 v[124:127], a[244:247], v[200:203], 0
    v_perm_b32 v216, v165, v164, s61
    v_perm_b32 v232, v167, v166, s61
    v_perm_b32 v217, v169, v168, s61
    v_perm_b32 v233, v171, v170, s61
    v_pk_mul_f32 v[244:245], v[220:221], v[232:233]
    v_pk_mul_f32 v[220:221], v[220:221], v[216:217]
    v_pk_fma_f32 v[220:221], v[84:85], v[232:233], v[220:221] neg_lo:[1,0,0] neg_hi:[1,0,0]
    v_pk_fma_f32 v[84:85], v[84:85], v[216:217], v[244:245]
    v_perm_b32 v216, v173, v172, s61
    v_perm_b32 v232, v175, v174, s61
    v_perm_b32 v217, v177, v176, s61
    s_add_u32 m0, s15, 0x24000
    s_nop 0
    buffer_load_dwordx4 v253, s[32:35], s95 offen offset:0 sc1 lds
    buffer_load_dwordx4 v253, s[32:35], s95 offen offset:1024 sc1 lds
    v_perm_b32 v233, v179, v178, s61
    v_pk_mul_f32 v[244:245], v[222:223], v[232:233]
    v_pk_mul_f32 v[222:223], v[222:223], v[216:217]
    v_pk_fma_f32 v[222:223], v[86:87], v[232:233], v[222:223] neg_lo:[1,0,0] neg_hi:[1,0,0]
    v_pk_fma_f32 v[86:87], v[86:87], v[216:217], v[244:245]
    v_perm_b32 v216, v165, v164, s12
    v_perm_b32 v232, v167, v166, s12
    v_perm_b32 v217, v169, v168, s12
    v_perm_b32 v233, v171, v170, s12
    v_pk_mul_f32 v[244:245], v[224:225], v[232:233]
    v_pk_mul_f32 v[224:225], v[224:225], v[216:217]
    v_pk_fma_f32 v[224:225], v[116:117], v[232:233], v[224:225] neg_lo:[1,0,0] neg_hi:[1,0,0]
    v_pk_fma_f32 v[116:117], v[116:117], v[216:217], v[244:245]
    v_perm_b32 v216, v173, v172, s12
    s_add_u32 m0, s15, 0x24000
    s_nop 0
    buffer_load_dwordx4 v253, s[32:35], s95 offen offset:2048 sc1 lds
    buffer_load_dwordx4 v253, s[32:35], s95 offen offset:3072 sc1 lds
    v_perm_b32 v232, v175, v174, s12
    v_perm_b32 v217, v177, v176, s12
    v_perm_b32 v233, v179, v178, s12
    v_pk_mul_f32 v[244:245], v[226:227], v[232:233]
    v_pk_mul_f32 v[226:227], v[226:227], v[216:217]
    v_pk_fma_f32 v[226:227], v[118:119], v[232:233], v[226:227] neg_lo:[1,0,0] neg_hi:[1,0,0]
    v_pk_fma_f32 v[118:119], v[118:119], v[216:217], v[244:245]
    v_perm_b32 v216, v165, v164, s13
    v_perm_b32 v232, v167, v166, s13
    v_perm_b32 v217, v169, v168, s13
    v_perm_b32 v233, v171, v170, s13
    v_pk_mul_f32 v[244:245], v[76:77], v[232:233]
    v_pk_mul_f32 v[76:77], v[76:77], v[216:217]
    v_pk_fma_f32 v[76:77], v[120:121], v[232:233], v[76:77] neg_lo:[1,0,0] neg_hi:[1,0,0]
    buffer_load_dwordx4 a[208:211], v253, s[32:35], s14 offen offset:2048 sc1
    v_pk_fma_f32 v[120:121], v[120:121], v[216:217], v[244:245]
    v_perm_b32 v216, v173, v172, s13
    v_perm_b32 v232, v175, v174, s13
    v_perm_b32 v217, v177, v176, s13
    v_perm_b32 v233, v179, v178, s13
    v_pk_mul_f32 v[244:245], v[78:79], v[232:233]
    v_pk_mul_f32 v[78:79], v[78:79], v[216:217]
    v_pk_fma_f32 v[78:79], v[122:123], v[232:233], v[78:79] neg_lo:[1,0,0] neg_hi:[1,0,0]
    v_pk_fma_f32 v[122:123], v[122:123], v[216:217], v[244:245]
    v_perm_b32 v216, v180, v165, s12
    v_perm_b32 v232, v181, v167, s12
    v_perm_b32 v217, v182, v169, s12
    v_perm_b32 v233, v183, v171, s12
    v_pk_mul_f32 v[244:245], v[80:81], v[232:233]
    buffer_load_dwordx4 a[212:215], v253, s[32:35], s14 offen offset:3072 sc1
    v_pk_mul_f32 v[80:81], v[80:81], v[216:217]
    v_pk_fma_f32 v[80:81], v[124:125], v[232:233], v[80:81] neg_lo:[1,0,0] neg_hi:[1,0,0]
    v_pk_fma_f32 v[124:125], v[124:125], v[216:217], v[244:245]
    v_perm_b32 v216, v184, v173, s12
    v_perm_b32 v232, v185, v175, s12
    v_perm_b32 v217, v186, v177, s12
    v_perm_b32 v233, v187, v179, s12
    v_pk_mul_f32 v[244:245], v[82:83], v[232:233]
    v_pk_mul_f32 v[82:83], v[82:83], v[216:217]
    v_pk_fma_f32 v[82:83], v[126:127], v[232:233], v[82:83] neg_lo:[1,0,0] neg_hi:[1,0,0]
    v_pk_fma_f32 v[126:127], v[126:127], v[216:217], v[244:245]
    v_cvt_pk_bf16_f32 v188, v220, v84
    v_cvt_pk_bf16_f32 v189, v221, v85
    v_cvt_pk_bf16_f32 v190, v222, v86
    buffer_load_dwordx4 a[216:219], v98, s[32:35], s14 offen offset:0 sc1
    v_cvt_pk_bf16_f32 v191, v223, v87
    s_nop 1
    v_mfma_f32_16x16x32_bf16 v[220:223], v[188:191], a[248:251], 0
    v_mfma_f32_16x16x32_bf16 v[84:87], v[188:191], a[252:255], 0
    v_cvt_pk_bf16_f32 v212, v224, v116
    v_cvt_pk_bf16_f32 v213, v225, v117
    v_cvt_pk_bf16_f32 v214, v226, v118
    v_cvt_pk_bf16_f32 v215, v227, v119
    s_nop 1
    v_mfma_f32_16x16x32_bf16 v[224:227], v[212:215], a[248:251], 0
    v_mfma_f32_16x16x32_bf16 v[116:119], v[212:215], a[252:255], 0
    v_cvt_pk_bf16_f32 v196, v76, v120
    v_cvt_pk_bf16_f32 v197, v77, v121
    v_cvt_pk_bf16_f32 v198, v78, v122
    v_cvt_pk_bf16_f32 v199, v79, v123
    s_nop 1
    v_mfma_f32_16x16x32_bf16 v[76:79], v[196:199], a[248:251], 0
    s_add_u32 s14, s63, 409600
    buffer_load_dwordx4 a[220:223], v253, s[32:35], s14 offen offset:0 sc1
    v_mfma_f32_16x16x32_bf16 v[120:123], v[196:199], a[252:255], 0
    v_cvt_pk_bf16_f32 v200, v80, v124
    v_cvt_pk_bf16_f32 v201, v81, v125
    v_cvt_pk_bf16_f32 v202, v82, v126
    v_cvt_pk_bf16_f32 v203, v83, v127
    s_nop 1
    v_mfma_f32_16x16x32_bf16 v[80:83], v[200:203], a[248:251], 0
    v_mfma_f32_16x16x32_bf16 v[124:127], v[200:203], a[252:255], 0
    v_pk_mul_f32 v[244:245], v[220:221], v[208:209]
    v_pk_mul_f32 v[220:221], v[220:221], v[204:205]
    v_pk_fma_f32 v[220:221], v[84:85], v[208:209], v[220:221] neg_lo:[1,0,0] neg_hi:[1,0,0]
    v_pk_fma_f32 v[84:85], v[84:85], v[204:205], v[244:245]
    v_pk_mul_f32 v[244:245], v[222:223], v[210:211]
    v_pk_mul_f32 v[222:223], v[222:223], v[206:207]
    v_pk_fma_f32 v[222:223], v[86:87], v[210:211], v[222:223] neg_lo:[1,0,0] neg_hi:[1,0,0]
    buffer_load_dwordx4 a[224:227], v253, s[32:35], s14 offen offset:1024 sc1
    v_pk_fma_f32 v[86:87], v[86:87], v[206:207], v[244:245]
    v_pk_mul_f32 v[244:245], v[224:225], v[208:209]
    v_pk_mul_f32 v[224:225], v[224:225], v[204:205]
    v_pk_fma_f32 v[224:225], v[116:117], v[208:209], v[224:225] neg_lo:[1,0,0] neg_hi:[1,0,0]
    v_pk_fma_f32 v[116:117], v[116:117], v[204:205], v[244:245]
    v_pk_mul_f32 v[244:245], v[226:227], v[210:211]
    v_pk_mul_f32 v[226:227], v[226:227], v[206:207]
    v_pk_fma_f32 v[226:227], v[118:119], v[210:211], v[226:227] neg_lo:[1,0,0] neg_hi:[1,0,0]
    v_pk_fma_f32 v[118:119], v[118:119], v[206:207], v[244:245]
    v_pk_mul_f32 v[244:245], v[76:77], v[208:209]
    v_pk_mul_f32 v[76:77], v[76:77], v[204:205]
    v_pk_fma_f32 v[76:77], v[120:121], v[208:209], v[76:77] neg_lo:[1,0,0] neg_hi:[1,0,0]
    v_pk_fma_f32 v[120:121], v[120:121], v[204:205], v[244:245]
    v_pk_mul_f32 v[244:245], v[78:79], v[210:211]
    buffer_load_dwordx4 a[228:231], v253, s[32:35], s14 offen offset:2048 sc1
    v_pk_mul_f32 v[78:79], v[78:79], v[206:207]
    v_pk_fma_f32 v[78:79], v[122:123], v[210:211], v[78:79] neg_lo:[1,0,0] neg_hi:[1,0,0]
    v_pk_fma_f32 v[122:123], v[122:123], v[206:207], v[244:245]
    v_pk_mul_f32 v[244:245], v[80:81], v[208:209]
    v_pk_mul_f32 v[80:81], v[80:81], v[204:205]
    v_pk_fma_f32 v[80:81], v[124:125], v[208:209], v[80:81] neg_lo:[1,0,0] neg_hi:[1,0,0]
    v_pk_fma_f32 v[124:125], v[124:125], v[204:205], v[244:245]
    v_pk_mul_f32 v[244:245], v[82:83], v[210:211]
    v_pk_mul_f32 v[82:83], v[82:83], v[206:207]
    v_pk_fma_f32 v[82:83], v[126:127], v[210:211], v[82:83] neg_lo:[1,0,0] neg_hi:[1,0,0]
    v_pk_fma_f32 v[126:127], v[126:127], v[206:207], v[244:245]
    v_cvt_pk_bf16_f32 v188, v220, v84
    v_cvt_pk_bf16_f32 v189, v221, v85
    v_cvt_pk_bf16_f32 v190, v222, v86
    buffer_load_dwordx4 a[232:235], v253, s[32:35], s14 offen offset:3072 sc1
    v_cvt_pk_bf16_f32 v191, v223, v87
    s_nop 1
    v_mfma_f32_16x16x32_bf16 v[220:223], a[248:251], v[188:191], 0
    v_mfma_f32_16x16x32_bf16 v[84:87], a[252:255], v[188:191], 0
    v_cvt_pk_bf16_f32 v212, v224, v116
    v_cvt_pk_bf16_f32 v213, v225, v117
    v_cvt_pk_bf16_f32 v214, v226, v118
    v_cvt_pk_bf16_f32 v215, v227, v119
    s_nop 1
    v_mfma_f32_16x16x32_bf16 v[224:227], a[248:251], v[212:215], 0
    v_mfma_f32_16x16x32_bf16 v[116:119], a[252:255], v[212:215], 0
    v_cvt_pk_bf16_f32 v196, v76, v120
    v_cvt_pk_bf16_f32 v197, v77, v121
    v_cvt_pk_bf16_f32 v198, v78, v122
    v_cvt_pk_bf16_f32 v199, v79, v123
    s_nop 1
    v_mfma_f32_16x16x32_bf16 v[76:79], a[248:251], v[196:199], 0
    buffer_load_dwordx4 a[236:239], v98, s[32:35], s14 offen offset:0 sc1
    v_mfma_f32_16x16x32_bf16 v[120:123], a[252:255], v[196:199], 0
    v_cvt_pk_bf16_f32 v200, v80, v124
    v_cvt_pk_bf16_f32 v201, v81, v125
    v_cvt_pk_bf16_f32 v202, v82, v126
    v_cvt_pk_bf16_f32 v203, v83, v127
    s_nop 1
    v_mfma_f32_16x16x32_bf16 v[80:83], a[248:251], v[200:203], 0
    v_mfma_f32_16x16x32_bf16 v[124:127], a[252:255], v[200:203], 0
    s_barrier
    v_cvt_pk_bf16_f32 v100, v220, v84
    v_cvt_pk_bf16_f32 v101, v224, v116
    v_cvt_pk_bf16_f32 v102, v76, v120
    s_nop 3
    v_cvt_pk_bf16_f32 v103, v80, v124
    ds_write_b128 v218, v[100:103] offset:26624
    v_cvt_pk_bf16_f32 v104, v221, v85
    v_cvt_pk_bf16_f32 v105, v225, v117
    v_cvt_pk_bf16_f32 v106, v77, v121
    v_cvt_pk_bf16_f32 v107, v81, v125
    ds_write_b128 v218, v[104:107] offset:27648
    v_cvt_pk_bf16_f32 v108, v222, v86
    v_cvt_pk_bf16_f32 v109, v226, v118
    v_cvt_pk_bf16_f32 v110, v78, v122
    v_cvt_pk_bf16_f32 v111, v82, v126
    ds_write_b128 v218, v[108:111] offset:28672
    v_cvt_pk_bf16_f32 v112, v223, v87
    v_cvt_pk_bf16_f32 v113, v227, v119
    v_cvt_pk_bf16_f32 v114, v79, v123
    v_cvt_pk_bf16_f32 v115, v83, v127
    ds_write_b128 v218, v[112:115] offset:29696
    s_waitcnt lgkmcnt(0)
    s_barrier
    ds_read_b128 v[100:103], v97 offset:26624
    ds_read_b128 v[104:107], v97 offset:30720
    ds_read_b128 v[108:111], v97 offset:34816
    ds_read_b128 v[112:115], v97 offset:38912
    ds_read_b128 v[116:119], v249 offset:59392
    v_mov_b32 v76, 0
    ds_read_b128 v[120:123], v249 offset:59904
    v_mov_b32 v77, 0
    ds_read_b128 v[124:127], v249 offset:60416
    v_mov_b32 v78, 0
    ds_read_b128 v[128:131], v249 offset:60928
    v_mov_b32 v79, 0
    s_waitcnt vmcnt(29)
    s_barrier
    ds_read_b128 v[80:83], v88 offset:0
    ds_read_b128 v[84:87], v88 offset:1024
    ds_read_b128 v[180:183], v89 offset:0
    ds_read_b128 v[184:187], v89 offset:1024
    ds_read_b128 v[212:215], v90 offset:0
    ds_read_b128 v[216:219], v90 offset:1024
    s_waitcnt lgkmcnt(4)
    v_mfma_f32_32x32x16_bf16 v[164:179], v[80:83], a[0:3], 0
    ds_read_b128 v[220:223], v91 offset:0
    v_cndmask_b32 v103, v103, v246, s[0:1]
    buffer_store_dwordx4 v[100:103], v251, s[32:35], s66 offen sc1
    v_add_f32 v116, v116, v117
    v_add_f32 v118, v118, v119
    v_add_f32 v116, v116, v118
    v_mfma_f32_32x32x16_bf16 v[196:211], v[84:87], a[0:3], 0
    v_smfmac_f32_16x16x64_bf16 v[76:79], v[92:95], v[80:87], v237
    ds_read_b128 v[224:227], v91 offset:1024
    s_waitcnt lgkmcnt(4)
    v_cndmask_b32 v107, v107, v246, s[0:1]
    s_add_u32 s48, s66, 1048576
    buffer_store_dwordx4 v[104:107], v251, s[32:35], s48 offen sc1
    v_and_b32 v119, 0xffff0000, v116
    v_sub_f32 v116, v116, v119
    v_and_b32 v118, 0xffff0000, v116
    v_sub_f32 v116, v116, v118
    v_mfma_f32_32x32x16_bf16 v[164:179], v[180:183], a[4:7], v[164:179]
    ds_read_b128 v[80:83], v88 offset:8192
    v_cndmask_b32 v111, v111, v246, s[0:1]
    s_add_u32 s48, s66, 2097152
    buffer_store_dwordx4 v[108:111], v251, s[32:35], s48 offen sc1
    v_lshrrev_b32 v117, 16, v116
    v_perm_b32 v116, v118, v119, s3
    v_mfma_f32_32x32x16_bf16 v[196:211], v[184:187], a[4:7], v[196:211]
    ds_read_b128 v[84:87], v88 offset:9216
    s_waitcnt lgkmcnt(4)
    v_cndmask_b32 v115, v115, v246, s[0:1]
    s_add_u32 s48, s66, 3145728
    buffer_store_dwordx4 v[112:115], v251, s[32:35], s48 offen sc1
    v_mfma_f32_32x32x16_bf16 v[12:27], v[116:119], v[160:163], v[12:27]
    v_mfma_f32_32x32x16_bf16 v[164:179], v[212:215], a[8:11], v[164:179]
    ds_read_b128 v[180:183], v89 offset:8192
    v_add_f32 v124, v124, v125
    v_add_f32 v126, v126, v127
    v_add_f32 v124, v124, v126
    v_and_b32 v127, 0xffff0000, v124
    v_sub_f32 v124, v124, v127
    v_mfma_f32_32x32x16_bf16 v[196:211], v[216:219], a[8:11], v[196:211]
    ds_read_b128 v[184:187], v89 offset:9216
    s_waitcnt lgkmcnt(4)
    v_and_b32 v126, 0xffff0000, v124
    v_sub_f32 v124, v124, v126
    v_lshrrev_b32 v125, 16, v124
    v_perm_b32 v124, v126, v127, s3
    s_nop 1
    v_mfma_f32_32x32x16_bf16 v[44:59], v[124:127], v[160:163], v[44:59]
    v_mfma_f32_32x32x16_bf16 v[164:179], v[220:223], a[12:15], v[164:179]
    ds_read_b128 v[212:215], v90 offset:8192
    v_mul_f32 v188, v12, v229
    v_mul_f32 v189, v13, v229
    v_mul_f32 v190, v14, v229
    v_mul_f32 v191, v15, v229
    v_mfma_f32_32x32x16_bf16 v[196:211], v[224:227], a[12:15], v[196:211]
    ds_read_b128 v[216:219], v90 offset:9216
    s_waitcnt lgkmcnt(4)
    v_exp_f32 v12, v188
    s_nop 1
    v_mul_f32 v188, v188, v44
    v_exp_f32 v13, v189
    v_mfma_f32_32x32x16_bf16 v[164:179], v[80:83], a[16:19], v[164:179]
    ds_read_b128 v[220:223], v91 offset:8192
    v_mul_f32 v189, v189, v45
    v_exp_f32 v14, v190
    v_mul_f32 v190, v190, v46
    v_mfma_f32_32x32x16_bf16 v[196:211], v[84:87], a[16:19], v[196:211]
    v_smfmac_f32_16x16x64_bf16 v[76:79], v[92:95], v[80:87], v237
    ds_read_b128 v[224:227], v91 offset:9216
    s_waitcnt lgkmcnt(4)
    v_exp_f32 v15, v191
    v_mul_f32 v191, v191, v47
    v_fma_f32 v12, v12, v230, v230
    v_fma_f32 v13, v13, v230, v230
    v_fma_f32 v14, v14, v230, v230
    v_mfma_f32_32x32x16_bf16 v[164:179], v[180:183], a[20:23], v[164:179]
    v_fma_f32 v15, v15, v230, v230
    v_rcp_f32 v12, v12
    v_rcp_f32 v13, v13
    s_waitcnt vmcnt(24)
    s_barrier
    ds_read_b128 v[80:83], v88 offset:16384
    v_mfma_f32_32x32x16_bf16 v[196:211], v[184:187], a[20:23], v[196:211]
    s_add_u32 s14, s63, 40960
    buffer_load_dwordx4 a[0:3], v253, s[32:35], s14 offen offset:0 sc1
    ds_read_b128 v[84:87], v88 offset:17408
    s_waitcnt lgkmcnt(4)
    v_rcp_f32 v14, v14
    v_rcp_f32 v15, v15
    v_mfma_f32_32x32x16_bf16 v[164:179], v[212:215], a[24:27], v[164:179]
    s_add_u32 s12, s69, 4096
    ds_read_b128 v[180:183], v89 offset:16384
    v_mul_f32 v12, v12, v188
    v_mul_f32 v13, v13, v189
    v_mul_f32 v14, v14, v190
    v_mul_f32 v15, v15, v191
    v_cvt_pk_bf16_f32 v44, v12, v13
    v_mfma_f32_32x32x16_bf16 v[196:211], v[216:219], a[24:27], v[196:211]
    buffer_load_dwordx4 a[4:7], v253, s[32:35], s14 offen offset:1024 sc1
    ds_read_b128 v[184:187], v89 offset:17408
    s_waitcnt lgkmcnt(4)
    v_cvt_pk_bf16_f32 v45, v14, v15
    v_mul_f32 v188, v16, v229
    v_mul_f32 v189, v17, v229
    v_mul_f32 v190, v18, v229
    v_mul_f32 v191, v19, v229
    v_mfma_f32_32x32x16_bf16 v[164:179], v[220:223], a[28:31], v[164:179]
    ds_read_b128 v[212:215], v90 offset:16384
    v_exp_f32 v16, v188
    v_mul_f32 v188, v188, v48
    v_exp_f32 v17, v189
    v_mfma_f32_32x32x16_bf16 v[196:211], v[224:227], a[28:31], v[196:211]
    buffer_load_dwordx4 a[8:11], v253, s[32:35], s14 offen offset:2048 sc1
    ds_read_b128 v[216:219], v90 offset:17408
    s_waitcnt lgkmcnt(4)
    v_mul_f32 v189, v189, v49
    v_exp_f32 v18, v190
    v_mul_f32 v190, v190, v50
    v_mfma_f32_32x32x16_bf16 v[164:179], v[80:83], a[32:35], v[164:179]
    ds_read_b128 v[220:223], v91 offset:16384
    v_exp_f32 v19, v191
    v_mul_f32 v191, v191, v51
    v_fma_f32 v16, v16, v230, v230
    v_fma_f32 v17, v17, v230, v230
    v_mfma_f32_32x32x16_bf16 v[196:211], v[84:87], a[32:35], v[196:211]
    v_smfmac_f32_16x16x64_bf16 v[76:79], v[92:95], v[80:87], v237
    buffer_load_dwordx4 a[12:15], v253, s[32:35], s14 offen offset:3072 sc1
    ds_read_b128 v[224:227], v91 offset:17408
    s_waitcnt lgkmcnt(4)
    v_fma_f32 v18, v18, v230, v230
    v_fma_f32 v19, v19, v230, v230
    v_rcp_f32 v16, v16
    v_rcp_f32 v17, v17
    v_mfma_f32_32x32x16_bf16 v[164:179], v[180:183], a[36:39], v[164:179]
    ds_read_b128 v[80:83], v88 offset:24576
    v_rcp_f32 v18, v18
    v_rcp_f32 v19, v19
    v_mul_f32 v16, v16, v188
    v_mfma_f32_32x32x16_bf16 v[196:211], v[184:187], a[36:39], v[196:211]
    buffer_load_dwordx4 a[16:19], v98, s[32:35], s14 offen offset:0 sc1
    ds_read_b128 v[84:87], v88 offset:25600
    s_waitcnt lgkmcnt(4)
    v_mul_f32 v17, v17, v189
    v_mul_f32 v18, v18, v190
    v_mul_f32 v19, v19, v191
    v_cvt_pk_bf16_f32 v46, v16, v17
    v_cvt_pk_bf16_f32 v47, v18, v19
    v_mfma_f32_32x32x16_bf16 v[164:179], v[212:215], a[40:43], v[164:179]
    ds_read_b128 v[180:183], v89 offset:24576
    v_mul_f32 v188, v20, v229
    v_mul_f32 v189, v21, v229
    v_mul_f32 v190, v22, v229
    v_mfma_f32_32x32x16_bf16 v[196:211], v[216:219], a[40:43], v[196:211]
    s_add_u32 s14, s63, 204800
    buffer_load_dwordx4 a[20:23], v253, s[32:35], s14 offen offset:0 sc1
    ds_read_b128 v[184:187], v89 offset:25600
    s_waitcnt lgkmcnt(4)
    v_mul_f32 v191, v23, v229
    v_exp_f32 v20, v188
    v_mul_f32 v188, v188, v52
    v_mfma_f32_32x32x16_bf16 v[164:179], v[220:223], a[44:47], v[164:179]
    ds_read_b128 v[212:215], v90 offset:24576
    v_exp_f32 v21, v189
    v_mul_f32 v189, v189, v53
    v_exp_f32 v22, v190
    v_mfma_f32_32x32x16_bf16 v[196:211], v[224:227], a[44:47], v[196:211]
    buffer_load_dwordx4 a[24:27], v253, s[32:35], s14 offen offset:1024 sc1
    ds_read_b128 v[216:219], v90 offset:25600
    s_waitcnt lgkmcnt(4)
    v_mul_f32 v190, v190, v54
    v_exp_f32 v23, v191
    v_mul_f32 v191, v191, v55
    v_fma_f32 v20, v20, v230, v230
    v_mfma_f32_32x32x16_bf16 v[164:179], v[80:83], a[48:51], v[164:179]
    ds_read_b128 v[220:223], v91 offset:24576
    v_fma_f32 v21, v21, v230, v230
    v_fma_f32 v22, v22, v230, v230
    v_fma_f32 v23, v23, v230, v230
    v_rcp_f32 v20, v20
    v_mfma_f32_32x32x16_bf16 v[196:211], v[84:87], a[48:51], v[196:211]
    v_smfmac_f32_16x16x64_bf16 v[76:79], v[92:95], v[80:87], v237
    buffer_load_dwordx4 a[28:31], v253, s[32:35], s14 offen offset:2048 sc1
    ds_read_b128 v[224:227], v91 offset:25600
    s_waitcnt lgkmcnt(4)
    v_rcp_f32 v21, v21
    v_rcp_f32 v22, v22
    v_rcp_f32 v23, v23
    v_mul_f32 v20, v20, v188
    v_mfma_f32_32x32x16_bf16 v[164:179], v[180:183], a[52:55], v[164:179]
    v_mul_f32 v21, v21, v189
    v_mul_f32 v22, v22, v190
    v_mul_f32 v23, v23, v191
    v_cvt_pk_bf16_f32 v48, v20, v21
    s_waitcnt vmcnt(28)
    s_barrier
    ds_read_b128 v[80:83], v88 offset:32768
    v_mfma_f32_32x32x16_bf16 v[196:211], v[184:187], a[52:55], v[196:211]
    buffer_load_dwordx4 a[32:35], v253, s[32:35], s14 offen offset:3072 sc1
    ds_read_b128 v[84:87], v88 offset:33792
    s_waitcnt lgkmcnt(4)
    v_cvt_pk_bf16_f32 v49, v22, v23
    v_mul_f32 v188, v24, v229
    v_mul_f32 v189, v25, v229
    v_mul_f32 v190, v26, v229
    v_mfma_f32_32x32x16_bf16 v[164:179], v[212:215], a[56:59], v[164:179]
    ds_read_b128 v[180:183], v89 offset:32768
    v_mul_f32 v191, v27, v229
    v_exp_f32 v24, v188
    v_mul_f32 v188, v188, v56
    v_mfma_f32_32x32x16_bf16 v[196:211], v[216:219], a[56:59], v[196:211]
    buffer_load_dwordx4 a[36:39], v98, s[32:35], s14 offen offset:0 sc1
    ds_read_b128 v[184:187], v89 offset:33792
    s_waitcnt lgkmcnt(4)
    v_exp_f32 v25, v189
    v_mul_f32 v189, v189, v57
    v_exp_f32 v26, v190
    v_mfma_f32_32x32x16_bf16 v[164:179], v[220:223], a[60:63], v[164:179]
    ds_read_b128 v[212:215], v90 offset:32768
    v_mul_f32 v190, v190, v58
    v_exp_f32 v27, v191
    v_mul_f32 v191, v191, v59
    v_fma_f32 v24, v24, v230, v230
    v_mfma_f32_32x32x16_bf16 v[196:211], v[224:227], a[60:63], v[196:211]
    s_add_u32 s14, s63, 286720
    buffer_load_dwordx4 a[40:43], v253, s[32:35], s14 offen offset:0 sc1
    ds_read_b128 v[216:219], v90 offset:33792
    s_waitcnt lgkmcnt(4)
    v_fma_f32 v25, v25, v230, v230
    v_fma_f32 v26, v26, v230, v230
    v_fma_f32 v27, v27, v230, v230
    v_mfma_f32_32x32x16_bf16 v[164:179], v[80:83], a[64:67], v[164:179]
    ds_read_b128 v[220:223], v91 offset:32768
    v_rcp_f32 v24, v24
    v_rcp_f32 v25, v25
    v_mfma_f32_32x32x16_bf16 v[196:211], v[84:87], a[64:67], v[196:211]
    v_smfmac_f32_16x16x64_bf16 v[76:79], v[92:95], v[80:87], v237
    buffer_load_dwordx4 a[44:47], v253, s[32:35], s14 offen offset:1024 sc1
    ds_read_b128 v[224:227], v91 offset:33792
    s_waitcnt lgkmcnt(4)
    v_rcp_f32 v26, v26
    v_rcp_f32 v27, v27
    v_mul_f32 v24, v24, v188
    v_mul_f32 v25, v25, v189
    v_mul_f32 v26, v26, v190
    v_mfma_f32_32x32x16_bf16 v[164:179], v[180:183], a[68:71], v[164:179]
    ds_read_b128 v[80:83], v88 offset:40960
    v_mul_f32 v27, v27, v191
    v_cvt_pk_bf16_f32 v50, v24, v25
    v_cvt_pk_bf16_f32 v51, v26, v27
    buffer_store_dwordx4 v[44:47], v99, s[32:35], s69 offen offset:0 sc1
    buffer_store_dwordx4 v[48:51], v99, s[32:35], s69 offen offset:512 sc1
    v_mfma_f32_32x32x16_bf16 v[196:211], v[184:187], a[68:71], v[196:211]
    buffer_load_dwordx4 a[48:51], v253, s[32:35], s14 offen offset:2048 sc1
    ds_read_b128 v[84:87], v88 offset:41984
    s_waitcnt lgkmcnt(4)
    v_add_f32 v120, v120, v121
    v_add_f32 v122, v122, v123
    v_add_f32 v120, v120, v122
    v_and_b32 v123, 0xffff0000, v120
    v_mfma_f32_32x32x16_bf16 v[164:179], v[212:215], a[72:75], v[164:179]
    ds_read_b128 v[180:183], v89 offset:40960
    v_sub_f32 v120, v120, v123
    v_and_b32 v122, 0xffff0000, v120
    v_sub_f32 v120, v120, v122
    v_mfma_f32_32x32x16_bf16 v[196:211], v[216:219], a[72:75], v[196:211]
    buffer_load_dwordx4 a[52:55], v253, s[32:35], s14 offen offset:3072 sc1
    ds_read_b128 v[184:187], v89 offset:41984
    s_waitcnt lgkmcnt(4)
    v_lshrrev_b32 v121, 16, v120
    v_perm_b32 v120, v122, v123, s3
    s_nop 1
    v_mfma_f32_32x32x16_bf16 v[28:43], v[120:123], v[160:163], v[28:43]
    v_mfma_f32_32x32x16_bf16 v[164:179], v[220:223], a[76:79], v[164:179]
    ds_read_b128 v[212:215], v90 offset:40960
    v_add_f32 v128, v128, v129
    v_add_f32 v130, v130, v131
    v_add_f32 v128, v128, v130
    v_and_b32 v131, 0xffff0000, v128
    v_mfma_f32_32x32x16_bf16 v[196:211], v[224:227], a[76:79], v[196:211]
    buffer_load_dwordx4 a[56:59], v98, s[32:35], s14 offen offset:0 sc1
    ds_read_b128 v[216:219], v90 offset:41984
    s_waitcnt lgkmcnt(4)
    v_sub_f32 v128, v128, v131
    v_and_b32 v130, 0xffff0000, v128
    v_sub_f32 v128, v128, v130
    v_mfma_f32_32x32x16_bf16 v[164:179], v[80:83], a[80:83], v[164:179]
    ds_read_b128 v[220:223], v91 offset:40960
    v_lshrrev_b32 v129, 16, v128
    v_perm_b32 v128, v130, v131, s3
    s_nop 1
    v_mfma_f32_32x32x16_bf16 v[60:75], v[128:131], v[160:163], v[60:75]
    v_mfma_f32_32x32x16_bf16 v[196:211], v[84:87], a[80:83], v[196:211]
    v_smfmac_f32_16x16x64_bf16 v[76:79], v[92:95], v[80:87], v237
    s_add_u32 s14, s63, 450560
    buffer_load_dwordx4 a[60:63], v253, s[32:35], s14 offen offset:0 sc1
    ds_read_b128 v[224:227], v91 offset:41984
    s_waitcnt lgkmcnt(4)
    v_mul_f32 v188, v28, v229
    v_mul_f32 v189, v29, v229
    v_mul_f32 v190, v30, v229
    v_mul_f32 v191, v31, v229
    v_mfma_f32_32x32x16_bf16 v[164:179], v[180:183], a[84:87], v[164:179]
    v_exp_f32 v28, v188
    v_mul_f32 v188, v188, v60
    v_exp_f32 v29, v189
    s_waitcnt vmcnt(34)
    s_barrier
    v_add_u32 v88, 65536, v88
    v_add_u32 v89, 65536, v89
    v_add_u32 v90, 65536, v90
    v_add_u32 v91, 65536, v91
    ds_read_b128 v[80:83], v88 offset:0
    v_mfma_f32_32x32x16_bf16 v[196:211], v[184:187], a[84:87], v[196:211]
    buffer_load_dwordx4 a[64:67], v253, s[32:35], s14 offen offset:1024 sc1
    ds_read_b128 v[84:87], v88 offset:1024
    s_waitcnt lgkmcnt(4)
    v_mul_f32 v189, v189, v61
    v_exp_f32 v30, v190
    v_mul_f32 v190, v190, v62
    v_mfma_f32_32x32x16_bf16 v[164:179], v[212:215], a[88:91], v[164:179]
    ds_read_b128 v[180:183], v89 offset:0
    v_exp_f32 v31, v191
    v_mul_f32 v191, v191, v63
    v_fma_f32 v28, v28, v230, v230
    v_fma_f32 v29, v29, v230, v230
    v_mfma_f32_32x32x16_bf16 v[196:211], v[216:219], a[88:91], v[196:211]
    buffer_load_dwordx4 a[68:71], v253, s[32:35], s14 offen offset:2048 sc1
    ds_read_b128 v[184:187], v89 offset:1024
    s_waitcnt lgkmcnt(4)
    v_fma_f32 v30, v30, v230, v230
    v_fma_f32 v31, v31, v230, v230
    v_rcp_f32 v28, v28
    v_mfma_f32_32x32x16_bf16 v[164:179], v[220:223], a[92:95], v[164:179]
    ds_read_b128 v[212:215], v90 offset:0
    v_rcp_f32 v29, v29
    v_rcp_f32 v30, v30
    v_mfma_f32_32x32x16_bf16 v[196:211], v[224:227], a[92:95], v[196:211]
    buffer_load_dwordx4 a[72:75], v253, s[32:35], s14 offen offset:3072 sc1
    ds_read_b128 v[216:219], v90 offset:1024
    s_waitcnt lgkmcnt(4)
    v_rcp_f32 v31, v31
    v_mul_f32 v28, v28, v188
    v_mul_f32 v29, v29, v189
    v_mul_f32 v30, v30, v190
    v_mfma_f32_32x32x16_bf16 v[164:179], v[80:83], a[96:99], v[164:179]
    ds_read_b128 v[220:223], v91 offset:0
    v_mul_f32 v31, v31, v191
    v_cvt_pk_bf16_f32 v60, v28, v29
    v_cvt_pk_bf16_f32 v61, v30, v31
    v_mul_f32 v188, v32, v229
    v_mul_f32 v189, v33, v229
    v_mfma_f32_32x32x16_bf16 v[196:211], v[84:87], a[96:99], v[196:211]
    v_smfmac_f32_16x16x64_bf16 v[76:79], v[92:95], v[80:87], v237
    buffer_load_dwordx4 a[76:79], v98, s[32:35], s14 offen offset:0 sc1
    ds_read_b128 v[224:227], v91 offset:1024
    s_waitcnt lgkmcnt(4)
    v_mul_f32 v190, v34, v229
    v_mul_f32 v191, v35, v229
    v_exp_f32 v32, v188
    v_mul_f32 v188, v188, v64
    v_mfma_f32_32x32x16_bf16 v[164:179], v[180:183], a[100:103], v[164:179]
    ds_read_b128 v[80:83], v88 offset:8192
    v_exp_f32 v33, v189
    v_mul_f32 v189, v189, v65
    v_exp_f32 v34, v190
    v_mfma_f32_32x32x16_bf16 v[196:211], v[184:187], a[100:103], v[196:211]
    s_add_u32 s14, s63, 81920
    buffer_load_dwordx4 a[80:83], v253, s[32:35], s14 offen offset:0 sc1
    ds_read_b128 v[84:87], v88 offset:9216
    s_waitcnt lgkmcnt(4)
    v_mul_f32 v190, v190, v66
    v_exp_f32 v35, v191
    v_mul_f32 v191, v191, v67
    v_mfma_f32_32x32x16_bf16 v[164:179], v[212:215], a[104:107], v[164:179]
    ds_read_b128 v[180:183], v89 offset:8192
    v_fma_f32 v32, v32, v230, v230
    v_fma_f32 v33, v33, v230, v230
    v_fma_f32 v34, v34, v230, v230
    v_fma_f32 v35, v35, v230, v230
    v_mfma_f32_32x32x16_bf16 v[196:211], v[216:219], a[104:107], v[196:211]
    buffer_load_dwordx4 a[84:87], v253, s[32:35], s14 offen offset:1024 sc1
    ds_read_b128 v[184:187], v89 offset:9216
    s_waitcnt lgkmcnt(4)
    v_rcp_f32 v32, v32
    v_rcp_f32 v33, v33
    v_mfma_f32_32x32x16_bf16 v[164:179], v[220:223], a[108:111], v[164:179]
    ds_read_b128 v[212:215], v90 offset:8192
    v_rcp_f32 v34, v34
    v_rcp_f32 v35, v35
    v_mul_f32 v32, v32, v188
    v_mfma_f32_32x32x16_bf16 v[196:211], v[224:227], a[108:111], v[196:211]
    buffer_load_dwordx4 a[88:91], v253, s[32:35], s14 offen offset:2048 sc1
    ds_read_b128 v[216:219], v90 offset:9216
    s_waitcnt lgkmcnt(4)
    v_mul_f32 v33, v33, v189
    v_mul_f32 v34, v34, v190
    v_mul_f32 v35, v35, v191
    v_cvt_pk_bf16_f32 v62, v32, v33
    v_cvt_pk_bf16_f32 v63, v34, v35
    v_mfma_f32_32x32x16_bf16 v[164:179], v[80:83], a[112:115], v[164:179]
    ds_read_b128 v[220:223], v91 offset:8192
    v_mul_f32 v188, v36, v229
    v_mul_f32 v189, v37, v229
    v_mul_f32 v190, v38, v229
    v_mul_f32 v191, v39, v229
    v_mfma_f32_32x32x16_bf16 v[196:211], v[84:87], a[112:115], v[196:211]
    v_smfmac_f32_16x16x64_bf16 v[76:79], v[92:95], v[80:87], v237
    buffer_load_dwordx4 a[92:95], v253, s[32:35], s14 offen offset:3072 sc1
    ds_read_b128 v[224:227], v91 offset:9216
    s_waitcnt lgkmcnt(4)
    v_exp_f32 v36, v188
    v_mul_f32 v188, v188, v68
    v_exp_f32 v37, v189
    v_mul_f32 v189, v189, v69
    v_mfma_f32_32x32x16_bf16 v[164:179], v[180:183], a[116:119], v[164:179]
    buffer_load_dwordx4 v[100:103], v1, s[32:35], s67 offen sc1
    s_waitcnt vmcnt(13)
    s_mov_b64 exec, 1
    buffer_store_dword v246, v254, s[32:35], s71 offen offset:0 sc1
    s_mov_b64 exec, -1
    v_exp_f32 v38, v190
    s_barrier
    ds_read_b128 v[80:83], v88 offset:16384
    v_mfma_f32_32x32x16_bf16 v[196:211], v[184:187], a[116:119], v[196:211]
    buffer_load_dwordx4 a[96:99], v98, s[32:35], s14 offen offset:0 sc1
    ds_read_b128 v[84:87], v88 offset:17408
    s_waitcnt lgkmcnt(4)
    v_mul_f32 v190, v190, v70
    v_exp_f32 v39, v191
    v_mul_f32 v191, v191, v71
    v_fma_f32 v36, v36, v230, v230
    v_mfma_f32_32x32x16_bf16 v[164:179], v[212:215], a[120:123], v[164:179]
    ds_read_b128 v[180:183], v89 offset:16384
    v_fma_f32 v37, v37, v230, v230
    v_fma_f32 v38, v38, v230, v230
    v_fma_f32 v39, v39, v230, v230
    v_rcp_f32 v36, v36
    v_mfma_f32_32x32x16_bf16 v[196:211], v[216:219], a[120:123], v[196:211]
    s_add_u32 s48, s67, 4096
    buffer_load_dwordx4 v[104:107], v1, s[32:35], s48 offen sc1
    ds_read_b128 v[184:187], v89 offset:17408
    s_waitcnt lgkmcnt(4)
    v_rcp_f32 v37, v37
    v_rcp_f32 v38, v38
    v_mfma_f32_32x32x16_bf16 v[164:179], v[220:223], a[124:127], v[164:179]
    s_add_u32 s14, s63, 122880
    buffer_load_dwordx4 a[100:103], v253, s[32:35], s14 offen offset:0 sc1
    ds_read_b128 v[212:215], v90 offset:16384
    v_rcp_f32 v39, v39
    v_mul_f32 v36, v36, v188
    v_mul_f32 v37, v37, v189
    v_mfma_f32_32x32x16_bf16 v[196:211], v[224:227], a[124:127], v[196:211]
    buffer_load_dwordx4 a[104:107], v253, s[32:35], s14 offen offset:1024 sc1
    ds_read_b128 v[216:219], v90 offset:17408
    s_waitcnt lgkmcnt(4)
    v_mul_f32 v38, v38, v190
    v_mul_f32 v39, v39, v191
    v_cvt_pk_bf16_f32 v64, v36, v37
    v_cvt_pk_bf16_f32 v65, v38, v39
    v_mul_f32 v188, v40, v229
    v_mfma_f32_32x32x16_bf16 v[164:179], v[80:83], a[128:131], v[164:179]
    ds_read_b128 v[220:223], v91 offset:16384
    v_mul_f32 v189, v41, v229
    v_mul_f32 v190, v42, v229
    v_mul_f32 v191, v43, v229
    v_exp_f32 v40, v188
    v_mfma_f32_32x32x16_bf16 v[196:211], v[84:87], a[128:131], v[196:211]
    v_smfmac_f32_16x16x64_bf16 v[76:79], v[92:95], v[80:87], v237
    buffer_load_dwordx4 v[108:111], v1, s[32:35], s68 offen sc1
    ds_read_b128 v[224:227], v91 offset:17408
    s_waitcnt lgkmcnt(4)
    v_mul_f32 v188, v188, v72
    v_exp_f32 v41, v189
    v_mul_f32 v189, v189, v73
    v_exp_f32 v42, v190
    v_mul_f32 v190, v190, v74
    v_mfma_f32_32x32x16_bf16 v[164:179], v[180:183], a[132:135], v[164:179]
    buffer_load_dwordx4 a[108:111], v253, s[32:35], s14 offen offset:2048 sc1
    ds_read_b128 v[80:83], v88 offset:24576
    v_exp_f32 v43, v191
    v_mul_f32 v191, v191, v75
    v_fma_f32 v40, v40, v230, v230
    v_fma_f32 v41, v41, v230, v230
    v_mfma_f32_32x32x16_bf16 v[196:211], v[184:187], a[132:135], v[196:211]
    buffer_load_dwordx4 a[112:115], v253, s[32:35], s14 offen offset:3072 sc1
    ds_read_b128 v[84:87], v88 offset:25600
    s_waitcnt lgkmcnt(4)
    v_fma_f32 v42, v42, v230, v230
    v_fma_f32 v43, v43, v230, v230
    v_rcp_f32 v40, v40
    v_mfma_f32_32x32x16_bf16 v[164:179], v[212:215], a[136:139], v[164:179]
    ds_read_b128 v[180:183], v89 offset:24576
    v_rcp_f32 v41, v41
    v_rcp_f32 v42, v42
    v_mfma_f32_32x32x16_bf16 v[196:211], v[216:219], a[136:139], v[196:211]
    buffer_load_dwordx4 a[116:119], v98, s[32:35], s14 offen offset:0 sc1
    ds_read_b128 v[184:187], v89 offset:25600
    s_waitcnt lgkmcnt(4)
    v_rcp_f32 v43, v43
    v_mul_f32 v40, v40, v188
    v_mul_f32 v41, v41, v189
    v_mul_f32 v42, v42, v190
    v_mfma_f32_32x32x16_bf16 v[164:179], v[220:223], a[140:143], v[164:179]
    ds_read_b128 v[212:215], v90 offset:24576
    v_mul_f32 v43, v43, v191
    v_cvt_pk_bf16_f32 v66, v40, v41
    v_cvt_pk_bf16_f32 v67, v42, v43
    buffer_store_dwordx4 v[60:63], v99, s[32:35], s12 offen offset:0 sc1
    buffer_store_dwordx4 v[64:67], v99, s[32:35], s12 offen offset:512 sc1
    v_mfma_f32_32x32x16_bf16 v[196:211], v[224:227], a[140:143], v[196:211]
    ds_read_b128 v[216:219], v90 offset:25600
    s_waitcnt lgkmcnt(4)
    v_mfma_f32_32x32x16_bf16 v[164:179], v[80:83], a[144:147], v[164:179]
    ds_read_b128 v[220:223], v91 offset:24576
    v_mfma_f32_32x32x16_bf16 v[196:211], v[84:87], a[144:147], v[196:211]
    v_smfmac_f32_16x16x64_bf16 v[76:79], v[92:95], v[80:87], v237
    ds_read_b128 v[224:227], v91 offset:25600
    s_waitcnt lgkmcnt(4)
    v_mfma_f32_32x32x16_bf16 v[164:179], v[180:183], a[148:151], v[164:179]
    v_mfma_f32_32x32x16_bf16 v[196:211], v[184:187], a[148:151], v[196:211]
    s_nop 3
    v_add_f32 v76, v76, v77
    v_add_f32 v78, v78, v79
    s_mov_b64 exec, 0xffffffff
    ds_write2st64_b32 v250, v76, v78 offset0:8 offset1:9
    s_mov_b64 exec, -1
    s_waitcnt lgkmcnt(3)
    v_mfma_f32_32x32x16_bf16 v[164:179], v[212:215], a[152:155], v[164:179]
    v_mfma_f32_32x32x16_bf16 v[196:211], v[216:219], a[152:155], v[196:211]
    s_waitcnt lgkmcnt(1)
    v_mfma_f32_32x32x16_bf16 v[164:179], v[220:223], a[156:159], v[164:179]
    s_waitcnt lgkmcnt(0)
    s_barrier
    ds_read_b128 v[116:119], v249 offset:61440
    ds_read_b128 v[120:123], v249 offset:61952
    v_mfma_f32_32x32x16_bf16 v[196:211], v[224:227], a[156:159], v[196:211]
    v_min_u32 v233, 23, v255
    v_lshlrev_b32 v233, 2, v233
    s_waitcnt lgkmcnt(1)
    v_add_f32 v116, v116, v117
    v_add_f32 v118, v118, v119
    v_add_f32 v116, v116, v118
    v_and_b32 v119, 0xffff0000, v116
    v_sub_f32 v116, v116, v119
    v_and_b32 v118, 0xffff0000, v116
    s_add_u32 s14, s63, 327680
    buffer_load_dwordx4 a[120:123], v253, s[32:35], s14 offen offset:0 sc1
    v_sub_f32 v116, v116, v118
    v_lshrrev_b32 v117, 16, v116
    v_perm_b32 v116, v118, v119, s3
    s_nop 1
    v_mfma_f32_32x32x16_bf16 v[164:179], v[116:119], v[160:163], v[164:179]
    s_waitcnt lgkmcnt(0)
    v_add_f32 v120, v120, v121
    v_add_f32 v122, v122, v123
    v_add_f32 v120, v120, v122
    v_and_b32 v123, 0xffff0000, v120
    v_sub_f32 v120, v120, v123
    v_and_b32 v122, 0xffff0000, v120
    v_sub_f32 v120, v120, v122
    v_lshrrev_b32 v121, 16, v120
    v_perm_b32 v120, v122, v123, s3
    s_nop 1
    v_mfma_f32_32x32x16_bf16 v[196:211], v[120:123], v[160:163], v[196:211]
    s_waitcnt vmcnt(12)
    v_xor_b32 v97, s42, v103
    s_waitcnt vmcnt(9)
    v_bitop3_b32 v97, v97, v107, v246 bitop3:0xf6
    s_waitcnt vmcnt(6)
    v_bitop3_b32 v97, v97, v111, v246 bitop3:0xf6
    v_cmp_ne_u32 vcc, 0, v97
    s_nop 0
    s_and_b64 vcc, vcc, s[0:1]
    s_cbranch_vccnz L_vps_10
L_vpb_11:
    v_add_u32 v97, 26624, v1
    ds_write_b128 v97, v[100:103] offset:0
    ds_write_b128 v97, v[104:107] offset:4096
    ds_write_b128 v97, v[108:111] offset:8192
    v_mul_f32 v188, v164, v229
    v_mul_f32 v189, v165, v229
    buffer_load_dwordx4 a[124:127], v253, s[32:35], s14 offen offset:1024 sc1
    v_mul_f32 v190, v166, v229
    v_mul_f32 v191, v167, v229
    v_exp_f32 v164, v188
    v_mul_f32 v188, v188, v196
    v_exp_f32 v165, v189
    v_mul_f32 v189, v189, v197
    v_exp_f32 v166, v190
    v_mul_f32 v190, v190, v198
    v_exp_f32 v167, v191
    v_mul_f32 v191, v191, v199
    v_fma_f32 v164, v164, v230, v230
    v_fma_f32 v165, v165, v230, v230
    v_fma_f32 v166, v166, v230, v230
    v_fma_f32 v167, v167, v230, v230
    v_rcp_f32 v164, v164
    v_rcp_f32 v165, v165
    v_rcp_f32 v166, v166
    v_rcp_f32 v167, v167
    v_mul_f32 v164, v164, v188
    v_mul_f32 v165, v165, v189
    v_mul_f32 v166, v166, v190
    v_mul_f32 v167, v167, v191
    v_cvt_pk_bf16_f32 v196, v164, v165
    v_cvt_pk_bf16_f32 v197, v166, v167
    v_mul_f32 v188, v168, v229
    v_mul_f32 v189, v169, v229
    buffer_load_dwordx4 a[128:131], v253, s[32:35], s14 offen offset:2048 sc1
    v_mul_f32 v190, v170, v229
    v_mul_f32 v191, v171, v229
    v_exp_f32 v168, v188
    v_mul_f32 v188, v188, v200
    v_exp_f32 v169, v189
    v_mul_f32 v189, v189, v201
    v_exp_f32 v170, v190
    v_mul_f32 v190, v190, v202
    v_exp_f32 v171, v191
    v_mul_f32 v191, v191, v203
    v_fma_f32 v168, v168, v230, v230
    v_fma_f32 v169, v169, v230, v230
    v_fma_f32 v170, v170, v230, v230
    v_fma_f32 v171, v171, v230, v230
    v_rcp_f32 v168, v168
    v_rcp_f32 v169, v169
    v_rcp_f32 v170, v170
    v_rcp_f32 v171, v171
    v_mul_f32 v168, v168, v188
    v_mul_f32 v169, v169, v189
    v_mul_f32 v170, v170, v190
    v_mul_f32 v171, v171, v191
    v_cvt_pk_bf16_f32 v198, v168, v169
    v_cvt_pk_bf16_f32 v199, v170, v171
    v_mul_f32 v188, v172, v229
    v_mul_f32 v189, v173, v229
    buffer_load_dwordx4 a[132:135], v253, s[32:35], s14 offen offset:3072 sc1
    v_mul_f32 v190, v174, v229
    v_mul_f32 v191, v175, v229
    v_exp_f32 v172, v188
    v_mul_f32 v188, v188, v204
    v_exp_f32 v173, v189
    v_mul_f32 v189, v189, v205
    v_exp_f32 v174, v190
    v_mul_f32 v190, v190, v206
    v_exp_f32 v175, v191
    v_mul_f32 v191, v191, v207
    v_fma_f32 v172, v172, v230, v230
    v_fma_f32 v173, v173, v230, v230
    v_fma_f32 v174, v174, v230, v230
    v_fma_f32 v175, v175, v230, v230
    v_rcp_f32 v172, v172
    v_rcp_f32 v173, v173
    v_rcp_f32 v174, v174
    v_rcp_f32 v175, v175
    v_mul_f32 v172, v172, v188
    v_mul_f32 v173, v173, v189
    v_mul_f32 v174, v174, v190
    v_mul_f32 v175, v175, v191
    v_cvt_pk_bf16_f32 v200, v172, v173
    v_cvt_pk_bf16_f32 v201, v174, v175
    v_mul_f32 v188, v176, v229
    v_mul_f32 v189, v177, v229
    buffer_load_dwordx4 a[136:139], v98, s[32:35], s14 offen offset:0 sc1
    v_mul_f32 v190, v178, v229
    v_mul_f32 v191, v179, v229
    v_exp_f32 v176, v188
    v_mul_f32 v188, v188, v208
    v_exp_f32 v177, v189
    v_mul_f32 v189, v189, v209
    v_exp_f32 v178, v190
    v_mul_f32 v190, v190, v210
    v_exp_f32 v179, v191
    v_mul_f32 v191, v191, v211
    v_fma_f32 v176, v176, v230, v230
    v_fma_f32 v177, v177, v230, v230
    v_fma_f32 v178, v178, v230, v230
    v_fma_f32 v179, v179, v230, v230
    v_rcp_f32 v176, v176
    v_rcp_f32 v177, v177
    v_rcp_f32 v178, v178
    v_rcp_f32 v179, v179
    v_mul_f32 v176, v176, v188
    v_mul_f32 v177, v177, v189
    v_mul_f32 v178, v178, v190
    v_mul_f32 v179, v179, v191
    v_cvt_pk_bf16_f32 v202, v176, v177
    v_cvt_pk_bf16_f32 v203, v178, v179
    s_waitcnt vmcnt(5)
    s_mov_b64 exec, 1
    buffer_store_dword v246, v254, s[32:35], s71 offen offset:8 sc1
    s_mov_b64 exec, -1
    buffer_store_dwordx4 v[196:199], v99, s[32:35], s70 offen offset:0 sc1
    s_add_u32 s14, s63, 368640
    buffer_load_dwordx4 a[140:143], v253, s[32:35], s14 offen offset:0 sc1
    buffer_store_dwordx4 v[200:203], v99, s[32:35], s70 offen offset:512 sc1
    v_lshrrev_b32 v237, 5, v255
    v_mul_u32_u24 v244, 5632, v237
    v_add_u32 v244, 26624, v244
    v_add_u32 v230, v234, v244
    v_add_u32 v231, v235, v244
    v_add_u32 v232, v236, v244
    s_waitcnt lgkmcnt(0)
    s_barrier
    ds_read_b32 v12, v230 offset:0
    ds_read_b32 v13, v230 offset:1408
    ds_read_b32 v14, v230 offset:2816
    ds_read_b32 v15, v230 offset:4224
    ds_read_b32 v16, v231 offset:0
    ds_read_b32 v17, v231 offset:1408
    ds_read_b32 v18, v231 offset:2816
    ds_read_b32 v19, v231 offset:4224
    ds_read_b32 v20, v232 offset:0
    ds_read_b32 v21, v232 offset:1408
    ds_read_b32 v22, v232 offset:2816
    ds_read_b32 v23, v232 offset:4224
    v_mul_u32_u24 v237, 3072, v237
    v_add_u32 v237, 53248, v237
    v_lshl_add_u32 v226, v238, 2, v237
    v_sub_u32 v244, 640, v238
    v_cmp_eq_u32 vcc, 0, v238
    v_mov_b32 v242, 700
    v_lshlrev_b32 v245, 2, v255
    buffer_load_dwordx4 a[144:147], v253, s[32:35], s14 offen offset:1024 sc1
    v_cndmask_b32 v244, v244, v242, vcc
    v_cndmask_b32_e64 v242, 1.0, 0.5, vcc
    v_cndmask_b32_e64 v220, 0, 0.5, vcc
    v_lshl_add_u32 v222, v244, 2, v237
    s_waitcnt lgkmcnt(8)
    v_mfma_f32_32x32x16_bf16 v[28:43], v[192:195], v[12:15], 0
    v_lshl_add_u32 v227, v239, 2, v237
    v_sub_u32 v244, 640, v239
    v_lshl_add_u32 v223, v244, 2, v237
    s_waitcnt lgkmcnt(4)
    v_mfma_f32_32x32x16_bf16 v[44:59], v[192:195], v[16:19], 0
    v_lshl_add_u32 v228, v240, 2, v237
    v_sub_u32 v244, 640, v240
    v_cmp_eq_u32 vcc, 320, v240
    v_mov_b32 v243, 700
    v_lshlrev_b32 v245, 2, v255
    v_cndmask_b32 v244, v244, v243, vcc
    v_cndmask_b32_e64 v243, 1.0, 0.5, vcc
    v_cndmask_b32_e64 v221, 0, 0.5, vcc
    v_lshl_add_u32 v224, v244, 2, v237
    s_waitcnt lgkmcnt(0)
    v_mfma_f32_32x32x16_bf16 v[60:75], v[192:195], v[20:23], 0
    ds_read_b128 v[196:199], v253 offset:14336
    ds_read_b128 v[208:211], v253 offset:17408
    ds_read_b128 v[200:203], v253 offset:15360
    ds_read_b128 v[212:215], v253 offset:18432
    ds_read_b128 v[204:207], v253 offset:16384
    ds_read_b128 v[216:219], v253 offset:19456
    s_add_u32 s49, s40, 1
    s_and_b32 s49, s49, 3
    v_lshl_add_u32 v76, s49, 10, v253
    buffer_load_dwordx4 a[148:151], v253, s[32:35], s14 offen offset:2048 sc1
    s_add_u32 s49, s40, 2
    s_and_b32 s49, s49, 3
    v_lshl_add_u32 v77, s49, 10, v253
    s_add_u32 s49, s40, 3
    s_and_b32 s49, s49, 3
    v_lshl_add_u32 v78, s49, 10, v253
    s_add_u32 s49, s40, 4
    s_and_b32 s49, s49, 3
    v_lshl_add_u32 v79, s49, 10, v253
    s_mul_i32 s49, s40, 3072
    s_add_u32 s49, s49, 55296
    v_add_u32 v230, 53248, v241
    v_add_u32 v231, 1024, v230
    v_and_b32 v244, 127, v245
    v_add_u32 v232, s49, v244
    v_mul_f32 v28, v28, v242
    v_fmac_f32 v28, v30, v220
    v_mul_f32 v29, v29, v242
    v_fmac_f32 v29, v31, v220
    v_mul_f32 v32, v32, v242
    v_fmac_f32 v32, v34, v220
    v_mul_f32 v33, v33, v242
    v_fmac_f32 v33, v35, v220
    v_cvt_pk_bf16_f32 v37, v30, v31
    v_cvt_pk_bf16_f32 v36, v28, v29
    ds_write_b32 v222, v37 offset:0
    buffer_load_dwordx4 a[152:155], v253, s[32:35], s14 offen offset:3072 sc1
    ds_write_b32 v226, v36 offset:0
    v_cvt_pk_bf16_f32 v39, v34, v35
    v_cvt_pk_bf16_f32 v38, v32, v33
    ds_write_b32 v222, v39 offset:6144
    ds_write_b32 v226, v38 offset:6144
    v_cvt_pk_bf16_f32 v53, v46, v47
    v_cvt_pk_bf16_f32 v52, v44, v45
    ds_write_b32 v223, v53 offset:0
    ds_write_b32 v227, v52 offset:0
    v_cvt_pk_bf16_f32 v55, v50, v51
    v_cvt_pk_bf16_f32 v54, v48, v49
    ds_write_b32 v223, v55 offset:6144
    ds_write_b32 v227, v54 offset:6144
    v_mul_f32 v60, v60, v243
    v_fmac_f32 v60, v62, v221
    v_mul_f32 v61, v61, v243
    v_fmac_f32 v61, v63, v221
    v_mul_f32 v64, v64, v243
    v_fmac_f32 v64, v66, v221
    v_mul_f32 v65, v65, v243
    v_fmac_f32 v65, v67, v221
    v_cvt_pk_bf16_f32 v69, v62, v63
    v_cvt_pk_bf16_f32 v68, v60, v61
    ds_write_b32 v224, v69 offset:0
    ds_write_b32 v228, v68 offset:0
    v_cvt_pk_bf16_f32 v71, v66, v67
    buffer_load_dwordx4 a[156:159], v98, s[32:35], s14 offen offset:0 sc1
    v_cvt_pk_bf16_f32 v70, v64, v65
    ds_write_b32 v224, v71 offset:6144
    ds_write_b32 v228, v70 offset:6144
    s_waitcnt lgkmcnt(0)
    s_barrier
    ds_read2_b32 v[12:13], v230 offset0:0 offset1:32
    ds_read2_b32 v[14:15], v230 offset0:64 offset1:96
    ds_read2_b32 v[16:17], v231 offset0:0 offset1:32
    ds_read2_b32 v[18:19], v231 offset0:64 offset1:96
    ds_read2_b32 v[20:21], v232 offset0:0 offset1:32
    ds_read2_b32 v[22:23], v232 offset0:64 offset1:96
    ds_read_b128 v[60:63], v253 offset:6144
    ds_read_b128 v[80:83], v253 offset:10240
    ds_read_b128 v[64:67], v253 offset:7168
    ds_read_b128 v[84:87], v253 offset:11264
    ds_read_b128 v[68:71], v253 offset:8192
    ds_read_b128 v[88:91], v253 offset:12288
    ds_read_b128 v[72:75], v253 offset:9216
    ds_read_b128 v[92:95], v253 offset:13312
    v_and_b32 v244, 31, v255
    v_mul_u32_u24 v244, 40, v244
    v_lshrrev_b32 v237, 5, v255
    v_lshl_add_u32 v244, v237, 3, v244
    s_mul_i32 s49, s40, 2560
    v_add_u32 v97, s49, v244
    s_waitcnt lgkmcnt(12)
    v_mfma_f32_32x32x16_bf16 v[28:43], v[12:15], v[196:199], 0
    v_mfma_f32_32x32x16_bf16 v[44:59], v[12:15], v[208:211], 0
    s_waitcnt lgkmcnt(10)
    v_mfma_f32_32x32x16_bf16 v[28:43], v[16:19], v[200:203], v[28:43]
    v_mfma_f32_32x32x16_bf16 v[44:59], v[16:19], v[212:215], v[44:59]
    s_waitcnt lgkmcnt(8)
    v_mfma_f32_32x32x16_bf16 v[28:43], v[20:23], v[204:207], v[28:43]
    v_mfma_f32_32x32x16_bf16 v[44:59], v[20:23], v[216:219], v[44:59]
    ds_read_b128 v[196:199], v253 offset:0
    ds_read_b128 v[200:203], v253 offset:2048
    ds_read_b128 v[204:207], v253 offset:4096
    ds_read_b128 v[208:211], v253 offset:1024
    ds_read_b128 v[212:215], v253 offset:3072
    ds_read_b128 v[216:219], v253 offset:5120
    buffer_load_dword v96, v233, s[32:35], s72 offen sc1
    s_waitcnt vmcnt(5)
    s_mov_b64 exec, 1
    buffer_store_dword v246, v254, s[32:35], s71 offen offset:16 sc1
    s_mov_b64 exec, -1
    s_waitcnt lgkmcnt(12)
    v_pk_mul_f32 v[244:245], v[28:29], v[80:81]
    v_pk_mul_f32 v[28:29], v[28:29], v[60:61]
    v_pk_fma_f32 v[28:29], v[44:45], v[80:81], v[28:29] neg_lo:[1,0,0] neg_hi:[1,0,0]
    v_pk_fma_f32 v[44:45], v[44:45], v[60:61], v[244:245]
    v_pk_mul_f32 v[244:245], v[30:31], v[82:83]
    v_pk_mul_f32 v[30:31], v[30:31], v[62:63]
    v_pk_fma_f32 v[30:31], v[46:47], v[82:83], v[30:31] neg_lo:[1,0,0] neg_hi:[1,0,0]
    v_pk_fma_f32 v[46:47], v[46:47], v[62:63], v[244:245]
    s_waitcnt lgkmcnt(10)
    v_pk_mul_f32 v[244:245], v[32:33], v[84:85]
    v_pk_mul_f32 v[32:33], v[32:33], v[64:65]
    v_pk_fma_f32 v[32:33], v[48:49], v[84:85], v[32:33] neg_lo:[1,0,0] neg_hi:[1,0,0]
    v_pk_fma_f32 v[48:49], v[48:49], v[64:65], v[244:245]
    v_pk_mul_f32 v[244:245], v[34:35], v[86:87]
    v_pk_mul_f32 v[34:35], v[34:35], v[66:67]
    v_pk_fma_f32 v[34:35], v[50:51], v[86:87], v[34:35] neg_lo:[1,0,0] neg_hi:[1,0,0]
    v_pk_fma_f32 v[50:51], v[50:51], v[66:67], v[244:245]
    s_waitcnt lgkmcnt(8)
    v_pk_mul_f32 v[244:245], v[36:37], v[88:89]
    v_pk_mul_f32 v[36:37], v[36:37], v[68:69]
    v_pk_fma_f32 v[36:37], v[52:53], v[88:89], v[36:37] neg_lo:[1,0,0] neg_hi:[1,0,0]
    v_pk_fma_f32 v[52:53], v[52:53], v[68:69], v[244:245]
    v_pk_mul_f32 v[244:245], v[38:39], v[90:91]
    v_pk_mul_f32 v[38:39], v[38:39], v[70:71]
    v_pk_fma_f32 v[38:39], v[54:55], v[90:91], v[38:39] neg_lo:[1,0,0] neg_hi:[1,0,0]
    v_pk_fma_f32 v[54:55], v[54:55], v[70:71], v[244:245]
    s_waitcnt lgkmcnt(6)
    v_pk_mul_f32 v[244:245], v[40:41], v[92:93]
    v_pk_mul_f32 v[40:41], v[40:41], v[72:73]
    v_pk_fma_f32 v[40:41], v[56:57], v[92:93], v[40:41] neg_lo:[1,0,0] neg_hi:[1,0,0]
    v_pk_fma_f32 v[56:57], v[56:57], v[72:73], v[244:245]
    v_pk_mul_f32 v[244:245], v[42:43], v[94:95]
    v_pk_mul_f32 v[42:43], v[42:43], v[74:75]
    v_pk_fma_f32 v[42:43], v[58:59], v[94:95], v[42:43] neg_lo:[1,0,0] neg_hi:[1,0,0]
    v_pk_fma_f32 v[58:59], v[58:59], v[74:75], v[244:245]
    v_cvt_pk_bf16_f32 v12, v28, v29
    v_cvt_pk_bf16_f32 v20, v44, v45
    v_cvt_pk_bf16_f32 v13, v30, v31
    v_cvt_pk_bf16_f32 v21, v46, v47
    v_cvt_pk_bf16_f32 v14, v32, v33
    v_cvt_pk_bf16_f32 v22, v48, v49
    v_cvt_pk_bf16_f32 v15, v34, v35
    v_cvt_pk_bf16_f32 v23, v50, v51
    s_waitcnt lgkmcnt(5)
    v_mfma_f32_32x32x16_bf16 v[60:75], v[12:15], v[196:199], 0
    v_cvt_pk_bf16_f32 v16, v36, v37
    v_cvt_pk_bf16_f32 v24, v52, v53
    v_cvt_pk_bf16_f32 v17, v38, v39
    v_cvt_pk_bf16_f32 v25, v54, v55
    s_waitcnt lgkmcnt(4)
    v_mfma_f32_32x32x16_bf16 v[80:95], v[12:15], v[200:203], 0
    v_cvt_pk_bf16_f32 v18, v40, v41
    v_cvt_pk_bf16_f32 v26, v56, v57
    v_cvt_pk_bf16_f32 v19, v42, v43
    v_cvt_pk_bf16_f32 v27, v58, v59
    s_waitcnt lgkmcnt(3)
    v_mfma_f32_32x32x16_bf16 v[60:75], v[20:23], v[204:207], v[60:75]
    v_mfma_f32_32x32x16_bf16 v[80:95], v[20:23], v[196:199], v[80:95]
    v_lshlrev_b32 v28, 16, v2
    v_and_b32 v29, 0xffff0000, v2
    v_lshlrev_b32 v30, 16, v3
    v_and_b32 v31, 0xffff0000, v3
    s_waitcnt lgkmcnt(2)
    v_mfma_f32_32x32x16_bf16 v[60:75], v[16:19], v[208:211], v[60:75]
    v_lshlrev_b32 v32, 16, v4
    v_and_b32 v33, 0xffff0000, v4
    v_lshlrev_b32 v34, 16, v5
    v_and_b32 v35, 0xffff0000, v5
    s_waitcnt lgkmcnt(1)
    v_mfma_f32_32x32x16_bf16 v[80:95], v[16:19], v[212:215], v[80:95]
    v_lshlrev_b32 v36, 16, v6
    v_and_b32 v37, 0xffff0000, v6
    v_lshlrev_b32 v38, 16, v7
    v_and_b32 v39, 0xffff0000, v7
    s_waitcnt lgkmcnt(0)
    v_mfma_f32_32x32x16_bf16 v[60:75], v[24:27], v[216:219], v[60:75]
    v_lshlrev_b32 v40, 16, v8
    v_and_b32 v41, 0xffff0000, v8
    v_lshlrev_b32 v42, 16, v9
    v_and_b32 v43, 0xffff0000, v9
    v_mfma_f32_32x32x16_bf16 v[80:95], v[24:27], v[208:211], v[80:95]
    v_lshlrev_b32 v44, 16, v10
    v_and_b32 v45, 0xffff0000, v10
    v_lshlrev_b32 v46, 16, v11
    v_and_b32 v47, 0xffff0000, v11
    s_nop 2
    v_cvt_pk_bf16_f32 v12, v60, v61
    v_cvt_pk_bf16_f32 v13, v62, v63
    ds_write_b64 v97, v[12:13] offset:43008
    v_cvt_pk_bf16_f32 v14, v64, v65
    v_cvt_pk_bf16_f32 v15, v66, v67
    ds_write_b64 v97, v[14:15] offset:43024
    v_cvt_pk_bf16_f32 v16, v68, v69
    v_cvt_pk_bf16_f32 v17, v70, v71
    v_cvt_pk_bf16_f32 v18, v80, v81
    v_cvt_pk_bf16_f32 v19, v82, v83
    ds_write_b64 v97, v[18:19] offset:44288
    v_cvt_pk_bf16_f32 v20, v84, v85
    v_cvt_pk_bf16_f32 v21, v86, v87
    ds_write_b64 v97, v[20:21] offset:44304
    v_cvt_pk_bf16_f32 v22, v88, v89
    v_cvt_pk_bf16_f32 v23, v90, v91
    s_mov_b64 exec, 0xffffffff
    ds_write_b64 v97, v[16:17] offset:43040
    ds_write_b64 v97, v[22:23] offset:44320
    s_mov_b64 exec, -1
    ds_read_b64 v[12:13], v247 offset:43008
    ds_read_b64 v[14:15], v247 offset:43264
    ds_read_b64 v[16:17], v247 offset:43520
    ds_read_b64 v[18:19], v247 offset:43776
    ds_read_b64 v[20:21], v247 offset:44032
    s_waitcnt vmcnt(1)
    v_cmp_ne_u32 vcc, s42, v96
    s_nop 0
    s_and_b64 vcc, vcc, 0xc30c3
    s_cbranch_vccnz L_hfs_13
L_hfb_14:
    s_add_u32 s12, s73, 0
    buffer_load_dwordx4 v[240:243], v76, s[32:35], s12 offen sc1
    buffer_load_dwordx4 v[60:63], v77, s[32:35], s12 offen sc1
    buffer_load_dwordx4 v[64:67], v78, s[32:35], s12 offen sc1
    buffer_load_dwordx4 v[68:71], v79, s[32:35], s12 offen sc1
    s_add_u32 s13, s73, 16384
    buffer_load_dwordx4 v[72:75], v76, s[32:35], s13 offen sc1
    buffer_load_dwordx4 v[80:83], v77, s[32:35], s13 offen sc1
    buffer_load_dwordx4 v[84:87], v78, s[32:35], s13 offen sc1
    buffer_load_dwordx4 v[88:91], v79, s[32:35], s13 offen sc1
    buffer_load_dword v96, v233, s[32:35], s72 offen sc1
    s_add_u32 s49, s44, 20971520
    s_waitcnt lgkmcnt(4)
    v_lshlrev_b32 v244, 16, v12
    v_and_b32 v245, 0xffff0000, v12
    v_pk_add_f32 v[244:245], v[244:245], v[28:29]
    v_cvt_pk_bf16_f32 v12, v244, v245
    v_lshlrev_b32 v244, 16, v13
    v_and_b32 v245, 0xffff0000, v13
    v_pk_add_f32 v[244:245], v[244:245], v[30:31]
    v_cvt_pk_bf16_f32 v13, v244, v245
    buffer_store_dwordx2 v[12:13], v252, s[32:35], s49 offen offset:0 sc1
    s_waitcnt lgkmcnt(3)
    v_lshlrev_b32 v244, 16, v14
    v_and_b32 v245, 0xffff0000, v14
    v_pk_add_f32 v[244:245], v[244:245], v[32:33]
    v_cvt_pk_bf16_f32 v14, v244, v245
    v_lshlrev_b32 v244, 16, v15
    v_and_b32 v245, 0xffff0000, v15
    v_pk_add_f32 v[244:245], v[244:245], v[34:35]
    v_cvt_pk_bf16_f32 v15, v244, v245
    buffer_store_dwordx2 v[14:15], v252, s[32:35], s49 offen offset:256 sc1
    s_waitcnt lgkmcnt(2)
    v_lshlrev_b32 v244, 16, v16
    v_and_b32 v245, 0xffff0000, v16
    v_pk_add_f32 v[244:245], v[244:245], v[36:37]
    v_cvt_pk_bf16_f32 v16, v244, v245
    v_lshlrev_b32 v244, 16, v17
    v_and_b32 v245, 0xffff0000, v17
    v_pk_add_f32 v[244:245], v[244:245], v[38:39]
    v_cvt_pk_bf16_f32 v17, v244, v245
    buffer_store_dwordx2 v[16:17], v252, s[32:35], s49 offen offset:512 sc1
    s_waitcnt lgkmcnt(1)
    v_lshlrev_b32 v244, 16, v18
    v_and_b32 v245, 0xffff0000, v18
    v_pk_add_f32 v[244:245], v[244:245], v[40:41]
    v_cvt_pk_bf16_f32 v18, v244, v245
    v_lshlrev_b32 v244, 16, v19
    v_and_b32 v245, 0xffff0000, v19
    v_pk_add_f32 v[244:245], v[244:245], v[42:43]
    v_cvt_pk_bf16_f32 v19, v244, v245
    buffer_store_dwordx2 v[18:19], v252, s[32:35], s49 offen offset:768 sc1
    s_waitcnt lgkmcnt(0)
    v_lshlrev_b32 v244, 16, v20
    v_and_b32 v245, 0xffff0000, v20
    v_pk_add_f32 v[244:245], v[244:245], v[44:45]
    v_cvt_pk_bf16_f32 v20, v244, v245
    v_lshlrev_b32 v244, 16, v21
    v_and_b32 v245, 0xffff0000, v21
    v_pk_add_f32 v[244:245], v[244:245], v[46:47]
    v_cvt_pk_bf16_f32 v21, v244, v245
    buffer_store_dwordx2 v[20:21], v252, s[32:35], s49 offen offset:1024 sc1
    s_add_u32 s14, s73, 24576
    buffer_load_dwordx4 v[92:95], v76, s[32:35], s14 offen sc1
    buffer_load_dwordx4 v[100:103], v77, s[32:35], s14 offen sc1
    buffer_load_dwordx4 v[104:107], v78, s[32:35], s14 offen sc1
    buffer_load_dwordx4 v[108:111], v79, s[32:35], s14 offen sc1
    s_waitcnt vmcnt(17)
    v_mfma_f32_16x16x32_bf16 v[16:19], a[160:163], v[240:243], 0
    s_add_u32 s15, s73, 40960
    buffer_load_dwordx4 v[112:115], v76, s[32:35], s15 offen sc1
    v_mfma_f32_16x16x32_bf16 v[20:23], a[164:167], v[240:243], 0
    v_mfma_f32_16x16x32_bf16 v[24:27], a[168:171], v[240:243], 0
    v_mfma_f32_16x16x32_bf16 v[28:31], a[172:175], v[240:243], 0
    v_mfma_f32_16x16x32_bf16 v[32:35], a[176:179], v[240:243], 0
    s_mov_b32 s17, 65536
    s_waitcnt vmcnt(17)
    v_mfma_f32_16x16x32_bf16 v[36:39], a[160:163], v[60:63], 0
    buffer_load_dwordx4 v[116:119], v77, s[32:35], s15 offen sc1
    v_mfma_f32_16x16x32_bf16 v[40:43], a[164:167], v[60:63], 0
    v_mov_b32 v252, 176
    v_mfma_f32_16x16x32_bf16 v[44:47], a[168:171], v[60:63], 0
    v_mfma_f32_16x16x32_bf16 v[48:51], a[172:175], v[60:63], 0
    v_add_u32 v56, 0, v255
    v_mfma_f32_16x16x32_bf16 v[52:55], a[176:179], v[60:63], 0
    s_waitcnt vmcnt(17)
    v_mfma_f32_16x16x32_bf16 v[128:131], a[160:163], v[64:67], 0
    buffer_load_dwordx4 v[120:123], v78, s[32:35], s15 offen sc1
    v_min_u32 v57, 159, v56
    v_mfma_f32_16x16x32_bf16 v[132:135], a[164:167], v[64:67], 0
    v_mfma_f32_16x16x32_bf16 v[136:139], a[168:171], v[64:67], 0
    v_mfma_f32_16x16x32_bf16 v[140:143], a[172:175], v[64:67], 0
    v_mul_u32_u24 v58, 6554, v57
    v_mfma_f32_16x16x32_bf16 v[144:147], a[176:179], v[64:67], 0
    s_waitcnt vmcnt(17)
    v_mfma_f32_16x16x32_bf16 v[148:151], a[160:163], v[68:71], 0
    buffer_load_dwordx4 v[124:127], v79, s[32:35], s15 offen sc1
    v_lshrrev_b32 v58, 16, v58
    v_mfma_f32_16x16x32_bf16 v[152:155], a[164:167], v[68:71], 0
    v_mfma_f32_16x16x32_bf16 v[156:159], a[168:171], v[68:71], 0
    v_mul_u32_u24 v59, 10, v58
    v_mfma_f32_16x16x32_bf16 v[160:163], a[172:175], v[68:71], 0
    v_mfma_f32_16x16x32_bf16 v[164:167], a[176:179], v[68:71], 0
    v_sub_u32 v59, v57, v59
    s_waitcnt vmcnt(17)
    v_mfma_f32_16x16x32_bf16 v[16:19], a[180:183], v[72:75], v[16:19]
    s_waitcnt vmcnt(13)
    v_cmp_ne_u32 vcc, s42, v96
    s_nop 0
    s_and_b64 vcc, vcc, 0x3cf3cf
    s_cbranch_vccnz L_hf1s_16
L_hf1b_17:
    v_mfma_f32_16x16x32_bf16 v[20:23], a[184:187], v[72:75], v[20:23]
    s_add_u32 s12, s73, 4096
    buffer_load_dwordx4 v[236:239], v76, s[32:35], s12 offen sc1
    v_mfma_f32_16x16x32_bf16 v[24:27], a[188:191], v[72:75], v[24:27]
    v_lshlrev_b32 v59, 4, v59
    v_mfma_f32_16x16x32_bf16 v[28:31], a[192:195], v[72:75], v[28:31]
    v_mfma_f32_16x16x32_bf16 v[32:35], a[196:199], v[72:75], v[32:35]
    v_mad_u32_u24 v230, v58, v252, v59
    v_mfma_f32_16x16x32_bf16 v[36:39], a[180:183], v[80:83], v[36:39]
    buffer_load_dwordx4 v[4:7], v77, s[32:35], s12 offen sc1
    v_mfma_f32_16x16x32_bf16 v[40:43], a[184:187], v[80:83], v[40:43]
    v_lshl_add_u32 v230, s40, 12, v230
    v_mfma_f32_16x16x32_bf16 v[44:47], a[188:191], v[80:83], v[44:47]
    v_mfma_f32_16x16x32_bf16 v[48:51], a[192:195], v[80:83], v[48:51]
    v_mul_u32_u24 v226, 1280, v58
    v_mfma_f32_16x16x32_bf16 v[52:55], a[196:199], v[80:83], v[52:55]
    v_mfma_f32_16x16x32_bf16 v[128:131], a[180:183], v[84:87], v[128:131]
    buffer_load_dwordx4 v[8:11], v78, s[32:35], s12 offen sc1
    v_mfma_f32_16x16x32_bf16 v[132:135], a[184:187], v[84:87], v[132:135]
    v_add_u32 v226, v226, v59
    v_mfma_f32_16x16x32_bf16 v[136:139], a[188:191], v[84:87], v[136:139]
    v_mfma_f32_16x16x32_bf16 v[140:143], a[192:195], v[84:87], v[140:143]
    v_add_u32 v56, 64, v255
    v_mfma_f32_16x16x32_bf16 v[144:147], a[196:199], v[84:87], v[144:147]
    v_mfma_f32_16x16x32_bf16 v[148:151], a[180:183], v[88:91], v[148:151]
    buffer_load_dwordx4 v[12:15], v79, s[32:35], s12 offen sc1
    v_min_u32 v57, 159, v56
    v_mfma_f32_16x16x32_bf16 v[152:155], a[184:187], v[88:91], v[152:155]
    v_mfma_f32_16x16x32_bf16 v[156:159], a[188:191], v[88:91], v[156:159]
    v_mfma_f32_16x16x32_bf16 v[160:163], a[192:195], v[88:91], v[160:163]
    v_mul_u32_u24 v58, 6554, v57
    v_mfma_f32_16x16x32_bf16 v[164:167], a[196:199], v[88:91], v[164:167]
    s_waitcnt vmcnt(11)
    v_mfma_f32_16x16x32_bf16 v[16:19], a[200:203], v[92:95], v[16:19]
    buffer_load_dword v96, v233, s[32:35], s72 offen sc1
    v_lshrrev_b32 v58, 16, v58
    v_mfma_f32_16x16x32_bf16 v[20:23], a[204:207], v[92:95], v[20:23]
    s_add_u32 s13, s73, 20480
    buffer_load_dwordx4 v[240:243], v76, s[32:35], s13 offen sc1
    v_mfma_f32_16x16x32_bf16 v[24:27], a[208:211], v[92:95], v[24:27]
    v_mul_u32_u24 v59, 10, v58
    v_mfma_f32_16x16x32_bf16 v[28:31], a[212:215], v[92:95], v[28:31]
    v_mfma_f32_16x16x32_bf16 v[32:35], a[216:219], v[92:95], v[32:35]
    v_sub_u32 v59, v57, v59
    s_waitcnt vmcnt(12)
    v_mfma_f32_16x16x32_bf16 v[36:39], a[200:203], v[100:103], v[36:39]
    buffer_load_dwordx4 v[60:63], v77, s[32:35], s13 offen sc1
    v_mfma_f32_16x16x32_bf16 v[40:43], a[204:207], v[100:103], v[40:43]
    v_mfma_f32_16x16x32_bf16 v[44:47], a[208:211], v[100:103], v[44:47]
    v_lshlrev_b32 v59, 4, v59
    v_mfma_f32_16x16x32_bf16 v[48:51], a[212:215], v[100:103], v[48:51]
    v_mfma_f32_16x16x32_bf16 v[52:55], a[216:219], v[100:103], v[52:55]
    v_mad_u32_u24 v231, v58, v252, v59
    s_waitcnt vmcnt(12)
    v_mfma_f32_16x16x32_bf16 v[128:131], a[200:203], v[104:107], v[128:131]
    buffer_load_dwordx4 v[64:67], v78, s[32:35], s13 offen sc1
    v_mfma_f32_16x16x32_bf16 v[132:135], a[204:207], v[104:107], v[132:135]
    v_lshl_add_u32 v231, s40, 12, v231
    v_mfma_f32_16x16x32_bf16 v[136:139], a[208:211], v[104:107], v[136:139]
    v_mfma_f32_16x16x32_bf16 v[140:143], a[212:215], v[104:107], v[140:143]
    v_mul_u32_u24 v227, 1280, v58
    v_mfma_f32_16x16x32_bf16 v[144:147], a[216:219], v[104:107], v[144:147]
    s_waitcnt vmcnt(12)
    v_mfma_f32_16x16x32_bf16 v[148:151], a[200:203], v[108:111], v[148:151]
    buffer_load_dwordx4 v[68:71], v79, s[32:35], s13 offen sc1
    v_mfma_f32_16x16x32_bf16 v[152:155], a[204:207], v[108:111], v[152:155]
    v_add_u32 v227, v227, v59
    v_mfma_f32_16x16x32_bf16 v[156:159], a[208:211], v[108:111], v[156:159]
    v_mfma_f32_16x16x32_bf16 v[160:163], a[212:215], v[108:111], v[160:163]
    v_add_u32 v56, 128, v255
    v_mfma_f32_16x16x32_bf16 v[164:167], a[216:219], v[108:111], v[164:167]
    s_waitcnt vmcnt(12)
    v_mfma_f32_16x16x32_bf16 v[16:19], a[220:223], v[112:115], v[16:19]
    s_add_u32 s14, s73, 28672
    buffer_load_dwordx4 v[72:75], v76, s[32:35], s14 offen sc1
    v_mfma_f32_16x16x32_bf16 v[20:23], a[224:227], v[112:115], v[20:23]
    v_min_u32 v57, 159, v56
    v_mfma_f32_16x16x32_bf16 v[24:27], a[228:231], v[112:115], v[24:27]
    v_mul_u32_u24 v58, 6554, v57
    v_mfma_f32_16x16x32_bf16 v[28:31], a[232:235], v[112:115], v[28:31]
    v_mfma_f32_16x16x32_bf16 v[32:35], a[236:239], v[112:115], v[32:35]
    s_waitcnt vmcnt(12)
    v_mfma_f32_16x16x32_bf16 v[36:39], a[220:223], v[116:119], v[36:39]
    buffer_load_dwordx4 v[80:83], v77, s[32:35], s14 offen sc1
    v_lshrrev_b32 v58, 16, v58
    v_mfma_f32_16x16x32_bf16 v[40:43], a[224:227], v[116:119], v[40:43]
    v_mfma_f32_16x16x32_bf16 v[44:47], a[228:231], v[116:119], v[44:47]
    v_mul_u32_u24 v59, 10, v58
    v_mfma_f32_16x16x32_bf16 v[48:51], a[232:235], v[116:119], v[48:51]
    v_mfma_f32_16x16x32_bf16 v[52:55], a[236:239], v[116:119], v[52:55]
    v_sub_u32 v59, v57, v59
    s_waitcnt vmcnt(12)
    v_mfma_f32_16x16x32_bf16 v[128:131], a[220:223], v[120:123], v[128:131]
    buffer_load_dwordx4 v[84:87], v78, s[32:35], s14 offen sc1
    s_mov_b64 exec, 1
    buffer_store_dword v246, v254, s[32:35], s74 offen offset:0 sc1
    s_mov_b64 exec, -1
    v_mfma_f32_16x16x32_bf16 v[132:135], a[224:227], v[120:123], v[132:135]
    v_mfma_f32_16x16x32_bf16 v[136:139], a[228:231], v[120:123], v[136:139]
    v_lshlrev_b32 v59, 4, v59
    v_mfma_f32_16x16x32_bf16 v[140:143], a[232:235], v[120:123], v[140:143]
    v_mfma_f32_16x16x32_bf16 v[144:147], a[236:239], v[120:123], v[144:147]
    v_mad_u32_u24 v232, v58, v252, v59
    s_waitcnt vmcnt(13)
    v_mfma_f32_16x16x32_bf16 v[148:151], a[220:223], v[124:127], v[148:151]
    buffer_load_dwordx4 v[88:91], v79, s[32:35], s14 offen sc1
    v_mfma_f32_16x16x32_bf16 v[152:155], a[224:227], v[124:127], v[152:155]
    v_lshl_add_u32 v232, s40, 12, v232
    v_mfma_f32_16x16x32_bf16 v[156:159], a[228:231], v[124:127], v[156:159]
    v_mfma_f32_16x16x32_bf16 v[160:163], a[232:235], v[124:127], v[160:163]
    v_mul_u32_u24 v228, 1280, v58
    v_mfma_f32_16x16x32_bf16 v[164:167], a[236:239], v[124:127], v[164:167]
    s_waitcnt vmcnt(13)
    v_mfma_f32_16x16x32_bf16 v[16:19], a[0:3], v[236:239], v[16:19]
    s_add_u32 s15, s73, 45056
    buffer_load_dwordx4 v[92:95], v76, s[32:35], s15 offen sc1
    v_mfma_f32_16x16x32_bf16 v[20:23], a[4:7], v[236:239], v[20:23]
    v_add_u32 v228, v228, v59
    v_mfma_f32_16x16x32_bf16 v[24:27], a[8:11], v[236:239], v[24:27]
    v_mfma_f32_16x16x32_bf16 v[28:31], a[12:15], v[236:239], v[28:31]
    v_and_b32 v57, 15, v255
    v_mfma_f32_16x16x32_bf16 v[32:35], a[16:19], v[236:239], v[32:35]
    s_waitcnt vmcnt(13)
    v_mfma_f32_16x16x32_bf16 v[36:39], a[0:3], v[4:7], v[36:39]
    buffer_load_dwordx4 v[100:103], v77, s[32:35], s15 offen sc1
    v_lshrrev_b32 v58, 4, v255
    v_mfma_f32_16x16x32_bf16 v[40:43], a[4:7], v[4:7], v[40:43]
    v_mfma_f32_16x16x32_bf16 v[44:47], a[8:11], v[4:7], v[44:47]
    v_lshlrev_b32 v58, 3, v58
    v_mfma_f32_16x16x32_bf16 v[48:51], a[12:15], v[4:7], v[48:51]
    v_mfma_f32_16x16x32_bf16 v[52:55], a[16:19], v[4:7], v[52:55]
    s_waitcnt vmcnt(13)
    v_mfma_f32_16x16x32_bf16 v[128:131], a[0:3], v[8:11], v[128:131]
    buffer_load_dwordx4 v[104:107], v78, s[32:35], s15 offen sc1
    v_mad_u32_u24 v229, v57, v252, v58
    v_mfma_f32_16x16x32_bf16 v[132:135], a[4:7], v[8:11], v[132:135]
    v_mfma_f32_16x16x32_bf16 v[136:139], a[8:11], v[8:11], v[136:139]
    v_lshl_add_u32 v229, s40, 12, v229
    v_mfma_f32_16x16x32_bf16 v[140:143], a[12:15], v[8:11], v[140:143]
    v_mfma_f32_16x16x32_bf16 v[144:147], a[16:19], v[8:11], v[144:147]
    v_lshrrev_b32 v57, 10, v76
    s_waitcnt vmcnt(13)
    v_mfma_f32_16x16x32_bf16 v[148:151], a[0:3], v[12:15], v[148:151]
    buffer_load_dwordx4 v[108:111], v79, s[32:35], s15 offen sc1
    v_mfma_f32_16x16x32_bf16 v[152:155], a[4:7], v[12:15], v[152:155]
    v_mul_u32_u24 v57, 15360, v57
    v_mfma_f32_16x16x32_bf16 v[156:159], a[8:11], v[12:15], v[156:159]
    v_mfma_f32_16x16x32_bf16 v[160:163], a[12:15], v[12:15], v[160:163]
    v_mfma_f32_16x16x32_bf16 v[164:167], a[16:19], v[12:15], v[164:167]
    v_add3_u32 v222, v57, v253, s17
    s_waitcnt vmcnt(12)
    v_mfma_f32_16x16x32_bf16 v[16:19], a[20:23], v[240:243], v[16:19]
    v_cmp_ne_u32 vcc, s42, v96
    s_nop 0
    s_cbranch_vccnz L_hf2s_19
L_hf2b_20:
    v_mfma_f32_16x16x32_bf16 v[20:23], a[24:27], v[240:243], v[20:23]
    s_add_u32 s12, s73, 8192
    buffer_load_dwordx4 v[112:115], v76, s[32:35], s12 offen sc1
    v_mfma_f32_16x16x32_bf16 v[24:27], a[28:31], v[240:243], v[24:27]
    v_lshrrev_b32 v57, 10, v77
    v_mfma_f32_16x16x32_bf16 v[28:31], a[32:35], v[240:243], v[28:31]
    v_mul_u32_u24 v57, 15360, v57
    v_mfma_f32_16x16x32_bf16 v[32:35], a[36:39], v[240:243], v[32:35]
    s_waitcnt vmcnt(12)
    v_mfma_f32_16x16x32_bf16 v[36:39], a[20:23], v[60:63], v[36:39]
    s_add_u32 s13, s73, 12288
    buffer_load_dwordx4 v[116:119], v76, s[32:35], s13 offen sc1
    v_mfma_f32_16x16x32_bf16 v[40:43], a[24:27], v[60:63], v[40:43]
    v_add3_u32 v223, v57, v253, s17
    v_mfma_f32_16x16x32_bf16 v[44:47], a[28:31], v[60:63], v[44:47]
    v_mfma_f32_16x16x32_bf16 v[48:51], a[32:35], v[60:63], v[48:51]
    v_lshrrev_b32 v57, 10, v78
    v_mfma_f32_16x16x32_bf16 v[52:55], a[36:39], v[60:63], v[52:55]
    s_waitcnt vmcnt(12)
    v_mfma_f32_16x16x32_bf16 v[128:131], a[20:23], v[64:67], v[128:131]
    s_add_u32 s14, s73, 32768
    buffer_load_dwordx4 v[120:123], v76, s[32:35], s14 offen sc1
    v_mfma_f32_16x16x32_bf16 v[132:135], a[24:27], v[64:67], v[132:135]
    v_mul_u32_u24 v57, 15360, v57
    v_mfma_f32_16x16x32_bf16 v[136:139], a[28:31], v[64:67], v[136:139]
    v_add3_u32 v224, v57, v253, s17
    v_mfma_f32_16x16x32_bf16 v[140:143], a[32:35], v[64:67], v[140:143]
    v_mfma_f32_16x16x32_bf16 v[144:147], a[36:39], v[64:67], v[144:147]
    s_waitcnt vmcnt(12)
    v_mfma_f32_16x16x32_bf16 v[148:151], a[20:23], v[68:71], v[148:151]
    s_add_u32 s15, s73, 36864
    buffer_load_dwordx4 v[124:127], v76, s[32:35], s15 offen sc1
    v_mfma_f32_16x16x32_bf16 v[152:155], a[24:27], v[68:71], v[152:155]
    s_mul_i32 s49, s40, 15360
    v_mfma_f32_16x16x32_bf16 v[156:159], a[28:31], v[68:71], v[156:159]
    s_add_u32 s49, s49, 65536
    v_mfma_f32_16x16x32_bf16 v[160:163], a[32:35], v[68:71], v[160:163]
    v_mfma_f32_16x16x32_bf16 v[164:167], a[36:39], v[68:71], v[164:167]
    v_add_u32 v247, s49, v253
    s_waitcnt vmcnt(12)
    v_mfma_f32_16x16x32_bf16 v[16:19], a[40:43], v[72:75], v[16:19]
    buffer_load_dwordx4 v[236:239], v77, s[32:35], s12 offen sc1
    v_mfma_f32_16x16x32_bf16 v[20:23], a[44:47], v[72:75], v[20:23]
    v_lshlrev_b32 v252, 2, v255
    v_mfma_f32_16x16x32_bf16 v[24:27], a[48:51], v[72:75], v[24:27]
    v_mfma_f32_16x16x32_bf16 v[28:31], a[52:55], v[72:75], v[28:31]
    v_mfma_f32_16x16x32_bf16 v[32:35], a[56:59], v[72:75], v[32:35]
    s_mul_i32 s17, s40, 327680
    s_waitcnt vmcnt(12)
    v_mfma_f32_16x16x32_bf16 v[36:39], a[40:43], v[80:83], v[36:39]
    buffer_load_dwordx4 v[4:7], v77, s[32:35], s13 offen sc1
    v_mfma_f32_16x16x32_bf16 v[40:43], a[44:47], v[80:83], v[40:43]
    s_add_u32 s76, s76, s17
    v_mfma_f32_16x16x32_bf16 v[44:47], a[48:51], v[80:83], v[44:47]
    v_mfma_f32_16x16x32_bf16 v[48:51], a[52:55], v[80:83], v[48:51]
    v_cmp_gt_u32 vcc, 160, v56
    v_mov_b32 v57, 0x40000000
    s_nop 0
    v_cndmask_b32 v228, v57, v228, vcc
    v_mfma_f32_16x16x32_bf16 v[52:55], a[56:59], v[80:83], v[52:55]
    s_waitcnt vmcnt(12)
    v_mfma_f32_16x16x32_bf16 v[128:131], a[40:43], v[84:87], v[128:131]
    buffer_load_dwordx4 v[8:11], v77, s[32:35], s14 offen sc1
    v_mfma_f32_16x16x32_bf16 v[132:135], a[44:47], v[84:87], v[132:135]
    v_mfma_f32_16x16x32_bf16 v[136:139], a[48:51], v[84:87], v[136:139]
    v_mfma_f32_16x16x32_bf16 v[140:143], a[52:55], v[84:87], v[140:143]
    v_mfma_f32_16x16x32_bf16 v[144:147], a[56:59], v[84:87], v[144:147]
    s_waitcnt vmcnt(11)
    v_mfma_f32_16x16x32_bf16 v[148:151], a[40:43], v[88:91], v[148:151]
    buffer_load_dwordx4 v[12:15], v77, s[32:35], s15 offen sc1
    v_mfma_f32_16x16x32_bf16 v[152:155], a[44:47], v[88:91], v[152:155]
    v_mfma_f32_16x16x32_bf16 v[156:159], a[48:51], v[88:91], v[156:159]
    v_mfma_f32_16x16x32_bf16 v[160:163], a[52:55], v[88:91], v[160:163]
    v_mfma_f32_16x16x32_bf16 v[164:167], a[56:59], v[88:91], v[164:167]
    s_waitcnt vmcnt(11)
    v_mfma_f32_16x16x32_bf16 v[16:19], a[60:63], v[92:95], v[16:19]
    buffer_load_dwordx4 v[240:243], v78, s[32:35], s12 offen sc1
    v_mfma_f32_16x16x32_bf16 v[20:23], a[64:67], v[92:95], v[20:23]
    v_mfma_f32_16x16x32_bf16 v[24:27], a[68:71], v[92:95], v[24:27]
    v_mfma_f32_16x16x32_bf16 v[28:31], a[72:75], v[92:95], v[28:31]
    v_mfma_f32_16x16x32_bf16 v[32:35], a[76:79], v[92:95], v[32:35]
    s_waitcnt vmcnt(11)
    v_mfma_f32_16x16x32_bf16 v[36:39], a[60:63], v[100:103], v[36:39]
    buffer_load_dwordx4 v[60:63], v78, s[32:35], s13 offen sc1
    v_mfma_f32_16x16x32_bf16 v[40:43], a[64:67], v[100:103], v[40:43]
    v_mfma_f32_16x16x32_bf16 v[44:47], a[68:71], v[100:103], v[44:47]
    v_mfma_f32_16x16x32_bf16 v[48:51], a[72:75], v[100:103], v[48:51]
    v_mfma_f32_16x16x32_bf16 v[52:55], a[76:79], v[100:103], v[52:55]
    s_waitcnt vmcnt(11)
    v_mfma_f32_16x16x32_bf16 v[128:131], a[60:63], v[104:107], v[128:131]
    buffer_load_dwordx4 v[64:67], v78, s[32:35], s14 offen sc1
    v_mfma_f32_16x16x32_bf16 v[132:135], a[64:67], v[104:107], v[132:135]
    v_mfma_f32_16x16x32_bf16 v[136:139], a[68:71], v[104:107], v[136:139]
    v_mfma_f32_16x16x32_bf16 v[140:143], a[72:75], v[104:107], v[140:143]
    v_mfma_f32_16x16x32_bf16 v[144:147], a[76:79], v[104:107], v[144:147]
    s_waitcnt vmcnt(11)
    v_mfma_f32_16x16x32_bf16 v[148:151], a[60:63], v[108:111], v[148:151]
    buffer_load_dwordx4 v[68:71], v78, s[32:35], s15 offen sc1
    v_mfma_f32_16x16x32_bf16 v[152:155], a[64:67], v[108:111], v[152:155]
    v_mfma_f32_16x16x32_bf16 v[156:159], a[68:71], v[108:111], v[156:159]
    v_mfma_f32_16x16x32_bf16 v[160:163], a[72:75], v[108:111], v[160:163]
    v_mfma_f32_16x16x32_bf16 v[164:167], a[76:79], v[108:111], v[164:167]
    s_waitcnt vmcnt(11)
    v_mfma_f32_16x16x32_bf16 v[16:19], a[80:83], v[112:115], v[16:19]
    buffer_load_dwordx4 v[72:75], v79, s[32:35], s12 offen sc1
    v_mfma_f32_16x16x32_bf16 v[20:23], a[84:87], v[112:115], v[20:23]
    v_mfma_f32_16x16x32_bf16 v[24:27], a[88:91], v[112:115], v[24:27]
    v_mfma_f32_16x16x32_bf16 v[28:31], a[92:95], v[112:115], v[28:31]
    v_mfma_f32_16x16x32_bf16 v[32:35], a[96:99], v[112:115], v[32:35]
    s_waitcnt vmcnt(11)
    v_mfma_f32_16x16x32_bf16 v[16:19], a[100:103], v[116:119], v[16:19]
    buffer_load_dwordx4 v[80:83], v79, s[32:35], s13 offen sc1
    v_mfma_f32_16x16x32_bf16 v[20:23], a[104:107], v[116:119], v[20:23]
    v_mfma_f32_16x16x32_bf16 v[24:27], a[108:111], v[116:119], v[24:27]
    v_mfma_f32_16x16x32_bf16 v[28:31], a[112:115], v[116:119], v[28:31]
    v_mfma_f32_16x16x32_bf16 v[32:35], a[116:119], v[116:119], v[32:35]
    s_waitcnt vmcnt(11)
    v_mfma_f32_16x16x32_bf16 v[16:19], a[120:123], v[120:123], v[16:19]
    buffer_load_dwordx4 v[84:87], v79, s[32:35], s14 offen sc1
    v_mfma_f32_16x16x32_bf16 v[20:23], a[124:127], v[120:123], v[20:23]
    v_mfma_f32_16x16x32_bf16 v[24:27], a[128:131], v[120:123], v[24:27]
    v_mfma_f32_16x16x32_bf16 v[28:31], a[132:135], v[120:123], v[28:31]
    v_mfma_f32_16x16x32_bf16 v[32:35], a[136:139], v[120:123], v[32:35]
    s_waitcnt vmcnt(11)
    v_mfma_f32_16x16x32_bf16 v[16:19], a[140:143], v[124:127], v[16:19]
    buffer_load_dwordx4 v[88:91], v79, s[32:35], s15 offen sc1
    v_mfma_f32_16x16x32_bf16 v[20:23], a[144:147], v[124:127], v[20:23]
    v_mfma_f32_16x16x32_bf16 v[24:27], a[148:151], v[124:127], v[24:27]
    v_mfma_f32_16x16x32_bf16 v[28:31], a[152:155], v[124:127], v[28:31]
    v_mfma_f32_16x16x32_bf16 v[32:35], a[156:159], v[124:127], v[32:35]
    s_waitcnt vmcnt(11)
    v_mfma_f32_16x16x32_bf16 v[36:39], a[80:83], v[236:239], v[36:39]
    v_mfma_f32_16x16x32_bf16 v[40:43], a[84:87], v[236:239], v[40:43]
    v_mfma_f32_16x16x32_bf16 v[44:47], a[88:91], v[236:239], v[44:47]
    ds_write_b128 v222, v[16:19] offset:0
    v_mfma_f32_16x16x32_bf16 v[48:51], a[92:95], v[236:239], v[48:51]
    v_mfma_f32_16x16x32_bf16 v[52:55], a[96:99], v[236:239], v[52:55]
    s_waitcnt vmcnt(10)
    v_mfma_f32_16x16x32_bf16 v[36:39], a[100:103], v[4:7], v[36:39]
    ds_write_b128 v222, v[20:23] offset:1024
    v_mfma_f32_16x16x32_bf16 v[40:43], a[104:107], v[4:7], v[40:43]
    v_mfma_f32_16x16x32_bf16 v[44:47], a[108:111], v[4:7], v[44:47]
    v_mfma_f32_16x16x32_bf16 v[48:51], a[112:115], v[4:7], v[48:51]
    ds_write_b128 v222, v[24:27] offset:2048
    v_mfma_f32_16x16x32_bf16 v[52:55], a[116:119], v[4:7], v[52:55]
    s_waitcnt vmcnt(9)
    v_mfma_f32_16x16x32_bf16 v[36:39], a[120:123], v[8:11], v[36:39]
    v_mfma_f32_16x16x32_bf16 v[40:43], a[124:127], v[8:11], v[40:43]
    ds_write_b128 v222, v[28:31] offset:3072
    v_mfma_f32_16x16x32_bf16 v[44:47], a[128:131], v[8:11], v[44:47]
    v_mfma_f32_16x16x32_bf16 v[48:51], a[132:135], v[8:11], v[48:51]
    v_mfma_f32_16x16x32_bf16 v[52:55], a[136:139], v[8:11], v[52:55]
    ds_write_b128 v222, v[32:35] offset:4096
    s_waitcnt vmcnt(8)
    v_mfma_f32_16x16x32_bf16 v[36:39], a[140:143], v[12:15], v[36:39]
    v_mfma_f32_16x16x32_bf16 v[40:43], a[144:147], v[12:15], v[40:43]
    v_mfma_f32_16x16x32_bf16 v[44:47], a[148:151], v[12:15], v[44:47]
    v_mfma_f32_16x16x32_bf16 v[48:51], a[152:155], v[12:15], v[48:51]
    v_mfma_f32_16x16x32_bf16 v[52:55], a[156:159], v[12:15], v[52:55]
    s_waitcnt vmcnt(7)
    v_mfma_f32_16x16x32_bf16 v[128:131], a[80:83], v[240:243], v[128:131]
    buffer_load_dword v56, v252, s[32:35], s75 offen sc1
    v_mfma_f32_16x16x32_bf16 v[132:135], a[84:87], v[240:243], v[132:135]
    v_mfma_f32_16x16x32_bf16 v[136:139], a[88:91], v[240:243], v[136:139]
    ds_write_b128 v223, v[36:39] offset:5120
    v_mfma_f32_16x16x32_bf16 v[140:143], a[92:95], v[240:243], v[140:143]
    v_mfma_f32_16x16x32_bf16 v[144:147], a[96:99], v[240:243], v[144:147]
    s_waitcnt vmcnt(7)
    v_mfma_f32_16x16x32_bf16 v[128:131], a[100:103], v[60:63], v[128:131]
    ds_write_b128 v223, v[40:43] offset:6144
    v_mfma_f32_16x16x32_bf16 v[132:135], a[104:107], v[60:63], v[132:135]
    v_mfma_f32_16x16x32_bf16 v[136:139], a[108:111], v[60:63], v[136:139]
    v_mfma_f32_16x16x32_bf16 v[140:143], a[112:115], v[60:63], v[140:143]
    ds_write_b128 v223, v[44:47] offset:7168
    v_mfma_f32_16x16x32_bf16 v[144:147], a[116:119], v[60:63], v[144:147]
    s_waitcnt vmcnt(6)
    v_mfma_f32_16x16x32_bf16 v[128:131], a[120:123], v[64:67], v[128:131]
    v_mfma_f32_16x16x32_bf16 v[132:135], a[124:127], v[64:67], v[132:135]
    ds_write_b128 v223, v[48:51] offset:8192
    v_mfma_f32_16x16x32_bf16 v[136:139], a[128:131], v[64:67], v[136:139]
    v_mfma_f32_16x16x32_bf16 v[140:143], a[132:135], v[64:67], v[140:143]
    v_mfma_f32_16x16x32_bf16 v[144:147], a[136:139], v[64:67], v[144:147]
    ds_write_b128 v223, v[52:55] offset:9216
    s_waitcnt vmcnt(5)
    v_mfma_f32_16x16x32_bf16 v[128:131], a[140:143], v[68:71], v[128:131]
    v_mfma_f32_16x16x32_bf16 v[132:135], a[144:147], v[68:71], v[132:135]
    v_mfma_f32_16x16x32_bf16 v[136:139], a[148:151], v[68:71], v[136:139]
    v_mfma_f32_16x16x32_bf16 v[140:143], a[152:155], v[68:71], v[140:143]
    v_mfma_f32_16x16x32_bf16 v[144:147], a[156:159], v[68:71], v[144:147]
    s_waitcnt vmcnt(4)
    v_mfma_f32_16x16x32_bf16 v[148:151], a[80:83], v[72:75], v[148:151]
    v_mfma_f32_16x16x32_bf16 v[152:155], a[84:87], v[72:75], v[152:155]
    v_mfma_f32_16x16x32_bf16 v[156:159], a[88:91], v[72:75], v[156:159]
    ds_write_b128 v224, v[128:131] offset:10240
    v_mfma_f32_16x16x32_bf16 v[160:163], a[92:95], v[72:75], v[160:163]
    v_mfma_f32_16x16x32_bf16 v[164:167], a[96:99], v[72:75], v[164:167]
    ds_write_b128 v224, v[132:135] offset:11264
    s_waitcnt vmcnt(3)
    v_mfma_f32_16x16x32_bf16 v[148:151], a[100:103], v[80:83], v[148:151]
    v_mfma_f32_16x16x32_bf16 v[152:155], a[104:107], v[80:83], v[152:155]
    ds_write_b128 v224, v[136:139] offset:12288
    v_mfma_f32_16x16x32_bf16 v[156:159], a[108:111], v[80:83], v[156:159]
    s_waitcnt vmcnt(0)
    v_cmp_ne_u32 vcc, s42, v56
    s_nop 0
    s_or_b64 s[24:25], vcc, vcc
    s_cselect_b32 s16, 0x40000000, s76
    v_mfma_f32_16x16x32_bf16 v[160:163], a[112:115], v[80:83], v[160:163]
    s_add_u32 s48, s16, 20971520
    buffer_load_dwordx4 v[168:171], v226, s[32:35], s48 offen sc1
    v_mfma_f32_16x16x32_bf16 v[164:167], a[116:119], v[80:83], v[164:167]
    ds_write_b128 v224, v[140:143] offset:13312
    v_mfma_f32_16x16x32_bf16 v[148:151], a[120:123], v[84:87], v[148:151]
    v_mfma_f32_16x16x32_bf16 v[152:155], a[124:127], v[84:87], v[152:155]
    ds_write_b128 v224, v[144:147] offset:14336
    v_mfma_f32_16x16x32_bf16 v[156:159], a[128:131], v[84:87], v[156:159]
    s_add_u32 s48, s16, 20971520
    buffer_load_dwordx4 v[172:175], v227, s[32:35], s48 offen sc1
    v_mfma_f32_16x16x32_bf16 v[160:163], a[132:135], v[84:87], v[160:163]
    v_mfma_f32_16x16x32_bf16 v[164:167], a[136:139], v[84:87], v[164:167]
    s_add_u32 s48, s16, 20971520
    buffer_load_dwordx4 v[176:179], v228, s[32:35], s48 offen sc1
    v_mfma_f32_16x16x32_bf16 v[148:151], a[140:143], v[88:91], v[148:151]
    v_mfma_f32_16x16x32_bf16 v[152:155], a[144:147], v[88:91], v[152:155]
    v_mfma_f32_16x16x32_bf16 v[156:159], a[148:151], v[88:91], v[156:159]
    v_mfma_f32_16x16x32_bf16 v[160:163], a[152:155], v[88:91], v[160:163]
    v_mfma_f32_16x16x32_bf16 v[164:167], a[156:159], v[88:91], v[164:167]
    s_waitcnt lgkmcnt(0)
    s_barrier
    ds_read_b128 v[16:19], v247 offset:0
    ds_read_b128 v[36:39], v247 offset:5120
    ds_read_b128 v[128:131], v247 offset:10240
    ds_read_b128 v[20:23], v247 offset:1024
    ds_read_b128 v[40:43], v247 offset:6144
    ds_read_b128 v[132:135], v247 offset:11264
    ds_read_b128 v[24:27], v247 offset:2048
    ds_read_b128 v[44:47], v247 offset:7168
    ds_read_b128 v[136:139], v247 offset:12288
    ds_read_b128 v[28:31], v247 offset:3072
    ds_read_b128 v[48:51], v247 offset:8192
    ds_read_b128 v[140:143], v247 offset:13312
    ds_read_b128 v[32:35], v247 offset:4096
    ds_read_b128 v[52:55], v247 offset:9216
    ds_read_b128 v[144:147], v247 offset:14336
    s_mov_b64 vcc, s[24:25]
    s_cbranch_vccnz L_yfs_22
L_yfb_23:
    s_waitcnt vmcnt(2)
    v_lshlrev_b32 v240, 16, v168
    v_and_b32 v241, 0xffff0000, v168
    v_lshlrev_b32 v242, 16, v169
    v_and_b32 v243, 0xffff0000, v169
    v_lshlrev_b32 v60, 16, v170
    v_and_b32 v61, 0xffff0000, v170
    v_lshlrev_b32 v62, 16, v171
    v_and_b32 v63, 0xffff0000, v171
    s_waitcnt lgkmcnt(14)
    v_pk_add_f32 v[148:149], v[148:149], v[16:17]
    s_waitcnt lgkmcnt(12)
    v_pk_add_f32 v[36:37], v[36:37], v[128:129]
    v_pk_add_f32 v[148:149], v[148:149], v[36:37]
    v_pk_add_f32 v[150:151], v[150:151], v[18:19]
    v_pk_add_f32 v[38:39], v[38:39], v[130:131]
    v_pk_add_f32 v[150:151], v[150:151], v[38:39]
    v_cvt_pk_bf16_f32 v148, v148, v149
    v_cvt_pk_bf16_f32 v149, v150, v151
    ds_write_b64 v229, v[148:149] offset:0
    s_waitcnt lgkmcnt(12)
    v_pk_add_f32 v[152:153], v[152:153], v[20:21]
    s_waitcnt lgkmcnt(10)
    v_pk_add_f32 v[40:41], v[40:41], v[132:133]
    v_pk_add_f32 v[152:153], v[152:153], v[40:41]
    v_pk_add_f32 v[154:155], v[154:155], v[22:23]
    v_pk_add_f32 v[42:43], v[42:43], v[134:135]
    v_pk_add_f32 v[154:155], v[154:155], v[42:43]
    v_cvt_pk_bf16_f32 v152, v152, v153
    v_cvt_pk_bf16_f32 v153, v154, v155
    ds_write_b64 v229, v[152:153] offset:32
    s_waitcnt lgkmcnt(10)
    v_pk_add_f32 v[156:157], v[156:157], v[24:25]
    s_waitcnt lgkmcnt(8)
    v_pk_add_f32 v[44:45], v[44:45], v[136:137]
    v_pk_add_f32 v[156:157], v[156:157], v[44:45]
    v_pk_add_f32 v[158:159], v[158:159], v[26:27]
    v_pk_add_f32 v[46:47], v[46:47], v[138:139]
    v_pk_add_f32 v[158:159], v[158:159], v[46:47]
    v_cvt_pk_bf16_f32 v156, v156, v157
    v_cvt_pk_bf16_f32 v157, v158, v159
    ds_write_b64 v229, v[156:157] offset:64
    s_waitcnt lgkmcnt(8)
    v_pk_add_f32 v[160:161], v[160:161], v[28:29]
    s_waitcnt lgkmcnt(6)
    v_pk_add_f32 v[48:49], v[48:49], v[140:141]
    v_pk_add_f32 v[160:161], v[160:161], v[48:49]
    v_pk_add_f32 v[162:163], v[162:163], v[30:31]
    v_pk_add_f32 v[50:51], v[50:51], v[142:143]
    v_pk_add_f32 v[162:163], v[162:163], v[50:51]
    v_cvt_pk_bf16_f32 v160, v160, v161
    v_cvt_pk_bf16_f32 v161, v162, v163
    ds_write_b64 v229, v[160:161] offset:96
    s_waitcnt lgkmcnt(6)
    v_pk_add_f32 v[164:165], v[164:165], v[32:33]
    s_waitcnt lgkmcnt(4)
    v_pk_add_f32 v[52:53], v[52:53], v[144:145]
    v_pk_add_f32 v[164:165], v[164:165], v[52:53]
    v_pk_add_f32 v[166:167], v[166:167], v[34:35]
    v_pk_add_f32 v[54:55], v[54:55], v[146:147]
    v_pk_add_f32 v[166:167], v[166:167], v[54:55]
    v_cvt_pk_bf16_f32 v164, v164, v165
    v_cvt_pk_bf16_f32 v165, v166, v167
    ds_write_b64 v229, v[164:165] offset:128
    ds_read_b128 v[16:19], v230 offset:0
    ds_read_b128 v[20:23], v231 offset:0
    ds_read_b128 v[24:27], v232 offset:0
    s_waitcnt vmcnt(1)
    v_lshlrev_b32 v64, 16, v172
    v_and_b32 v65, 0xffff0000, v172
    v_lshlrev_b32 v66, 16, v173
    v_and_b32 v67, 0xffff0000, v173
    v_lshlrev_b32 v68, 16, v174
    v_and_b32 v69, 0xffff0000, v174
    v_lshlrev_b32 v70, 16, v175
    v_and_b32 v71, 0xffff0000, v175
    s_waitcnt vmcnt(0)
    v_lshlrev_b32 v72, 16, v176
    v_and_b32 v73, 0xffff0000, v176
    v_lshlrev_b32 v74, 16, v177
    v_and_b32 v75, 0xffff0000, v177
    v_lshlrev_b32 v80, 16, v178
    v_and_b32 v81, 0xffff0000, v178
    v_lshlrev_b32 v82, 16, v179
    v_and_b32 v83, 0xffff0000, v179
    s_waitcnt lgkmcnt(2)
    v_lshlrev_b32 v56, 16, v16
    v_and_b32 v57, 0xffff0000, v16
    v_pk_add_f32 v[56:57], v[56:57], v[240:241]
    v_cvt_pk_bf16_f32 v168, v56, v57
    v_lshlrev_b32 v56, 16, v17
    v_and_b32 v57, 0xffff0000, v17
    v_pk_add_f32 v[56:57], v[56:57], v[242:243]
    v_cvt_pk_bf16_f32 v169, v56, v57
    v_lshlrev_b32 v56, 16, v18
    v_and_b32 v57, 0xffff0000, v18
    v_pk_add_f32 v[56:57], v[56:57], v[60:61]
    v_cvt_pk_bf16_f32 v170, v56, v57
    v_lshlrev_b32 v56, 16, v19
    v_and_b32 v57, 0xffff0000, v19
    v_pk_add_f32 v[56:57], v[56:57], v[62:63]
    v_cvt_pk_bf16_f32 v171, v56, v57
    buffer_store_dwordx4 v[168:171], v226, s[28:31], s76 offen
    s_waitcnt lgkmcnt(1)
    v_lshlrev_b32 v56, 16, v20
    v_and_b32 v57, 0xffff0000, v20
    v_pk_add_f32 v[56:57], v[56:57], v[64:65]
    v_cvt_pk_bf16_f32 v172, v56, v57
    v_lshlrev_b32 v56, 16, v21
    v_and_b32 v57, 0xffff0000, v21
    v_pk_add_f32 v[56:57], v[56:57], v[66:67]
    v_cvt_pk_bf16_f32 v173, v56, v57
    v_lshlrev_b32 v56, 16, v22
    v_and_b32 v57, 0xffff0000, v22
    v_pk_add_f32 v[56:57], v[56:57], v[68:69]
    v_cvt_pk_bf16_f32 v174, v56, v57
    v_lshlrev_b32 v56, 16, v23
    v_and_b32 v57, 0xffff0000, v23
    v_pk_add_f32 v[56:57], v[56:57], v[70:71]
    v_cvt_pk_bf16_f32 v175, v56, v57
    buffer_store_dwordx4 v[172:175], v227, s[28:31], s76 offen
    s_waitcnt lgkmcnt(0)
    v_lshlrev_b32 v56, 16, v24
    v_and_b32 v57, 0xffff0000, v24
    v_pk_add_f32 v[56:57], v[56:57], v[72:73]
    v_cvt_pk_bf16_f32 v176, v56, v57
    v_lshlrev_b32 v56, 16, v25
    v_and_b32 v57, 0xffff0000, v25
    v_pk_add_f32 v[56:57], v[56:57], v[74:75]
    v_cvt_pk_bf16_f32 v177, v56, v57
    v_lshlrev_b32 v56, 16, v26
    v_and_b32 v57, 0xffff0000, v26
    v_pk_add_f32 v[56:57], v[56:57], v[80:81]
    v_cvt_pk_bf16_f32 v178, v56, v57
    v_lshlrev_b32 v56, 16, v27
    v_and_b32 v57, 0xffff0000, v27
    v_pk_add_f32 v[56:57], v[56:57], v[82:83]
    v_cvt_pk_bf16_f32 v179, v56, v57
    buffer_store_dwordx4 v[176:179], v228, s[28:31], s76 offen
L_end:
    s_endpgm
L_sts_1:
    s_mov_b32 s51, 0
L_stl_3:
    s_sleep 2
    buffer_load_dwordx4 v[156:159], v232, s[32:35], s59 offen sc1
    s_waitcnt vmcnt(0)
    v_cmp_ne_u32 vcc, s42, v159
    s_nop 0
    s_cbranch_vccz L_stb_2
    s_add_u32 s51, s51, 1
    s_cmp_lt_u32 s51, 0x40000
    s_cbranch_scc1 L_stl_3
    s_branch L_stb_2
L_w2fs_4:
    s_mov_b32 s51, 0
L_w2fl_6:
    s_sleep 2
    s_mov_b32 s48, 65536
    buffer_load_dwordx4 v[188:191], v253, s[32:35], s48 offen sc1
    s_waitcnt vmcnt(0)
    v_xor_b32 v188, s42, v188
    v_bitop3_b32 v188, v188, v189, v246 bitop3:0xf6
    v_bitop3_b32 v188, v188, v190, v246 bitop3:0xf6
    v_bitop3_b32 v188, v188, v191, v246 bitop3:0xf6
    v_cmp_ne_u32 vcc, 0, v188
    s_nop 0
    s_cbranch_vccz L_w2fb_5
    s_add_u32 s51, s51, 1
    s_cmp_lt_u32 s51, 0x40000
    s_cbranch_scc1 L_w2fl_6
    s_branch L_w2fb_5
L_vs_7:
    s_mov_b32 s51, 0
L_vl_9:
    s_sleep 2
    buffer_load_dwordx4 v[100:103], v1, s[32:35], s62 offen sc1
    s_add_u32 s48, s62, 4096
    buffer_load_dwordx4 v[104:107], v1, s[32:35], s48 offen sc1
    s_add_u32 s48, s62, 8192
    buffer_load_dwordx4 v[108:111], v1, s[32:35], s48 offen sc1
    s_add_u32 s48, s62, 12288
    buffer_load_dwordx4 v[112:115], v1, s[32:35], s48 offen sc1
    s_waitcnt vmcnt(0)
    v_xor_b32 v219, s42, v103
    v_bitop3_b32 v219, v219, v107, v246 bitop3:0xf6
    v_bitop3_b32 v219, v219, v111, v246 bitop3:0xf6
    v_bitop3_b32 v219, v219, v115, v246 bitop3:0xf6
    v_cmp_ne_u32 vcc, 0, v219
    s_nop 0
    s_and_b64 vcc, vcc, s[64:65]
    s_cbranch_vccz L_vb_8
    s_add_u32 s51, s51, 1
    s_cmp_lt_u32 s51, 0x40000
    s_cbranch_scc1 L_vl_9
    s_branch L_vb_8
L_vps_10:
    s_mov_b32 s51, 0
L_vpl_12:
    s_sleep 2
    buffer_load_dwordx4 v[100:103], v1, s[32:35], s67 offen sc1
    s_add_u32 s48, s67, 4096
    buffer_load_dwordx4 v[104:107], v1, s[32:35], s48 offen sc1
    buffer_load_dwordx4 v[108:111], v1, s[32:35], s68 offen sc1
    s_waitcnt vmcnt(0)
    v_xor_b32 v97, s42, v103
    v_bitop3_b32 v97, v97, v107, v246 bitop3:0xf6
    v_bitop3_b32 v97, v97, v111, v246 bitop3:0xf6
    v_cmp_ne_u32 vcc, 0, v97
    s_nop 0
    s_and_b64 vcc, vcc, s[0:1]
    s_cbranch_vccz L_vpb_11
    s_add_u32 s51, s51, 1
    s_cmp_lt_u32 s51, 0x40000
    s_cbranch_scc1 L_vpl_12
    s_branch L_vpb_11
L_hfs_13:
    s_mov_b32 s51, 0
L_hfl_15:
    s_sleep 2
    buffer_load_dword v96, v233, s[32:35], s72 offen sc1
    s_waitcnt vmcnt(0)
    v_cmp_ne_u32 vcc, s42, v96
    s_nop 0
    s_and_b64 vcc, vcc, 0xc30c3
    s_cbranch_vccz L_hfb_14
    s_add_u32 s51, s51, 1
    s_cmp_lt_u32 s51, 0x40000
    s_cbranch_scc1 L_hfl_15
    s_branch L_hfb_14
L_hf1s_16:
    s_waitcnt vmcnt(0)
    s_mov_b64 exec, 1
    buffer_store_dword v246, v254, s[32:35], s74 offen offset:0 sc1
    s_mov_b64 exec, -1
    s_mov_b32 s51, 0
L_hf1l_18:
    s_sleep 2
    buffer_load_dword v96, v233, s[32:35], s72 offen sc1
    s_waitcnt vmcnt(0)
    v_cmp_ne_u32 vcc, s42, v96
    s_nop 0
    s_and_b64 vcc, vcc, 0x3cf3cf
    s_cbranch_vccz L_hf1b_17
    s_add_u32 s51, s51, 1
    s_cmp_lt_u32 s51, 0x40000
    s_cbranch_scc1 L_hf1l_18
    s_branch L_hf1b_17
L_hf2s_19:
    s_waitcnt vmcnt(0)
    s_mov_b64 exec, 1
    buffer_store_dword v246, v254, s[32:35], s74 offen offset:0 sc1
    s_mov_b64 exec, -1
    s_mov_b32 s51, 0
L_hf2l_21:
    s_sleep 2
    buffer_load_dword v96, v233, s[32:35], s72 offen sc1
    s_waitcnt vmcnt(0)
    v_cmp_ne_u32 vcc, s42, v96
    s_nop 0
    s_cbranch_vccz L_hf2b_20
    s_add_u32 s51, s51, 1
    s_cmp_lt_u32 s51, 0x40000
    s_cbranch_scc1 L_hf2l_21
    s_branch L_hf2b_20
L_yfs_22:
    s_mov_b32 s51, 0
L_yfl_24:
    s_sleep 2
    buffer_load_dword v56, v252, s[32:35], s75 offen sc1
    s_waitcnt vmcnt(0)
    v_cmp_ne_u32 vcc, s42, v56
    s_nop 0
    s_cbranch_vccz L_yfo_25
    s_add_u32 s51, s51, 1
    s_cmp_lt_u32 s51, 0x40000
    s_cbranch_scc1 L_yfl_24
L_yfo_25:
    s_add_u32 s48, s76, 20971520
    buffer_load_dwordx4 v[168:171], v226, s[32:35], s48 offen sc1
    s_add_u32 s48, s76, 20971520
    buffer_load_dwordx4 v[172:175], v227, s[32:35], s48 offen sc1
    s_add_u32 s48, s76, 20971520
    buffer_load_dwordx4 v[176:179], v228, s[32:35], s48 offen sc1
    s_waitcnt vmcnt(0)
    s_branch L_yfb_23
.p2align 8
.type tab_data,@object
tab_data:
.long 1065369472,1065369472,1065369472,1065369472,1065041792,1062551405,3192398989,3205414596,1064124288,1053048629,3211640704
.long 3200565045,1062551424,3192405700,1057924436,1065041773,1060454272,3207931021,1060454272,3207931312,1057898368,3212558020
.long 3210028464,3192438637,1053048704,3211640629,3200565120,1064124213,1044922240,3205414765,1065068023,3210034884,613236608
.long 2773794688,639582080,2805055360,3192405888,1057931117,3212518943,1062551236,3200532352,1064156981,1053081472,3211607861
.long 3205382016,1065074372,1062577969,1044954989,3207937920,1060480340,3207937920,1060480834,3210035072,1044922052,3205408397
.long 3212525421,3211607936,3200532277,1064157056,1053081397,3212525440,3210035053,1044948802,1057930948,3212853120,3212853120
.long 3212853120,3212853120,3212525440,3210035053,1044948564,1057930948,3211607936,3200532277,1064157056,1053081397,3210035072
.long 1044922052,3205408596,3212525421,3207937920,1060447664,3207937920,1060480398,3205382016,1065074372,1062577677,1044954989
.long 3200532352,1064156981,1053081472,3211607861,3192405888,1057931117,3212552037,1062551236,2773761920,639614848,2809610112
.long 630046592,1044922240,3205414765,1065067918,3210034884,1053048704,3211640629,3200565120,1064124213,1057898368,3212558020
.long 3210061687,3192438637,1060454272,3207964151,1060454272,3207964557,1062551424,3192405700,1057923383,1065041773,1064124288
.long 1053048629,3211640704,3200565045,1065041792,1062551405,3192432516,3205414596,1065369472,1065369472,1065369472,1065369472
.long 1057898293,1044922052,3210067765,3212558189,3200525453,3211640629,1053074772,1064124213,3212558133,3205414765,1044922165
.long 3210067652,3207970688,1060480340,3207970688,1060480503,1044954933,1062551405,1065041717,3205381828,1064150356,3200532277
.long 3211601439,1053081397,1062551349,3212558020,1057931061,3192405869,632307584,2784477056,2794274688,2806169472,3210034997
.long 1065074372,3205414709,1044922221,3211601328,1053048629,1064150850,3200565045,3192438581,3210035053,3212525365,1057898180
.long 1060487040,3207931423,1060487040,3207964173,1065074485,1057931117,3192405813,1062584004,1053074935,1064156981,3200558605
.long 3211607861,3205381941,3192405700,1062584117,1065074541,3212853120,3212853120,3212853120,3212853120,3205381941,3192405700
.long 1062584117,1065074541,1053042207,1064156981,3200558967,3211607861,1065074485,1057931117,3192405813,1062584004,1060487040
.long 3207964482,1060487040,3207964557,3192438581,3210035053,3212525365,1057898180,3211634481,1053048629,1064118276,3200565045
.long 3210034997,1065074372,3205414709,1044922221,2806136704,2785918848,2811641728,646823808,1062551349,3212558020,1057931061
.long 3192405869,1064150669,3200532277,3211601748,1053081397,1044954933,1062551405,1065041717,3205381828,3207970688,1060480525
.long 3207970688,1060448278,3212558133,3205414765,1044922165,3210067652,3200558914,3211640629,1053042825,1064124213,1057898293
.long 1044922052,3210067765,3212558189,1065369472,1065369472,1065369472,1065369472,3212558208,3210067821,1044948308,1057898180
.long 1064124288,1053048629,3211640704,3200565045,3210067840,1044954820,3205375519,3212558189,1060454272,3207931423,1060454272
.long 3207964301,3205414784,1065041604,1062577986,1044922221,1053048704,3211640629,3200565120,1064124213,3192438656,1057898349
.long 3212551693,1062584004,2790539136,2807349120,2777563008,2809642880,1044955008,3205381997,1065068407,3210067652,3200532352
.long 1064156981,1053081472,3211607861,1057931136,3212525252,3210029060,3192405869,3207937920,1060480887,3207937920,1060480918
.long 1062584192,3192438468,1057892180,1065074541,3211607936,3200532277,1064157056,1053081397,1065074560,1062584173,3192400009
.long 3205381828,3212853120,3212853120,3212853120,3212853120,1065074560,1062584173,3192399912,3205381828,3211607936,3200532277
.long 1064157056,1053081397,1062584192,3192438468,1057892383,1065074541,3207937920,1060447885,3207937920,1060448296,1057931136
.long 3212525252,3210028756,3192405869,3200532352,1064156981,1053081472,3211607861,1044955008,3205381997,1065035568,3210067652
.long 2813411200,673169280,2816819072,674873216,3192438656,1057898349,3212552165,1062584004,1053048704,3211640629,3200565120
.long 1064124213,3205414784,1065041604,1062545465,1044922221,1060454272,3207931604,1060454272,3207964676,3210067840,1044954820
.long 3205408896,3212558189,1064124288,1053048629,3211640704,3200565045,3212558208,3210067821,1044916387,1057898180,1065369472
.long 1065369472,1065369472,1065369472,3205414709,3192438468,1062551349,1065041773,3200525744,3211640629,1053074935,1064124213
.long 1065041717,1057898349,3192438581,1062551236,3207970688,1060480817,3207970688,1060480834,3192405813,3210067821,3212558133
.long 1057930948,1064150850,3200532277,3211634189,1053081397,3210067765,1065041604,3205381941,1044954989,2785886080,2808463232
.long 2704752512,2810494848,1062584117,3212525252,1057898293,3192438637,3211634062,1053048629,1064150925,3200565045,1044922165
.long 1062584173,1065074485,3205414596,1060487040,3207931277,1060487040,3207931533,3212525365,3205381997,1044954933,3210034884
.long 1053075341,1064156981,3200526358,3211607861,1057931061,1044954820,3210034997,3212525421,3212853120,3212853120,3212853120
.long 3212853120,1057931061,1044954820,3210034997,3212525421,1053042317,1064156981,3200526036,3211607861,3212525365,3205381997
.long 1044954933,3210034884,1060487040,3207931661,1060487040,3207964645,1044922165,1062584173,1065074485,3205414596,3211634781
.long 1053048629,1064118426,3200565045,1062584117,3212525252,1057898293,3192438637,651444096,657506176,2826977152,681820032
.long 3210067765,1065041604,3205381941,1044954989,1064150961,3200532277,3211602110,1053081397,3192405813,3210067821,3212558133
.long 1057930948,3207970688,1060448084,3207970688,1060480817,1065041717,1057898349,3192438581,1062551236,3200559077,3211640629
.long 1053042922,1064124213,3205414709,3192438468,1062551349,1065041773,0,0,0,0,1044905984
.long 1057898180,1065041792,1062551405,1053032448,1064124213,3200525581,3211640629,1057882112,1065041773,3210067840,1044954820
.long 1060438016,1060454272,1060480397,1060454272,1062535168,1044922221,1057898368,3212558020,1064108032,3200532277,3211601364
.long 1053081397,1065025536,3210034884,3192438656,1057898349,1065353216,3212846349,1065395725,3212846640,1065025536,3210067652
.long 3192405888,1057931117,1064108032,3200565045,3211601456,1053048629,1062535168,1044954989,1057931136,3212525252,1060438016
.long 1060487040,1060480596,1060487040,1057882112,1065074541,3210035072,1044922052,1053032448,1064156981,3200525943,3211607861
.long 1044905984,1057930948,1065074560,1062584173,621608960,634693005,647997069,665953968,3192389632,3205381828,3212525440
.long 3210035053,3200516096,3211607861,1053042335,1064156981,3205365760,3212525421,1062584192,3192438468,3207921664,3207937920
.long 3207964336,3207937920,3210018816,3192405869,3205382016,1065074372,3211591680,1053048629,1064118193,3200565045,3212509184
.long 1062551236,1044955008,3205381997,3212836864,1065362900,3212879572,1065363394,3212509184,1062584004,1044922240,3205414765
.long 3211591680,1053081397,1064150797,3200532277,3210018816,3192438637,3205414784,1065041604,3207921664,3207970688,3207964407
.long 3207970688,3205365760,3212558189,1062551424,3192405700,3200516096,3211640629,1053042626,1064124213,3192389632,3205414596
.long 3212558208,3210067821,0,0,0,0,1062551349,1065041773,1057898293,1044922052,1064124288
.long 1053048629,3211640704,3200565045,1044922165,3210067652,1065041717,1057898349,3207931149,3207970688,3207931348,3207970688
.long 3212558133,1057930948,1044954933,1062551405,3200565120,1064124213,1053048704,3211640629,1057931061,3192405869,3210067765
.long 1065041604,1065395597,3212846548,1065395796,3212846711,1057898293,3192438637,3210034997,1065074372,3200532352,1064156981
.long 1053081472,3211607861,3212525365,1057898180,1044922165,1062584173,3207931348,3207937920,3207931551,3207937920,1044954933
.long 3210034884,1065074485,1057931117,1064157056,1053081397,3211607936,3200532277,1062584117,1065074541,1057931061,1044954820
.long 640722445,645375572,2802689748,667068151,3210034997,3212525421,3205381941,3192405700,3211607936,3200532277,1064157056
.long 1053081397,3192405813,1062584004,3212525365,3205381997,1060447792,1060487040,1060448194,1060487040,1065074485,3205414596
.long 3192438581,3210035053,1053081472,3211607861,3200532352,1064156981,3205414709,1044922221,1062584117,3212525252,3212879444
.long 1065363103,3212879647,1065395853,3205381941,1044954989,1062551349,3212558020,1053048704,3211640629,3200565120,1064124213
.long 1065041717,3205381828,3192405813,3210067821,1060447863,1060454272,1060480653,1060454272,3192438581,1062551236,3212558133
.long 3205414765,3211640704,3200565045,1064124288,1053048629,3210067765,3212558189,3205414709,3192438468,0,0
.long 0,0,3192399117,3205414596,3212558208,3210067821,1053074829,1064124213,3200525780,3211640629,3205375444
.long 3212558189,1062551424,3192405700,1060480525,1060454272,1060480596,1060454272,3210028592,3192438637,3205414784,1065041604
.long 1064150612,3200532277,3211601567,1053081397,3212519031,1062584004,1044922240,3205414765,1065395853,3212846751,1065395924
.long 3212879629,3212519071,1062551236,1044955008,3205381997,1064150704,3200565045,3211601858,1053048629,3210028977,3192405869
.long 3205382016,1065074372,1060480724,1060487040,1060480799,1060487040,3205408525,3212525421,1062584192,3192438468,1053075191
.long 1064156981,3200558733,3211607861,3192399810,3205381828,3212525440,3210035053,2798954253,668247839,2785978196,670508941
.long 1044948692,1057930948,1065074560,1062584173,3200558879,3211607861,1053042679,1064156981,1057892308,1065074541,3210035072
.long 1044922052,3207964464,3207937920,3207964738,3207937920,1062577805,1044954989,1057931136,3212525252,3211634737,1053048629
.long 1064118404,3200565045,1065035749,3210067652,3192405888,1057931117,3212879700,1065363447,3212879775,1065363478,1065068046
.long 3210034884,3192438656,1057898349,3211601805,1053081397,1064150996,3200532277,1062545399,1044922221,1057898368,3212558020
.long 3207964535,3207970688,3207931661,3207970688,1057923511,1065041773,3210067840,1044954820,3200559170,3211640629,1053042953
.long 1064124213,1044916228,1057898180,1065041792,1062551405,0,0,0,0,3210067765,3212558189
.long 3205414709,3192438468,1064124288,1053048629,3211640704,3200565045,3192438581,1062551236,3212558133,3205414765,3207931440
.long 3207970688,3207931511,3207970688,1065041717,3205381828,3192405813,3210067821,3200565120,1064124213,1053048704,3211640629
.long 3205381941,1044954989,1062551349,3212558020,1065395888,3212847025,1065395959,3212847042,3205414709,1044922221,1062584117
.long 3212525252,3200532352,1064156981,1053081472,3211607861,1065074485,3205414596,3192438581,3210035053,3207931842,3207937920
.long 3207964301,3207937920,3192405813,1062584004,3212525365,3205381997,1064157056,1053081397,3211607936,3200532277,3210034997
.long 3212525421,3205381941,3192405700,2794301232,669362225,2713167735,671393858,1062584117,1065074541,1057931061,1044954820
.long 3211607936,3200532277,1064157056,1053081397,1044954933,3210034884,1065074485,1057931117,1060480526,1060487040,1060448269
.long 1060487040,3212525365,1057898180,1044922165,1062584173,1053081472,3211607861,3200532352,1064156981,1057898293,3192438637
.long 3210034997,1065074372,3212879938,1065362957,3212846861,1065363213,1057931061,3192405869,3210067765,1065041604,1053048704
.long 3211640629,3200565120,1064124213,3212558133,1057930948,1044954933,1062551405,1060448269,1060454272,1060448406,1060454272
.long 1044922165,3210067652,1065041717,1057898349,3211640704,3200565045,1064124288,1053048629,1062551349,1065041773,1057898293
.long 1044922052,2147516416,2147516416,2147516416,2147516416,3192422400,3205414596,3212558208,3210067821,3200548864,3211640629
.long 1053074701,1064124213,3205398528,3212558189,1062551424,3192405700,3207954432,3207970688,3207931277,3207970688,3210051584
.long 3192438637,3205414784,1065041604,3211624448,1053081397,1064150484,3200532277,3212541952,1062584004,1044922240,3205414765
.long 3212869632,1065395469,3212846605,1065395760,3212541952,1062551236,1044955008,3205381997,3211624448,1053048629,1064150576
.long 3200565045,3210051584,3192405869,3205382016,1065074372,3207954432,3207937920,3207931476,3207937920,3205398528,3212525421
.long 1062584192,3192438468,3200548864,3211607861,1053075063,1064156981,3192422400,3205381828,3212525440,3210035053,2769125376
.long 2782143885,2795447949,2813404848,1044938752,1057930948,1065074560,1062584173,1053065216,1064156981,3200558751,3211607861
.long 1057914880,1065074541,3210035072,1044922052,1060470784,1060487040,1060447920,1060487040,1062567936,1044954989,1057931136
.long 3212525252,1064140800,3200565045,3211634609,1053048629,1065058304,3210067652,3192405888,1057931117,1065385984,3212879316
.long 1065363156,3212879810,1065058304,3210034884,3192438656,1057898349,1064140800,3200532277,3211601677,1053081397,1062567936
.long 1044922221,1057898368,3212558020,1060470784,1060454272,1060447991,1060454272,1057914880,1065041773,3210067840,1044954820
.long 1053065216,1064124213,3200559042,3211640629,1044938752,1057898180,1065041792,1062551405,2147516416,2147516416,2147516416
.long 2147516416,3210067765,3212558189,3205414709,3192438468,3211640704,3200565045,1064124288,1053048629,3192438581,1062551236
.long 3212558133,3205414765,1060480269,1060454272,1060480468,1060454272,1065041717,3205381828,3192405813,3210067821,1053048704
.long 3211640629,3200565120,1064124213,3205381941,1044954989,1062551349,3212558020,3212846477,1065395668,3212846676,1065395831
.long 3205414709,1044922221,1062584117,3212525252,1053081472,3211607861,3200532352,1064156981,1065074485,3205414596,3192438581
.long 3210035053,1060480468,1060487040,1060480671,1060487040,3192405813,1062584004,3212525365,3205381997,3211607936,3200532277
.long 1064157056,1053081397,3210034997,3212525421,3205381941,3192405700,2788173325,2792826452,655173332,2814519031,1062584117
.long 1065074541,1057931061,1044954820,1064157056,1053081397,3211607936,3200532277,1044954933,3210034884,1065074485,1057931117
.long 3207964208,3207937920,3207964610,3207937920,3212525365,1057898180,1044922165,1062584173,3200532352,1064156981,1053081472
.long 3211607861,1057898293,3192438637,3210034997,1065074372,1065363028,3212879519,1065363231,3212846733,1057931061,3192405869
.long 3210067765,1065041604,3200565120,1064124213,1053048704,3211640629,3212558133,1057930948,1044954933,1062551405,3207964279
.long 3207970688,3207931533,3207970688,1044922165,3210067652,1065041717,1057898349,1064124288,1053048629,3211640704,3200565045
.long 1062551349,1065041773,1057898293,1044922052,2147516416,2147516416,2147516416,2147516416,1044948237,1057898180,1065041792
.long 1062551405,3200525709,3211640629,1053074900,1064124213,1057924564,1065041773,3210067840,1044954820,3207931405,3207970688
.long 3207931476,3207970688,1062577712,1044922221,1057898368,3212558020,3211601492,1053081397,1064150687,3200532277,1065068151
.long 3210034884,3192438656,1057898349,3212846733,1065395871,3212846804,1065363213,1065068191,3210067652,3192405888,1057931117
.long 3211601584,1053048629,1064150978,3200565045,1062578097,1044954989,1057931136,3212525252,3207931604,3207937920,3207931679
.long 3207937920,1057892109,1065074541,3210035072,1044922052,3200526071,3211607861,1053042317,1064156981,1044948930,1057930948
.long 1065074560,1062584173,651437837,2815698719,638461780,2818025357,3192399572,3205381828,3212525440,3210035053,1053042463
.long 1064156981,3200559095,3211607861,3205408724,3212525421,1062584192,3192438468,1060448048,1060487040,1060448322,1060487040
.long 3210028685,3192405869,3205382016,1065074372,1064118321,3200565045,3211634820,1053048629,3212552165,1062551236,1044955008
.long 3205381997,1065363284,3212879863,1065363359,3212879894,3212518926,1062584004,1044922240,3205414765,1064150925,3200532277
.long 3211601876,1053081397,3210061815,3192438637,3205414784,1065041604,1060448119,1060454272,1060480781,1060454272,3205374391
.long 3212558189,1062551424,3192405700,1053042754,1064124213,3200559369,3211640629,3192432644,3205414596,3212558208,3210067821
.long 2147516416,2147516416,2147516416,2147516416,1062551349,1065041773,1057898293,1044922052,3211640704,3200565045,1064124288
.long 1053048629,1044922165,3210067652,1065041717,1057898349,1060480560,1060454272,1060480631,1060454272,3212558133,1057930948
.long 1044954933,1062551405,1053048704,3211640629,3200565120,1064124213,1057931061,3192405869,3210067765,1065041604,3212846768
.long 1065396145,3212846839,1065396162,1057898293,3192438637,3210034997,1065074372,1053081472,3211607861,3200532352,1064156981
.long 3212525365,1057898180,1044922165,1062584173,1060480962,1060487040,1060447885,1060487040,1044954933,3210034884,1065074485
.long 1057931117,3211607936,3200532277,1064157056,1053081397,1062584117,1065074541,1057931061,1044954820,646784816,2816813105
.long 565651319,2818844738,3210034997,3212525421,3205381941,3192405700,1064157056,1053081397,3211607936,3200532277,3192405813
.long 1062584004,3212525365,3205381997,3207931406,3207937920,3207964685,3207937920,1065074485,3205414596,3192438581,3210035053
.long 3200532352,1064156981,1053081472,3211607861,3205414709,1044922221,1062584117,3212525252,1065363522,3212879373,1065395981
.long 3212879629,3205381941,1044954989,1062551349,3212558020,3200565120,1064124213,1053048704,3211640629,1065041717,3205381828
.long 3192405813,3210067821,3207964685,3207970688,3207964822,3207970688,3192438581,1062551236,3212558133,3205414765,1064124288
.long 1053048629,3211640704,3200565045,3210067765,3212558189,3205414709,3192438468,1065353216,1065353216,1065353216,1065353216
.long 1065353216,1065352407,1065349982,1065345940,1065353216,1065349982,1065340281,1065324118,1065353216,1065345940,1065324118
.long 1065287769,1065353216,1065340281,1065301497,1065236924,1065353216,1065333007,1065272429,1065171628,1065353216,1065324118
.long 1065236924,1065091937,1065353216,1065313614,1065194996,1064997921,1065353216,1065301497,1065146661,1064889660,1065353216
.long 1065287769,1065091937,1064767249,1065353216,1065272429,1065030846,1064630795,1065353216,1065255480,1064963412,1064480414
.long 1065353216,1065236924,1064889660,1064316239,1065353216,1065216762,1064809619,1064138410,1065353216,1065194996,1064723319
.long 1063947083,1065353216,1065171628,1064630795,1063742424,1065353216,1065146661,1064532081,1063524609,1065353216,1065120096
.long 1064427215,1063293828,1065353216,1065091937,1064316239,1063050281,1065353216,1065062186,1064199194,1062794180,1065353216
.long 1065030846,1064076126,1062525745,1065353216,1064997921,1063947083,1062245211,1065353216,1064963412,1063812114,1061952821
.long 1065353216,1064927324,1063671271,1061648828,1065353216,1064889660,1063524609,1061333495,1065353216,1064850424,1063372184
.long 1061007097,1065353216,1064809619,1063214054,1060669916,1065353216,1064767249,1063050281,1060322246,1065353216,1064723319
.long 1062880928,1059964387,1065353216,1064677833,1062706060,1059596650,1065353216,1064630795,1062525745,1059219353,1065353216
.long 1064582209,1062340052,1058832825,1065353216,1065353216,1065353216,1065353216,1065340281,1065333007,1065324118,1065313614
.long 1065301497,1065272429,1065236924,1065194996,1065236924,1065171628,1065091937,1064997921,1065146661,1065030846,1064889660
.long 1064723319,1065030846,1064850424,1064630795,1064372488,1064889660,1064630795,1064316239,1063947083,1064723319,1064372488
.long 1063947083,1063449113,1064532081,1064076126,1063524609,1062880928,1064316239,1063742424,1063050281,1062245211,1064076126
.long 1063372184,1062525745,1061544963,1063812114,1062966298,1061952821,1060783490,1063524609,1062525745,1061333495,1059964387
.long 1063214054,1062051586,1060669916,1059091520,1062880928,1061544963,1059964387,1058169010,1062525745,1061007097,1059219353
.long 1057201213,1062149053,1060439283,1058437400,1055420785,1061751432,1059842890,1057621240,1053331838,1061333495,1059219353
.long 1056582800,1051180837,1060895887,1058570176,1054830856,1048977936,1060439283,1057896922,1053028117,1044891074,1059964387
.long 1057201213,1051180837,1040340468,1059471930,1056004842,1049295422,1030824579,1058962673,1054533760,1046180828,3156269266
.long 1058437400,1053028117,1042296923,3181424426,1057896922,1051491540,1036565814,3189129347,1057342071,1049927729,1025560295
.long 3193664476,1056582800,1048104908,3164657366,3197095678,1055420785,1044891074,3181424426,3199284801,1054235282,1041645699
.long 3188477175,3201419097,1053028117,1036565814,3192374722,3203488490,1051801153,1028193072,3196143251,3204965733,1065353216
.long 1065353216,1065353216,1065353216,1065301497,1065287769,1065272429,1065255480,1065146661,1065091937,1065030846,1064963412
.long 1064889660,1064767249,1064630795,1064480414,1064532081,1064316239,1064076126,1063812114,1064076126,1063742424,1063372184
.long 1062966298,1063524609,1063050281,1062525745,1061952821,1062880928,1062245211,1061544963,1060783490,1062149053,1061333495
.long 1060439283,1059471930,1061333495,1060322246,1059219353,1058033422,1060439283,1059219353,1057896922,1056004842,1059471930
.long 1058033422,1056004842,1052723159,1058437400,1056582800,1053028117,1049295422,1057342071,1053935449,1049927729,1042947135
.long 1055420785,1051180837,1044891074,1030824579,1053028117,1048104908,1036565814,3175676720,1050556282,1042296923,613232946
.long 3189780571,1047465037,1032626674,3184049462,3196461584,1042296923,3164657366,3192374722,3199900641,1033940778,3185360141
.long 3197411377,3203197210,613232946,3192374722,3200511765,3205380570,3181424426,3197095678,3203488490,3206829809,3189780571
.long 3199900641,3205380570,3208153564,3194948685,3202610189,3206703001,3209336414,3198039930,3204825719,3207922931,3210364576
.long 3200511765,3206053824,3209028611,3211226072,3202904433,3207203955,3210009393,3211910863,3204825719,3208267138,3210855832
.long 3212410972,3205921048,3209235080,3211559774,3212720572,3206955578,3210100227,3212114443,3212836055,3207922931,3210855832
.long 3212514494,3212756077,3208817143,3211495997,3212756077,3212481569,1065353216,1065353216,1065353216,1065353216,1065236924
.long 1065216762,1065194996,1065171628,1064889660,1064809619,1064723319,1064630795,1064316239,1064138410,1063947083,1063742424
.long 1063524609,1063214054,1062880928,1062525745,1062525745,1062051586,1061544963,1061007097,1061333495,1060669916,1059964387
.long 1059219353,1059964387,1059091520,1058169010,1057201213,1058437400,1057342071,1055420785,1053028117,1056582800,1053935449
.long 1051180837,1048104908,1053028117,1049927729,1044891074,1036565814,1049295422,1042947135,1030824579,3175676720,1042296923
.long 1025560295,3181424426,3192374722,1025560295,3182737514,3193664476,3198975188,3181424426,3193664476,3199284801,3203488490
.long 3192374722,3198975188,3203488490,3206053824,3198039930,3202904433,3205921048,3207922931,3201718930,3205517070,3207687724
.long 3209535234,3204825719,3207203955,3209235080,3210855832,3206446321,3208709560,3210533929,3211856136,3207922931,3210009393
.long 3211559774,3212514494,3209235080,3211082312,3212293267,3212816655,3210364576,3211910863,3212720572,3212756077,3211295762
.long 3212481569,3212833630,3212334072,3212015729,3212785145,3212630309,3211559774,3212514494,3212816655,3212114443,3210449946
.long 3212785145,3212575585,3211295762,3209028611,3212823929,3212065857,3210189708,3207326538,3212630309,3211295762,3208817143
.long 3205380570,3212206967,3210277828,3207203955,3202017408,3211559774,3209028611,3205380570,3197411377,3210697702,3207568434
.long 3202314504,3189129347,1065353216,1065353216,1065353216,1065353216,1065146661,1065120096,1065091937,1065062186,1064532081
.long 1064427215,1064316239,1064199194,1063524609,1063293828,1063050281,1062794180,1062149053,1061751432,1061333495,1060895887
.long 1060439283,1059842890,1059219353,1058570176,1058437400,1057621240,1056582800,1054830856,1055420785,1053331838,1051180837
.long 1048977936,1050556282,1047465037,1042296923,1033940778,1042296923,1032626674,3164657366,3185360141,613232946,3184049462
.long 3192374722,3197411377,3189780571,3196461584,3199900641,3203197210,3198039930,3201718930,3204825719,3206446321,3202904433
.long 3205517070,3207203955,3208709560,3205921048,3207687724,3209235080,3210533929,3207922931,3209535234,3210855832,3211856136
.long 3209632701,3211008257,3212015729,3212630309,3211008257,3212065857,3212678644,3212829588,3212015729,3212678644,3212823929
.long 3212447060,3212630309,3212829588,3212447060,3211495997,3212836864,3212514494,3211559774,3210009393,3212630309,3211742120
.long 3210189708,3208038825,3212015729,3210533929,3208379535,3205652658,3211008257,3208923497,3206185636,3201419097,3209632701
.long 3206955578,3202904433,3194948685,3207922931,3204684861,3197411377,3175676720,3205921048,3199900641,3186669426,1040993527
.long 3202904433,3193020261,1030824579,1050869074,3198039930,3173043943,1047465037,1056582800,3189780571,1040340468,1053634291
.long 1059346161,2773731786,1049927729,1057896922,1061544963,1042296923,1055126541,1060204076,1063293828,1065353216,1065353216
.long 1065353216,1065353216,1065030846,1064997921,1064963412,1064927324,1064076126,1063947083,1063812114,1063671271,1062525745
.long 1062245211,1061952821,1061648828,1060439283,1059964387,1059471930,1058962673,1057896922,1057201213,1056004842,1054533760
.long 1053028117,1051180837,1049295422,1046180828,1044891074,1040340468,1030824579,3156269266,613232946,3181424426,3189780571
.long 3194948685,3192374722,3197095678,3199900641,3202610189,3200511765,3203488490,3205380570,3206703001,3205380570,3206829809
.long 3208153564,3209336414,3207922931,3209235080,3210364576,3211295762,3210009393,3211082312,3211910863,3212481569,3211559774
.long 3212293267,3212720572,3212833630,3212514494,3212816655,3212756077,3212334072,3212836864,3212630309,3212015729,3211008257
.long 3212514494,3211742120,3210533929,3208923497,3211559774,3210189708,3208379535,3206185636,3210009393,3208038825,3205652658
.long 3201419097,3207922931,3205380570,3200511765,3192374722,3205380570,3200206807,3191079921,1022442828,3200511765,3191079921
.long 1025560295,1048659603,3192374722,1022442828,1048659603,1055713562,2773731786,1047465037,1055420785,1059471930,1044891074
.long 1054533760,1059219353,1062051586,1053028117,1058701988,1061751432,1063947083,1057896922,1061225912,1063671271,1065062186
.long 1060439283,1063214054,1064889660,1065340281,1062525745,1064582209,1065349982,1064767249,1064076126,1065272429,1065030846
.long 1063372184,1065030846,1065255480,1063947083,1061225912,1065353216,1065353216,1065353216,1065353216,1064889660,1064850424
.long 1064809619,1064767249,1063524609,1063372184,1063214054,1063050281,1061333495,1061007097,1060669916,1060322246,1058437400
.long 1057896922,1057342071,1056582800,1053028117,1051491540,1049927729,1048104908,1042296923,1036565814,1025560295,3164657366
.long 3181424426,3189129347,3193664476,3197095678,3198039930,3200511765,3202904433,3204825719,3204825719,3206053824,3207203955
.long 3208267138,3207922931,3209028611,3210009393,3210855832,3210364576,3211226072,3211910863,3212410972,3212015729,3212514494
.long 3212785145,3212823929,3212785145,3212816655,3212575585,3212065857,3212630309,3212114443,3211295762,3210189708,3211559774
.long 3210449946,3209028611,3207326538,3209632701,3207922931,3205921048,3202904433,3206955578,3204684861,3199900641,3193020261
.long 3202904433,3197411377,3186669426,1030824579,3194948685,3175676720,1040993527,1050869074,2773731786,1044891074,1053028117
.long 1057896922,1047465037,1054533760,1058701988,1061225912,1055420785,1059219353,1061751432,1063671271,1059471930,1062051586
.long 1063947083,1065062186,1062149053,1064076126,1065146661,1065301497,1064076126,1065171628,1065272429,1064372488,1065146661
.long 1065272429,1064316239,1062340052,1065301497,1064372488,1062340052,1059346161,1064532081,1062525745,1059471930,1054235282
.long 1062880928,1059842890,1054830856,1042947135,1060439283,1056004842,1044891074,3184049462,1057342071,1048104908,3178308227
.long 3199593295,1065353216,1065353216,1065353216,1065353216,1064723319,1064677833,1064630795,1064582209,1062880928,1062706060
.long 1062525745,1062340052,1059964387,1059596650,1059219353,1058832825,1055420785,1054235282,1053028117,1051801153,1044891074
.long 1041645699,1036565814,1028193072,3181424426,3188477175,3192374722,3196143251,3199284801,3201419097,3203488490,3204965733
.long 3205921048,3206955578,3207922931,3208817143,3209235080,3210100227,3210855832,3211495997,3211559774,3212114443,3212514494
.long 3212756077,3212720572,3212836055,3212756077,3212481569,3212630309,3212206967,3211559774,3210697702,3211295762,3210277828
.long 3209028611,3207568434,3208817143,3207203955,3205380570,3202314504,3205380570,3202017408,3197411377,3189129347,3198039930
.long 3189780571,2773731786,1042296923,3173043943,1040340468,1049927729,1055126541,1047465037,1053634291,1057896922,1060204076
.long 1056582800,1059346161,1061544963,1063293828,1060439283,1062525745,1064076126,1065030846,1063214054,1064582209,1065272429
.long 1065255480,1064889660,1065349982,1065030846,1063947083,1065340281,1064767249,1063372184,1061225912,1064532081,1062880928
.long 1060439283,1057342071,1062525745,1059842890,1056004842,1048104908,1059471930,1054830856,1044891074,3178308227,1054235282
.long 1042947135,3184049462,3199593295,1042296923,3186669426,3200511765,3206446321,3186669426,3200815486,3206703001,3209917215
.long 3200511765,3206703001,3210009393,3212114443,3206446321,3209917215,3212114443,3212836055,0,0,0
.long 0,0,1008785618,1017173718,1022442828,0,1017173718,1025560295,1030824579,0,1022442828
.long 1030824579,1035253866,0,1025560295,1033940778,1039185778,0,1028193072,1036565814,1041645699,0
.long 1030824579,1039185778,1043596273,0,1032626674,1040993527,1045536613,0,1033940778,1042296923,1047465037
.long 0,1035253866,1043596273,1048977936,0,1036565814,1044891074,1049927729,0,1037876493,1046180828
.long 1050869074,0,1039185778,1047465037,1051801153,0,1040340468,1048659603,1052723159,0,1040993527
.long 1049295422,1053634291,0,1041645699,1049927729,1054533760,0,1042296923,1050556282,1055420785,0
.long 1042947135,1051180837,1056294597,0,1043596273,1051801153,1057059523,0,1044244273,1052416993,1057482085
.long 0,1044891074,1053028117,1057896922,0,1045536613,1053634291,1058303674,0,1046180828,1054235282
.long 1058701988,0,1046823657,1054830856,1059091520,0,1047465037,1055420785,1059471930,0,1048104908
.long 1056004842,1059842890,0,1048659603,1056582800,1060204076,0,1048977936,1057059523,1060555177,0
.long 1049295422,1057342071,1060895887,0,1049612030,1057621240,1061225912,0,1049927729,1057896922,1061544963
.long 0,1050242490,1058169010,1061852766,0,0,0,0,1025560295,1028193072,1030824579
.long 1032626674,1033940778,1036565814,1039185778,1040993527,1039185778,1041645699,1043596273,1045536613,1042296923,1044891074
.long 1047465037,1049295422,1044891074,1048104908,1049927729,1051491540,1047465037,1049927729,1051801153,1053634291,1049295422
.long 1051491540,1053634291,1055713562,1050556282,1053028117,1055420785,1057342071,1051801153,1054533760,1057059523,1058303674
.long 1053028117,1056004842,1057896922,1059219353,1054235282,1057201213,1058701988,1060084786,1055420785,1057896922,1059471930
.long 1060895887,1056582800,1058570176,1060204076,1061648828,1057342071,1059219353,1060895887,1062340052,1057896922,1059842890
.long 1061544963,1062966298,1058437400,1060439283,1062149053,1063524609,1058962673,1061007097,1062706060,1064012349,1059471930
.long 1061544963,1063214054,1064427215,1059964387,1062051586,1063671271,1064767249,1060439283,1062525745,1064076126,1065030846
.long 1060895887,1062966298,1064427215,1065216762,1061333495,1063372184,1064723319,1065324118,1061751432,1063742424,1064963412
.long 1065352407,1062149053,1064076126,1065146661,1065301497,1062525745,1064372488,1065272429,1065171628,1062880928,1064630795
.long 1065340281,1064963412,1063214054,1064850424,1065349982,1064677833,1063524609,1065030846,1065301497,1064316239,1063812114
.long 1065171628,1065194996,1063880336,1064076126,1065272429,1065030846,1063372184,1064316239,1065333007,1064809619,1062794180
.long 0,0,0,0,1033940778,1035253866,1036565814,1037876493,1042296923,1043596273,1044891074
.long 1046180828,1047465037,1048977936,1049927729,1050869074,1050556282,1051801153,1053028117,1054235282,1053028117,1054533760
.long 1056004842,1057201213,1055420785,1057059523,1057896922,1058701988,1057342071,1058303674,1059219353,1060084786,1058437400
.long 1059471930,1060439283,1061333495,1059471930,1060555177,1061544963,1062433567,1060439283,1061544963,1062525745,1063372184
.long 1061333495,1062433567,1063372184,1064138410,1062149053,1063214054,1064076126,1064723319,1062880928,1063880336,1064630795
.long 1065120096,1063524609,1064427215,1065030846,1065324118,1064076126,1064850424,1065272429,1065333007,1064532081,1065146661
.long 1065353216,1065146661,1064889660,1065313614,1065272429,1064767249,1065146661,1065349982,1065030846,1064199194,1065301497
.long 1065255480,1064630795,1063449113,1065353216,1065030846,1064076126,1062525745,1065301497,1064677833,1063372184,1061439849
.long 1065146661,1064199194,1062525745,1060204076,1064889660,1063598664,1061544963,1058832825,1064532081,1062880928,1060439283
.long 1057342071,1064076126,1062051586,1059219353,1054533760,1063524609,1061117109,1057896922,1051180837,1062880928,1060084786
.long 1056004842,1046823657,1062149053,1058962673,1053028117,1039185778,1061333495,1057759524,1049927729,1008785618,1060439283
.long 1056004842,1044891074,3184049462,1059471930,1053331838,1036565814,3193020261,0,0,0,0
.long 1039185778,1040340468,1040993527,1041645699,1047465037,1048659603,1049295422,1049927729,1051801153,1052723159,1053634291
.long 1054533760,1055420785,1056582800,1057342071,1057896922,1057896922,1058570176,1059219353,1059842890,1059471930,1060204076
.long 1060895887,1061544963,1060895887,1061648828,1062340052,1062966298,1062149053,1062880928,1063524609,1064076126,1063214054
.long 1063880336,1064427215,1064850424,1064076126,1064630795,1065030846,1065272429,1064723319,1065120096,1065324118,1065333007
.long 1065146661,1065340281,1065301497,1065030846,1065340281,1065287769,1064963412,1064372488,1065301497,1064963412,1064316239
.long 1063372184,1065030846,1064372488,1063372184,1062051586,1064532081,1063524609,1062149053,1060439283,1063812114,1062433567
.long 1060669916,1058570176,1062880928,1061117109,1058962673,1056004842,1061751432,1059596650,1057059523,1051491540,1060439283
.long 1057896922,1053028117,1044891074,1058962673,1055126541,1048659603,1028193072,1057342071,1051180837,1039185778,3184049462
.long 1054235282,1045536613,3164657366,3195588556,1050556282,1033940778,3189780571,3200511765,1044891074,3175676720,3197411377
.long 3204684861,1033940778,3191079921,3201718930,3206703001,3173043943,3197726138,3205104888,3208490745,3189780571,3201718930
.long 3206955578,3210009393,3196779070,3204965733,3208600757,3211226072,3200511765,3206703001,3210009393,3212114443,3204066448
.long 3208267138,3211154919,3212655276,0,0,0,0,1042296923,1042947135,1043596273,1044244273
.long 1050556282,1051180837,1051801153,1052416993,1055420785,1056294597,1057059523,1057482085,1058437400,1058962673,1059471930
.long 1059964387,1060439283,1061007097,1061544963,1062051586,1062149053,1062706060,1063214054,1063671271,1063524609,1064012349
.long 1064427215,1064767249,1064532081,1064889660,1065146661,1065301497,1065146661,1065313614,1065349982,1065255480,1065353216
.long 1065272429,1065030846,1064630795,1065146661,1064767249,1064199194,1063449113,1064532081,1063812114,1062880928,1061751432
.long 1063524609,1062433567,1061117109,1059596650,1062149053,1060669916,1058962673,1057059523,1060439283,1058570176,1056004842
.long 1051491540,1058437400,1055420785,1050556282,1042296923,1055420785,1050242490,1040993527,3169926476,1050556282,1040993527
.long 3173043943,3193664476,1042296923,3169926476,3193664476,3200815486,621621554,3192374722,3200511765,3205380570,3189780571
.long 3199593295,3205104888,3207805894,3198039930,3204543171,3207448035,3209823700,3202904433,3206829809,3209436469,3211363984
.long 3205921048,3208817143,3211008257,3212373308,3207922931,3210449946,3212114443,3212816655,3209632701,3211682842,3212720572
.long 3212678644,3211008257,3212481569,3212807766,3211964062,3212015729,3212823929,3212373308,3210697702,3212630309,3212700410
.long 3211430731,3208923497,3212836864,3212114443,3210009393,3206703001,3212630309,3211082312,3208153564,3203778245,0
.long 0,0,0,1044891074,1045536613,1046180828,1046823657,1053028117,1053634291,1054235282,1054830856
.long 1057896922,1058303674,1058701988,1059091520,1060439283,1060895887,1061333495,1061751432,1062525745,1062966298,1063372184
.long 1063742424,1064076126,1064427215,1064723319,1064963412,1065030846,1065216762,1065324118,1065352407,1065353216,1065301497
.long 1065146661,1064889660,1065030846,1064677833,1064199194,1063598664,1064076126,1063372184,1062525745,1061544963,1062525745
.long 1061439849,1060204076,1058832825,1060439283,1058962673,1057342071,1054235282,1057896922,1055126541,1051180837,1045536613
.long 1053028117,1048659603,1039185778,3164657366,1044891074,1028193072,3184049462,3195588556,621621554,3189780571,3198039930
.long 3202904433,3192374722,3199593295,3204543171,3206829809,3200511765,3205104888,3207448035,3209436469,3205380570,3207805894
.long 3209823700,3211363984,3207922931,3210009393,3211559774,3212514494,3210009393,3211622058,3212575585,3212829588,3211559774
.long 3212575585,3212823929,3212293267,3212514494,3212829588,3212293267,3210932761,3212836864,3212373308,3211008257,3208817143
.long 3212514494,3211226072,3209028611,3206053824,3211559774,3209436469,3206446321,3201117939,3210009393,3207080298,3202314504
.long 3191727921,3207922931,3204066448,3194948685,1025560295,3205380570,3197726138,3164657366,1048977936,3200511765,3184049462
.long 1044891074,1056004842,3192374722,1037876493,1053634291,1059596650,0,0,0,0,1047465037
.long 1048104908,1048659603,1048977936,1055420785,1056004842,1056582800,1057059523,1059471930,1059842890,1060204076,1060555177
.long 1062149053,1062525745,1062880928,1063214054,1064076126,1064372488,1064630795,1064850424,1065146661,1065272429,1065340281
.long 1065349982,1065301497,1065171628,1064963412,1064677833,1064532081,1064076126,1063524609,1062880928,1062880928,1062051586
.long 1061117109,1060084786,1060439283,1059219353,1057896922,1056004842,1057342071,1054533760,1051180837,1046823657,1050556282
.long 1044891074,1033940778,3173043943,1033940778,3175676720,3191079921,3197726138,3189780571,3197411377,3201718930,3205104888
.long 3200511765,3204684861,3206703001,3208490745,3205921048,3207922931,3209632701,3211008257,3208817143,3210449946,3211682842
.long 3212481569,3211008257,3212114443,3212720572,3212807766,3212373308,3212816655,3212678644,3211964062,3212836864,3212514494
.long 3211559774,3210009393,3212373308,3211226072,3209436469,3207080298,3211008257,3209028611,3206446321,3202314504,3208817143
.long 3206053824,3201117939,3191727921,3205921048,3200511765,3189780571,1033940778,3200511765,3189129347,1036565814,1051491540
.long 3189780571,1036565814,1051801153,1058169010,1033940778,1051491540,1058169010,1061439849,1050556282,1057896922,1061333495
.long 1063812114,1057342071,1061007097,1063671271,1065120096,1060439283,1063372184,1065030846,1065272429,1062880928,1064850424
.long 1065324118,1064258472,0,0,0,0,1049295422,1049612030,1049927729,1050242490,1057342071
.long 1057621240,1057896922,1058169010,1060895887,1061225912,1061544963,1061852766,1063524609,1063812114,1064076126,1064316239
.long 1065030846,1065171628,1065272429,1065333007,1065301497,1065194996,1065030846,1064809619,1064316239,1063880336,1063372184
.long 1062794180,1062149053,1061333495,1060439283,1059471930,1058962673,1057759524,1056004842,1053331838,1053028117,1049927729
.long 1044891074,1036565814,1039185778,1008785618,3184049462,3193020261,3189780571,3196779070,3200511765,3204066448,3201718930
.long 3204965733,3206703001,3208267138,3206955578,3208600757,3210009393,3211154919,3210009393,3211226072,3212114443,3212655276
.long 3212015729,3212630309,3212836864,3212630309,3212823929,3212700410,3212114443,3211082312,3212373308,3211430731,3210009393
.long 3208153564,3210697702,3208923497,3206703001,3203778245,3207922931,3205380570,3200511765,3192374722,3204066448,3197726138
.long 3184049462,1037876493,3194948685,3164657366,1044891074,1053634291,1025560295,1048977936,1056004842,1059596650,1050556282
.long 1057342071,1060439283,1062880928,1057896922,1061007097,1063372184,1064850424,1061333495,1063671271,1065030846,1065324118
.long 1063812114,1065120096,1065272429,1064258472,1065146661,1065236924,1064076126,1061751432,1065236924,1064012349,1061544963
.long 1058033422,1064076126,1061544963,1057896922,1049927729,1061751432,1058033422,1049927729,3156269266,2147497361,2147497361
.long 2147497361,2147497361,2147497361,3031643530,3039442282,3043636522,2147497361,3039442282,3045733555,3045766323,2147497361
.long 3043636522,3045766323,3031676298,2147497361,3045733555,3039475050,891991402,2147497361,3046185632,2602612113,898734960
.long 2147497361,3045766323,891991402,891958634,2147497361,3043669290,898282675,3031643530,2147497361,3039475050,898249907
.long 3045733555,2147497361,3031676298,891958634,3043669290,2147497361,2602612113,463484305,2616243601,2147497361,884192650
.long 3039442282,896185642,2147497361,891991402,3045733555,898249907,2147497361,896185642,3045766323,884159882,2147497361
.long 898282675,3039475050,3039442282,2147497361,898734960,2616243601,3046186302,2147497361,898249907,891991402,3039475050
.long 2147497361,896152874,898282675,884192650,2147497361,891958634,898249907,898282675,2147497361,884159882,891958634
.long 896152874,0,0,0,0,0,0,0,0,0,0
.long 0,0,0,0,0,0,0,0,0,0,0
.long 0,0,0,0,0,0,0,0,0,0,0
.long 0,0,0,0,0,0,0,0,0,0,0
.long 0,0,0,0,0,2147497361,2147497361,2147497361,2147497361,3045733555,3046185632
.long 3045766323,3043669290,3039475050,2602612113,891991402,898282675,891991402,898734960,891958634,3031643530,898249907
.long 463484305,3045733555,3039475050,463484305,3046185928,2616243601,898735116,3045733555,2616243601,898249907,3039442282
.long 3039475050,898735116,3039442282,3031676298,891991402,471872913,3039475050,898249907,898249907,3046186036,898282675
.long 3043636522,471872913,2622010769,477115793,2626467217,3045733555,898735432,3045766323,896152874,3039475050,477115793
.long 891991402,3045733555,891991402,3046218912,891958634,884192650,898249907,2626467217,3045733555,891958634,477115793
.long 898735452,2646521233,3046186503,3045733555,480261521,898249907,891991402,3039475050,3046218864,3039442282,884159882
.long 891991402,2629088657,3039475050,3045766323,898249907,898702408,898282675,896185642,0,0,0
.long 0,0,0,0,0,0,0,0,0,0,0
.long 0,0,0,0,0,0,0,0,0,0,0
.long 0,0,0,0,0,0,0,0,0,0,0
.long 0,0,0,0,0,0,0,0,0,0,0
.long 0,2147497361,2147497361,2147497361,2147497361,3039475050,3031676298,2602612113,884192650,898249907,891958634
.long 463484305,3039442282,3045733555,3043669290,2616243601,896185642,891991402,898249907,471872913,3045733555,471872913
.long 3046186036,2622010769,898702516,3039475050,898282675,477115793,3045766323,898249907,3043636522,2626467217,896152874
.long 3045733555,891991402,480261521,3039475050,891991402,3031643530,2629088657,884159882,480261521,2629088657,482882961
.long 489993617,3039475050,884159882,2647176593,3031643530,898249907,3039475050,485504401,891991402,3045733555,896152874
.long 488682897,3043636522,891991402,3045766323,487339409,898282675,485504401,898735500,2648487313,3046186518,3039475050
.long 3045733555,488650129,898249907,898249907,896185642,485537169,3043669290,3045733555,3039442282,489960849,891958634
.long 891991402,884192650,482915729,3031676298,0,0,0,0,0,0,0
.long 0,0,0,0,0,0,0,0,0,0,0
.long 0,0,0,0,0,0,0,0,0,0,0
.long 0,0,0,0,0,0,0,0,0,0,0
.long 0,0,0,0,0,0,0,0,2147497361,2147497361,2147497361
.long 2147497361,891991402,896185642,898282675,898734960,3045733555,3045766323,3039475050,2616243601,898249907,884159882
.long 3039442282,3046186036,3039475050,891991402,898249907,477115793,477115793,3046186322,2626467217,898735452,891991402
.long 891958634,3045733555,2629088657,3045733555,884192650,891958634,3046218784,898249907,3045733555,891991402,485504401
.long 3039475050,896152874,3045766323,898735500,485504401,2647831953,487339409,2648487313,891991402,3043636522,898282675
.long 3046186518,3045733555,898249907,3039475050,489960849,898249907,3031676298,3039442282,898702704,3039475050,3039442282
.long 898249907,480294289,507393425,898735530,2659693969,3046186144,891991402,3039475050,3045733555,493893009,3045733555
.long 3031643530,891958634,898735560,898249907,898282675,891991402,2651633041,3039475050,3043669290,3045766323,3046186548
.long 0,0,0,0,0,0,0,0,0,0,0
.long 0,0,0,0,0,0,0,0,0,0,0
.long 0,0,0,0,0,0,0,0,0,0,0
.long 0,0,0,0,0,0,0,0,0,0,0
.long 0,0,0,0,2147497361,2147497361,2147497361,2147497361,898249907,896152874,891958634
.long 884159882,891991402,898282675,898249907,891958634,3039475050,884192650,898282675,896152874,3045733555,3039475050
.long 891991402,898249907,480261521,3046218864,2629088657,898702408,898249907,3039442282,3039475050,898282675,891991402
.long 884159882,3045766323,896185642,3039475050,898249907,3045733555,891991402,3045733555,896185642,3039442282,884192650
.long 488650129,485537169,489960849,482915729,898249907,3043669290,891958634,3031676298,891991402,3045733555,898249907
.long 3039475050,3039475050,3031643530,898282675,3043669290,3045733555,891958634,891991402,3045766323,493893009,898735811
.long 2651633041,3046186548,898249907,891991402,3039475050,3045733555,891991402,3031676298,3045766323,3043636522,3039475050
.long 3045766323,3045733555,3039442282,3045733555,3043636522,3039442282,3031643530,0,0,0,0
.long 0,0,0,0,0,0,0,0,0,0,0
.long 0,0,0,0,0,0,0,0,0,0,0
.long 0,0,0,0,0,0,0,0,0,0,0
.long 0,0,0,0,0,0,0,0,0,0,0
.long 0,0,0,0,0,0,0,0,0,0,0
.long 0,0,0,0,0,0,0,0,0,0,0
.long 0,0,0,0,0,0,0,0,0,0,0
.long 0,0,0,0,0,0,0,0,0,0,0
.long 0,0,0,0,0,0,0,0,0,0,0
.long 0,0,0,0,0,0,0,0,0,0,0
.long 0,0,0,0,0,0,0,0,0,0,0
.long 0,0,0,0,0,0,0,0,0,0,0
.long 0,0,0,0,0,0,0,0,0,0,0
.long 0,0,0,0,0,0,0,0,0,0,0
.long 0,0,0,0,0,0,0,0,0,0,0
.long 0,0,0,0,0,0,0,898695168,898695168,898695168,898695168
.long 898695168,898249907,896152874,891958634,898695168,896152874,884159882,3031643530,898695168,891958634,3031643530
.long 3045733555,898695168,884159882,3043636522,3043669290,898695168,446707089,3046185760,2607854993,898695168,3031643530
.long 3043669290,896185642,898695168,3039442282,3031676298,898249907,898695168,3043636522,884192650,884159882,898695168
.long 3045733555,896185642,3039442282,898695168,3046185760,898735008,3046185968,898695168,3045766323,896152874,3039475050
.long 898695168,3043669290,884159882,884192650,898695168,3039475050,3031643530,898282675,898695168,3031676298,3043636522
.long 896152874,898695168,2607854993,3046185968,490616209,898695168,884192650,3043669290,3043636522,898695168,891991402
.long 3031676298,3045766323,898695168,896185642,884192650,3031676298,898695168,898282675,896185642,891991402,0
.long 0,0,0,0,0,0,0,0,0,0,0
.long 0,0,0,0,0,0,0,0,0,0,0
.long 0,0,0,0,0,0,0,0,0,0,0
.long 0,0,0,0,0,0,0,0,0,0,0
.long 0,0,0,898695168,898695168,898695168,898695168,884159882,446707089,3031643530,3039442282
.long 3043636522,3046185760,3043669290,3031676298,3043669290,2607854993,896185642,898249907,884192650,898735008,884159882
.long 3043636522,898735008,466105745,3046185968,2618078609,884159882,3046185968,884192650,896152874,3043636522,2618078609
.long 896152874,3045733555,3043669290,898735136,3043636522,884192650,884192650,473183633,3031676298,891958634,898735136
.long 3046186056,898735216,3046186124,884159882,2638787985,3031643530,891991402,3043636522,898735216,3043669290,884159882
.long 3043669290,2627745169,896185642,3045766323,884192650,3046186124,884159882,896185642,898735216,2640098705,3046186430
.long 503788945,884159882,898735264,884192650,3043669290,3043636522,2624599441,896152874,898282675,3043669290,3046186164
.long 3043636522,3031643530,884192650,474527121,3031676298,3039475050,0,0,0,0,0
.long 0,0,0,0,0,0,0,0,0,0,0
.long 0,0,0,0,0,0,0,0,0,0,0
.long 0,0,0,0,0,0,0,0,0,0,0
.long 0,0,0,0,0,0,0,0,0,0,898695168
.long 898695168,898695168,898695168,3043636522,3045733555,3046185760,3045766323,884192650,896185642,898735008,896152874
.long 884159882,3039442282,3046185968,3039475050,3043669290,884192650,898735136,884159882,898735136,473183633,3046186056
.long 481605009,3043636522,3031676298,898735216,3031643530,884192650,891958634,3046186124,891991402,884159882,3043669290
.long 898735264,3043636522,3043669290,898249907,3046186164,898282675,898735264,3046186164,898735304,3046219060,3043636522
.long 898282675,3046186440,898249907,884192650,3043636522,898735344,3043669290,884159882,891991402,3046219040,891958634
.long 3043669290,3031643530,898735372,3031676298,898735344,2643244433,3046186460,504771985,3043636522,884159882,898735392
.long 884192650,884192650,3039475050,3046218992,3039442282,884159882,896152874,898735412,896185642,3043669290,3045766323
.long 3046218952,3045733555,0,0,0,0,0,0,0,0,0
.long 0,0,0,0,0,0,0,0,0,0,0
.long 0,0,0,0,0,0,0,0,0,0,0
.long 0,0,0,0,0,0,0,0,0,0,0
.long 0,0,0,0,0,0,898695168,898695168,898695168,898695168,3043669290
.long 3039475050,3031676298,2607854993,884159882,3031643530,3043636522,3046185968,884192650,898282675,896152874,473183633
.long 3043636522,3043669290,884192650,898735216,898735216,491926929,3046186124,2640098705,3043669290,896185642,884159882
.long 3046186164,884159882,3045766323,896185642,2619356561,884192650,884159882,3043669290,898735344,3043636522,891991402
.long 3031643530,2643244433,898735344,3046186450,898735372,3046186460,3043669290,891958634,3031676298,504771985,884159882
.long 884192650,3043636522,898735412,884192650,3045733555,896152874,493925777,3043636522,896152874,884192650,3046218912
.long 898735678,2645210513,3046186631,480261521,3043669290,3043636522,884159882,898735472,884159882,898249907,896185642
.long 2647176593,884192650,3031676298,3043669290,3046186508,3043636522,3039442282,3031643530,506738065,0,0
.long 0,0,0,0,0,0,0,0,0,0,0
.long 0,0,0,0,0,0,0,0,0,0,0
.long 0,0,0,0,0,0,0,0,0,0,0
.long 0,0,0,0,0,0,0,0,0,0,0
.long 0,0,898695168,898695168,898695168,898695168,884192650,891991402,896185642,898282675,3043669290
.long 3031676298,884192650,896185642,3043636522,3045766323,3031676298,891991402,884159882,3043636522,3043669290,884192650
.long 898735264,2624599441,3046186164,474527121,884192650,896152874,3043636522,3031676298,3043669290,898282675,3031643530
.long 3039475050,3043636522,884192650,884159882,3043669290,884159882,3039475050,896152874,3045766323,898735392,3046218992
.long 898735412,3046218952,884192650,3039442282,896185642,3045733555,3043669290,884159882,884192650,3043636522,3043636522
.long 898249907,3031676298,3039442282,884159882,896185642,3043669290,3031643530,898735472,2663626129,3046186508,506738065
.long 884192650,3043669290,3043636522,884159882,3043669290,3045733555,3031643530,891958634,3043636522,3031643530,884159882
.long 896152874,884159882,891958634,896152874,898249907,0,0,0,0,0,0
.long 0,0,0,0,0,0,0,0,0,0,0
.long 0,0,0,0,0,0,0,0,0,0,0
.long 0,0,0,0,0,0,0,0,0,0,0
.long 0,0,0,0,0,0,0,0,0,0,0
.long 0,0,0,0,0,0,0,0,0,0,0
.long 0,0,0,0,0,0,0,0,0,0,0
.long 0,0,0,0,0,0,0,0,0,0,0
.long 0,0,0,0,0,0,0,0,0,0,0
.long 0,0,0,0,0,0,0,0,0,0,0
.long 0,0,0,0,0,0,0,0,0,0,0
.long 0,0,0,0,0,0,0,0,0,0,0
.long 0,0,0,0,0,0,0,0,0,0,0
.long 0,0,0,0,0,0,0,0,0,0,0
.long 0,0,0,0,0,0,0,0,0,0,0
.long 0,0,0,0,0,0,0,0,0,0,0
.long 0,0,0,0,0,16256,16256,16256,16256,16256,1053048685
.long 1060454197,1064124100,16256,1060454197,1065362573,1060486965,16256,1064124100,1060486965,3200565101,16256
.long 1065362573,621657984,3212879188,16256,1064156868,3207970613,3200532333,16256,1060486965,3212879188,1060454197
.long 16256,1053081453,3207937845,1064156868,16256,621657984,2777497472,634699648,16256,3200565101,1060454197
.long 3211640516,16256,3207970613,1065362864,3207937845,16256,3211640516,1060486965,1053048685,16256,3212879188
.long 634699648,1065362975,16256,3211607748,3207970613,1053081453,16256,3207937845,3212879351,3207970613,16256
.long 3200532333,3207937845,3211607748,16256,16256,16256,16256,1065362573,1064156868,1060486965,1053081453
.long 621657984,3207970613,3212879188,3207937845,3212879188,3200532333,1060454197,1064156868,2777497472,1065362864,634699648
.long 3212879351,1065362864,3200565101,3207937845,1064124100,634699648,3207937845,1065362975,3207970613,3212879351,1064124100
.long 3207970613,1053048685,2785886080,640728960,2790539136,645382016,1065362975,3211607748,1060486965,3200532333,640728960
.long 1060454197,3212879682,1060486965,3212879665,1053081453,1060454197,3211607748,2790539136,3212879682,648003456,1065395725
.long 1065395853,1053048685,3207937845,3211640516,645382016,1060486965,1065395725,1060454197,3212879682,3211640516,3207970613
.long 3200565101,16256,16256,16256,16256,621657984,3200565101,3207970613,3211640516,2777497472,1060454197
.long 1065362864,1060486965,634699648,3211640516,3207937845,1053048685,2785886080,1065362975,640728960,3212879665,640728960
.long 3211607748,1060454197,1053081453,2790539136,1060486965,3212879682,1060454197,645382016,3200532333,1060486965,3211607748
.long 2794274688,648003456,2796568448,665960320,648003456,1053048685,3207970613,1064124100,2796568448,3207970613,1065395598
.long 3207937845,665960320,1064124100,3207937845,3200565101,2798927744,3212879735,667074432,1065362829,2802696064,1064156868
.long 1060454197,3200532333,2801221504,3207937845,3212879757,3207970613,667074432,1053081453,1060486965,1064156868,16256
.long 16256,16256,16256,3212879188,3211607748,3207937845,3200532333,634699648,3207970613,3212879351,3207937845
.long 1065362975,1053081453,3207970613,3211607748,2790539136,1065395853,645382016,3212879682,3212879682,1053048685,1060486965
.long 3211640516,648003456,3207937845,1065395725,3207970613,1065395725,3211640516,1060454197,3200565101,2798927744,2802696064
.long 2801221504,667074432,3212879735,1064156868,3207937845,1053081453,667074432,1060454197,3212879757,1060486965,1065363460
.long 3200532333,3207970613,1064156868,2803842944,3212879766,2794307456,1065363085,3212846932,3200565101,1060486965,1064124100
.long 2794307456,1060486965,1065363478,1060454197,1065363593,1064124100,1060454197,1053048685,1065385984,1065385984,1065385984
.long 1065385984,1065385984,1064156868,1060486965,1053081453,1065385984,1060486965,613269376,3207970613,1065385984,1053081453
.long 3207970613,3211607748,1065385984,613269376,3212879117,2773761920,1065385984,3200565101,3207937845,1064124100,1065385984
.long 3207970613,2773761920,1060486965,1065385984,3211640516,1060454197,3200565101,1065385984,3212879117,1065362829,3212879316
.long 1065385984,3211607748,1060486965,3200532333,1065385984,3207937845,632340352,1060454197,1065385984,3200532333,3207970613
.long 1064156868,1065385984,2773761920,3212879316,639614848,1065385984,1053048685,3207937845,3211640516,1065385984,1060454197
.long 2784444288,3207937845,1065385984,1064124100,1060454197,1053048685,1065385984,1065385984,1065385984,1065385984,613269376
.long 3200565101,3207970613,3211640516,3212879117,3207937845,2773761920,1060454197,2773761920,1064124100,1060486965,3200565101
.long 1065362829,632340352,3212879316,2784444288,632340352,3211607748,1060454197,1053081453,3212879316,1060454197,639614848
.long 3207937845,2784444288,1053081453,3207937845,1064156868,1065362957,3212879408,1065363028,3212879479,639614848,1053048685
.long 3207970613,1064124100,3212879408,1060486965,2806136704,3207970613,2805022592,3211640516,1060486965,1053048685,1065363028
.long 2806136704,3212879519,2785918848,2794307456,1064156868,1060454197,3200532333,3212879479,3207970613,2785918848,1060486965
.long 2806136704,3200532333,3207937845,3211607748,1065385984,1065385984,1065385984,1065385984,3212879117,3211607748,3207937845
.long 3200532333,1065362829,1060486965,632340352,3207970613,3212879316,3200532333,1060454197,1064156868,1065362957,639614848
.long 3212879408,2805022592,3212879408,1053048685,1060486965,3211640516,1065363028,3207970613,2806136704,1060486965,3212879479
.long 1064124100,3207970613,1053048685,1065363085,3212879519,1065363120,3212879793,3212879519,1064156868,3207937845,1053081453
.long 1065363120,3207937845,2777595776,1060454197,3212879793,1053081453,1060454197,3211607748,1065363156,2809610112,3212879810
.long 630046592,3212846861,3200565101,1060486965,1064124100,1065363191,1060454197,2811051904,3207937845,3212879810,3211640516
.long 3207970613,3200565101,1065385984,1065385984,1065385984,1065385984,2773761920,1053048685,1060454197,1064124100,3212879316
.long 3207937845,2784444288,1060454197,639614848,3211640516,3207937845,1053048685,1065363028,2794307456,3212879479,2806136704
.long 2806136704,1064156868,3207970613,3200532333,3212879519,1060454197,2785918848,3207937845,2785918848,3200532333,1060486965
.long 3211607748,1065363156,3212846861,1065363191,3212879810,2809610112,3200565101,1060454197,3211640516,3212879810,1060486965
.long 2811051904,3207970613,671399808,1064124100,3207937845,3200565101,1065363231,2811641728,3212846733,646823808,659832704
.long 3211607748,3207970613,1053081453,3212846733,3207970613,672579456,1060486965,680116096,1053081453,1060486965,1064156868
.long 2147499904,2147499904,2147499904,2147499904,2147499904,3200532333,3207937845,3211607748,2147499904,3207937845,3212846221
.long 3207970613,2147499904,3211607748,3207970613,1053081453,2147499904,3212846221,2769141632,1065395540,2147499904,3211640516
.long 1060486965,1053048685,2147499904,3207970613,1065395540,3207937845,2147499904,3200565101,1060454197,3211640516,2147499904
.long 2769141632,630013824,2782183296,2147499904,1053081453,3207937845,1064156868,2147499904,1060486965,3212846512,1060454197
.long 2147499904,1064156868,3207970613,3200532333,2147499904,1065395540,2782183296,3212846623,2147499904,1064124100,1060486965
.long 3200565101,2147499904,1060454197,1065395703,1060486965,2147499904,1053048685,1060454197,1064124100,2147499904,2147499904
.long 2147499904,2147499904,3212846221,3211640516,3207970613,3200565101,2769141632,1060486965,1065395540,1060454197,1065395540
.long 1053048685,3207937845,3211640516,630013824,3212846512,2782183296,1065395703,3212846512,1053081453,1060454197,3211607748
.long 2782183296,1060454197,3212846623,1060486965,1065395703,3211607748,1060486965,3200532333,638402432,2788212608,643055488
.long 2792865664,3212846623,1064124100,3207970613,1053048685,2788212608,3207937845,1065396034,3207970613,1065396017,3200565101
.long 3207937845,1064124100,643055488,1065396034,2795487104,3212879373,3212879501,3200532333,1060454197,1064156868,2792865664
.long 3207970613,3212879373,3207937845,1065396034,1064156868,1060486965,1053081453,2147499904,2147499904,2147499904,2147499904
.long 2769141632,1053081453,1060486965,1064156868,630013824,3207937845,3212846512,3207970613,2782183296,1064156868,1060454197
.long 3200532333,638402432,3212846623,2788212608,1065396017,2788212608,1064124100,3207937845,3200565101,643055488,3207970613
.long 1065396034,3207937845,2792865664,1053048685,3207970613,1064124100,646791040,2795487104,649084800,2813443968,2795487104
.long 3200532333,1060486965,3211607748,649084800,1060486965,3212879246,1060454197,2813443968,3211607748,1060454197,1053081453
.long 651444096,1065396087,2814558080,3212846477,655212416,3211640516,3207937845,1053048685,653737856,1060454197,1065396109
.long 1060486965,2814558080,3200565101,3207970613,3211640516,2147499904,2147499904,2147499904,2147499904,1065395540,1064124100
.long 1060454197,1053048685,2782183296,1060486965,1065395703,1060454197,3212846623,3200565101,1060486965,1064124100,643055488
.long 3212879501,2792865664,1065396034,1065396034,3200532333,3207970613,1064156868,2795487104,1060454197,3212879373,1060486965
.long 3212879373,1064156868,3207937845,1053081453,651444096,655212416,653737856,2814558080,1065396087,3211640516,1060454197
.long 3200565101,2814558080,3207937845,1065396109,3207970613,3212847108,1053048685,1060486965,3211640516,656359296,1065396118
.long 646823808,3212846733,1065363284,1053081453,3207970613,3211607748,646823808,3207970613,3212847126,3207937845,3212847241
.long 3211607748,3207937845,3200532333,1065353216,1065353216,1065353216,1065353216,1065353216,1064124100,1060454197,1053048685
.long 1065353216,1060454197,613236608,3207937845,1065353216,1053048685,3207937845,3211640516,1065353216,613236608,3212846349
.long 2773794688,1065353216,3200532333,3207970613,1064156868,1065353216,3207937845,2773794688,1060454197,1065353216,3211607748
.long 1060486965,3200532333,1065353216,3212846349,1065395597,3212846548,1065353216,3211640516,1060454197,3200565101,1065353216
.long 3207970613,632307584,1060486965,1065353216,3200565101,3207937845,1064124100,1065353216,2773794688,3212846548,639582080
.long 1065353216,1053081453,3207970613,3211607748,1065353216,1060486965,2784477056,3207970613,1065353216,1064156868,1060486965
.long 1053081453,1065353216,1065353216,1065353216,1065353216,613236608,3200532333,3207937845,3211607748,3212846349,3207970613
.long 2773794688,1060486965,2773794688,1064156868,1060454197,3200532333,1065395597,632307584,3212846548,2784477056,632307584
.long 3211640516,1060486965,1053048685,3212846548,1060486965,639582080,3207970613,2784477056,1053048685,3207970613,1064124100
.long 1065395725,3212846640,1065395796,3212846711,639582080,1053081453,3207937845,1064156868,3212846640,1060454197,2806169472
.long 3207937845,2805055360,3211607748,1060454197,1053081453,1065395796,2806169472,3212846751,2785886080,2794274688,1064124100
.long 1060486965,3200565101,3212846711,3207937845,2785886080,1060454197,2806169472,3200565101,3207970613,3211640516,1065353216
.long 1065353216,1065353216,1065353216,3212846349,3211640516,3207970613,3200565101,1065395597,1060454197,632307584,3207937845
.long 3212846548,3200565101,1060486965,1064124100,1065395725,639582080,3212846640,2805055360,3212846640,1053081453,1060454197
.long 3211607748,1065395796,3207937845,2806169472,1060454197,3212846711,1064156868,3207937845,1053081453,1065395853,3212846751
.long 1065395888,3212847025,3212846751,1064124100,3207970613,1053048685,1065395888,3207970613,2777563008,1060486965,3212847025
.long 1053048685,1060486965,3211640516,1065395924,2809642880,3212847042,630013824,3212879629,3200532333,1060454197,1064156868
.long 1065395959,1060486965,2811084672,3207970613,3212847042,3211607748,3207937845,3200532333,1065353216,1065353216,1065353216
.long 1065353216,2773794688,1053081453,1060486965,1064156868,3212846548,3207970613,2784477056,1060486965,639582080,3211607748
.long 3207970613,1053081453,1065395796,2794274688,3212846711,2806169472,2806169472,1064124100,3207937845,3200565101,3212846751
.long 1060486965,2785886080,3207970613,2785886080,3200565101,1060454197,3211640516,1065395924,3212879629,1065395959,3212847042
.long 2809642880,3200532333,1060486965,3211607748,3212847042,1060454197,2811084672,3207937845,671367040,1064156868,3207970613
.long 3200532333,1065395999,2811674496,3212879501,646791040,659865472,3211640516,3207937845,1053048685,3212879501,3207937845
.long 672546688,1060454197,680083328,1053048685,1060454197,1064124100,1065353216,1065353216,1065353216,1065353216,1065353216
.long 1065348163,1065333007,1065307757,1065353216,1065333007,1065272429,1065171628,1065353216,1065307757,1065171628,1064945565
.long 1065353216,1065272429,1065030846,1064630795,1065353216,1065227044,1064850424,1064229022,1065353216,1065171628,1064630795
.long 1063742424,1065353216,1065106216,1064372488,1063173637,1065353216,1065030846,1064076126,1062525745,1065353216,1064945565
.long 1063742424,1061802258,1065353216,1064850424,1063372184,1061007097,1065353216,1064745479,1062966298,1060144571,1065353216
.long 1064630795,1062525745,1059219353,1065353216,1064506439,1062051586,1058236458,1065353216,1064372488,1061544963,1057201213
.long 1065353216,1064229022,1061007097,1055273845,1065353216,1065353216,1065353216,1065353216,1065272429,1065227044,1065171628
.long 1065106216,1065030846,1064850424,1064630795,1064372488,1064630795,1064229022,1063742424,1063173637,1064076126,1063372184
.long 1062525745,1061544963,1063372184,1062292797,1061007097,1059534422,1062525745,1061007097,1059219353,1057201213,1061544963
.long 1059534422,1057201213,1052263466,1060439283,1057896922,1053028117,1044891074,1059219353,1055273845,1048104908,1019808432
.long 1057896922,1051491540,1036565814,3189129347,1056004842,1046502419,3175676720,3198196453,1053028117,1036565814,3192374722
.long 3203488490,1049927729,3167292080,3198975188,3206381521,1044891074,3189129347,3203488490,3208490745,1036565814,3196620435
.long 3206053824,3210233939,1065353216,1065353216,1065353216,1065353216,1065030846,1064945565,1064850424,1064745479,1064076126
.long 1063742424,1063372184,1062966298,1062525745,1061802258,1061007097,1060144571,1060439283,1059219353,1057896922,1056004842
.long 1057896922,1055273845,1051491540,1046502419,1053028117,1048104908,1036565814,3175676720,1044891074,1019808432,3189129347
.long 3198196453,613232946,3192374722,3200511765,3205380570,3192374722,3201268682,3206053824,3208763504,3200511765,3206053824
.long 3209028611,3211226072,3205380570,3208763504,3211226072,3212589864,3207922931,3210855832,3212514494,3212756077,3210009393
.long 3212229127,3212816655,3211712670,3211559774,3212816655,3212114443,3209535234,3212514494,3212589864,3210449946,3206381521
.long 1065353216,1065353216,1065353216,1065353216,1064630795,1064506439,1064372488,1064229022,1062525745,1062051586,1061544963
.long 1061007097,1059219353,1058236458,1057201213,1055273845,1053028117,1049927729,1044891074,1036565814,1036565814,3167292080
.long 3189129347,3196620435,3192374722,3198975188,3203488490,3206053824,3203488490,3206381521,3208490745,3210233939,3207922931
.long 3210009393,3211559774,3212514494,3210855832,3212229127,3212816655,3212589864,3212514494,3212816655,3212114443,3210449946
.long 3212756077,3211712670,3209535234,3206381521,3211559774,3209028611,3205380570,3197411377,3209028611,3205035419,3195588556
.long 1033283845,3205380570,3195588556,1036565814,1054533760,3197411377,1033283845,1054533760,1060726850,0,0
.long 0,0,0,1019808432,1028193072,1033283845,0,1028193072,1036565814,1041645699,0
.long 1033283845,1041645699,1046502419,0,1036565814,1044891074,1049927729,0,1039839859,1048104908,1052263466
.long 0,1041645699,1049927729,1054533760,0,1043271842,1051491540,1056726311,0,1044891074,1053028117
.long 1057896922,0,1046502419,1054533760,1058897873,0,1048104908,1056004842,1059842890,0,1049136787
.long 1057201213,1060726850,0,1049927729,1057896922,1061544963,0,1050712805,1058570176,1062292797,0
.long 1051491540,1059219353,1062966298,0,1052263466,1059842890,1063561817,0,0,0,0
.long 1036565814,1039839859,1041645699,1043271842,1044891074,1048104908,1049927729,1051491540,1049927729,1052263466,1054533760
.long 1056726311,1053028117,1056004842,1057896922,1059219353,1056004842,1058236458,1059842890,1061279856,1057896922,1059842890
.long 1061544963,1062966298,1059219353,1061279856,1062966298,1064229022,1060439283,1062525745,1064076126,1065030846,1061544963
.long 1063561817,1064850424,1065348163,1062525745,1064372488,1065272429,1065171628,1063372184,1064945565,1065333007,1064506439
.long 1064076126,1065272429,1065030846,1063372184,1064630795,1065348163,1064372488,1061802258,1065030846,1065171628,1063372184
.long 1059842890,1065272429,1064745479,1062051586,1057551771,0,0,0,0,1044891074,1046502419
.long 1048104908,1049136787,1053028117,1054533760,1056004842,1057201213,1057896922,1058897873,1059842890,1060726850,1060439283
.long 1061544963,1062525745,1063372184,1062525745,1063561817,1064372488,1064945565,1064076126,1064850424,1065272429,1065333007
.long 1065030846,1065348163,1065171628,1064506439,1065353216,1065030846,1064076126,1062525745,1065030846,1063913895,1062051586
.long 1059534422,1064076126,1062051586,1059219353,1054533760,1062525745,1059534422,1054533760,1043271842,1060439283,1056004842
.long 1044891074,3184049462,1057896922,1049136787,3175676720,3199747114,1053028117,1028193072,3197411377,3206053824,1044891074
.long 3190755490,3204684861,3209285906,0,0,0,0,1049927729,1050712805,1051491540,1052263466
.long 1057896922,1058570176,1059219353,1059842890,1061544963,1062292797,1062966298,1063561817,1064076126,1064630795,1065030846
.long 1065272429,1065272429,1065348163,1065171628,1064745479,1065030846,1064372488,1063372184,1062051586,1063372184,1061802258
.long 1059842890,1057551771,1060439283,1057896922,1053028117,1044891074,1056004842,1049136787,1028193072,3190755490,1044891074
.long 3175676720,3197411377,3204684861,3184049462,3199747114,3206053824,3209285906,3200511765,3206703001,3210009393,3212114443
.long 3206703001,3210233939,3212334072,3212791405,3210009393,3212334072,3212756077,3211226072,3212114443,3212791405,3211226072
.long 3207628219,1060454197,1060454197,1060454197,1060454197,1059864373,1054162706,3207380754,3207380789,1058160437,3193978464
.long 1058160224,1058160437,1054162741,3207380576,3201646176,3201679157,1046495029,3205676818,1046527762,1046495029,608714549
.long 2769731381,635518773,643940149,3193978677,1058193170,3194011410,3193978677,3201646389,1059896928,1054162528,1054195509
.long 3205644085,1046494816,3205643872,3205644085,3207348021,3201646354,1059897106,1059897141,3207937845,3207937845,3207937845
.long 3207937845,3207348021,3201646354,1059897106,1059897141,3205644085,1046494816,3205643872,3205644085,3201646389,1059896928
.long 1054162528,1054195509,3193978677,1058193170,3194011410,3193978677,2769698613,653115189,2804891445,666615605,1046495029
.long 3205676818,1046527762,1046495029,1054162741,3207380576,3201646176,3201679157,1058160437,3193978464,1058160224,1058160437
.long 1059864373,1054162706,3207380754,3207380789,0,0,0,0,0,0,0
.long 0,0,0,0,0,0,0,0,0,0,0
.long 0,0,0,0,0,0,0,0,0,0,0
.long 0,0,0,0,0,0,0,0,0,0,0
.long 0,0,0,0,0,0,0,0,1060454197,1060454197,1060454197
.long 1060454197,608714336,3201678944,3201679122,2769731168,3207970578,3194011410,3193978464,3207970578,2769731346,1059864338
.long 1059864160,635518738,1060453984,3205643872,3205676818,1060453984,628768565,2779758389,654524213,2802433845,3207937632
.long 1058160224,1058193170,3207937632,2779758354,3207347986,3207347808,2781363986,1060486930,1046527762,1046494816,1060486930
.long 635518560,1054195296,1054195474,2804924000,3207937845,3207937845,3207937845,3207937845,2801417824,1054195296,1054195474
.long 666615392,1060486930,1046527762,1046494816,1060486930,2789785362,3207347986,3207347808,655769362,3207937632,1058160224
.long 1058193170,3207937632,2802401077,665435957,2807316277,642301749,1060453984,3205643872,3205676818,1060453984,2786508562
.long 1059864338,1059864160,2809806610,3207970578,3194011410,3193978464,3207970578,637156960,3201678944,3201679122,669105760
.long 0,0,0,0,0,0,0,0,0,0,0
.long 0,0,0,0,0,0,0,0,0,0,0
.long 0,0,0,0,0,0,0,0,0,0,0
.long 0,0,0,0,0,0,0,0,0,0,0
.long 0,0,0,0,0,0,0,0,1046478848,1058160341,1046494933
.long 3193971912,1054146560,1059864364,3201679148,1054188872,1058144256,1046495020,1058160428,3205637526,1059848192,3201646293
.long 3207380693,1059890632,1060438016,3207931080,1060480456,3207931386,1059848192,3201679061,3207347925,1059890710,1058144256
.long 1046527788,1058193196,3205637679,1054146560,1059897132,3201646380,1054189128,1046478848,1058193109,1046527701,3193972321
.long 617086976,630629704,643933768,2799806074,3193962496,3205643989,3193978581,1046488954,3201630208,3207348012,1054195500
.long 3201672854,3205627904,3193978668,3205644076,1058186952,3207331840,1054162645,1059897045,3207374511,3207921664,1060447638
.long 3207964310,1060448137,3207331840,1054195413,1059864277,3207374536,3205627904,3194011436,3205676844,1058186902,3201630208
.long 3207380780,1054162732,3201672929,3193962496,3205676757,3194011349,1046521466,0,0,0,0
.long 0,0,0,0,0,0,0,0,0,0,0
.long 0,0,0,0,0,0,0,0,0,0,0
.long 0,0,0,0,0,0,0,0,0,0,0
.long 0,0,0,0,0,0,0,0,0,0,0
.long 0,0,0,0,1060454188,1058160428,3205676757,3207970604,617103061,3207380693,1059864364
.long 630603477,3207970517,1046527701,3194011436,1060454101,2773008172,1054162732,3201646293,2786508588,1060480328,3207931286
.long 1060480534,3207931439,630603564,1054195500,3201679061,643907372,3207937749,1046494933,3193978668,1060486869,2781396693
.long 3207347925,1059897132,2794897109,1060486956,1058193196,3205643989,3207937836,637183432,640656918,662939286,663332527
.long 3207937836,3205644076,1058193109,1060486956,2786475733,1059897045,3207348012,2799779541,1060486869,3194011349,1046527788
.long 3207937749,640663340,3201646380,1054162645,2789785388,3207964182,1060448109,3207964653,1060448297,2789752620,3201679148
.long 1054195413,2803253036,1060454101,3193978581,1046495020,3207970517,643940053,1059864277,3207380780,665829077,3207970604
.long 3205676844,1058160341,1060454188,0,0,0,0,0,0,0,0
.long 0,0,0,0,0,0,0,0,0,0,0
.long 0,0,0,0,0,0,0,0,0,0,0
.long 0,0,0,0,0,0,0,0,0,0,0
.long 0,0,0,0,0,0,0,2147516416,2147516416,2147516416,2147516416
.long 3193995264,3205676757,3194011349,1046521032,3201662976,3207380780,1054162732,3201639752,3205660672,3194011436,3205676844
.long 1058186646,3207364608,1054195413,1059864277,3207341512,3207954432,1060480200,3207931336,1060480506,3207364608,1054162645
.long 1059897045,3207341590,3205660672,3193978668,3205644076,1058186799,3201662976,3207348012,1054195500,3201640008,3193995264
.long 3205643989,3193978581,1046521441,2764603392,2778080584,2791384648,652289658,1046511616,1058193109,1046527701,3194005370
.long 1054179328,1059897132,3201646380,1054156438,1058177024,1046527788,1058193196,3205637832,1059880960,3201679061,3207347925
.long 1059858095,1060470784,3207964054,1060447894,3207964553,1059880960,3201646293,3207380693,1059858120,1058177024,1046495020
.long 1058160428,3205637782,1054179328,1059864364,3201679148,1054156513,1046511616,1058160341,1046494933,3193972346,0
.long 0,0,0,0,0,0,0,0,0,0,0
.long 0,0,0,0,0,0,0,0,0,0,0
.long 0,0,0,0,0,0,0,0,0,0,0
.long 0,0,0,0,0,0,0,0,0,0,0
.long 0,0,0,2147516416,2147516416,2147516416,2147516416,3207970604,3205676844,1058160341,1060454188
.long 2764619477,1059864277,3207380780,2778119893,1060454101,3193978581,1046495020,3207970517,625491756,3201679148,1054195413
.long 638992172,3207931208,1060480406,3207931414,1060480559,2778119980,3201646380,1054162645,2791423788,1060486869,3194011349
.long 1046527788,3207937749,633880277,1059897045,3207348012,647380693,3207937836,3205644076,1058193109,1060486956,2784634312
.long 2788107798,2810390166,2810783407,1060486956,1058193196,3205643989,3207937836,639024853,3207347925,1059897132,652328661
.long 3207937749,1046494933,3193978668,1060486869,2788114220,1054195500,3201679061,642268972,1060447766,3207964525,1060448237
.long 3207964713,642301740,1054162732,3201646293,655802156,3207970517,1046527701,3194011436,1060454101,2791390933,3207380693
.long 1059864364,2813279957,1060454188,1058160428,3205676757,3207970604,0,0,0,0,0
.long 0,0,0,0,0,0,0,0,0,0,0
.long 0,0,0,0,0,0,0,0,0,0,0
.long 0,0,0,0,0,0,0,0,0,0,0
.long 0,0,0,0,0,0,0,0,0,0,1060454197
.long 1060454197,0,0,1054162528,1059864338,3205676844,3194011349,3194011410,1058160224,3207380693,3201679148
.long 3207380754,1054195296,3193978581,3205676844,3205643872,1046527762,1054162732,3207380693,2786475829,637189941,1060480584
.long 3207931489,1058160224,3194011410,1054195500,3207347925,1059897106,3201678944,3194011349,3205644076,1046527762,3205643872
.long 3207347925,3201646380,3201646176,3207347986,3205644076,3193978581,3207937845,3207937845,2794890952,2793055969,3201646176
.long 3207347986,1058193196,1046527701,1046527762,3205643872,1059897045,1054195500,1059897106,3201678944,1046494933,1058193196
.long 1058160224,3194011410,3201646380,1059897045,2826125109,669105973,3207964438,1060448175,3205643872,1046527762,3201679148
.long 1059864277,3207380754,1054195296,1046527701,1058160428,3194011410,1058160224,1059864277,1054162732,1054162528,1059864338
.long 1058160428,1046494933,0,0,0,0,0,0,0,0,0
.long 0,0,0,0,0,0,0,0,0,0,0
.long 0,0,0,0,0,0,0,0,0,0,0
.long 0,0,0,0,0,0,0,0,0,0,0
.long 0,0,0,0,0,0,0,0,0,0,0
.long 0,0,0,0,0,0,0,0,0,0,0
.long 0,0,0,0,0,0,0,0,0,0,0
.long 0,0,0,0,0,0,0,0,0,0,0
.long 0,0,0,0,0,0,0,0,0,0,0
.long 0,0,0,0,0,0,0,0,0,0,0
.long 0,0,0,0,0,0,0,0,0,0,0
.long 0,0,0,0,0,0,0,0,0,0,0
.long 0,0,0,0,0,0,0,0,0,0,0
.long 0,0,0,0,0,0,0,0,0,0,0
.long 0,0,0,0,0,0,0,0,0,0,0
.long 0,0,0,0,0,0,0,0,0,0,0
.long 0,0,2147516416,2147516416,1060454197,1060454197,1058160428,1046494933,1054162528,1059864338,1059864277
.long 1054162732,3194011410,1058160224,1046527701,1058160428,3207380754,1054195296,3201679148,1059864277,3205643872,1046527762
.long 3207931464,1060480609,2786475829,637189941,3201646380,1059897045,1058160224,3194011410,1046494933,1058193196,1059897106
.long 3201678944,1059897045,1054195500,1046527762,3205643872,1058193196,1046527701,3201646176,3207347986,647374536,645539553
.long 3207937845,3207937845,3205644076,3193978581,3201646176,3207347986,3207347925,3201646380,1046527762,3205643872,3194011349
.long 3205644076,1059897106,3201678944,1054195500,3207347925,1058160224,3194011410,1060448022,3207964591,2826125109,669105973
.long 1054162732,3207380693,3205643872,1046527762,3193978581,3205676844,3207380754,1054195296,3207380693,3201679148,3194011410
.long 1058160224,3205676844,3194011349,1054162528,1059864338,0,0,0,0,0,0
.long 0,0,0,0,0,0,0,0,0,0,0
.long 0,0,0,0,0,0,0,0,0,0,0
.long 0,0,0,0,0,0,0,0,0,0,0
.long 0,0,0,0,0,0,0,0,0,0,0
.long 0,0,0,0,0,0,0,0,0,0,0
.long 0,0,0,0,0,0,0,0,0,0,0
.long 0,0,0,0,0,0,0,0,0,0,0
.long 0,0,0,0,0,0,0,0,0,0,0
.long 0,0,0,0,0,0,0,0,0,0,0
.long 0,0,0,0,0,0,0,0,0,0,0
.long 0,0,0,0,0,0,0,0,0,0,0
.long 0,0,0,0,0,0,0,0,0,0,0
.long 0,0,0,0,0,0,0,0,0,0,0
.long 0,0,0,0,0,0,0,0,0,0,0
.long 0,0,0,0,0,0,0,0,0,0,0
.long 0,0,0,0,0,4096,0,24117248,1073741824,1073741824,1048576
.long 3145728,4096,0,16780300,1048576,24117248,2290649224,2290649224,9437184,9437184,9445376
.long 13631488,13639680,69632,69632,13631488,90112,90112,0,384,512,640
.long 768,896,1024,1152,589824,786432,983040,1179648,1376256,1572864,1769472
.long 27262976,27279360,27295744,27312128,27328512,4112,10240,24119296,1073741824,1073741824,1048576
.long 3145728,4128,657408,16780300,1048576,24608768,2290649224,2290649224,9437184,9437184,9445376
.long 13633536,13641728,69636,69760,13680640,90116,90112,0,655744,655872,656000
.long 656128,656256,656384,656512,638976,835584,1032192,1228800,1425408,1622016,1818624
.long 27267072,27283456,27299840,27316224,27332608,4128,20480,24121344,1073741824,1073741824,1048576
.long 3145728,4160,0,16780300,1048576,25100288,2290649224,2290649224,9437184,9437184,9445376
.long 13828096,13836288,70144,69888,13729792,90120,90112,0,1311104,1311232,1311360
.long 1311488,1311616,1311744,1311872,688128,884736,1081344,1277952,1474560,1671168,1867776
.long 27271168,27287552,27303936,27320320,27336704,4144,30720,24123392,1073741824,1073741824,1048576
.long 1073741824,4192,657408,16780300,1048576,25591808,2290649224,2290649224,9437184,9437184,9437184
.long 13830144,13838336,70148,70016,13778944,90124,90112,0,1966464,1966592,1966720
.long 1966848,1966976,1967104,1967232,737280,933888,1130496,1327104,1523712,1720320,1916928
.long 27275264,27291648,27308032,27324416,27340800,20480,245760,24363008,1073741824,1073741824,1056768
.long 3153920,20480,640,50465804,1409024,24117248,2290649224,2290649224,9438592,11534336,11542528
.long 16777216,16785408,77824,71680,14417920,92160,90624,40960,164864,164992,163840
.long 163968,164096,164224,164352,1572864,1769472,0,196608,393216,589824,786432
.long 27303936,27320320,27336704,27271168,27287552,20496,256000,24365056,1073741824,1073741824,1056768
.long 3153920,20512,658048,50465804,1409024,24608768,2290649224,2290649224,9438592,11534336,11542528
.long 16779264,16787456,77828,71808,14467072,92164,90624,40960,820224,820352,819200
.long 819328,819456,819584,819712,1622016,1818624,49152,245760,442368,638976,835584
.long 27308032,27324416,27340800,27275264,27291648,20512,266240,24367104,1073741824,1073741824,1056768
.long 3153920,20544,640,50465804,1409024,25100288,2290649224,2290649224,9438592,11534336,11542528
.long 16973824,16982016,78336,71936,14516224,92168,90624,40960,1475584,1475712,1474560
.long 1474688,1474816,1474944,1475072,1671168,1867776,98304,294912,491520,688128,884736
.long 27312128,27328512,27262976,27279360,27295744,20528,276480,24369152,1073741824,1073741824,1056768
.long 1073741824,20576,658048,50465804,1409024,25591808,2290649224,2290649224,9438592,11534336,11534336
.long 16975872,16984064,78340,72064,14565376,92172,90624,40960,2130944,2131072,2129920
.long 2130048,2130176,2130304,2130432,1720320,1916928,147456,344064,540672,737280,933888
.long 27316224,27332608,27267072,27283456,27299840,8192,491520,24608768,1073741824,1073741824,1050624
.long 3147776,4096,1284,16780300,1769472,24117248,2290649224,2290649224,9440000,9961472,9969664
.long 13680640,13688832,69760,73728,15204352,90624,91136,81920,384,512,640
.long 768,896,1024,1152,590592,787200,983808,1180416,1377024,1573632,1770240
.long 27590656,27607040,27623424,27639808,27656192,8208,501760,24610816,1073741824,1073741824,1050624
.long 3147776,4128,658692,16780300,1769472,24608768,2290649224,2290649224,9440000,9961472,9969664
.long 13682688,13690880,69764,73856,15253504,90628,91136,81920,655744,655872,656000
.long 656128,656256,656384,656512,639744,836352,1032960,1229568,1426176,1622784,1819392
.long 27594752,27611136,27627520,27643904,27660288,8224,512000,24612864,1073741824,1073741824,1050624
.long 3147776,4160,1284,16780300,1769472,25100288,2290649224,2290649224,9440000,9961472,9969664
.long 13877248,13885440,70272,73984,15302656,90632,91136,81920,1311104,1311232,1311360
.long 1311488,1311616,1311744,1311872,688896,885504,1082112,1278720,1475328,1671936,1868544
.long 27598848,27615232,27631616,27648000,27664384,8240,522240,24614912,1073741824,1073741824,1050624
.long 1073741824,4192,658692,16780300,1769472,25591808,2290649224,2290649224,9440000,9961472,9961472
.long 13879296,13887488,70276,74112,15351808,90636,91136,81920,1966464,1966592,1966720
.long 1966848,1966976,1967104,1967232,738048,934656,1131264,1327872,1524480,1721088,1917696
.long 27602944,27619328,27635712,27652096,27668480,24576,737280,24854528,1073741824,1073741824,1058816
.long 3155968,20480,1924,50465804,2129920,24117248,2290649224,2290649224,9441408,12058624,12066816
.long 16826368,16834560,77952,75776,15990784,92672,91648,122880,164864,164992,163840
.long 163968,164096,164224,164352,1573632,1770240,768,197376,393984,590592,787200
.long 27631616,27648000,27664384,27598848,27615232,24592,747520,24856576,1073741824,1073741824,1058816
.long 3155968,20512,659332,50465804,2129920,24608768,2290649224,2290649224,9441408,12058624,12066816
.long 16828416,16836608,77956,75904,16039936,92676,91648,122880,820224,820352,819200
.long 819328,819456,819584,819712,1622784,1819392,49920,246528,443136,639744,836352
.long 27635712,27652096,27668480,27602944,27619328,24608,757760,24858624,1073741824,1073741824,1058816
.long 3155968,20544,1924,50465804,2129920,25100288,2290649224,2290649224,9441408,12058624,12066816
.long 17022976,17031168,78464,76032,16089088,92680,91648,122880,1475584,1475712,1474560
.long 1474688,1474816,1474944,1475072,1671936,1868544,99072,295680,492288,688896,885504
.long 27639808,27656192,27590656,27607040,27623424,24624,768000,24860672,1073741824,1073741824,1058816
.long 1073741824,20576,659332,50465804,2129920,25591808,2290649224,2290649224,9441408,12058624,12058624
.long 17025024,17033216,78468,76160,16138240,92684,91648,122880,2130944,2131072,2129920
.long 2130048,2130176,2130304,2130432,1721088,1917696,148224,344832,541440,738048,934656
.long 27643904,27660288,27594752,27611136,27627520,12288,983040,25100288,1073741824,1073741824,1052672
.long 3149824,4096,2568,16780300,2490368,24117248,2290649224,2290649224,9442816,10485760,10493952
.long 13729792,13737984,69888,77824,16777216,91136,92160,163840,384,512,640
.long 768,896,1024,1152,591360,787968,984576,1181184,1377792,1574400,1771008
.long 27918336,27934720,27951104,27967488,27983872,12304,993280,25102336,1073741824,1073741824,1052672
.long 3149824,4128,659976,16780300,2490368,24608768,2290649224,2290649224,9442816,10485760,10493952
.long 13731840,13740032,69892,77952,16826368,91140,92160,163840,655744,655872,656000
.long 656128,656256,656384,656512,640512,837120,1033728,1230336,1426944,1623552,1820160
.long 27922432,27938816,27955200,27971584,27987968,12320,1003520,25104384,1073741824,1073741824,1052672
.long 3149824,4160,2568,16780300,2490368,25100288,2290649224,2290649224,9442816,10485760,10493952
.long 13926400,13934592,70400,78080,16875520,91144,92160,163840,1311104,1311232,1311360
.long 1311488,1311616,1311744,1311872,689664,886272,1082880,1279488,1476096,1672704,1869312
.long 27926528,27942912,27959296,27975680,27992064,12336,1013760,25106432,1073741824,1073741824,1052672
.long 1073741824,4192,659976,16780300,2490368,25591808,2290649224,2290649224,9442816,10485760,10485760
.long 13928448,13936640,70404,78208,16924672,91148,92160,163840,1966464,1966592,1966720
.long 1966848,1966976,1967104,1967232,738816,935424,1132032,1328640,1525248,1721856,1918464
.long 27930624,27947008,27963392,27979776,27996160,28672,1228800,25346048,1073741824,1073741824,1060864
.long 3158016,20480,3208,50465804,2850816,24117248,2290649224,2290649224,9444224,12582912,12591104
.long 16875520,16883712,78080,79872,17563648,93184,92672,204800,164864,164992,163840
.long 163968,164096,164224,164352,1574400,1771008,1536,198144,394752,591360,787968
.long 27959296,27975680,27992064,27926528,27942912,28688,1239040,25348096,1073741824,1073741824,1060864
.long 3158016,20512,660616,50465804,2850816,24608768,2290649224,2290649224,9444224,12582912,12591104
.long 16877568,16885760,78084,80000,17612800,93188,92672,204800,820224,820352,819200
.long 819328,819456,819584,819712,1623552,1820160,50688,247296,443904,640512,837120
.long 27963392,27979776,27996160,27930624,27947008,28704,1249280,25350144,1073741824,1073741824,1060864
.long 3158016,20544,3208,50465804,2850816,25100288,2290649224,2290649224,9444224,12582912,12591104
.long 17072128,17080320,78592,80128,17661952,93192,92672,204800,1475584,1475712,1474560
.long 1474688,1474816,1474944,1475072,1672704,1869312,99840,296448,493056,689664,886272
.long 27967488,27983872,27918336,27934720,27951104,28720,1259520,25352192,1073741824,1073741824,1060864
.long 1073741824,20576,660616,50465804,2850816,25591808,2290649224,2290649224,9444224,12582912,12582912
.long 17074176,17082368,78596,80256,17711104,93196,92672,204800,2130944,2131072,2129920
.long 2130048,2130176,2130304,2130432,1721856,1918464,148992,345600,542208,738816,935424
.long 27971584,27987968,27922432,27938816,27955200,16384,1474560,25591808,1073741824,1073741824,1054720
.long 3151872,4096,3852,16780300,3211264,24117248,2290649224,2290649224,9445632,11010048,11018240
.long 13778944,13787136,70016,81920,18350080,91648,93184,245760,384,512,640
.long 768,896,1024,1152,592128,788736,985344,1181952,1378560,1575168,1771776
.long 28246016,28262400,28278784,28295168,28311552,16400,1484800,25593856,1073741824,1073741824,1054720
.long 3151872,4128,661260,16780300,3211264,24608768,2290649224,2290649224,9445632,11010048,11018240
.long 13780992,13789184,70020,82048,18399232,91652,93184,245760,655744,655872,656000
.long 656128,656256,656384,656512,641280,837888,1034496,1231104,1427712,1624320,1820928
.long 28250112,28266496,28282880,28299264,28315648,16416,1495040,25595904,1073741824,1073741824,1054720
.long 3151872,4160,3852,16780300,3211264,25100288,2290649224,2290649224,9445632,11010048,11018240
.long 13975552,13983744,70528,82176,18448384,91656,93184,245760,1311104,1311232,1311360
.long 1311488,1311616,1311744,1311872,690432,887040,1083648,1280256,1476864,1673472,1870080
.long 28254208,28270592,28286976,28303360,28319744,16432,1505280,25597952,1073741824,1073741824,1054720
.long 1073741824,4192,661260,16780300,3211264,25591808,2290649224,2290649224,9445632,11010048,11010048
.long 13977600,13985792,70532,82304,18497536,91660,93184,245760,1966464,1966592,1966720
.long 1966848,1966976,1967104,1967232,739584,936192,1132800,1329408,1526016,1722624,1919232
.long 28258304,28274688,28291072,28307456,28323840,32768,1720320,25837568,1073741824,1073741824,1062912
.long 3160064,20480,4492,50465804,3571712,24117248,2290649224,2290649224,9447040,13107200,13115392
.long 16924672,16932864,78208,83968,19136512,93696,93696,286720,164864,164992,163840
.long 163968,164096,164224,164352,1575168,1771776,2304,198912,395520,592128,788736
.long 28286976,28303360,28319744,28254208,28270592,32784,1730560,25839616,1073741824,1073741824,1062912
.long 3160064,20512,661900,50465804,3571712,24608768,2290649224,2290649224,9447040,13107200,13115392
.long 16926720,16934912,78212,84096,19185664,93700,93696,286720,820224,820352,819200
.long 819328,819456,819584,819712,1624320,1820928,51456,248064,444672,641280,837888
.long 28291072,28307456,28323840,28258304,28274688,32800,1740800,25841664,1073741824,1073741824,1062912
.long 3160064,20544,4492,50465804,3571712,25100288,2290649224,2290649224,9447040,13107200,13115392
.long 17121280,17129472,78720,84224,19234816,93704,93696,286720,1475584,1475712,1474560
.long 1474688,1474816,1474944,1475072,1673472,1870080,100608,297216,493824,690432,887040
.long 28295168,28311552,28246016,28262400,28278784,32816,1751040,25843712,1073741824,1073741824,1062912
.long 1073741824,20576,661900,50465804,3571712,25591808,2290649224,2290649224,9447040,13107200,13107200
.long 17123328,17131520,78724,84352,19283968,93708,93696,286720,2130944,2131072,2129920
.long 2130048,2130176,2130304,2130432,1722624,1919232,149760,346368,542976,739584,936192
.long 28299264,28315648,28250112,28266496,28282880,4224,256,24125440,1073741824,1073741824,1048640
.long 3145792,6144,28,50465804,1064960,24117248,2290649224,2290649224,9437248,9453568,9461760
.long 14024704,14032896,70656,70144,13828096,90128,90112,1310720,20864,20992,21120
.long 21248,21376,21504,21632,589824,786432,983040,1179648,1376256,1572864,1769472
.long 27262976,27279360,27295744,27312128,27328512,4240,10496,24127488,1073741824,1073741824,1048640
.long 3145792,6176,657436,50465804,1064960,24608768,2290649224,2290649224,9437248,9453568,9461760
.long 14026752,14034944,70660,70272,13877248,90132,90112,1310720,676224,676352,676480
.long 676608,676736,676864,676992,638976,835584,1032192,1228800,1425408,1622016,1818624
.long 27267072,27283456,27299840,27316224,27332608,4256,20736,24129536,1073741824,1073741824,1048640
.long 3145792,6208,28,50465804,1064960,25100288,2290649224,2290649224,9437248,9453568,9461760
.long 14221312,14229504,71168,70400,13926400,90136,90112,1310720,1331584,1331712,1331840
.long 1331968,1332096,1332224,1332352,688128,884736,1081344,1277952,1474560,1671168,1867776
.long 27271168,27287552,27303936,27320320,27336704,4272,30976,24131584,1073741824,1073741824,1048640
.long 1073741824,6240,657436,50465804,1064960,25591808,2290649224,2290649224,9437248,9453568,9453568
.long 14223360,14231552,71172,70528,13975552,90140,90112,1310720,1986944,1987072,1987200
.long 1987328,1987456,1987584,1987712,737280,933888,1130496,1327104,1523712,1720320,1916928
.long 27275264,27291648,27308032,27324416,27340800,20608,246016,24371200,1073741824,1073741824,1056832
.long 3153984,22528,672,16780300,1425408,24117248,2290649224,2290649224,9438656,11550720,11558912
.long 17170432,17178624,78848,72192,14614528,92176,90624,1351680,185344,185472,184320
.long 184448,184576,184704,184832,1572864,1769472,0,196608,393216,589824,786432
.long 27303936,27320320,27336704,27271168,27287552,20624,256256,24373248,1073741824,1073741824,1056832
.long 3153984,22560,658080,16780300,1425408,24608768,2290649224,2290649224,9438656,11550720,11558912
.long 17172480,17180672,78852,72320,14663680,92180,90624,1351680,840704,840832,839680
.long 839808,839936,840064,840192,1622016,1818624,49152,245760,442368,638976,835584
.long 27308032,27324416,27340800,27275264,27291648,20640,266496,24375296,1073741824,1073741824,1056832
.long 3153984,22592,672,16780300,1425408,25100288,2290649224,2290649224,9438656,11550720,11558912
.long 17367040,17375232,79360,72448,14712832,92184,90624,1351680,1496064,1496192,1495040
.long 1495168,1495296,1495424,1495552,1671168,1867776,98304,294912,491520,688128,884736
.long 27312128,27328512,27262976,27279360,27295744,20656,276736,24377344,1073741824,1073741824,1056832
.long 1073741824,22624,658080,16780300,1425408,25591808,2290649224,2290649224,9438656,11550720,11550720
.long 17369088,17377280,79364,72576,14761984,92188,90624,1351680,2151424,2151552,2150400
.long 2150528,2150656,2150784,2150912,1720320,1916928,147456,344064,540672,737280,933888
.long 27316224,27332608,27267072,27283456,27299840,8320,491776,24616960,1073741824,1073741824,1050688
.long 3147840,6144,1312,50465804,1785856,24117248,2290649224,2290649224,9440064,9977856,9986048
.long 14073856,14082048,70784,74240,15400960,90640,91136,1392640,20864,20992,21120
.long 21248,21376,21504,21632,590592,787200,983808,1180416,1377024,1573632,1770240
.long 27590656,27607040,27623424,27639808,27656192,8336,502016,24619008,1073741824,1073741824,1050688
.long 3147840,6176,658720,50465804,1785856,24608768,2290649224,2290649224,9440064,9977856,9986048
.long 14075904,14084096,70788,74368,15450112,90644,91136,1392640,676224,676352,676480
.long 676608,676736,676864,676992,639744,836352,1032960,1229568,1426176,1622784,1819392
.long 27594752,27611136,27627520,27643904,27660288,8352,512256,24621056,1073741824,1073741824,1050688
.long 3147840,6208,1312,50465804,1785856,25100288,2290649224,2290649224,9440064,9977856,9986048
.long 14270464,14278656,71296,74496,15499264,90648,91136,1392640,1331584,1331712,1331840
.long 1331968,1332096,1332224,1332352,688896,885504,1082112,1278720,1475328,1671936,1868544
.long 27598848,27615232,27631616,27648000,27664384,8368,522496,24623104,1073741824,1073741824,1050688
.long 1073741824,6240,658720,50465804,1785856,25591808,2290649224,2290649224,9440064,9977856,9977856
.long 14272512,14280704,71300,74624,15548416,90652,91136,1392640,1986944,1987072,1987200
.long 1987328,1987456,1987584,1987712,738048,934656,1131264,1327872,1524480,1721088,1917696
.long 27602944,27619328,27635712,27652096,27668480,24704,737536,24862720,1073741824,1073741824,1058880
.long 3156032,22528,1956,16780300,2146304,24117248,2290649224,2290649224,9441472,12075008,12083200
.long 17219584,17227776,78976,76288,16187392,92688,91648,1433600,185344,185472,184320
.long 184448,184576,184704,184832,1573632,1770240,768,197376,393984,590592,787200
.long 27631616,27648000,27664384,27598848,27615232,24720,747776,24864768,1073741824,1073741824,1058880
.long 3156032,22560,659364,16780300,2146304,24608768,2290649224,2290649224,9441472,12075008,12083200
.long 17221632,17229824,78980,76416,16236544,92692,91648,1433600,840704,840832,839680
.long 839808,839936,840064,840192,1622784,1819392,49920,246528,443136,639744,836352
.long 27635712,27652096,27668480,27602944,27619328,24736,758016,24866816,1073741824,1073741824,1058880
.long 3156032,22592,1956,16780300,2146304,25100288,2290649224,2290649224,9441472,12075008,12083200
.long 17416192,17424384,79488,76544,16285696,92696,91648,1433600,1496064,1496192,1495040
.long 1495168,1495296,1495424,1495552,1671936,1868544,99072,295680,492288,688896,885504
.long 27639808,27656192,27590656,27607040,27623424,24752,768256,24868864,1073741824,1073741824,1058880
.long 1073741824,22624,659364,16780300,2146304,25591808,2290649224,2290649224,9441472,12075008,12075008
.long 17418240,17426432,79492,76672,16334848,92700,91648,1433600,2151424,2151552,2150400
.long 2150528,2150656,2150784,2150912,1721088,1917696,148224,344832,541440,738048,934656
.long 27643904,27660288,27594752,27611136,27627520,12416,983296,25108480,1073741824,1073741824,1052736
.long 3149888,6144,2596,50465804,2506752,24117248,2290649224,2290649224,9442880,10502144,10510336
.long 14123008,14131200,70912,78336,16973824,91152,92160,1474560,20864,20992,21120
.long 21248,21376,21504,21632,591360,787968,984576,1181184,1377792,1574400,1771008
.long 27918336,27934720,27951104,27967488,27983872,12432,993536,25110528,1073741824,1073741824,1052736
.long 3149888,6176,660004,50465804,2506752,24608768,2290649224,2290649224,9442880,10502144,10510336
.long 14125056,14133248,70916,78464,17022976,91156,92160,1474560,676224,676352,676480
.long 676608,676736,676864,676992,640512,837120,1033728,1230336,1426944,1623552,1820160
.long 27922432,27938816,27955200,27971584,27987968,12448,1003776,25112576,1073741824,1073741824,1052736
.long 3149888,6208,2596,50465804,2506752,25100288,2290649224,2290649224,9442880,10502144,10510336
.long 14319616,14327808,71424,78592,17072128,91160,92160,1474560,1331584,1331712,1331840
.long 1331968,1332096,1332224,1332352,689664,886272,1082880,1279488,1476096,1672704,1869312
.long 27926528,27942912,27959296,27975680,27992064,12464,1014016,25114624,1073741824,1073741824,1052736
.long 1073741824,6240,660004,50465804,2506752,25591808,2290649224,2290649224,9442880,10502144,10502144
.long 14321664,14329856,71428,78720,17121280,91164,92160,1474560,1986944,1987072,1987200
.long 1987328,1987456,1987584,1987712,738816,935424,1132032,1328640,1525248,1721856,1918464
.long 27930624,27947008,27963392,27979776,27996160,28800,1229056,25354240,1073741824,1073741824,1060928
.long 3158080,22528,3240,16780300,2867200,24117248,2290649224,2290649224,9444288,12599296,12607488
.long 17268736,17276928,79104,80384,17760256,93200,92672,1515520,185344,185472,184320
.long 184448,184576,184704,184832,1574400,1771008,1536,198144,394752,591360,787968
.long 27959296,27975680,27992064,27926528,27942912,28816,1239296,25356288,1073741824,1073741824,1060928
.long 3158080,22560,660648,16780300,2867200,24608768,2290649224,2290649224,9444288,12599296,12607488
.long 17270784,17278976,79108,80512,17809408,93204,92672,1515520,840704,840832,839680
.long 839808,839936,840064,840192,1623552,1820160,50688,247296,443904,640512,837120
.long 27963392,27979776,27996160,27930624,27947008,28832,1249536,25358336,1073741824,1073741824,1060928
.long 3158080,22592,3240,16780300,2867200,25100288,2290649224,2290649224,9444288,12599296,12607488
.long 17465344,17473536,79616,80640,17858560,93208,92672,1515520,1496064,1496192,1495040
.long 1495168,1495296,1495424,1495552,1672704,1869312,99840,296448,493056,689664,886272
.long 27967488,27983872,27918336,27934720,27951104,28848,1259776,25360384,1073741824,1073741824,1060928
.long 1073741824,22624,660648,16780300,2867200,25591808,2290649224,2290649224,9444288,12599296,12599296
.long 17467392,17475584,79620,80768,17907712,93212,92672,1515520,2151424,2151552,2150400
.long 2150528,2150656,2150784,2150912,1721856,1918464,148992,345600,542208,738816,935424
.long 27971584,27987968,27922432,27938816,27955200,16512,1474816,25600000,1073741824,1073741824,1054784
.long 3151936,6144,3880,50465804,3227648,24117248,2290649224,2290649224,9445696,11026432,11034624
.long 14172160,14180352,71040,82432,18546688,91664,93184,1556480,20864,20992,21120
.long 21248,21376,21504,21632,592128,788736,985344,1181952,1378560,1575168,1771776
.long 28246016,28262400,28278784,28295168,28311552,16528,1485056,25602048,1073741824,1073741824,1054784
.long 3151936,6176,661288,50465804,3227648,24608768,2290649224,2290649224,9445696,11026432,11034624
.long 14174208,14182400,71044,82560,18595840,91668,93184,1556480,676224,676352,676480
.long 676608,676736,676864,676992,641280,837888,1034496,1231104,1427712,1624320,1820928
.long 28250112,28266496,28282880,28299264,28315648,16544,1495296,25604096,1073741824,1073741824,1054784
.long 3151936,6208,3880,50465804,3227648,25100288,2290649224,2290649224,9445696,11026432,11034624
.long 14368768,14376960,71552,82688,18644992,91672,93184,1556480,1331584,1331712,1331840
.long 1331968,1332096,1332224,1332352,690432,887040,1083648,1280256,1476864,1673472,1870080
.long 28254208,28270592,28286976,28303360,28319744,16560,1505536,25606144,1073741824,1073741824,1054784
.long 1073741824,6240,661288,50465804,3227648,25591808,2290649224,2290649224,9445696,11026432,11026432
.long 14370816,14379008,71556,82816,18694144,91676,93184,1556480,1986944,1987072,1987200
.long 1987328,1987456,1987584,1987712,739584,936192,1132800,1329408,1526016,1722624,1919232
.long 28258304,28274688,28291072,28307456,28323840,32896,1720576,25845760,1073741824,1073741824,1062976
.long 3160128,22528,4524,16780300,3588096,24117248,2290649224,2290649224,9447104,13123584,13131776
.long 17317888,17326080,79232,84480,19333120,93712,93696,1597440,185344,185472,184320
.long 184448,184576,184704,184832,1575168,1771776,2304,198912,395520,592128,788736
.long 28286976,28303360,28319744,28254208,28270592,32912,1730816,25847808,1073741824,1073741824,1062976
.long 3160128,22560,661932,16780300,3588096,24608768,2290649224,2290649224,9447104,13123584,13131776
.long 17319936,17328128,79236,84608,19382272,93716,93696,1597440,840704,840832,839680
.long 839808,839936,840064,840192,1624320,1820928,51456,248064,444672,641280,837888
.long 28291072,28307456,28323840,28258304,28274688,32928,1741056,25849856,1073741824,1073741824,1062976
.long 3160128,22592,4524,16780300,3588096,25100288,2290649224,2290649224,9447104,13123584,13131776
.long 17514496,17522688,79744,84736,19431424,93720,93696,1597440,1496064,1496192,1495040
.long 1495168,1495296,1495424,1495552,1673472,1870080,100608,297216,493824,690432,887040
.long 28295168,28311552,28246016,28262400,28278784,32944,1751296,25851904,1073741824,1073741824,1062976
.long 1073741824,22624,661932,16780300,3588096,25591808,2290649224,2290649224,9447104,13123584,13123584
.long 17516544,17524736,79748,84864,19480576,93724,93696,1597440,2151424,2151552,2150400
.long 2150528,2150656,2150784,2150912,1722624,1919232,149760,346368,542976,739584,936192
.long 28299264,28315648,28250112,28266496,28282880,4352,512,24133632,1073741824,1073741824,1048704
.long 3145856,8192,60,16780300,1081344,24117248,2290649224,2290649224,9437312,9469952,9478144
.long 14417920,14426112,71680,70656,14024704,90144,90368,20480,41472,41600,41728
.long 41856,41984,42112,40960,786432,983040,1179648,1376256,1572864,1769472,0
.long 27271168,27287552,27303936,27320320,27336704,4368,10752,24135680,1073741824,1073741824,1048704
.long 3145856,8224,657468,16780300,1081344,24608768,2290649224,2290649224,9437312,9469952,9478144
.long 14419968,14428160,71684,70784,14073856,90148,90368,20480,696832,696960,697088
.long 697216,697344,697472,696320,835584,1032192,1228800,1425408,1622016,1818624,49152
.long 27275264,27291648,27308032,27324416,27340800,4384,20992,24137728,1073741824,1073741824,1048704
.long 3145856,8256,60,16780300,1081344,25100288,2290649224,2290649224,9437312,9469952,9478144
.long 14614528,14622720,72192,70912,14123008,90152,90368,20480,1352192,1352320,1352448
.long 1352576,1352704,1352832,1351680,884736,1081344,1277952,1474560,1671168,1867776,98304
.long 27279360,27295744,27312128,27328512,27262976,4400,31232,24139776,1073741824,1073741824,1048704
.long 1073741824,8288,657468,16780300,1081344,25591808,2290649224,2290649224,9437312,9469952,9469952
.long 14616576,14624768,72196,71040,14172160,90156,90368,20480,2007552,2007680,2007808
.long 2007936,2008064,2008192,2007040,933888,1130496,1327104,1523712,1720320,1916928,147456
.long 27283456,27299840,27316224,27332608,27267072,20736,246272,24379392,1073741824,1073741824,1056896
.long 3154048,24576,700,50465804,1441792,24117248,2290649224,2290649224,9438720,11567104,11575296
.long 17563648,17571840,79872,72704,14811136,92192,90880,61440,205952,204800,204928
.long 205056,205184,205312,205440,1769472,0,196608,393216,589824,786432,983040
.long 27312128,27328512,27262976,27279360,27295744,20752,256512,24381440,1073741824,1073741824,1056896
.long 3154048,24608,658108,50465804,1441792,24608768,2290649224,2290649224,9438720,11567104,11575296
.long 17565696,17573888,79876,72832,14860288,92196,90880,61440,861312,860160,860288
.long 860416,860544,860672,860800,1818624,49152,245760,442368,638976,835584,1032192
.long 27316224,27332608,27267072,27283456,27299840,20768,266752,24383488,1073741824,1073741824,1056896
.long 3154048,24640,700,50465804,1441792,25100288,2290649224,2290649224,9438720,11567104,11575296
.long 17760256,17768448,80384,72960,14909440,92200,90880,61440,1516672,1515520,1515648
.long 1515776,1515904,1516032,1516160,1867776,98304,294912,491520,688128,884736,1081344
.long 27320320,27336704,27271168,27287552,27303936,20784,276992,24385536,1073741824,1073741824,1056896
.long 1073741824,24672,658108,50465804,1441792,25591808,2290649224,2290649224,9438720,11567104,11567104
.long 17762304,17770496,80388,73088,14958592,92204,90880,61440,2172032,2170880,2171008
.long 2171136,2171264,2171392,2171520,1916928,147456,344064,540672,737280,933888,1130496
.long 27324416,27340800,27275264,27291648,27308032,8448,492032,24625152,1073741824,1073741824,1050752
.long 3147904,8192,1344,16780300,1802240,24117248,2290649224,2290649224,9440128,9994240,10002432
.long 14467072,14475264,71808,74752,15597568,90656,91392,102400,41472,41600,41728
.long 41856,41984,42112,40960,787200,983808,1180416,1377024,1573632,1770240,768
.long 27598848,27615232,27631616,27648000,27664384,8464,502272,24627200,1073741824,1073741824,1050752
.long 3147904,8224,658752,16780300,1802240,24608768,2290649224,2290649224,9440128,9994240,10002432
.long 14469120,14477312,71812,74880,15646720,90660,91392,102400,696832,696960,697088
.long 697216,697344,697472,696320,836352,1032960,1229568,1426176,1622784,1819392,49920
.long 27602944,27619328,27635712,27652096,27668480,8480,512512,24629248,1073741824,1073741824,1050752
.long 3147904,8256,1344,16780300,1802240,25100288,2290649224,2290649224,9440128,9994240,10002432
.long 14663680,14671872,72320,75008,15695872,90664,91392,102400,1352192,1352320,1352448
.long 1352576,1352704,1352832,1351680,885504,1082112,1278720,1475328,1671936,1868544,99072
.long 27607040,27623424,27639808,27656192,27590656,8496,522752,24631296,1073741824,1073741824,1050752
.long 1073741824,8288,658752,16780300,1802240,25591808,2290649224,2290649224,9440128,9994240,9994240
.long 14665728,14673920,72324,75136,15745024,90668,91392,102400,2007552,2007680,2007808
.long 2007936,2008064,2008192,2007040,934656,1131264,1327872,1524480,1721088,1917696,148224
.long 27611136,27627520,27643904,27660288,27594752,24832,737792,24870912,1073741824,1073741824,1058944
.long 3156096,24576,1984,50465804,2162688,24117248,2290649224,2290649224,9441536,12091392,12099584
.long 17612800,17620992,80000,76800,16384000,92704,91904,143360,205952,204800,204928
.long 205056,205184,205312,205440,1770240,768,197376,393984,590592,787200,983808
.long 27639808,27656192,27590656,27607040,27623424,24848,748032,24872960,1073741824,1073741824,1058944
.long 3156096,24608,659392,50465804,2162688,24608768,2290649224,2290649224,9441536,12091392,12099584
.long 17614848,17623040,80004,76928,16433152,92708,91904,143360,861312,860160,860288
.long 860416,860544,860672,860800,1819392,49920,246528,443136,639744,836352,1032960
.long 27643904,27660288,27594752,27611136,27627520,24864,758272,24875008,1073741824,1073741824,1058944
.long 3156096,24640,1984,50465804,2162688,25100288,2290649224,2290649224,9441536,12091392,12099584
.long 17809408,17817600,80512,77056,16482304,92712,91904,143360,1516672,1515520,1515648
.long 1515776,1515904,1516032,1516160,1868544,99072,295680,492288,688896,885504,1082112
.long 27648000,27664384,27598848,27615232,27631616,24880,768512,24877056,1073741824,1073741824,1058944
.long 1073741824,24672,659392,50465804,2162688,25591808,2290649224,2290649224,9441536,12091392,12091392
.long 17811456,17819648,80516,77184,16531456,92716,91904,143360,2172032,2170880,2171008
.long 2171136,2171264,2171392,2171520,1917696,148224,344832,541440,738048,934656,1131264
.long 27652096,27668480,27602944,27619328,27635712,12544,983552,25116672,1073741824,1073741824,1052800
.long 3149952,8192,2628,16780300,2523136,24117248,2290649224,2290649224,9442944,10518528,10526720
.long 14516224,14524416,71936,78848,17170432,91168,92416,184320,41472,41600,41728
.long 41856,41984,42112,40960,787968,984576,1181184,1377792,1574400,1771008,1536
.long 27926528,27942912,27959296,27975680,27992064,12560,993792,25118720,1073741824,1073741824,1052800
.long 3149952,8224,660036,16780300,2523136,24608768,2290649224,2290649224,9442944,10518528,10526720
.long 14518272,14526464,71940,78976,17219584,91172,92416,184320,696832,696960,697088
.long 697216,697344,697472,696320,837120,1033728,1230336,1426944,1623552,1820160,50688
.long 27930624,27947008,27963392,27979776,27996160,12576,1004032,25120768,1073741824,1073741824,1052800
.long 3149952,8256,2628,16780300,2523136,25100288,2290649224,2290649224,9442944,10518528,10526720
.long 14712832,14721024,72448,79104,17268736,91176,92416,184320,1352192,1352320,1352448
.long 1352576,1352704,1352832,1351680,886272,1082880,1279488,1476096,1672704,1869312,99840
.long 27934720,27951104,27967488,27983872,27918336,12592,1014272,25122816,1073741824,1073741824,1052800
.long 1073741824,8288,660036,16780300,2523136,25591808,2290649224,2290649224,9442944,10518528,10518528
.long 14714880,14723072,72452,79232,17317888,91180,92416,184320,2007552,2007680,2007808
.long 2007936,2008064,2008192,2007040,935424,1132032,1328640,1525248,1721856,1918464,148992
.long 27938816,27955200,27971584,27987968,27922432,28928,1229312,25362432,1073741824,1073741824,1060992
.long 3158144,24576,3268,50465804,2883584,24117248,2290649224,2290649224,9444352,12615680,12623872
.long 17661952,17670144,80128,80896,17956864,93216,92928,225280,205952,204800,204928
.long 205056,205184,205312,205440,1771008,1536,198144,394752,591360,787968,984576
.long 27967488,27983872,27918336,27934720,27951104,28944,1239552,25364480,1073741824,1073741824,1060992
.long 3158144,24608,660676,50465804,2883584,24608768,2290649224,2290649224,9444352,12615680,12623872
.long 17664000,17672192,80132,81024,18006016,93220,92928,225280,861312,860160,860288
.long 860416,860544,860672,860800,1820160,50688,247296,443904,640512,837120,1033728
.long 27971584,27987968,27922432,27938816,27955200,28960,1249792,25366528,1073741824,1073741824,1060992
.long 3158144,24640,3268,50465804,2883584,25100288,2290649224,2290649224,9444352,12615680,12623872
.long 17858560,17866752,80640,81152,18055168,93224,92928,225280,1516672,1515520,1515648
.long 1515776,1515904,1516032,1516160,1869312,99840,296448,493056,689664,886272,1082880
.long 27975680,27992064,27926528,27942912,27959296,28976,1260032,25368576,1073741824,1073741824,1060992
.long 1073741824,24672,660676,50465804,2883584,25591808,2290649224,2290649224,9444352,12615680,12615680
.long 17860608,17868800,80644,81280,18104320,93228,92928,225280,2172032,2170880,2171008
.long 2171136,2171264,2171392,2171520,1918464,148992,345600,542208,738816,935424,1132032
.long 27979776,27996160,27930624,27947008,27963392,16640,1475072,25608192,1073741824,1073741824,1054848
.long 3152000,8192,3912,16780300,3244032,24117248,2290649224,2290649224,9445760,11042816,11051008
.long 14565376,14573568,72064,82944,18743296,91680,93440,266240,41472,41600,41728
.long 41856,41984,42112,40960,788736,985344,1181952,1378560,1575168,1771776,2304
.long 28254208,28270592,28286976,28303360,28319744,16656,1485312,25610240,1073741824,1073741824,1054848
.long 3152000,8224,661320,16780300,3244032,24608768,2290649224,2290649224,9445760,11042816,11051008
.long 14567424,14575616,72068,83072,18792448,91684,93440,266240,696832,696960,697088
.long 697216,697344,697472,696320,837888,1034496,1231104,1427712,1624320,1820928,51456
.long 28258304,28274688,28291072,28307456,28323840,16672,1495552,25612288,1073741824,1073741824,1054848
.long 3152000,8256,3912,16780300,3244032,25100288,2290649224,2290649224,9445760,11042816,11051008
.long 14761984,14770176,72576,83200,18841600,91688,93440,266240,1352192,1352320,1352448
.long 1352576,1352704,1352832,1351680,887040,1083648,1280256,1476864,1673472,1870080,100608
.long 28262400,28278784,28295168,28311552,28246016,16688,1505792,25614336,1073741824,1073741824,1054848
.long 1073741824,8288,661320,16780300,3244032,25591808,2290649224,2290649224,9445760,11042816,11042816
.long 14764032,14772224,72580,83328,18890752,91692,93440,266240,2007552,2007680,2007808
.long 2007936,2008064,2008192,2007040,936192,1132800,1329408,1526016,1722624,1919232,149760
.long 28266496,28282880,28299264,28315648,28250112,33024,1720832,25853952,1073741824,1073741824,1063040
.long 3160192,24576,4552,50465804,3604480,24117248,2290649224,2290649224,9447168,13139968,13148160
.long 17711104,17719296,80256,84992,19529728,93728,93952,307200,205952,204800,204928
.long 205056,205184,205312,205440,1771776,2304,198912,395520,592128,788736,985344
.long 28295168,28311552,28246016,28262400,28278784,33040,1731072,25856000,1073741824,1073741824,1063040
.long 3160192,24608,661960,50465804,3604480,24608768,2290649224,2290649224,9447168,13139968,13148160
.long 17713152,17721344,80260,85120,19578880,93732,93952,307200,861312,860160,860288
.long 860416,860544,860672,860800,1820928,51456,248064,444672,641280,837888,1034496
.long 28299264,28315648,28250112,28266496,28282880,33056,1741312,25858048,1073741824,1073741824,1063040
.long 3160192,24640,4552,50465804,3604480,25100288,2290649224,2290649224,9447168,13139968,13148160
.long 17907712,17915904,80768,85248,19628032,93736,93952,307200,1516672,1515520,1515648
.long 1515776,1515904,1516032,1516160,1870080,100608,297216,493824,690432,887040,1083648
.long 28303360,28319744,28254208,28270592,28286976,33072,1751552,25860096,1073741824,1073741824,1063040
.long 1073741824,24672,661960,50465804,3604480,25591808,2290649224,2290649224,9447168,13139968,13139968
.long 17909760,17917952,80772,85376,19677184,93740,93952,307200,2172032,2170880,2171008
.long 2171136,2171264,2171392,2171520,1919232,149760,346368,542976,739584,936192,1132800
.long 28307456,28323840,28258304,28274688,28291072,4480,768,24141824,1073741824,1073741824,1048768
.long 3145920,10240,88,50465804,1097728,24117248,2290649224,2290649224,9437376,9486336,9494528
.long 14811136,14819328,72704,71168,14221312,90160,90368,1331200,61952,62080,62208
.long 62336,62464,62592,61440,786432,983040,1179648,1376256,1572864,1769472,0
.long 27271168,27287552,27303936,27320320,27336704,4496,11008,24143872,1073741824,1073741824,1048768
.long 3145920,10272,657496,50465804,1097728,24608768,2290649224,2290649224,9437376,9486336,9494528
.long 14813184,14821376,72708,71296,14270464,90164,90368,1331200,717312,717440,717568
.long 717696,717824,717952,716800,835584,1032192,1228800,1425408,1622016,1818624,49152
.long 27275264,27291648,27308032,27324416,27340800,4512,21248,24145920,1073741824,1073741824,1048768
.long 3145920,10304,88,50465804,1097728,25100288,2290649224,2290649224,9437376,9486336,9494528
.long 15007744,15015936,73216,71424,14319616,90168,90368,1331200,1372672,1372800,1372928
.long 1373056,1373184,1373312,1372160,884736,1081344,1277952,1474560,1671168,1867776,98304
.long 27279360,27295744,27312128,27328512,27262976,4528,31488,24147968,1073741824,1073741824,1048768
.long 1073741824,10336,657496,50465804,1097728,25591808,2290649224,2290649224,9437376,9486336,9486336
.long 15009792,15017984,73220,71552,14368768,90172,90368,1331200,2028032,2028160,2028288
.long 2028416,2028544,2028672,2027520,933888,1130496,1327104,1523712,1720320,1916928,147456
.long 27283456,27299840,27316224,27332608,27267072,20864,246528,24387584,1073741824,1073741824,1056960
.long 3154112,26624,732,16780300,1458176,24117248,2290649224,2290649224,9438784,11583488,11591680
.long 17956864,17965056,80896,73216,15007744,92208,90880,1372160,226432,225280,225408
.long 225536,225664,225792,225920,1769472,0,196608,393216,589824,786432,983040
.long 27312128,27328512,27262976,27279360,27295744,20880,256768,24389632,1073741824,1073741824,1056960
.long 3154112,26656,658140,16780300,1458176,24608768,2290649224,2290649224,9438784,11583488,11591680
.long 17958912,17967104,80900,73344,15056896,92212,90880,1372160,881792,880640,880768
.long 880896,881024,881152,881280,1818624,49152,245760,442368,638976,835584,1032192
.long 27316224,27332608,27267072,27283456,27299840,20896,267008,24391680,1073741824,1073741824,1056960
.long 3154112,26688,732,16780300,1458176,25100288,2290649224,2290649224,9438784,11583488,11591680
.long 18153472,18161664,81408,73472,15106048,92216,90880,1372160,1537152,1536000,1536128
.long 1536256,1536384,1536512,1536640,1867776,98304,294912,491520,688128,884736,1081344
.long 27320320,27336704,27271168,27287552,27303936,20912,277248,24393728,1073741824,1073741824,1056960
.long 1073741824,26720,658140,16780300,1458176,25591808,2290649224,2290649224,9438784,11583488,11583488
.long 18155520,18163712,81412,73600,15155200,92220,90880,1372160,2192512,2191360,2191488
.long 2191616,2191744,2191872,2192000,1916928,147456,344064,540672,737280,933888,1130496
.long 27324416,27340800,27275264,27291648,27308032,8576,492288,24633344,1073741824,1073741824,1050816
.long 3147968,10240,1372,50465804,1818624,24117248,2290649224,2290649224,9440192,10010624,10018816
.long 14860288,14868480,72832,75264,15794176,90672,91392,1413120,61952,62080,62208
.long 62336,62464,62592,61440,787200,983808,1180416,1377024,1573632,1770240,768
.long 27598848,27615232,27631616,27648000,27664384,8592,502528,24635392,1073741824,1073741824,1050816
.long 3147968,10272,658780,50465804,1818624,24608768,2290649224,2290649224,9440192,10010624,10018816
.long 14862336,14870528,72836,75392,15843328,90676,91392,1413120,717312,717440,717568
.long 717696,717824,717952,716800,836352,1032960,1229568,1426176,1622784,1819392,49920
.long 27602944,27619328,27635712,27652096,27668480,8608,512768,24637440,1073741824,1073741824,1050816
.long 3147968,10304,1372,50465804,1818624,25100288,2290649224,2290649224,9440192,10010624,10018816
.long 15056896,15065088,73344,75520,15892480,90680,91392,1413120,1372672,1372800,1372928
.long 1373056,1373184,1373312,1372160,885504,1082112,1278720,1475328,1671936,1868544,99072
.long 27607040,27623424,27639808,27656192,27590656,8624,523008,24639488,1073741824,1073741824,1050816
.long 1073741824,10336,658780,50465804,1818624,25591808,2290649224,2290649224,9440192,10010624,10010624
.long 15058944,15067136,73348,75648,15941632,90684,91392,1413120,2028032,2028160,2028288
.long 2028416,2028544,2028672,2027520,934656,1131264,1327872,1524480,1721088,1917696,148224
.long 27611136,27627520,27643904,27660288,27594752,24960,738048,24879104,1073741824,1073741824,1059008
.long 3156160,26624,2016,16780300,2179072,24117248,2290649224,2290649224,9441600,12107776,12115968
.long 18006016,18014208,81024,77312,16580608,92720,91904,1454080,226432,225280,225408
.long 225536,225664,225792,225920,1770240,768,197376,393984,590592,787200,983808
.long 27639808,27656192,27590656,27607040,27623424,24976,748288,24881152,1073741824,1073741824,1059008
.long 3156160,26656,659424,16780300,2179072,24608768,2290649224,2290649224,9441600,12107776,12115968
.long 18008064,18016256,81028,77440,16629760,92724,91904,1454080,881792,880640,880768
.long 880896,881024,881152,881280,1819392,49920,246528,443136,639744,836352,1032960
.long 27643904,27660288,27594752,27611136,27627520,24992,758528,24883200,1073741824,1073741824,1059008
.long 3156160,26688,2016,16780300,2179072,25100288,2290649224,2290649224,9441600,12107776,12115968
.long 18202624,18210816,81536,77568,16678912,92728,91904,1454080,1537152,1536000,1536128
.long 1536256,1536384,1536512,1536640,1868544,99072,295680,492288,688896,885504,1082112
.long 27648000,27664384,27598848,27615232,27631616,25008,768768,24885248,1073741824,1073741824,1059008
.long 1073741824,26720,659424,16780300,2179072,25591808,2290649224,2290649224,9441600,12107776,12107776
.long 18204672,18212864,81540,77696,16728064,92732,91904,1454080,2192512,2191360,2191488
.long 2191616,2191744,2191872,2192000,1917696,148224,344832,541440,738048,934656,1131264
.long 27652096,27668480,27602944,27619328,27635712,12672,983808,25124864,1073741824,1073741824,1052864
.long 3150016,10240,2656,50465804,2539520,24117248,2290649224,2290649224,9443008,10534912,10543104
.long 14909440,14917632,72960,79360,17367040,91184,92416,1495040,61952,62080,62208
.long 62336,62464,62592,61440,787968,984576,1181184,1377792,1574400,1771008,1536
.long 27926528,27942912,27959296,27975680,27992064,12688,994048,25126912,1073741824,1073741824,1052864
.long 3150016,10272,660064,50465804,2539520,24608768,2290649224,2290649224,9443008,10534912,10543104
.long 14911488,14919680,72964,79488,17416192,91188,92416,1495040,717312,717440,717568
.long 717696,717824,717952,716800,837120,1033728,1230336,1426944,1623552,1820160,50688
.long 27930624,27947008,27963392,27979776,27996160,12704,1004288,25128960,1073741824,1073741824,1052864
.long 3150016,10304,2656,50465804,2539520,25100288,2290649224,2290649224,9443008,10534912,10543104
.long 15106048,15114240,73472,79616,17465344,91192,92416,1495040,1372672,1372800,1372928
.long 1373056,1373184,1373312,1372160,886272,1082880,1279488,1476096,1672704,1869312,99840
.long 27934720,27951104,27967488,27983872,27918336,12720,1014528,25131008,1073741824,1073741824,1052864
.long 1073741824,10336,660064,50465804,2539520,25591808,2290649224,2290649224,9443008,10534912,10534912
.long 15108096,15116288,73476,79744,17514496,91196,92416,1495040,2028032,2028160,2028288
.long 2028416,2028544,2028672,2027520,935424,1132032,1328640,1525248,1721856,1918464,148992
.long 27938816,27955200,27971584,27987968,27922432,29056,1229568,25370624,1073741824,1073741824,1061056
.long 3158208,26624,3300,16780300,2899968,24117248,2290649224,2290649224,9444416,12632064,12640256
.long 18055168,18063360,81152,81408,18153472,93232,92928,1536000,226432,225280,225408
.long 225536,225664,225792,225920,1771008,1536,198144,394752,591360,787968,984576
.long 27967488,27983872,27918336,27934720,27951104,29072,1239808,25372672,1073741824,1073741824,1061056
.long 3158208,26656,660708,16780300,2899968,24608768,2290649224,2290649224,9444416,12632064,12640256
.long 18057216,18065408,81156,81536,18202624,93236,92928,1536000,881792,880640,880768
.long 880896,881024,881152,881280,1820160,50688,247296,443904,640512,837120,1033728
.long 27971584,27987968,27922432,27938816,27955200,29088,1250048,25374720,1073741824,1073741824,1061056
.long 3158208,26688,3300,16780300,2899968,25100288,2290649224,2290649224,9444416,12632064,12640256
.long 18251776,18259968,81664,81664,18251776,93240,92928,1536000,1537152,1536000,1536128
.long 1536256,1536384,1536512,1536640,1869312,99840,296448,493056,689664,886272,1082880
.long 27975680,27992064,27926528,27942912,27959296,29104,1260288,25376768,1073741824,1073741824,1061056
.long 1073741824,26720,660708,16780300,2899968,25591808,2290649224,2290649224,9444416,12632064,12632064
.long 18253824,18262016,81668,81792,18300928,93244,92928,1536000,2192512,2191360,2191488
.long 2191616,2191744,2191872,2192000,1918464,148992,345600,542208,738816,935424,1132032
.long 27979776,27996160,27930624,27947008,27963392,16768,1475328,25616384,1073741824,1073741824,1054912
.long 3152064,10240,3940,50465804,3260416,24117248,2290649224,2290649224,9445824,11059200,11067392
.long 14958592,14966784,73088,83456,18939904,91696,93440,1576960,61952,62080,62208
.long 62336,62464,62592,61440,788736,985344,1181952,1378560,1575168,1771776,2304
.long 28254208,28270592,28286976,28303360,28319744,16784,1485568,25618432,1073741824,1073741824,1054912
.long 3152064,10272,661348,50465804,3260416,24608768,2290649224,2290649224,9445824,11059200,11067392
.long 14960640,14968832,73092,83584,18989056,91700,93440,1576960,717312,717440,717568
.long 717696,717824,717952,716800,837888,1034496,1231104,1427712,1624320,1820928,51456
.long 28258304,28274688,28291072,28307456,28323840,16800,1495808,25620480,1073741824,1073741824,1054912
.long 3152064,10304,3940,50465804,3260416,25100288,2290649224,2290649224,9445824,11059200,11067392
.long 15155200,15163392,73600,83712,19038208,91704,93440,1576960,1372672,1372800,1372928
.long 1373056,1373184,1373312,1372160,887040,1083648,1280256,1476864,1673472,1870080,100608
.long 28262400,28278784,28295168,28311552,28246016,16816,1506048,25622528,1073741824,1073741824,1054912
.long 1073741824,10336,661348,50465804,3260416,25591808,2290649224,2290649224,9445824,11059200,11059200
.long 15157248,15165440,73604,83840,19087360,91708,93440,1576960,2028032,2028160,2028288
.long 2028416,2028544,2028672,2027520,936192,1132800,1329408,1526016,1722624,1919232,149760
.long 28266496,28282880,28299264,28315648,28250112,33152,1721088,25862144,1073741824,1073741824,1063104
.long 3160256,26624,4584,16780300,3620864,24117248,2290649224,2290649224,9447232,13156352,13164544
.long 18104320,18112512,81280,85504,19726336,93744,93952,1617920,226432,225280,225408
.long 225536,225664,225792,225920,1771776,2304,198912,395520,592128,788736,985344
.long 28295168,28311552,28246016,28262400,28278784,33168,1731328,25864192,1073741824,1073741824,1063104
.long 3160256,26656,661992,16780300,3620864,24608768,2290649224,2290649224,9447232,13156352,13164544
.long 18106368,18114560,81284,85632,19775488,93748,93952,1617920,881792,880640,880768
.long 880896,881024,881152,881280,1820928,51456,248064,444672,641280,837888,1034496
.long 28299264,28315648,28250112,28266496,28282880,33184,1741568,25866240,1073741824,1073741824,1063104
.long 3160256,26688,4584,16780300,3620864,25100288,2290649224,2290649224,9447232,13156352,13164544
.long 18300928,18309120,81792,85760,19824640,93752,93952,1617920,1537152,1536000,1536128
.long 1536256,1536384,1536512,1536640,1870080,100608,297216,493824,690432,887040,1083648
.long 28303360,28319744,28254208,28270592,28286976,33200,1751808,25868288,1073741824,1073741824,1063104
.long 1073741824,26720,661992,16780300,3620864,25591808,2290649224,2290649224,9447232,13156352,13156352
.long 18302976,18311168,81796,85888,19873792,93756,93952,1617920,2192512,2191360,2191488
.long 2191616,2191744,2191872,2192000,1919232,149760,346368,542976,739584,936192,1132800
.long 28307456,28323840,28258304,28274688,28291072,4608,1024,24150016,1073741824,1073741824,1048832
.long 3145984,12288,120,16780300,1114112,24122368,2290649224,2290649224,9437440,9502720,9510912
.long 15204352,15212544,73728,69632,13631488,90176,90112,160,82560,82688,82816
.long 82944,83072,81920,82048,983040,1179648,1376256,1572864,1769472,0,196608
.long 27279360,27295744,27312128,27328512,27262976,4624,11264,24152064,1073741824,1073741824,1048832
.long 3145984,12320,657528,16780300,1114112,24613888,2290649224,2290649224,9437440,9502720,9510912
.long 15206400,15214592,73732,69760,13680640,90180,90112,160,737920,738048,738176
.long 738304,738432,737280,737408,1032192,1228800,1425408,1622016,1818624,49152,245760
.long 27283456,27299840,27316224,27332608,27267072,4640,21504,24154112,1073741824,1073741824,1048832
.long 3145984,12352,120,16780300,1114112,25105408,2290649224,2290649224,9437440,9502720,9510912
.long 15400960,15409152,74240,69888,13729792,90184,90112,160,1393280,1393408,1393536
.long 1393664,1393792,1392640,1392768,1081344,1277952,1474560,1671168,1867776,98304,294912
.long 27287552,27303936,27320320,27336704,27271168,4656,31744,24156160,1073741824,1073741824,1048832
.long 1073741824,12384,657528,16780300,1114112,25596928,2290649224,2290649224,9437440,9502720,9502720
.long 15403008,15411200,74244,70016,13778944,90188,90112,160,2048640,2048768,2048896
.long 2049024,2049152,2048000,2048128,1130496,1327104,1523712,1720320,1916928,147456,344064
.long 27291648,27308032,27324416,27340800,27275264,20992,246784,24395776,1073741824,1073741824,1057024
.long 3154176,28672,760,50465804,1474560,24122368,2290649224,2290649224,9438848,11599872,11608064
.long 18350080,18358272,81920,71680,14417920,92224,90624,41120,245760,245888,246016
.long 246144,246272,246400,246528,0,196608,393216,589824,786432,983040,1179648
.long 27320320,27336704,27271168,27287552,27303936,21008,257024,24397824,1073741824,1073741824,1057024
.long 3154176,28704,658168,50465804,1474560,24613888,2290649224,2290649224,9438848,11599872,11608064
.long 18352128,18360320,81924,71808,14467072,92228,90624,41120,901120,901248,901376
.long 901504,901632,901760,901888,49152,245760,442368,638976,835584,1032192,1228800
.long 27324416,27340800,27275264,27291648,27308032,21024,267264,24399872,1073741824,1073741824,1057024
.long 3154176,28736,760,50465804,1474560,25105408,2290649224,2290649224,9438848,11599872,11608064
.long 18546688,18554880,82432,71936,14516224,92232,90624,41120,1556480,1556608,1556736
.long 1556864,1556992,1557120,1557248,98304,294912,491520,688128,884736,1081344,1277952
.long 27328512,27262976,27279360,27295744,27312128,21040,277504,24401920,1073741824,1073741824,1057024
.long 1073741824,28768,658168,50465804,1474560,25596928,2290649224,2290649224,9438848,11599872,11599872
.long 18548736,18556928,82436,72064,14565376,92236,90624,41120,2211840,2211968,2212096
.long 2212224,2212352,2212480,2212608,147456,344064,540672,737280,933888,1130496,1327104
.long 27332608,27267072,27283456,27299840,27316224,8704,492544,24641536,1073741824,1073741824,1050880
.long 3148032,12288,1404,16780300,1835008,24122368,2290649224,2290649224,9440256,10027008,10035200
.long 15253504,15261696,73856,73728,15204352,90688,91136,82080,82560,82688,82816
.long 82944,83072,81920,82048,983808,1180416,1377024,1573632,1770240,768,197376
.long 27607040,27623424,27639808,27656192,27590656,8720,502784,24643584,1073741824,1073741824,1050880
.long 3148032,12320,658812,16780300,1835008,24613888,2290649224,2290649224,9440256,10027008,10035200
.long 15255552,15263744,73860,73856,15253504,90692,91136,82080,737920,738048,738176
.long 738304,738432,737280,737408,1032960,1229568,1426176,1622784,1819392,49920,246528
.long 27611136,27627520,27643904,27660288,27594752,8736,513024,24645632,1073741824,1073741824,1050880
.long 3148032,12352,1404,16780300,1835008,25105408,2290649224,2290649224,9440256,10027008,10035200
.long 15450112,15458304,74368,73984,15302656,90696,91136,82080,1393280,1393408,1393536
.long 1393664,1393792,1392640,1392768,1082112,1278720,1475328,1671936,1868544,99072,295680
.long 27615232,27631616,27648000,27664384,27598848,8752,523264,24647680,1073741824,1073741824,1050880
.long 1073741824,12384,658812,16780300,1835008,25596928,2290649224,2290649224,9440256,10027008,10027008
.long 15452160,15460352,74372,74112,15351808,90700,91136,82080,2048640,2048768,2048896
.long 2049024,2049152,2048000,2048128,1131264,1327872,1524480,1721088,1917696,148224,344832
.long 27619328,27635712,27652096,27668480,27602944,25088,738304,24887296,1073741824,1073741824,1059072
.long 3156224,28672,2044,50465804,2195456,24122368,2290649224,2290649224,9441664,12124160,12132352
.long 18399232,18407424,82048,75776,15990784,92736,91648,123040,245760,245888,246016
.long 246144,246272,246400,246528,768,197376,393984,590592,787200,983808,1180416
.long 27648000,27664384,27598848,27615232,27631616,25104,748544,24889344,1073741824,1073741824,1059072
.long 3156224,28704,659452,50465804,2195456,24613888,2290649224,2290649224,9441664,12124160,12132352
.long 18401280,18409472,82052,75904,16039936,92740,91648,123040,901120,901248,901376
.long 901504,901632,901760,901888,49920,246528,443136,639744,836352,1032960,1229568
.long 27652096,27668480,27602944,27619328,27635712,25120,758784,24891392,1073741824,1073741824,1059072
.long 3156224,28736,2044,50465804,2195456,25105408,2290649224,2290649224,9441664,12124160,12132352
.long 18595840,18604032,82560,76032,16089088,92744,91648,123040,1556480,1556608,1556736
.long 1556864,1556992,1557120,1557248,99072,295680,492288,688896,885504,1082112,1278720
.long 27656192,27590656,27607040,27623424,27639808,25136,769024,24893440,1073741824,1073741824,1059072
.long 1073741824,28768,659452,50465804,2195456,25596928,2290649224,2290649224,9441664,12124160,12124160
.long 18597888,18606080,82564,76160,16138240,92748,91648,123040,2211840,2211968,2212096
.long 2212224,2212352,2212480,2212608,148224,344832,541440,738048,934656,1131264,1327872
.long 27660288,27594752,27611136,27627520,27643904,12800,984064,25133056,1073741824,1073741824,1052928
.long 3150080,12288,2688,16780300,2555904,24122368,2290649224,2290649224,9443072,10551296,10559488
.long 15302656,15310848,73984,77824,16777216,91200,92160,164000,82560,82688,82816
.long 82944,83072,81920,82048,984576,1181184,1377792,1574400,1771008,1536,198144
.long 27934720,27951104,27967488,27983872,27918336,12816,994304,25135104,1073741824,1073741824,1052928
.long 3150080,12320,660096,16780300,2555904,24613888,2290649224,2290649224,9443072,10551296,10559488
.long 15304704,15312896,73988,77952,16826368,91204,92160,164000,737920,738048,738176
.long 738304,738432,737280,737408,1033728,1230336,1426944,1623552,1820160,50688,247296
.long 27938816,27955200,27971584,27987968,27922432,12832,1004544,25137152,1073741824,1073741824,1052928
.long 3150080,12352,2688,16780300,2555904,25105408,2290649224,2290649224,9443072,10551296,10559488
.long 15499264,15507456,74496,78080,16875520,91208,92160,164000,1393280,1393408,1393536
.long 1393664,1393792,1392640,1392768,1082880,1279488,1476096,1672704,1869312,99840,296448
.long 27942912,27959296,27975680,27992064,27926528,12848,1014784,25139200,1073741824,1073741824,1052928
.long 1073741824,12384,660096,16780300,2555904,25596928,2290649224,2290649224,9443072,10551296,10551296
.long 15501312,15509504,74500,78208,16924672,91212,92160,164000,2048640,2048768,2048896
.long 2049024,2049152,2048000,2048128,1132032,1328640,1525248,1721856,1918464,148992,345600
.long 27947008,27963392,27979776,27996160,27930624,29184,1229824,25378816,1073741824,1073741824,1061120
.long 3158272,28672,3328,50465804,2916352,24122368,2290649224,2290649224,9444480,12648448,12656640
.long 18448384,18456576,82176,79872,17563648,93248,92672,204960,245760,245888,246016
.long 246144,246272,246400,246528,1536,198144,394752,591360,787968,984576,1181184
.long 27975680,27992064,27926528,27942912,27959296,29200,1240064,25380864,1073741824,1073741824,1061120
.long 3158272,28704,660736,50465804,2916352,24613888,2290649224,2290649224,9444480,12648448,12656640
.long 18450432,18458624,82180,80000,17612800,93252,92672,204960,901120,901248,901376
.long 901504,901632,901760,901888,50688,247296,443904,640512,837120,1033728,1230336
.long 27979776,27996160,27930624,27947008,27963392,29216,1250304,25382912,1073741824,1073741824,1061120
.long 3158272,28736,3328,50465804,2916352,25105408,2290649224,2290649224,9444480,12648448,12656640
.long 18644992,18653184,82688,80128,17661952,93256,92672,204960,1556480,1556608,1556736
.long 1556864,1556992,1557120,1557248,99840,296448,493056,689664,886272,1082880,1279488
.long 27983872,27918336,27934720,27951104,27967488,29232,1260544,25384960,1073741824,1073741824,1061120
.long 1073741824,28768,660736,50465804,2916352,25596928,2290649224,2290649224,9444480,12648448,12648448
.long 18647040,18655232,82692,80256,17711104,93260,92672,204960,2211840,2211968,2212096
.long 2212224,2212352,2212480,2212608,148992,345600,542208,738816,935424,1132032,1328640
.long 27987968,27922432,27938816,27955200,27971584,16896,1475584,25624576,1073741824,1073741824,1054976
.long 3152128,12288,3972,16780300,3276800,24122368,2290649224,2290649224,9445888,11075584,11083776
.long 15351808,15360000,74112,81920,18350080,91712,93184,245920,82560,82688,82816
.long 82944,83072,81920,82048,985344,1181952,1378560,1575168,1771776,2304,198912
.long 28262400,28278784,28295168,28311552,28246016,16912,1485824,25626624,1073741824,1073741824,1054976
.long 3152128,12320,661380,16780300,3276800,24613888,2290649224,2290649224,9445888,11075584,11083776
.long 15353856,15362048,74116,82048,18399232,91716,93184,245920,737920,738048,738176
.long 738304,738432,737280,737408,1034496,1231104,1427712,1624320,1820928,51456,248064
.long 28266496,28282880,28299264,28315648,28250112,16928,1496064,25628672,1073741824,1073741824,1054976
.long 3152128,12352,3972,16780300,3276800,25105408,2290649224,2290649224,9445888,11075584,11083776
.long 15548416,15556608,74624,82176,18448384,91720,93184,245920,1393280,1393408,1393536
.long 1393664,1393792,1392640,1392768,1083648,1280256,1476864,1673472,1870080,100608,297216
.long 28270592,28286976,28303360,28319744,28254208,16944,1506304,25630720,1073741824,1073741824,1054976
.long 1073741824,12384,661380,16780300,3276800,25596928,2290649224,2290649224,9445888,11075584,11075584
.long 15550464,15558656,74628,82304,18497536,91724,93184,245920,2048640,2048768,2048896
.long 2049024,2049152,2048000,2048128,1132800,1329408,1526016,1722624,1919232,149760,346368
.long 28274688,28291072,28307456,28323840,28258304,33280,1721344,25870336,1073741824,1073741824,1063168
.long 3160320,28672,4612,50465804,3637248,24122368,2290649224,2290649224,9447296,13172736,13180928
.long 18497536,18505728,82304,83968,19136512,93760,93696,286880,245760,245888,246016
.long 246144,246272,246400,246528,2304,198912,395520,592128,788736,985344,1181952
.long 28303360,28319744,28254208,28270592,28286976,33296,1731584,25872384,1073741824,1073741824,1063168
.long 3160320,28704,662020,50465804,3637248,24613888,2290649224,2290649224,9447296,13172736,13180928
.long 18499584,18507776,82308,84096,19185664,93764,93696,286880,901120,901248,901376
.long 901504,901632,901760,901888,51456,248064,444672,641280,837888,1034496,1231104
.long 28307456,28323840,28258304,28274688,28291072,33312,1741824,25874432,1073741824,1073741824,1063168
.long 3160320,28736,4612,50465804,3637248,25105408,2290649224,2290649224,9447296,13172736,13180928
.long 18694144,18702336,82816,84224,19234816,93768,93696,286880,1556480,1556608,1556736
.long 1556864,1556992,1557120,1557248,100608,297216,493824,690432,887040,1083648,1280256
.long 28311552,28246016,28262400,28278784,28295168,33328,1752064,25876480,1073741824,1073741824,1063168
.long 1073741824,28768,662020,50465804,3637248,25596928,2290649224,2290649224,9447296,13172736,13172736
.long 18696192,18704384,82820,84352,19283968,93772,93696,286880,2211840,2211968,2212096
.long 2212224,2212352,2212480,2212608,149760,346368,542976,739584,936192,1132800,1329408
.long 28315648,28250112,28266496,28282880,28299264,4736,123648,24264704,196737,27272192,1048896
.long 3146048,14336,600,16780300,1376256,24122368,2290649224,2290649224,9438464,9519104,9527296
.long 15597568,15605760,74752,70144,13828096,90192,90112,1310880,103168,103296,103424
.long 103552,102400,102528,102656,1179648,1376256,1572864,1769472,0,196608,393216
.long 27287552,27303936,27320320,27336704,27271168,4752,133888,24266752,245889,27274240,1048896
.long 3146048,14368,658008,16780300,1376256,24613888,2290649224,2290649224,9438464,9519104,9527296
.long 15599616,15607808,74756,70272,13877248,90196,90112,1310880,758528,758656,758784
.long 758912,757760,757888,758016,1228800,1425408,1622016,1818624,49152,245760,442368
.long 27291648,27308032,27324416,27340800,27275264,4768,144128,24268800,295041,27276288,1048896
.long 3146048,14400,600,16780300,1376256,25105408,2290649224,2290649224,9438464,9519104,9527296
.long 15794176,15802368,75264,70400,13926400,90200,90112,1310880,1413888,1414016,1414144
.long 1414272,1413120,1413248,1413376,1277952,1474560,1671168,1867776,98304,294912,491520
.long 27295744,27312128,27328512,27262976,27279360,4784,154368,24270848,344193,27278336,1048896
.long 1073741824,14432,658008,16780300,1376256,25596928,2290649224,2290649224,9438464,9519104,9519104
.long 15796224,15804416,75268,70528,13975552,90204,90112,1310880,2069248,2069376,2069504
.long 2069632,2068480,2068608,2068736,1327104,1523712,1720320,1916928,147456,344064,540672
.long 27299840,27316224,27332608,27267072,27283456,21120,369408,24510464,197121,27436032,1057088
.long 3154240,30720,1240,50465804,1736704,24122368,2290649224,2290649224,9439872,11616256,11624448
.long 18743296,18751488,82944,72192,14614528,92240,90624,1351840,266368,266496,266624
.long 266752,266880,267008,267136,196608,393216,589824,786432,983040,1179648,1376256
.long 27328512,27262976,27279360,27295744,27312128,21136,379648,24512512,246273,27438080,1057088
.long 3154240,30752,658648,50465804,1736704,24613888,2290649224,2290649224,9439872,11616256,11624448
.long 18745344,18753536,82948,72320,14663680,92244,90624,1351840,921728,921856,921984
.long 922112,922240,922368,922496,245760,442368,638976,835584,1032192,1228800,1425408
.long 27332608,27267072,27283456,27299840,27316224,21152,389888,24514560,295425,27440128,1057088
.long 3154240,30784,1240,50465804,1736704,25105408,2290649224,2290649224,9439872,11616256,11624448
.long 18939904,18948096,83456,72448,14712832,92248,90624,1351840,1577088,1577216,1577344
.long 1577472,1577600,1577728,1577856,294912,491520,688128,884736,1081344,1277952,1474560
.long 27336704,27271168,27287552,27303936,27320320,21168,400128,24516608,344577,27442176,1057088
.long 1073741824,30816,658648,50465804,1736704,25596928,2290649224,2290649224,9439872,11616256,11616256
.long 18941952,18950144,83460,72576,14761984,92252,90624,1351840,2232448,2232576,2232704
.long 2232832,2232960,2233088,2233216,344064,540672,737280,933888,1130496,1327104,1523712
.long 27340800,27275264,27291648,27308032,27324416,8832,615168,24756224,197505,27599872,1050944
.long 3148096,14336,1884,16780300,2097152,24122368,2290649224,2290649224,9441280,10043392,10051584
.long 15646720,15654912,74880,74240,15400960,90704,91136,1392800,103168,103296,103424
.long 103552,102400,102528,102656,1180416,1377024,1573632,1770240,768,197376,393984
.long 27615232,27631616,27648000,27664384,27598848,8848,625408,24758272,246657,27601920,1050944
.long 3148096,14368,659292,16780300,2097152,24613888,2290649224,2290649224,9441280,10043392,10051584
.long 15648768,15656960,74884,74368,15450112,90708,91136,1392800,758528,758656,758784
.long 758912,757760,757888,758016,1229568,1426176,1622784,1819392,49920,246528,443136
.long 27619328,27635712,27652096,27668480,27602944,8864,635648,24760320,295809,27603968,1050944
.long 3148096,14400,1884,16780300,2097152,25105408,2290649224,2290649224,9441280,10043392,10051584
.long 15843328,15851520,75392,74496,15499264,90712,91136,1392800,1413888,1414016,1414144
.long 1414272,1413120,1413248,1413376,1278720,1475328,1671936,1868544,99072,295680,492288
.long 27623424,27639808,27656192,27590656,27607040,8880,645888,24762368,344961,27606016,1050944
.long 1073741824,14432,659292,16780300,2097152,25596928,2290649224,2290649224,9441280,10043392,10043392
.long 15845376,15853568,75396,74624,15548416,90716,91136,1392800,2069248,2069376,2069504
.long 2069632,2068480,2068608,2068736,1327872,1524480,1721088,1917696,148224,344832,541440
.long 27627520,27643904,27660288,27594752,27611136,25216,860928,25001984,197889,27763712,1059136
.long 3156288,30720,2524,50465804,2457600,24122368,2290649224,2290649224,9442688,12140544,12148736
.long 18792448,18800640,83072,76288,16187392,92752,91648,1433760,266368,266496,266624
.long 266752,266880,267008,267136,197376,393984,590592,787200,983808,1180416,1377024
.long 27656192,27590656,27607040,27623424,27639808,25232,871168,25004032,247041,27765760,1059136
.long 3156288,30752,659932,50465804,2457600,24613888,2290649224,2290649224,9442688,12140544,12148736
.long 18794496,18802688,83076,76416,16236544,92756,91648,1433760,921728,921856,921984
.long 922112,922240,922368,922496,246528,443136,639744,836352,1032960,1229568,1426176
.long 27660288,27594752,27611136,27627520,27643904,25248,881408,25006080,296193,27767808,1059136
.long 3156288,30784,2524,50465804,2457600,25105408,2290649224,2290649224,9442688,12140544,12148736
.long 18989056,18997248,83584,76544,16285696,92760,91648,1433760,1577088,1577216,1577344
.long 1577472,1577600,1577728,1577856,295680,492288,688896,885504,1082112,1278720,1475328
.long 27664384,27598848,27615232,27631616,27648000,25264,891648,25008128,345345,27769856,1059136
.long 1073741824,30816,659932,50465804,2457600,25596928,2290649224,2290649224,9442688,12140544,12140544
.long 18991104,18999296,83588,76672,16334848,92764,91648,1433760,2232448,2232576,2232704
.long 2232832,2232960,2233088,2233216,344832,541440,738048,934656,1131264,1327872,1524480
.long 27668480,27602944,27619328,27635712,27652096,12928,1106688,25247744,198273,27927552,1052992
.long 3150144,14336,3168,16780300,2818048,24122368,2290649224,2290649224,9444096,10567680,10575872
.long 15695872,15704064,75008,78336,16973824,91216,92160,1474720,103168,103296,103424
.long 103552,102400,102528,102656,1181184,1377792,1574400,1771008,1536,198144,394752
.long 27942912,27959296,27975680,27992064,27926528,12944,1116928,25249792,247425,27929600,1052992
.long 3150144,14368,660576,16780300,2818048,24613888,2290649224,2290649224,9444096,10567680,10575872
.long 15697920,15706112,75012,78464,17022976,91220,92160,1474720,758528,758656,758784
.long 758912,757760,757888,758016,1230336,1426944,1623552,1820160,50688,247296,443904
.long 27947008,27963392,27979776,27996160,27930624,12960,1127168,25251840,296577,27931648,1052992
.long 3150144,14400,3168,16780300,2818048,25105408,2290649224,2290649224,9444096,10567680,10575872
.long 15892480,15900672,75520,78592,17072128,91224,92160,1474720,1413888,1414016,1414144
.long 1414272,1413120,1413248,1413376,1279488,1476096,1672704,1869312,99840,296448,493056
.long 27951104,27967488,27983872,27918336,27934720,12976,1137408,25253888,345729,27933696,1052992
.long 1073741824,14432,660576,16780300,2818048,25596928,2290649224,2290649224,9444096,10567680,10567680
.long 15894528,15902720,75524,78720,17121280,91228,92160,1474720,2069248,2069376,2069504
.long 2069632,2068480,2068608,2068736,1328640,1525248,1721856,1918464,148992,345600,542208
.long 27955200,27971584,27987968,27922432,27938816,29312,1352448,25493504,198657,28091392,1061184
.long 3158336,30720,3808,50465804,3178496,24122368,2290649224,2290649224,9445504,12664832,12673024
.long 18841600,18849792,83200,80384,17760256,93264,92672,1515680,266368,266496,266624
.long 266752,266880,267008,267136,198144,394752,591360,787968,984576,1181184,1377792
.long 27983872,27918336,27934720,27951104,27967488,29328,1362688,25495552,247809,28093440,1061184
.long 3158336,30752,661216,50465804,3178496,24613888,2290649224,2290649224,9445504,12664832,12673024
.long 18843648,18851840,83204,80512,17809408,93268,92672,1515680,921728,921856,921984
.long 922112,922240,922368,922496,247296,443904,640512,837120,1033728,1230336,1426944
.long 27987968,27922432,27938816,27955200,27971584,29344,1372928,25497600,296961,28095488,1061184
.long 3158336,30784,3808,50465804,3178496,25105408,2290649224,2290649224,9445504,12664832,12673024
.long 19038208,19046400,83712,80640,17858560,93272,92672,1515680,1577088,1577216,1577344
.long 1577472,1577600,1577728,1577856,296448,493056,689664,886272,1082880,1279488,1476096
.long 27992064,27926528,27942912,27959296,27975680,29360,1383168,25499648,346113,28097536,1061184
.long 1073741824,30816,661216,50465804,3178496,25596928,2290649224,2290649224,9445504,12664832,12664832
.long 19040256,19048448,83716,80768,17907712,93276,92672,1515680,2232448,2232576,2232704
.long 2232832,2232960,2233088,2233216,345600,542208,738816,935424,1132032,1328640,1525248
.long 27996160,27930624,27947008,27963392,27979776,17024,1598208,25739264,199041,28255232,1055040
.long 3152192,14336,4452,16780300,3538944,24122368,2290649224,2290649224,9446912,11091968,11100160
.long 15745024,15753216,75136,82432,18546688,91728,93184,1556640,103168,103296,103424
.long 103552,102400,102528,102656,1181952,1378560,1575168,1771776,2304,198912,395520
.long 28270592,28286976,28303360,28319744,28254208,17040,1608448,25741312,248193,28257280,1055040
.long 3152192,14368,661860,16780300,3538944,24613888,2290649224,2290649224,9446912,11091968,11100160
.long 15747072,15755264,75140,82560,18595840,91732,93184,1556640,758528,758656,758784
.long 758912,757760,757888,758016,1231104,1427712,1624320,1820928,51456,248064,444672
.long 28274688,28291072,28307456,28323840,28258304,17056,1618688,25743360,297345,28259328,1055040
.long 3152192,14400,4452,16780300,3538944,25105408,2290649224,2290649224,9446912,11091968,11100160
.long 15941632,15949824,75648,82688,18644992,91736,93184,1556640,1413888,1414016,1414144
.long 1414272,1413120,1413248,1413376,1280256,1476864,1673472,1870080,100608,297216,493824
.long 28278784,28295168,28311552,28246016,28262400,17072,1628928,25745408,346497,28261376,1055040
.long 1073741824,14432,661860,16780300,3538944,25596928,2290649224,2290649224,9446912,11091968,11091968
.long 15943680,15951872,75652,82816,18694144,91740,93184,1556640,2069248,2069376,2069504
.long 2069632,2068480,2068608,2068736,1329408,1526016,1722624,1919232,149760,346368,542976
.long 28282880,28299264,28315648,28250112,28266496,33408,1843968,25985024,199425,28419072,1063232
.long 3160384,30720,5092,50465804,3899392,24122368,2290649224,2290649224,9448320,13189120,13197312
.long 18890752,18898944,83328,84480,19333120,93776,93696,1597600,266368,266496,266624
.long 266752,266880,267008,267136,198912,395520,592128,788736,985344,1181952,1378560
.long 28311552,28246016,28262400,28278784,28295168,33424,1854208,25987072,248577,28421120,1063232
.long 3160384,30752,662500,50465804,3899392,24613888,2290649224,2290649224,9448320,13189120,13197312
.long 18892800,18900992,83332,84608,19382272,93780,93696,1597600,921728,921856,921984
.long 922112,922240,922368,922496,248064,444672,641280,837888,1034496,1231104,1427712
.long 28315648,28250112,28266496,28282880,28299264,33440,1864448,25989120,297729,28423168,1063232
.long 3160384,30784,5092,50465804,3899392,25105408,2290649224,2290649224,9448320,13189120,13197312
.long 19087360,19095552,83840,84736,19431424,93784,93696,1597600,1577088,1577216,1577344
.long 1577472,1577600,1577728,1577856,297216,493824,690432,887040,1083648,1280256,1476864
.long 28319744,28254208,28270592,28286976,28303360,33456,1874688,25991168,346881,28425216,1063232
.long 1073741824,30816,662500,50465804,3899392,25596928,2290649224,2290649224,9448320,13189120,13189120
.long 19089408,19097600,83844,84864,19480576,93788,93696,1597600,2232448,2232576,2232704
.long 2232832,2232960,2233088,2233216,346368,542976,739584,936192,1132800,1329408,1526016
.long 28323840,28258304,28274688,28291072,28307456,4864,123904,24272896,129,27264000,1048960
.long 3146112,16384,628,50465804,1392640,24122368,2290649224,2290649224,9438528,9535488,9543680
.long 15990784,15998976,75776,70656,14024704,90208,90368,20640,123648,123776,123904
.long 124032,122880,123008,123136,1179648,1376256,1572864,1769472,0,196608,393216
.long 27287552,27303936,27320320,27336704,27271168,4880,134144,24274944,49281,27266048,1048960
.long 3146112,16416,658036,50465804,1392640,24613888,2290649224,2290649224,9438528,9535488,9543680
.long 15992832,16001024,75780,70784,14073856,90212,90368,20640,779008,779136,779264
.long 779392,778240,778368,778496,1228800,1425408,1622016,1818624,49152,245760,442368
.long 27291648,27308032,27324416,27340800,27275264,4896,144384,24276992,98433,27268096,1048960
.long 3146112,16448,628,50465804,1392640,25105408,2290649224,2290649224,9438528,9535488,9543680
.long 16187392,16195584,76288,70912,14123008,90216,90368,20640,1434368,1434496,1434624
.long 1434752,1433600,1433728,1433856,1277952,1474560,1671168,1867776,98304,294912,491520
.long 27295744,27312128,27328512,27262976,27279360,4912,154624,24279040,147585,27270144,1048960
.long 1073741824,16480,658036,50465804,1392640,25596928,2290649224,2290649224,9438528,9535488,9535488
.long 16189440,16197632,76292,71040,14172160,90220,90368,20640,2089728,2089856,2089984
.long 2090112,2088960,2089088,2089216,1327104,1523712,1720320,1916928,147456,344064,540672
.long 27299840,27316224,27332608,27267072,27283456,21248,369664,24518656,513,27427840,1057152
.long 3154304,32768,1272,16780300,1753088,24122368,2290649224,2290649224,9439936,11632640,11640832
.long 19136512,19144704,83968,72704,14811136,92256,90880,61600,286848,286976,287104
.long 287232,287360,287488,287616,196608,393216,589824,786432,983040,1179648,1376256
.long 27328512,27262976,27279360,27295744,27312128,21264,379904,24520704,49665,27429888,1057152
.long 3154304,32800,658680,16780300,1753088,24613888,2290649224,2290649224,9439936,11632640,11640832
.long 19138560,19146752,83972,72832,14860288,92260,90880,61600,942208,942336,942464
.long 942592,942720,942848,942976,245760,442368,638976,835584,1032192,1228800,1425408
.long 27332608,27267072,27283456,27299840,27316224,21280,390144,24522752,98817,27431936,1057152
.long 3154304,32832,1272,16780300,1753088,25105408,2290649224,2290649224,9439936,11632640,11640832
.long 19333120,19341312,84480,72960,14909440,92264,90880,61600,1597568,1597696,1597824
.long 1597952,1598080,1598208,1598336,294912,491520,688128,884736,1081344,1277952,1474560
.long 27336704,27271168,27287552,27303936,27320320,21296,400384,24524800,147969,27433984,1057152
.long 1073741824,32864,658680,16780300,1753088,25596928,2290649224,2290649224,9439936,11632640,11632640
.long 19335168,19343360,84484,73088,14958592,92268,90880,61600,2252928,2253056,2253184
.long 2253312,2253440,2253568,2253696,344064,540672,737280,933888,1130496,1327104,1523712
.long 27340800,27275264,27291648,27308032,27324416,8960,615424,24764416,897,27591680,1051008
.long 3148160,16384,1912,50465804,2113536,24122368,2290649224,2290649224,9441344,10059776,10067968
.long 16039936,16048128,75904,74752,15597568,90720,91392,102560,123648,123776,123904
.long 124032,122880,123008,123136,1180416,1377024,1573632,1770240,768,197376,393984
.long 27615232,27631616,27648000,27664384,27598848,8976,625664,24766464,50049,27593728,1051008
.long 3148160,16416,659320,50465804,2113536,24613888,2290649224,2290649224,9441344,10059776,10067968
.long 16041984,16050176,75908,74880,15646720,90724,91392,102560,779008,779136,779264
.long 779392,778240,778368,778496,1229568,1426176,1622784,1819392,49920,246528,443136
.long 27619328,27635712,27652096,27668480,27602944,8992,635904,24768512,99201,27595776,1051008
.long 3148160,16448,1912,50465804,2113536,25105408,2290649224,2290649224,9441344,10059776,10067968
.long 16236544,16244736,76416,75008,15695872,90728,91392,102560,1434368,1434496,1434624
.long 1434752,1433600,1433728,1433856,1278720,1475328,1671936,1868544,99072,295680,492288
.long 27623424,27639808,27656192,27590656,27607040,9008,646144,24770560,148353,27597824,1051008
.long 1073741824,16480,659320,50465804,2113536,25596928,2290649224,2290649224,9441344,10059776,10059776
.long 16238592,16246784,76420,75136,15745024,90732,91392,102560,2089728,2089856,2089984
.long 2090112,2088960,2089088,2089216,1327872,1524480,1721088,1917696,148224,344832,541440
.long 27627520,27643904,27660288,27594752,27611136,25344,861184,25010176,1281,27755520,1059200
.long 3156352,32768,2556,16780300,2473984,24122368,2290649224,2290649224,9442752,12156928,12165120
.long 19185664,19193856,84096,76800,16384000,92768,91904,143520,286848,286976,287104
.long 287232,287360,287488,287616,197376,393984,590592,787200,983808,1180416,1377024
.long 27656192,27590656,27607040,27623424,27639808,25360,871424,25012224,50433,27757568,1059200
.long 3156352,32800,659964,16780300,2473984,24613888,2290649224,2290649224,9442752,12156928,12165120
.long 19187712,19195904,84100,76928,16433152,92772,91904,143520,942208,942336,942464
.long 942592,942720,942848,942976,246528,443136,639744,836352,1032960,1229568,1426176
.long 27660288,27594752,27611136,27627520,27643904,25376,881664,25014272,99585,27759616,1059200
.long 3156352,32832,2556,16780300,2473984,25105408,2290649224,2290649224,9442752,12156928,12165120
.long 19382272,19390464,84608,77056,16482304,92776,91904,143520,1597568,1597696,1597824
.long 1597952,1598080,1598208,1598336,295680,492288,688896,885504,1082112,1278720,1475328
.long 27664384,27598848,27615232,27631616,27648000,25392,891904,25016320,148737,27761664,1059200
.long 1073741824,32864,659964,16780300,2473984,25596928,2290649224,2290649224,9442752,12156928,12156928
.long 19384320,19392512,84612,77184,16531456,92780,91904,143520,2252928,2253056,2253184
.long 2253312,2253440,2253568,2253696,344832,541440,738048,934656,1131264,1327872,1524480
.long 27668480,27602944,27619328,27635712,27652096,13056,1106944,25255936,1665,27919360,1053056
.long 3150208,16384,3196,50465804,2834432,24122368,2290649224,2290649224,9444160,10584064,10592256
.long 16089088,16097280,76032,78848,17170432,91232,92416,184480,123648,123776,123904
.long 124032,122880,123008,123136,1181184,1377792,1574400,1771008,1536,198144,394752
.long 27942912,27959296,27975680,27992064,27926528,13072,1117184,25257984,50817,27921408,1053056
.long 3150208,16416,660604,50465804,2834432,24613888,2290649224,2290649224,9444160,10584064,10592256
.long 16091136,16099328,76036,78976,17219584,91236,92416,184480,779008,779136,779264
.long 779392,778240,778368,778496,1230336,1426944,1623552,1820160,50688,247296,443904
.long 27947008,27963392,27979776,27996160,27930624,13088,1127424,25260032,99969,27923456,1053056
.long 3150208,16448,3196,50465804,2834432,25105408,2290649224,2290649224,9444160,10584064,10592256
.long 16285696,16293888,76544,79104,17268736,91240,92416,184480,1434368,1434496,1434624
.long 1434752,1433600,1433728,1433856,1279488,1476096,1672704,1869312,99840,296448,493056
.long 27951104,27967488,27983872,27918336,27934720,13104,1137664,25262080,149121,27925504,1053056
.long 1073741824,16480,660604,50465804,2834432,25596928,2290649224,2290649224,9444160,10584064,10584064
.long 16287744,16295936,76548,79232,17317888,91244,92416,184480,2089728,2089856,2089984
.long 2090112,2088960,2089088,2089216,1328640,1525248,1721856,1918464,148992,345600,542208
.long 27955200,27971584,27987968,27922432,27938816,29440,1352704,25501696,2049,28083200,1061248
.long 3158400,32768,3840,16780300,3194880,24122368,2290649224,2290649224,9445568,12681216,12689408
.long 19234816,19243008,84224,80896,17956864,93280,92928,225440,286848,286976,287104
.long 287232,287360,287488,287616,198144,394752,591360,787968,984576,1181184,1377792
.long 27983872,27918336,27934720,27951104,27967488,29456,1362944,25503744,51201,28085248,1061248
.long 3158400,32800,661248,16780300,3194880,24613888,2290649224,2290649224,9445568,12681216,12689408
.long 19236864,19245056,84228,81024,18006016,93284,92928,225440,942208,942336,942464
.long 942592,942720,942848,942976,247296,443904,640512,837120,1033728,1230336,1426944
.long 27987968,27922432,27938816,27955200,27971584,29472,1373184,25505792,100353,28087296,1061248
.long 3158400,32832,3840,16780300,3194880,25105408,2290649224,2290649224,9445568,12681216,12689408
.long 19431424,19439616,84736,81152,18055168,93288,92928,225440,1597568,1597696,1597824
.long 1597952,1598080,1598208,1598336,296448,493056,689664,886272,1082880,1279488,1476096
.long 27992064,27926528,27942912,27959296,27975680,29488,1383424,25507840,149505,28089344,1061248
.long 1073741824,32864,661248,16780300,3194880,25596928,2290649224,2290649224,9445568,12681216,12681216
.long 19433472,19441664,84740,81280,18104320,93292,92928,225440,2252928,2253056,2253184
.long 2253312,2253440,2253568,2253696,345600,542208,738816,935424,1132032,1328640,1525248
.long 27996160,27930624,27947008,27963392,27979776,17152,1598464,25747456,2433,28247040,1055104
.long 3152256,16384,4480,50465804,3555328,24122368,2290649224,2290649224,9446976,11108352,11116544
.long 16138240,16146432,76160,82944,18743296,91744,93440,266400,123648,123776,123904
.long 124032,122880,123008,123136,1181952,1378560,1575168,1771776,2304,198912,395520
.long 28270592,28286976,28303360,28319744,28254208,17168,1608704,25749504,51585,28249088,1055104
.long 3152256,16416,661888,50465804,3555328,24613888,2290649224,2290649224,9446976,11108352,11116544
.long 16140288,16148480,76164,83072,18792448,91748,93440,266400,779008,779136,779264
.long 779392,778240,778368,778496,1231104,1427712,1624320,1820928,51456,248064,444672
.long 28274688,28291072,28307456,28323840,28258304,17184,1618944,25751552,100737,28251136,1055104
.long 3152256,16448,4480,50465804,3555328,25105408,2290649224,2290649224,9446976,11108352,11116544
.long 16334848,16343040,76672,83200,18841600,91752,93440,266400,1434368,1434496,1434624
.long 1434752,1433600,1433728,1433856,1280256,1476864,1673472,1870080,100608,297216,493824
.long 28278784,28295168,28311552,28246016,28262400,17200,1629184,25753600,149889,28253184,1055104
.long 1073741824,16480,661888,50465804,3555328,25596928,2290649224,2290649224,9446976,11108352,11108352
.long 16336896,16345088,76676,83328,18890752,91756,93440,266400,2089728,2089856,2089984
.long 2090112,2088960,2089088,2089216,1329408,1526016,1722624,1919232,149760,346368,542976
.long 28282880,28299264,28315648,28250112,28266496,33536,1844224,25993216,2817,28410880,1063296
.long 3160448,32768,5124,16780300,3915776,24122368,2290649224,2290649224,9448384,13205504,13213696
.long 19283968,19292160,84352,84992,19529728,93792,93952,307360,286848,286976,287104
.long 287232,287360,287488,287616,198912,395520,592128,788736,985344,1181952,1378560
.long 28311552,28246016,28262400,28278784,28295168,33552,1854464,25995264,51969,28412928,1063296
.long 3160448,32800,662532,16780300,3915776,24613888,2290649224,2290649224,9448384,13205504,13213696
.long 19286016,19294208,84356,85120,19578880,93796,93952,307360,942208,942336,942464
.long 942592,942720,942848,942976,248064,444672,641280,837888,1034496,1231104,1427712
.long 28315648,28250112,28266496,28282880,28299264,33568,1864704,25997312,101121,28414976,1063296
.long 3160448,32832,5124,16780300,3915776,25105408,2290649224,2290649224,9448384,13205504,13213696
.long 19480576,19488768,84864,85248,19628032,93800,93952,307360,1597568,1597696,1597824
.long 1597952,1598080,1598208,1598336,297216,493824,690432,887040,1083648,1280256,1476864
.long 28319744,28254208,28270592,28286976,28303360,33584,1874944,25999360,150273,28417024,1063296
.long 1073741824,32864,662532,16780300,3915776,25596928,2290649224,2290649224,9448384,13205504,13205504
.long 19482624,19490816,84868,85376,19677184,93804,93952,307360,2252928,2253056,2253184
.long 2253312,2253440,2253568,2253696,346368,542976,739584,936192,1132800,1329408,1526016
.long 28323840,28258304,28274688,28291072,28307456,4992,163840,24281088,1769600,27336704,1049024
.long 3146176,18432,1073741824,16780300,1073741824,24122368,0,0,1073741824,9551872,9560064
.long 16384000,16392192,76800,71168,14221312,90224,90368,1331360,144256,144384,144512
.long 143360,143488,143616,143744,1376256,1572864,1769472,0,196608,393216,589824
.long 27295744,27312128,27328512,27262976,27279360,5008,174080,24283136,1818752,27338752,1049024
.long 3146176,18464,1073741824,16780300,1073741824,24613888,0,0,1073741824,9551872,9560064
.long 16386048,16394240,76804,71296,14270464,90228,90368,1331360,799616,799744,799872
.long 798720,798848,798976,799104,1425408,1622016,1818624,49152,245760,442368,638976
.long 27299840,27316224,27332608,27267072,27283456,5024,184320,24285184,1867904,27340800,1049024
.long 3146176,18496,1073741824,16780300,1073741824,25105408,0,0,1073741824,9551872,9560064
.long 16580608,16588800,77312,71424,14319616,90232,90368,1331360,1454976,1455104,1455232
.long 1454080,1454208,1454336,1454464,1474560,1671168,1867776,98304,294912,491520,688128
.long 27303936,27320320,27336704,27271168,27287552,5040,194560,24287232,1917056,27342848,1049024
.long 1073741824,18528,1073741824,16780300,1073741824,25596928,0,0,1073741824,9551872,9551872
.long 16582656,16590848,77316,71552,14368768,90236,90368,1331360,2110336,2110464,2110592
.long 2109440,2109568,2109696,2109824,1523712,1720320,1916928,147456,344064,540672,737280
.long 27308032,27324416,27340800,27275264,27291648,21376,409600,24526848,1769984,27500544,1057216
.long 3154368,34816,1073741824,50465804,1073741824,24122368,0,0,1073741824,11649024,11657216
.long 19529728,19537920,84992,73216,15007744,92272,90880,1372320,307456,307584,307712
.long 307840,307968,308096,308224,393216,589824,786432,983040,1179648,1376256,1572864
.long 27336704,27271168,27287552,27303936,27320320,21392,419840,24528896,1819136,27502592,1057216
.long 3154368,34848,1073741824,50465804,1073741824,24613888,0,0,1073741824,11649024,11657216
.long 19531776,19539968,84996,73344,15056896,92276,90880,1372320,962816,962944,963072
.long 963200,963328,963456,963584,442368,638976,835584,1032192,1228800,1425408,1622016
.long 27340800,27275264,27291648,27308032,27324416,21408,430080,24530944,1868288,27504640,1057216
.long 3154368,34880,1073741824,50465804,1073741824,25105408,0,0,1073741824,11649024,11657216
.long 19726336,19734528,85504,73472,15106048,92280,90880,1372320,1618176,1618304,1618432
.long 1618560,1618688,1618816,1618944,491520,688128,884736,1081344,1277952,1474560,1671168
.long 27262976,27279360,27295744,27312128,27328512,21424,440320,24532992,1917440,27506688,1057216
.long 1073741824,34912,1073741824,50465804,1073741824,25596928,0,0,1073741824,11649024,11649024
.long 19728384,19736576,85508,73600,15155200,92284,90880,1372320,2273536,2273664,2273792
.long 2273920,2274048,2274176,2274304,540672,737280,933888,1130496,1327104,1523712,1720320
.long 27267072,27283456,27299840,27316224,27332608,9088,655360,24772608,1770368,27664384,1051072
.long 3148224,18432,1073741824,16780300,1073741824,24122368,0,0,1073741824,10076160,10084352
.long 16433152,16441344,76928,75264,15794176,90736,91392,1413280,144256,144384,144512
.long 143360,143488,143616,143744,1377024,1573632,1770240,768,197376,393984,590592
.long 27623424,27639808,27656192,27590656,27607040,9104,665600,24774656,1819520,27666432,1051072
.long 3148224,18464,1073741824,16780300,1073741824,24613888,0,0,1073741824,10076160,10084352
.long 16435200,16443392,76932,75392,15843328,90740,91392,1413280,799616,799744,799872
.long 798720,798848,798976,799104,1426176,1622784,1819392,49920,246528,443136,639744
.long 27627520,27643904,27660288,27594752,27611136,9120,675840,24776704,1868672,27668480,1051072
.long 3148224,18496,1073741824,16780300,1073741824,25105408,0,0,1073741824,10076160,10084352
.long 16629760,16637952,77440,75520,15892480,90744,91392,1413280,1454976,1455104,1455232
.long 1454080,1454208,1454336,1454464,1475328,1671936,1868544,99072,295680,492288,688896
.long 27631616,27648000,27664384,27598848,27615232,9136,686080,24778752,1917824,27670528,1051072
.long 1073741824,18528,1073741824,16780300,1073741824,25596928,0,0,1073741824,10076160,10076160
.long 16631808,16640000,77444,75648,15941632,90748,91392,1413280,2110336,2110464,2110592
.long 2109440,2109568,2109696,2109824,1524480,1721088,1917696,148224,344832,541440,738048
.long 27635712,27652096,27668480,27602944,27619328,25472,901120,25018368,1770752,27828224,1059264
.long 3156416,34816,1073741824,50465804,1073741824,24122368,0,0,1073741824,12173312,12181504
.long 19578880,19587072,85120,77312,16580608,92784,91904,1454240,307456,307584,307712
.long 307840,307968,308096,308224,393984,590592,787200,983808,1180416,1377024,1573632
.long 27664384,27598848,27615232,27631616,27648000,25488,911360,25020416,1819904,27830272,1059264
.long 3156416,34848,1073741824,50465804,1073741824,24613888,0,0,1073741824,12173312,12181504
.long 19580928,19589120,85124,77440,16629760,92788,91904,1454240,962816,962944,963072
.long 963200,963328,963456,963584,443136,639744,836352,1032960,1229568,1426176,1622784
.long 27668480,27602944,27619328,27635712,27652096,25504,921600,25022464,1869056,27832320,1059264
.long 3156416,34880,1073741824,50465804,1073741824,25105408,0,0,1073741824,12173312,12181504
.long 19775488,19783680,85632,77568,16678912,92792,91904,1454240,1618176,1618304,1618432
.long 1618560,1618688,1618816,1618944,492288,688896,885504,1082112,1278720,1475328,1671936
.long 27590656,27607040,27623424,27639808,27656192,25520,931840,25024512,1918208,27834368,1059264
.long 1073741824,34912,1073741824,50465804,1073741824,25596928,0,0,1073741824,12173312,12173312
.long 19777536,19785728,85636,77696,16728064,92796,91904,1454240,2273536,2273664,2273792
.long 2273920,2274048,2274176,2274304,541440,738048,934656,1131264,1327872,1524480,1721088
.long 27594752,27611136,27627520,27643904,27660288,13184,1146880,25264128,1771136,27992064,1053120
.long 3150272,18432,1073741824,16780300,1073741824,24122368,0,0,1073741824,10600448,10608640
.long 16482304,16490496,77056,79360,17367040,91248,92416,1495200,144256,144384,144512
.long 143360,143488,143616,143744,1377792,1574400,1771008,1536,198144,394752,591360
.long 27951104,27967488,27983872,27918336,27934720,13200,1157120,25266176,1820288,27994112,1053120
.long 3150272,18464,1073741824,16780300,1073741824,24613888,0,0,1073741824,10600448,10608640
.long 16484352,16492544,77060,79488,17416192,91252,92416,1495200,799616,799744,799872
.long 798720,798848,798976,799104,1426944,1623552,1820160,50688,247296,443904,640512
.long 27955200,27971584,27987968,27922432,27938816,13216,1167360,25268224,1869440,27996160,1053120
.long 3150272,18496,1073741824,16780300,1073741824,25105408,0,0,1073741824,10600448,10608640
.long 16678912,16687104,77568,79616,17465344,91256,92416,1495200,1454976,1455104,1455232
.long 1454080,1454208,1454336,1454464,1476096,1672704,1869312,99840,296448,493056,689664
.long 27959296,27975680,27992064,27926528,27942912,13232,1177600,25270272,1918592,27998208,1053120
.long 1073741824,18528,1073741824,16780300,1073741824,25596928,0,0,1073741824,10600448,10600448
.long 16680960,16689152,77572,79744,17514496,91260,92416,1495200,2110336,2110464,2110592
.long 2109440,2109568,2109696,2109824,1525248,1721856,1918464,148992,345600,542208,738816
.long 27963392,27979776,27996160,27930624,27947008,29568,1392640,25509888,1771520,28155904,1061312
.long 3158464,34816,1073741824,50465804,1073741824,24122368,0,0,1073741824,12697600,12705792
.long 19628032,19636224,85248,81408,18153472,93296,92928,1536160,307456,307584,307712
.long 307840,307968,308096,308224,394752,591360,787968,984576,1181184,1377792,1574400
.long 27992064,27926528,27942912,27959296,27975680,29584,1402880,25511936,1820672,28157952,1061312
.long 3158464,34848,1073741824,50465804,1073741824,24613888,0,0,1073741824,12697600,12705792
.long 19630080,19638272,85252,81536,18202624,93300,92928,1536160,962816,962944,963072
.long 963200,963328,963456,963584,443904,640512,837120,1033728,1230336,1426944,1623552
.long 27996160,27930624,27947008,27963392,27979776,29600,1413120,25513984,1869824,28160000,1061312
.long 3158464,34880,1073741824,50465804,1073741824,25105408,0,0,1073741824,12697600,12705792
.long 19824640,19832832,85760,81664,18251776,93304,92928,1536160,1618176,1618304,1618432
.long 1618560,1618688,1618816,1618944,493056,689664,886272,1082880,1279488,1476096,1672704
.long 27918336,27934720,27951104,27967488,27983872,29616,1423360,25516032,1918976,28162048,1061312
.long 1073741824,34912,1073741824,50465804,1073741824,25596928,0,0,1073741824,12697600,12697600
.long 19826688,19834880,85764,81792,18300928,93308,92928,1536160,2273536,2273664,2273792
.long 2273920,2274048,2274176,2274304,542208,738816,935424,1132032,1328640,1525248,1721856
.long 27922432,27938816,27955200,27971584,27987968,17280,1638400,25755648,1771904,28319744,1055168
.long 3152320,18432,1073741824,16780300,1073741824,24122368,0,0,1073741824,11124736,11132928
.long 16531456,16539648,77184,83456,18939904,91760,93440,1577120,144256,144384,144512
.long 143360,143488,143616,143744,1378560,1575168,1771776,2304,198912,395520,592128
.long 28278784,28295168,28311552,28246016,28262400,17296,1648640,25757696,1821056,28321792,1055168
.long 3152320,18464,1073741824,16780300,1073741824,24613888,0,0,1073741824,11124736,11132928
.long 16533504,16541696,77188,83584,18989056,91764,93440,1577120,799616,799744,799872
.long 798720,798848,798976,799104,1427712,1624320,1820928,51456,248064,444672,641280
.long 28282880,28299264,28315648,28250112,28266496,17312,1658880,25759744,1870208,28323840,1055168
.long 3152320,18496,1073741824,16780300,1073741824,25105408,0,0,1073741824,11124736,11132928
.long 16728064,16736256,77696,83712,19038208,91768,93440,1577120,1454976,1455104,1455232
.long 1454080,1454208,1454336,1454464,1476864,1673472,1870080,100608,297216,493824,690432
.long 28286976,28303360,28319744,28254208,28270592,17328,1669120,25761792,1919360,28325888,1055168
.long 1073741824,18528,1073741824,16780300,1073741824,25596928,0,0,1073741824,11124736,11124736
.long 16730112,16738304,77700,83840,19087360,91772,93440,1577120,2110336,2110464,2110592
.long 2109440,2109568,2109696,2109824,1526016,1722624,1919232,149760,346368,542976,739584
.long 28291072,28307456,28323840,28258304,28274688,33664,1884160,26001408,1772288,28483584,1063360
.long 3160512,34816,1073741824,50465804,1073741824,24122368,0,0,1073741824,13221888,13230080
.long 19677184,19685376,85376,85504,19726336,93808,93952,1618080,307456,307584,307712
.long 307840,307968,308096,308224,395520,592128,788736,985344,1181952,1378560,1575168
.long 28319744,28254208,28270592,28286976,28303360,33680,1894400,26003456,1821440,28485632,1063360
.long 3160512,34848,1073741824,50465804,1073741824,24613888,0,0,1073741824,13221888,13230080
.long 19679232,19687424,85380,85632,19775488,93812,93952,1618080,962816,962944,963072
.long 963200,963328,963456,963584,444672,641280,837888,1034496,1231104,1427712,1624320
.long 28323840,28258304,28274688,28291072,28307456,33696,1904640,26005504,1870592,28487680,1063360
.long 3160512,34880,1073741824,50465804,1073741824,25105408,0,0,1073741824,13221888,13230080
.long 19873792,19881984,85888,85760,19824640,93816,93952,1618080,1618176,1618304,1618432
.long 1618560,1618688,1618816,1618944,493824,690432,887040,1083648,1280256,1476864,1673472
.long 28246016,28262400,28278784,28295168,28311552,33712,1914880,26007552,1919744,28489728,1063360
.long 1073741824,34912,1073741824,50465804,1073741824,25596928,0,0,1073741824,13221888,13221888
.long 19875840,19884032,85892,85888,19873792,93820,93952,1618080,2273536,2273664,2273792
.long 2273920,2274048,2274176,2274304,542976,739584,936192,1132800,1329408,1526016,1722624
.long 28250112,28266496,28282880,28299264,28315648,5120,40960,24158208,1073741824,1073741824,1049088
.long 3146240,4096,148,50465804,1130496,24127488,2290649224,2290649224,9437504,9568256,9576448
.long 13647872,13643776,69656,69632,13631488,90240,90112,320,384,512,640
.long 768,896,1024,1152,590080,786688,983296,1179904,1376512,1573120,1769728
.long 27344896,27361280,27377664,27394048,27410432,5136,51200,24160256,1073741824,1073741824,1049088
.long 3146240,4128,657556,50465804,1130496,24619008,2290649224,2290649224,9437504,9568256,9576448
.long 13649920,13645824,69660,69760,13680640,90244,90112,320,655744,655872,656000
.long 656128,656256,656384,656512,639232,835840,1032448,1229056,1425664,1622272,1818880
.long 27348992,27365376,27381760,27398144,27414528,5152,61440,24162304,1073741824,1073741824,1049088
.long 3146240,4160,148,50465804,1130496,25110528,2290649224,2290649224,9437504,9568256,9576448
.long 13844480,13840384,70168,69888,13729792,90248,90112,320,1311104,1311232,1311360
.long 1311488,1311616,1311744,1311872,688384,884992,1081600,1278208,1474816,1671424,1868032
.long 27353088,27369472,27385856,27402240,27418624,5168,71680,24164352,1073741824,1073741824,1049088
.long 1073741824,4192,657556,50465804,1130496,25602048,2290649224,2290649224,9437504,9568256,9568256
.long 13846528,13842432,70172,70016,13778944,90252,90112,320,1966464,1966592,1966720
.long 1966848,1966976,1967104,1967232,737536,934144,1130752,1327360,1523968,1720576,1917184
.long 27357184,27373568,27389952,27406336,27422720,21504,286720,24403968,1073741824,1073741824,1057280
.long 3154432,20480,792,16780300,1490944,24127488,2290649224,2290649224,9438912,11665408,11673600
.long 16793600,16789504,77848,71680,14417920,92288,90624,41280,164864,164992,163840
.long 163968,164096,164224,164352,1573120,1769728,256,196864,393472,590080,786688
.long 27385856,27402240,27418624,27353088,27369472,21520,296960,24406016,1073741824,1073741824,1057280
.long 3154432,20512,658200,16780300,1490944,24619008,2290649224,2290649224,9438912,11665408,11673600
.long 16795648,16791552,77852,71808,14467072,92292,90624,41280,820224,820352,819200
.long 819328,819456,819584,819712,1622272,1818880,49408,246016,442624,639232,835840
.long 27389952,27406336,27422720,27357184,27373568,21536,307200,24408064,1073741824,1073741824,1057280
.long 3154432,20544,792,16780300,1490944,25110528,2290649224,2290649224,9438912,11665408,11673600
.long 16990208,16986112,78360,71936,14516224,92296,90624,41280,1475584,1475712,1474560
.long 1474688,1474816,1474944,1475072,1671424,1868032,98560,295168,491776,688384,884992
.long 27394048,27410432,27344896,27361280,27377664,21552,317440,24410112,1073741824,1073741824,1057280
.long 1073741824,20576,658200,16780300,1490944,25602048,2290649224,2290649224,9438912,11665408,11665408
.long 16992256,16988160,78364,72064,14565376,92300,90624,41280,2130944,2131072,2129920
.long 2130048,2130176,2130304,2130432,1720576,1917184,147712,344320,540928,737536,934144
.long 27398144,27414528,27348992,27365376,27381760,9216,532480,24649728,1073741824,1073741824,1051136
.long 3148288,4096,1432,50465804,1851392,24127488,2290649224,2290649224,9440320,10092544,10100736
.long 13697024,13692928,69784,73728,15204352,90752,91136,82240,384,512,640
.long 768,896,1024,1152,590848,787456,984064,1180672,1377280,1573888,1770496
.long 27672576,27688960,27705344,27721728,27738112,9232,542720,24651776,1073741824,1073741824,1051136
.long 3148288,4128,658840,50465804,1851392,24619008,2290649224,2290649224,9440320,10092544,10100736
.long 13699072,13694976,69788,73856,15253504,90756,91136,82240,655744,655872,656000
.long 656128,656256,656384,656512,640000,836608,1033216,1229824,1426432,1623040,1819648
.long 27676672,27693056,27709440,27725824,27742208,9248,552960,24653824,1073741824,1073741824,1051136
.long 3148288,4160,1432,50465804,1851392,25110528,2290649224,2290649224,9440320,10092544,10100736
.long 13893632,13889536,70296,73984,15302656,90760,91136,82240,1311104,1311232,1311360
.long 1311488,1311616,1311744,1311872,689152,885760,1082368,1278976,1475584,1672192,1868800
.long 27680768,27697152,27713536,27729920,27746304,9264,563200,24655872,1073741824,1073741824,1051136
.long 1073741824,4192,658840,50465804,1851392,25602048,2290649224,2290649224,9440320,10092544,10092544
.long 13895680,13891584,70300,74112,15351808,90764,91136,82240,1966464,1966592,1966720
.long 1966848,1966976,1967104,1967232,738304,934912,1131520,1328128,1524736,1721344,1917952
.long 27684864,27701248,27717632,27734016,27750400,25600,778240,24895488,1073741824,1073741824,1059328
.long 3156480,20480,2076,16780300,2211840,24127488,2290649224,2290649224,9441728,12189696,12197888
.long 16842752,16838656,77976,75776,15990784,92800,91648,123200,164864,164992,163840
.long 163968,164096,164224,164352,1573888,1770496,1024,197632,394240,590848,787456
.long 27713536,27729920,27746304,27680768,27697152,25616,788480,24897536,1073741824,1073741824,1059328
.long 3156480,20512,659484,16780300,2211840,24619008,2290649224,2290649224,9441728,12189696,12197888
.long 16844800,16840704,77980,75904,16039936,92804,91648,123200,820224,820352,819200
.long 819328,819456,819584,819712,1623040,1819648,50176,246784,443392,640000,836608
.long 27717632,27734016,27750400,27684864,27701248,25632,798720,24899584,1073741824,1073741824,1059328
.long 3156480,20544,2076,16780300,2211840,25110528,2290649224,2290649224,9441728,12189696,12197888
.long 17039360,17035264,78488,76032,16089088,92808,91648,123200,1475584,1475712,1474560
.long 1474688,1474816,1474944,1475072,1672192,1868800,99328,295936,492544,689152,885760
.long 27721728,27738112,27672576,27688960,27705344,25648,808960,24901632,1073741824,1073741824,1059328
.long 1073741824,20576,659484,16780300,2211840,25602048,2290649224,2290649224,9441728,12189696,12189696
.long 17041408,17037312,78492,76160,16138240,92812,91648,123200,2130944,2131072,2129920
.long 2130048,2130176,2130304,2130432,1721344,1917952,148480,345088,541696,738304,934912
.long 27725824,27742208,27676672,27693056,27709440,13312,1024000,25141248,1073741824,1073741824,1053184
.long 3150336,4096,2716,50465804,2572288,24127488,2290649224,2290649224,9443136,10616832,10625024
.long 13746176,13742080,69912,77824,16777216,91264,92160,164160,384,512,640
.long 768,896,1024,1152,591616,788224,984832,1181440,1378048,1574656,1771264
.long 28000256,28016640,28033024,28049408,28065792,13328,1034240,25143296,1073741824,1073741824,1053184
.long 3150336,4128,660124,50465804,2572288,24619008,2290649224,2290649224,9443136,10616832,10625024
.long 13748224,13744128,69916,77952,16826368,91268,92160,164160,655744,655872,656000
.long 656128,656256,656384,656512,640768,837376,1033984,1230592,1427200,1623808,1820416
.long 28004352,28020736,28037120,28053504,28069888,13344,1044480,25145344,1073741824,1073741824,1053184
.long 3150336,4160,2716,50465804,2572288,25110528,2290649224,2290649224,9443136,10616832,10625024
.long 13942784,13938688,70424,78080,16875520,91272,92160,164160,1311104,1311232,1311360
.long 1311488,1311616,1311744,1311872,689920,886528,1083136,1279744,1476352,1672960,1869568
.long 28008448,28024832,28041216,28057600,28073984,13360,1054720,25147392,1073741824,1073741824,1053184
.long 1073741824,4192,660124,50465804,2572288,25602048,2290649224,2290649224,9443136,10616832,10616832
.long 13944832,13940736,70428,78208,16924672,91276,92160,164160,1966464,1966592,1966720
.long 1966848,1966976,1967104,1967232,739072,935680,1132288,1328896,1525504,1722112,1918720
.long 28012544,28028928,28045312,28061696,28078080,29696,1269760,25387008,1073741824,1073741824,1061376
.long 3158528,20480,3360,16780300,2932736,24127488,2290649224,2290649224,9444544,12713984,12722176
.long 16891904,16887808,78104,79872,17563648,93312,92672,205120,164864,164992,163840
.long 163968,164096,164224,164352,1574656,1771264,1792,198400,395008,591616,788224
.long 28041216,28057600,28073984,28008448,28024832,29712,1280000,25389056,1073741824,1073741824,1061376
.long 3158528,20512,660768,16780300,2932736,24619008,2290649224,2290649224,9444544,12713984,12722176
.long 16893952,16889856,78108,80000,17612800,93316,92672,205120,820224,820352,819200
.long 819328,819456,819584,819712,1623808,1820416,50944,247552,444160,640768,837376
.long 28045312,28061696,28078080,28012544,28028928,29728,1290240,25391104,1073741824,1073741824,1061376
.long 3158528,20544,3360,16780300,2932736,25110528,2290649224,2290649224,9444544,12713984,12722176
.long 17088512,17084416,78616,80128,17661952,93320,92672,205120,1475584,1475712,1474560
.long 1474688,1474816,1474944,1475072,1672960,1869568,100096,296704,493312,689920,886528
.long 28049408,28065792,28000256,28016640,28033024,29744,1300480,25393152,1073741824,1073741824,1061376
.long 1073741824,20576,660768,16780300,2932736,25602048,2290649224,2290649224,9444544,12713984,12713984
.long 17090560,17086464,78620,80256,17711104,93324,92672,205120,2130944,2131072,2129920
.long 2130048,2130176,2130304,2130432,1722112,1918720,149248,345856,542464,739072,935680
.long 28053504,28069888,28004352,28020736,28037120,17408,1515520,25632768,1073741824,1073741824,1055232
.long 3152384,4096,4000,50465804,3293184,24127488,2290649224,2290649224,9445952,11141120,11149312
.long 13795328,13791232,70040,81920,18350080,91776,93184,246080,384,512,640
.long 768,896,1024,1152,592384,788992,985600,1182208,1378816,1575424,1772032
.long 28327936,28344320,28360704,28377088,28393472,17424,1525760,25634816,1073741824,1073741824,1055232
.long 3152384,4128,661408,50465804,3293184,24619008,2290649224,2290649224,9445952,11141120,11149312
.long 13797376,13793280,70044,82048,18399232,91780,93184,246080,655744,655872,656000
.long 656128,656256,656384,656512,641536,838144,1034752,1231360,1427968,1624576,1821184
.long 28332032,28348416,28364800,28381184,28397568,17440,1536000,25636864,1073741824,1073741824,1055232
.long 3152384,4160,4000,50465804,3293184,25110528,2290649224,2290649224,9445952,11141120,11149312
.long 13991936,13987840,70552,82176,18448384,91784,93184,246080,1311104,1311232,1311360
.long 1311488,1311616,1311744,1311872,690688,887296,1083904,1280512,1477120,1673728,1870336
.long 28336128,28352512,28368896,28385280,28401664,17456,1546240,25638912,1073741824,1073741824,1055232
.long 1073741824,4192,661408,50465804,3293184,25602048,2290649224,2290649224,9445952,11141120,11141120
.long 13993984,13989888,70556,82304,18497536,91788,93184,246080,1966464,1966592,1966720
.long 1966848,1966976,1967104,1967232,739840,936448,1133056,1329664,1526272,1722880,1919488
.long 28340224,28356608,28372992,28389376,28405760,33792,1761280,25878528,1073741824,1073741824,1063424
.long 3160576,20480,4644,16780300,3653632,24127488,2290649224,2290649224,9447360,13238272,13246464
.long 16941056,16936960,78232,83968,19136512,93824,93696,287040,164864,164992,163840
.long 163968,164096,164224,164352,1575424,1772032,2560,199168,395776,592384,788992
.long 28368896,28385280,28401664,28336128,28352512,33808,1771520,25880576,1073741824,1073741824,1063424
.long 3160576,20512,662052,16780300,3653632,24619008,2290649224,2290649224,9447360,13238272,13246464
.long 16943104,16939008,78236,84096,19185664,93828,93696,287040,820224,820352,819200
.long 819328,819456,819584,819712,1624576,1821184,51712,248320,444928,641536,838144
.long 28372992,28389376,28405760,28340224,28356608,33824,1781760,25882624,1073741824,1073741824,1063424
.long 3160576,20544,4644,16780300,3653632,25110528,2290649224,2290649224,9447360,13238272,13246464
.long 17137664,17133568,78744,84224,19234816,93832,93696,287040,1475584,1475712,1474560
.long 1474688,1474816,1474944,1475072,1673728,1870336,100864,297472,494080,690688,887296
.long 28377088,28393472,28327936,28344320,28360704,33840,1792000,25884672,1073741824,1073741824,1063424
.long 1073741824,20576,662052,16780300,3653632,25602048,2290649224,2290649224,9447360,13238272,13238272
.long 17139712,17135616,78748,84352,19283968,93836,93696,287040,2130944,2131072,2129920
.long 2130048,2130176,2130304,2130432,1722880,1919488,150016,346624,543232,739840,936448
.long 28381184,28397568,28332032,28348416,28364800,5248,41216,24166400,1073741824,1073741824,1049152
.long 3146304,6144,180,16780300,1146880,24127488,2290649224,2290649224,9437568,9584640,9592832
.long 14041088,14036992,70680,70144,13828096,90256,90112,1311040,20864,20992,21120
.long 21248,21376,21504,21632,590080,786688,983296,1179904,1376512,1573120,1769728
.long 27344896,27361280,27377664,27394048,27410432,5264,51456,24168448,1073741824,1073741824,1049152
.long 3146304,6176,657588,16780300,1146880,24619008,2290649224,2290649224,9437568,9584640,9592832
.long 14043136,14039040,70684,70272,13877248,90260,90112,1311040,676224,676352,676480
.long 676608,676736,676864,676992,639232,835840,1032448,1229056,1425664,1622272,1818880
.long 27348992,27365376,27381760,27398144,27414528,5280,61696,24170496,1073741824,1073741824,1049152
.long 3146304,6208,180,16780300,1146880,25110528,2290649224,2290649224,9437568,9584640,9592832
.long 14237696,14233600,71192,70400,13926400,90264,90112,1311040,1331584,1331712,1331840
.long 1331968,1332096,1332224,1332352,688384,884992,1081600,1278208,1474816,1671424,1868032
.long 27353088,27369472,27385856,27402240,27418624,5296,71936,24172544,1073741824,1073741824,1049152
.long 1073741824,6240,657588,16780300,1146880,25602048,2290649224,2290649224,9437568,9584640,9584640
.long 14239744,14235648,71196,70528,13975552,90268,90112,1311040,1986944,1987072,1987200
.long 1987328,1987456,1987584,1987712,737536,934144,1130752,1327360,1523968,1720576,1917184
.long 27357184,27373568,27389952,27406336,27422720,21632,286976,24412160,1073741824,1073741824,1057344
.long 3154496,22528,820,50465804,1507328,24127488,2290649224,2290649224,9438976,11681792,11689984
.long 17186816,17182720,78872,72192,14614528,92304,90624,1352000,185344,185472,184320
.long 184448,184576,184704,184832,1573120,1769728,256,196864,393472,590080,786688
.long 27385856,27402240,27418624,27353088,27369472,21648,297216,24414208,1073741824,1073741824,1057344
.long 3154496,22560,658228,50465804,1507328,24619008,2290649224,2290649224,9438976,11681792,11689984
.long 17188864,17184768,78876,72320,14663680,92308,90624,1352000,840704,840832,839680
.long 839808,839936,840064,840192,1622272,1818880,49408,246016,442624,639232,835840
.long 27389952,27406336,27422720,27357184,27373568,21664,307456,24416256,1073741824,1073741824,1057344
.long 3154496,22592,820,50465804,1507328,25110528,2290649224,2290649224,9438976,11681792,11689984
.long 17383424,17379328,79384,72448,14712832,92312,90624,1352000,1496064,1496192,1495040
.long 1495168,1495296,1495424,1495552,1671424,1868032,98560,295168,491776,688384,884992
.long 27394048,27410432,27344896,27361280,27377664,21680,317696,24418304,1073741824,1073741824,1057344
.long 1073741824,22624,658228,50465804,1507328,25602048,2290649224,2290649224,9438976,11681792,11681792
.long 17385472,17381376,79388,72576,14761984,92316,90624,1352000,2151424,2151552,2150400
.long 2150528,2150656,2150784,2150912,1720576,1917184,147712,344320,540928,737536,934144
.long 27398144,27414528,27348992,27365376,27381760,9344,532736,24657920,1073741824,1073741824,1051200
.long 3148352,6144,1464,16780300,1867776,24127488,2290649224,2290649224,9440384,10108928,10117120
.long 14090240,14086144,70808,74240,15400960,90768,91136,1392960,20864,20992,21120
.long 21248,21376,21504,21632,590848,787456,984064,1180672,1377280,1573888,1770496
.long 27672576,27688960,27705344,27721728,27738112,9360,542976,24659968,1073741824,1073741824,1051200
.long 3148352,6176,658872,16780300,1867776,24619008,2290649224,2290649224,9440384,10108928,10117120
.long 14092288,14088192,70812,74368,15450112,90772,91136,1392960,676224,676352,676480
.long 676608,676736,676864,676992,640000,836608,1033216,1229824,1426432,1623040,1819648
.long 27676672,27693056,27709440,27725824,27742208,9376,553216,24662016,1073741824,1073741824,1051200
.long 3148352,6208,1464,16780300,1867776,25110528,2290649224,2290649224,9440384,10108928,10117120
.long 14286848,14282752,71320,74496,15499264,90776,91136,1392960,1331584,1331712,1331840
.long 1331968,1332096,1332224,1332352,689152,885760,1082368,1278976,1475584,1672192,1868800
.long 27680768,27697152,27713536,27729920,27746304,9392,563456,24664064,1073741824,1073741824,1051200
.long 1073741824,6240,658872,16780300,1867776,25602048,2290649224,2290649224,9440384,10108928,10108928
.long 14288896,14284800,71324,74624,15548416,90780,91136,1392960,1986944,1987072,1987200
.long 1987328,1987456,1987584,1987712,738304,934912,1131520,1328128,1524736,1721344,1917952
.long 27684864,27701248,27717632,27734016,27750400,25728,778496,24903680,1073741824,1073741824,1059392
.long 3156544,22528,2104,50465804,2228224,24127488,2290649224,2290649224,9441792,12206080,12214272
.long 17235968,17231872,79000,76288,16187392,92816,91648,1433920,185344,185472,184320
.long 184448,184576,184704,184832,1573888,1770496,1024,197632,394240,590848,787456
.long 27713536,27729920,27746304,27680768,27697152,25744,788736,24905728,1073741824,1073741824,1059392
.long 3156544,22560,659512,50465804,2228224,24619008,2290649224,2290649224,9441792,12206080,12214272
.long 17238016,17233920,79004,76416,16236544,92820,91648,1433920,840704,840832,839680
.long 839808,839936,840064,840192,1623040,1819648,50176,246784,443392,640000,836608
.long 27717632,27734016,27750400,27684864,27701248,25760,798976,24907776,1073741824,1073741824,1059392
.long 3156544,22592,2104,50465804,2228224,25110528,2290649224,2290649224,9441792,12206080,12214272
.long 17432576,17428480,79512,76544,16285696,92824,91648,1433920,1496064,1496192,1495040
.long 1495168,1495296,1495424,1495552,1672192,1868800,99328,295936,492544,689152,885760
.long 27721728,27738112,27672576,27688960,27705344,25776,809216,24909824,1073741824,1073741824,1059392
.long 1073741824,22624,659512,50465804,2228224,25602048,2290649224,2290649224,9441792,12206080,12206080
.long 17434624,17430528,79516,76672,16334848,92828,91648,1433920,2151424,2151552,2150400
.long 2150528,2150656,2150784,2150912,1721344,1917952,148480,345088,541696,738304,934912
.long 27725824,27742208,27676672,27693056,27709440,13440,1024256,25149440,1073741824,1073741824,1053248
.long 3150400,6144,2748,16780300,2588672,24127488,2290649224,2290649224,9443200,10633216,10641408
.long 14139392,14135296,70936,78336,16973824,91280,92160,1474880,20864,20992,21120
.long 21248,21376,21504,21632,591616,788224,984832,1181440,1378048,1574656,1771264
.long 28000256,28016640,28033024,28049408,28065792,13456,1034496,25151488,1073741824,1073741824,1053248
.long 3150400,6176,660156,16780300,2588672,24619008,2290649224,2290649224,9443200,10633216,10641408
.long 14141440,14137344,70940,78464,17022976,91284,92160,1474880,676224,676352,676480
.long 676608,676736,676864,676992,640768,837376,1033984,1230592,1427200,1623808,1820416
.long 28004352,28020736,28037120,28053504,28069888,13472,1044736,25153536,1073741824,1073741824,1053248
.long 3150400,6208,2748,16780300,2588672,25110528,2290649224,2290649224,9443200,10633216,10641408
.long 14336000,14331904,71448,78592,17072128,91288,92160,1474880,1331584,1331712,1331840
.long 1331968,1332096,1332224,1332352,689920,886528,1083136,1279744,1476352,1672960,1869568
.long 28008448,28024832,28041216,28057600,28073984,13488,1054976,25155584,1073741824,1073741824,1053248
.long 1073741824,6240,660156,16780300,2588672,25602048,2290649224,2290649224,9443200,10633216,10633216
.long 14338048,14333952,71452,78720,17121280,91292,92160,1474880,1986944,1987072,1987200
.long 1987328,1987456,1987584,1987712,739072,935680,1132288,1328896,1525504,1722112,1918720
.long 28012544,28028928,28045312,28061696,28078080,29824,1270016,25395200,1073741824,1073741824,1061440
.long 3158592,22528,3388,50465804,2949120,24127488,2290649224,2290649224,9444608,12730368,12738560
.long 17285120,17281024,79128,80384,17760256,93328,92672,1515840,185344,185472,184320
.long 184448,184576,184704,184832,1574656,1771264,1792,198400,395008,591616,788224
.long 28041216,28057600,28073984,28008448,28024832,29840,1280256,25397248,1073741824,1073741824,1061440
.long 3158592,22560,660796,50465804,2949120,24619008,2290649224,2290649224,9444608,12730368,12738560
.long 17287168,17283072,79132,80512,17809408,93332,92672,1515840,840704,840832,839680
.long 839808,839936,840064,840192,1623808,1820416,50944,247552,444160,640768,837376
.long 28045312,28061696,28078080,28012544,28028928,29856,1290496,25399296,1073741824,1073741824,1061440
.long 3158592,22592,3388,50465804,2949120,25110528,2290649224,2290649224,9444608,12730368,12738560
.long 17481728,17477632,79640,80640,17858560,93336,92672,1515840,1496064,1496192,1495040
.long 1495168,1495296,1495424,1495552,1672960,1869568,100096,296704,493312,689920,886528
.long 28049408,28065792,28000256,28016640,28033024,29872,1300736,25401344,1073741824,1073741824,1061440
.long 1073741824,22624,660796,50465804,2949120,25602048,2290649224,2290649224,9444608,12730368,12730368
.long 17483776,17479680,79644,80768,17907712,93340,92672,1515840,2151424,2151552,2150400
.long 2150528,2150656,2150784,2150912,1722112,1918720,149248,345856,542464,739072,935680
.long 28053504,28069888,28004352,28020736,28037120,17536,1515776,25640960,1073741824,1073741824,1055296
.long 3152448,6144,4032,16780300,3309568,24127488,2290649224,2290649224,9446016,11157504,11165696
.long 14188544,14184448,71064,82432,18546688,91792,93184,1556800,20864,20992,21120
.long 21248,21376,21504,21632,592384,788992,985600,1182208,1378816,1575424,1772032
.long 28327936,28344320,28360704,28377088,28393472,17552,1526016,25643008,1073741824,1073741824,1055296
.long 3152448,6176,661440,16780300,3309568,24619008,2290649224,2290649224,9446016,11157504,11165696
.long 14190592,14186496,71068,82560,18595840,91796,93184,1556800,676224,676352,676480
.long 676608,676736,676864,676992,641536,838144,1034752,1231360,1427968,1624576,1821184
.long 28332032,28348416,28364800,28381184,28397568,17568,1536256,25645056,1073741824,1073741824,1055296
.long 3152448,6208,4032,16780300,3309568,25110528,2290649224,2290649224,9446016,11157504,11165696
.long 14385152,14381056,71576,82688,18644992,91800,93184,1556800,1331584,1331712,1331840
.long 1331968,1332096,1332224,1332352,690688,887296,1083904,1280512,1477120,1673728,1870336
.long 28336128,28352512,28368896,28385280,28401664,17584,1546496,25647104,1073741824,1073741824,1055296
.long 1073741824,6240,661440,16780300,3309568,25602048,2290649224,2290649224,9446016,11157504,11157504
.long 14387200,14383104,71580,82816,18694144,91804,93184,1556800,1986944,1987072,1987200
.long 1987328,1987456,1987584,1987712,739840,936448,1133056,1329664,1526272,1722880,1919488
.long 28340224,28356608,28372992,28389376,28405760,33920,1761536,25886720,1073741824,1073741824,1063488
.long 3160640,22528,4672,50465804,3670016,24127488,2290649224,2290649224,9447424,13254656,13262848
.long 17334272,17330176,79256,84480,19333120,93840,93696,1597760,185344,185472,184320
.long 184448,184576,184704,184832,1575424,1772032,2560,199168,395776,592384,788992
.long 28368896,28385280,28401664,28336128,28352512,33936,1771776,25888768,1073741824,1073741824,1063488
.long 3160640,22560,662080,50465804,3670016,24619008,2290649224,2290649224,9447424,13254656,13262848
.long 17336320,17332224,79260,84608,19382272,93844,93696,1597760,840704,840832,839680
.long 839808,839936,840064,840192,1624576,1821184,51712,248320,444928,641536,838144
.long 28372992,28389376,28405760,28340224,28356608,33952,1782016,25890816,1073741824,1073741824,1063488
.long 3160640,22592,4672,50465804,3670016,25110528,2290649224,2290649224,9447424,13254656,13262848
.long 17530880,17526784,79768,84736,19431424,93848,93696,1597760,1496064,1496192,1495040
.long 1495168,1495296,1495424,1495552,1673728,1870336,100864,297472,494080,690688,887296
.long 28377088,28393472,28327936,28344320,28360704,33968,1792256,25892864,1073741824,1073741824,1063488
.long 1073741824,22624,662080,50465804,3670016,25602048,2290649224,2290649224,9447424,13254656,13254656
.long 17532928,17528832,79772,84864,19480576,93852,93696,1597760,2151424,2151552,2150400
.long 2150528,2150656,2150784,2150912,1722880,1919488,150016,346624,543232,739840,936448
.long 28381184,28397568,28332032,28348416,28364800,5376,41472,24174592,1073741824,1073741824,1049216
.long 3146368,8192,208,50465804,1163264,24127488,2290649224,2290649224,9437632,9601024,9609216
.long 14434304,14430208,71704,70656,14024704,90272,90368,20800,41472,41600,41728
.long 41856,41984,42112,40960,786688,983296,1179904,1376512,1573120,1769728,256
.long 27353088,27369472,27385856,27402240,27418624,5392,51712,24176640,1073741824,1073741824,1049216
.long 3146368,8224,657616,50465804,1163264,24619008,2290649224,2290649224,9437632,9601024,9609216
.long 14436352,14432256,71708,70784,14073856,90276,90368,20800,696832,696960,697088
.long 697216,697344,697472,696320,835840,1032448,1229056,1425664,1622272,1818880,49408
.long 27357184,27373568,27389952,27406336,27422720,5408,61952,24178688,1073741824,1073741824,1049216
.long 3146368,8256,208,50465804,1163264,25110528,2290649224,2290649224,9437632,9601024,9609216
.long 14630912,14626816,72216,70912,14123008,90280,90368,20800,1352192,1352320,1352448
.long 1352576,1352704,1352832,1351680,884992,1081600,1278208,1474816,1671424,1868032,98560
.long 27361280,27377664,27394048,27410432,27344896,5424,72192,24180736,1073741824,1073741824,1049216
.long 1073741824,8288,657616,50465804,1163264,25602048,2290649224,2290649224,9437632,9601024,9601024
.long 14632960,14628864,72220,71040,14172160,90284,90368,20800,2007552,2007680,2007808
.long 2007936,2008064,2008192,2007040,934144,1130752,1327360,1523968,1720576,1917184,147712
.long 27365376,27381760,27398144,27414528,27348992,21760,287232,24420352,1073741824,1073741824,1057408
.long 3154560,24576,852,16780300,1523712,24127488,2290649224,2290649224,9439040,11698176,11706368
.long 17580032,17575936,79896,72704,14811136,92320,90880,61760,205952,204800,204928
.long 205056,205184,205312,205440,1769728,256,196864,393472,590080,786688,983296
.long 27394048,27410432,27344896,27361280,27377664,21776,297472,24422400,1073741824,1073741824,1057408
.long 3154560,24608,658260,16780300,1523712,24619008,2290649224,2290649224,9439040,11698176,11706368
.long 17582080,17577984,79900,72832,14860288,92324,90880,61760,861312,860160,860288
.long 860416,860544,860672,860800,1818880,49408,246016,442624,639232,835840,1032448
.long 27398144,27414528,27348992,27365376,27381760,21792,307712,24424448,1073741824,1073741824,1057408
.long 3154560,24640,852,16780300,1523712,25110528,2290649224,2290649224,9439040,11698176,11706368
.long 17776640,17772544,80408,72960,14909440,92328,90880,61760,1516672,1515520,1515648
.long 1515776,1515904,1516032,1516160,1868032,98560,295168,491776,688384,884992,1081600
.long 27402240,27418624,27353088,27369472,27385856,21808,317952,24426496,1073741824,1073741824,1057408
.long 1073741824,24672,658260,16780300,1523712,25602048,2290649224,2290649224,9439040,11698176,11698176
.long 17778688,17774592,80412,73088,14958592,92332,90880,61760,2172032,2170880,2171008
.long 2171136,2171264,2171392,2171520,1917184,147712,344320,540928,737536,934144,1130752
.long 27406336,27422720,27357184,27373568,27389952,9472,532992,24666112,1073741824,1073741824,1051264
.long 3148416,8192,1492,50465804,1884160,24127488,2290649224,2290649224,9440448,10125312,10133504
.long 14483456,14479360,71832,74752,15597568,90784,91392,102720,41472,41600,41728
.long 41856,41984,42112,40960,787456,984064,1180672,1377280,1573888,1770496,1024
.long 27680768,27697152,27713536,27729920,27746304,9488,543232,24668160,1073741824,1073741824,1051264
.long 3148416,8224,658900,50465804,1884160,24619008,2290649224,2290649224,9440448,10125312,10133504
.long 14485504,14481408,71836,74880,15646720,90788,91392,102720,696832,696960,697088
.long 697216,697344,697472,696320,836608,1033216,1229824,1426432,1623040,1819648,50176
.long 27684864,27701248,27717632,27734016,27750400,9504,553472,24670208,1073741824,1073741824,1051264
.long 3148416,8256,1492,50465804,1884160,25110528,2290649224,2290649224,9440448,10125312,10133504
.long 14680064,14675968,72344,75008,15695872,90792,91392,102720,1352192,1352320,1352448
.long 1352576,1352704,1352832,1351680,885760,1082368,1278976,1475584,1672192,1868800,99328
.long 27688960,27705344,27721728,27738112,27672576,9520,563712,24672256,1073741824,1073741824,1051264
.long 1073741824,8288,658900,50465804,1884160,25602048,2290649224,2290649224,9440448,10125312,10125312
.long 14682112,14678016,72348,75136,15745024,90796,91392,102720,2007552,2007680,2007808
.long 2007936,2008064,2008192,2007040,934912,1131520,1328128,1524736,1721344,1917952,148480
.long 27693056,27709440,27725824,27742208,27676672,25856,778752,24911872,1073741824,1073741824,1059456
.long 3156608,24576,2136,16780300,2244608,24127488,2290649224,2290649224,9441856,12222464,12230656
.long 17629184,17625088,80024,76800,16384000,92832,91904,143680,205952,204800,204928
.long 205056,205184,205312,205440,1770496,1024,197632,394240,590848,787456,984064
.long 27721728,27738112,27672576,27688960,27705344,25872,788992,24913920,1073741824,1073741824,1059456
.long 3156608,24608,659544,16780300,2244608,24619008,2290649224,2290649224,9441856,12222464,12230656
.long 17631232,17627136,80028,76928,16433152,92836,91904,143680,861312,860160,860288
.long 860416,860544,860672,860800,1819648,50176,246784,443392,640000,836608,1033216
.long 27725824,27742208,27676672,27693056,27709440,25888,799232,24915968,1073741824,1073741824,1059456
.long 3156608,24640,2136,16780300,2244608,25110528,2290649224,2290649224,9441856,12222464,12230656
.long 17825792,17821696,80536,77056,16482304,92840,91904,143680,1516672,1515520,1515648
.long 1515776,1515904,1516032,1516160,1868800,99328,295936,492544,689152,885760,1082368
.long 27729920,27746304,27680768,27697152,27713536,25904,809472,24918016,1073741824,1073741824,1059456
.long 1073741824,24672,659544,16780300,2244608,25602048,2290649224,2290649224,9441856,12222464,12222464
.long 17827840,17823744,80540,77184,16531456,92844,91904,143680,2172032,2170880,2171008
.long 2171136,2171264,2171392,2171520,1917952,148480,345088,541696,738304,934912,1131520
.long 27734016,27750400,27684864,27701248,27717632,13568,1024512,25157632,1073741824,1073741824,1053312
.long 3150464,8192,2776,50465804,2605056,24127488,2290649224,2290649224,9443264,10649600,10657792
.long 14532608,14528512,71960,78848,17170432,91296,92416,184640,41472,41600,41728
.long 41856,41984,42112,40960,788224,984832,1181440,1378048,1574656,1771264,1792
.long 28008448,28024832,28041216,28057600,28073984,13584,1034752,25159680,1073741824,1073741824,1053312
.long 3150464,8224,660184,50465804,2605056,24619008,2290649224,2290649224,9443264,10649600,10657792
.long 14534656,14530560,71964,78976,17219584,91300,92416,184640,696832,696960,697088
.long 697216,697344,697472,696320,837376,1033984,1230592,1427200,1623808,1820416,50944
.long 28012544,28028928,28045312,28061696,28078080,13600,1044992,25161728,1073741824,1073741824,1053312
.long 3150464,8256,2776,50465804,2605056,25110528,2290649224,2290649224,9443264,10649600,10657792
.long 14729216,14725120,72472,79104,17268736,91304,92416,184640,1352192,1352320,1352448
.long 1352576,1352704,1352832,1351680,886528,1083136,1279744,1476352,1672960,1869568,100096
.long 28016640,28033024,28049408,28065792,28000256,13616,1055232,25163776,1073741824,1073741824,1053312
.long 1073741824,8288,660184,50465804,2605056,25602048,2290649224,2290649224,9443264,10649600,10649600
.long 14731264,14727168,72476,79232,17317888,91308,92416,184640,2007552,2007680,2007808
.long 2007936,2008064,2008192,2007040,935680,1132288,1328896,1525504,1722112,1918720,149248
.long 28020736,28037120,28053504,28069888,28004352,29952,1270272,25403392,1073741824,1073741824,1061504
.long 3158656,24576,3420,16780300,2965504,24127488,2290649224,2290649224,9444672,12746752,12754944
.long 17678336,17674240,80152,80896,17956864,93344,92928,225600,205952,204800,204928
.long 205056,205184,205312,205440,1771264,1792,198400,395008,591616,788224,984832
.long 28049408,28065792,28000256,28016640,28033024,29968,1280512,25405440,1073741824,1073741824,1061504
.long 3158656,24608,660828,16780300,2965504,24619008,2290649224,2290649224,9444672,12746752,12754944
.long 17680384,17676288,80156,81024,18006016,93348,92928,225600,861312,860160,860288
.long 860416,860544,860672,860800,1820416,50944,247552,444160,640768,837376,1033984
.long 28053504,28069888,28004352,28020736,28037120,29984,1290752,25407488,1073741824,1073741824,1061504
.long 3158656,24640,3420,16780300,2965504,25110528,2290649224,2290649224,9444672,12746752,12754944
.long 17874944,17870848,80664,81152,18055168,93352,92928,225600,1516672,1515520,1515648
.long 1515776,1515904,1516032,1516160,1869568,100096,296704,493312,689920,886528,1083136
.long 28057600,28073984,28008448,28024832,28041216,30000,1300992,25409536,1073741824,1073741824,1061504
.long 1073741824,24672,660828,16780300,2965504,25602048,2290649224,2290649224,9444672,12746752,12746752
.long 17876992,17872896,80668,81280,18104320,93356,92928,225600,2172032,2170880,2171008
.long 2171136,2171264,2171392,2171520,1918720,149248,345856,542464,739072,935680,1132288
.long 28061696,28078080,28012544,28028928,28045312,17664,1516032,25649152,1073741824,1073741824,1055360
.long 3152512,8192,4060,50465804,3325952,24127488,2290649224,2290649224,9446080,11173888,11182080
.long 14581760,14577664,72088,82944,18743296,91808,93440,266560,41472,41600,41728
.long 41856,41984,42112,40960,788992,985600,1182208,1378816,1575424,1772032,2560
.long 28336128,28352512,28368896,28385280,28401664,17680,1526272,25651200,1073741824,1073741824,1055360
.long 3152512,8224,661468,50465804,3325952,24619008,2290649224,2290649224,9446080,11173888,11182080
.long 14583808,14579712,72092,83072,18792448,91812,93440,266560,696832,696960,697088
.long 697216,697344,697472,696320,838144,1034752,1231360,1427968,1624576,1821184,51712
.long 28340224,28356608,28372992,28389376,28405760,17696,1536512,25653248,1073741824,1073741824,1055360
.long 3152512,8256,4060,50465804,3325952,25110528,2290649224,2290649224,9446080,11173888,11182080
.long 14778368,14774272,72600,83200,18841600,91816,93440,266560,1352192,1352320,1352448
.long 1352576,1352704,1352832,1351680,887296,1083904,1280512,1477120,1673728,1870336,100864
.long 28344320,28360704,28377088,28393472,28327936,17712,1546752,25655296,1073741824,1073741824,1055360
.long 1073741824,8288,661468,50465804,3325952,25602048,2290649224,2290649224,9446080,11173888,11173888
.long 14780416,14776320,72604,83328,18890752,91820,93440,266560,2007552,2007680,2007808
.long 2007936,2008064,2008192,2007040,936448,1133056,1329664,1526272,1722880,1919488,150016
.long 28348416,28364800,28381184,28397568,28332032,34048,1761792,25894912,1073741824,1073741824,1063552
.long 3160704,24576,4704,16780300,3686400,24127488,2290649224,2290649224,9447488,13271040,13279232
.long 17727488,17723392,80280,84992,19529728,93856,93952,307520,205952,204800,204928
.long 205056,205184,205312,205440,1772032,2560,199168,395776,592384,788992,985600
.long 28377088,28393472,28327936,28344320,28360704,34064,1772032,25896960,1073741824,1073741824,1063552
.long 3160704,24608,662112,16780300,3686400,24619008,2290649224,2290649224,9447488,13271040,13279232
.long 17729536,17725440,80284,85120,19578880,93860,93952,307520,861312,860160,860288
.long 860416,860544,860672,860800,1821184,51712,248320,444928,641536,838144,1034752
.long 28381184,28397568,28332032,28348416,28364800,34080,1782272,25899008,1073741824,1073741824,1063552
.long 3160704,24640,4704,16780300,3686400,25110528,2290649224,2290649224,9447488,13271040,13279232
.long 17924096,17920000,80792,85248,19628032,93864,93952,307520,1516672,1515520,1515648
.long 1515776,1515904,1516032,1516160,1870336,100864,297472,494080,690688,887296,1083904
.long 28385280,28401664,28336128,28352512,28368896,34096,1792512,25901056,1073741824,1073741824,1063552
.long 1073741824,24672,662112,16780300,3686400,25602048,2290649224,2290649224,9447488,13271040,13271040
.long 17926144,17922048,80796,85376,19677184,93868,93952,307520,2172032,2170880,2171008
.long 2171136,2171264,2171392,2171520,1919488,150016,346624,543232,739840,936448,1133056
.long 28389376,28405760,28340224,28356608,28372992,5504,41728,24182784,1073741824,1073741824,1049280
.long 3146432,10240,240,16780300,1179648,24127488,2290649224,2290649224,9437696,9617408,9625600
.long 14827520,14823424,72728,71168,14221312,90288,90368,1331520,61952,62080,62208
.long 62336,62464,62592,61440,786688,983296,1179904,1376512,1573120,1769728,256
.long 27353088,27369472,27385856,27402240,27418624,5520,51968,24184832,1073741824,1073741824,1049280
.long 3146432,10272,657648,16780300,1179648,24619008,2290649224,2290649224,9437696,9617408,9625600
.long 14829568,14825472,72732,71296,14270464,90292,90368,1331520,717312,717440,717568
.long 717696,717824,717952,716800,835840,1032448,1229056,1425664,1622272,1818880,49408
.long 27357184,27373568,27389952,27406336,27422720,5536,62208,24186880,1073741824,1073741824,1049280
.long 3146432,10304,240,16780300,1179648,25110528,2290649224,2290649224,9437696,9617408,9625600
.long 15024128,15020032,73240,71424,14319616,90296,90368,1331520,1372672,1372800,1372928
.long 1373056,1373184,1373312,1372160,884992,1081600,1278208,1474816,1671424,1868032,98560
.long 27361280,27377664,27394048,27410432,27344896,5552,72448,24188928,1073741824,1073741824,1049280
.long 1073741824,10336,657648,16780300,1179648,25602048,2290649224,2290649224,9437696,9617408,9617408
.long 15026176,15022080,73244,71552,14368768,90300,90368,1331520,2028032,2028160,2028288
.long 2028416,2028544,2028672,2027520,934144,1130752,1327360,1523968,1720576,1917184,147712
.long 27365376,27381760,27398144,27414528,27348992,21888,287488,24428544,1073741824,1073741824,1057472
.long 3154624,26624,880,50465804,1540096,24127488,2290649224,2290649224,9439104,11714560,11722752
.long 17973248,17969152,80920,73216,15007744,92336,90880,1372480,226432,225280,225408
.long 225536,225664,225792,225920,1769728,256,196864,393472,590080,786688,983296
.long 27394048,27410432,27344896,27361280,27377664,21904,297728,24430592,1073741824,1073741824,1057472
.long 3154624,26656,658288,50465804,1540096,24619008,2290649224,2290649224,9439104,11714560,11722752
.long 17975296,17971200,80924,73344,15056896,92340,90880,1372480,881792,880640,880768
.long 880896,881024,881152,881280,1818880,49408,246016,442624,639232,835840,1032448
.long 27398144,27414528,27348992,27365376,27381760,21920,307968,24432640,1073741824,1073741824,1057472
.long 3154624,26688,880,50465804,1540096,25110528,2290649224,2290649224,9439104,11714560,11722752
.long 18169856,18165760,81432,73472,15106048,92344,90880,1372480,1537152,1536000,1536128
.long 1536256,1536384,1536512,1536640,1868032,98560,295168,491776,688384,884992,1081600
.long 27402240,27418624,27353088,27369472,27385856,21936,318208,24434688,1073741824,1073741824,1057472
.long 1073741824,26720,658288,50465804,1540096,25602048,2290649224,2290649224,9439104,11714560,11714560
.long 18171904,18167808,81436,73600,15155200,92348,90880,1372480,2192512,2191360,2191488
.long 2191616,2191744,2191872,2192000,1917184,147712,344320,540928,737536,934144,1130752
.long 27406336,27422720,27357184,27373568,27389952,9600,533248,24674304,1073741824,1073741824,1051328
.long 3148480,10240,1524,16780300,1900544,24127488,2290649224,2290649224,9440512,10141696,10149888
.long 14876672,14872576,72856,75264,15794176,90800,91392,1413440,61952,62080,62208
.long 62336,62464,62592,61440,787456,984064,1180672,1377280,1573888,1770496,1024
.long 27680768,27697152,27713536,27729920,27746304,9616,543488,24676352,1073741824,1073741824,1051328
.long 3148480,10272,658932,16780300,1900544,24619008,2290649224,2290649224,9440512,10141696,10149888
.long 14878720,14874624,72860,75392,15843328,90804,91392,1413440,717312,717440,717568
.long 717696,717824,717952,716800,836608,1033216,1229824,1426432,1623040,1819648,50176
.long 27684864,27701248,27717632,27734016,27750400,9632,553728,24678400,1073741824,1073741824,1051328
.long 3148480,10304,1524,16780300,1900544,25110528,2290649224,2290649224,9440512,10141696,10149888
.long 15073280,15069184,73368,75520,15892480,90808,91392,1413440,1372672,1372800,1372928
.long 1373056,1373184,1373312,1372160,885760,1082368,1278976,1475584,1672192,1868800,99328
.long 27688960,27705344,27721728,27738112,27672576,9648,563968,24680448,1073741824,1073741824,1051328
.long 1073741824,10336,658932,16780300,1900544,25602048,2290649224,2290649224,9440512,10141696,10141696
.long 15075328,15071232,73372,75648,15941632,90812,91392,1413440,2028032,2028160,2028288
.long 2028416,2028544,2028672,2027520,934912,1131520,1328128,1524736,1721344,1917952,148480
.long 27693056,27709440,27725824,27742208,27676672,25984,779008,24920064,1073741824,1073741824,1059520
.long 3156672,26624,2164,50465804,2260992,24127488,2290649224,2290649224,9441920,12238848,12247040
.long 18022400,18018304,81048,77312,16580608,92848,91904,1454400,226432,225280,225408
.long 225536,225664,225792,225920,1770496,1024,197632,394240,590848,787456,984064
.long 27721728,27738112,27672576,27688960,27705344,26000,789248,24922112,1073741824,1073741824,1059520
.long 3156672,26656,659572,50465804,2260992,24619008,2290649224,2290649224,9441920,12238848,12247040
.long 18024448,18020352,81052,77440,16629760,92852,91904,1454400,881792,880640,880768
.long 880896,881024,881152,881280,1819648,50176,246784,443392,640000,836608,1033216
.long 27725824,27742208,27676672,27693056,27709440,26016,799488,24924160,1073741824,1073741824,1059520
.long 3156672,26688,2164,50465804,2260992,25110528,2290649224,2290649224,9441920,12238848,12247040
.long 18219008,18214912,81560,77568,16678912,92856,91904,1454400,1537152,1536000,1536128
.long 1536256,1536384,1536512,1536640,1868800,99328,295936,492544,689152,885760,1082368
.long 27729920,27746304,27680768,27697152,27713536,26032,809728,24926208,1073741824,1073741824,1059520
.long 1073741824,26720,659572,50465804,2260992,25602048,2290649224,2290649224,9441920,12238848,12238848
.long 18221056,18216960,81564,77696,16728064,92860,91904,1454400,2192512,2191360,2191488
.long 2191616,2191744,2191872,2192000,1917952,148480,345088,541696,738304,934912,1131520
.long 27734016,27750400,27684864,27701248,27717632,13696,1024768,25165824,1073741824,1073741824,1053376
.long 3150528,10240,2808,16780300,2621440,24127488,2290649224,2290649224,9443328,10665984,10674176
.long 14925824,14921728,72984,79360,17367040,91312,92416,1495360,61952,62080,62208
.long 62336,62464,62592,61440,788224,984832,1181440,1378048,1574656,1771264,1792
.long 28008448,28024832,28041216,28057600,28073984,13712,1035008,25167872,1073741824,1073741824,1053376
.long 3150528,10272,660216,16780300,2621440,24619008,2290649224,2290649224,9443328,10665984,10674176
.long 14927872,14923776,72988,79488,17416192,91316,92416,1495360,717312,717440,717568
.long 717696,717824,717952,716800,837376,1033984,1230592,1427200,1623808,1820416,50944
.long 28012544,28028928,28045312,28061696,28078080,13728,1045248,25169920,1073741824,1073741824,1053376
.long 3150528,10304,2808,16780300,2621440,25110528,2290649224,2290649224,9443328,10665984,10674176
.long 15122432,15118336,73496,79616,17465344,91320,92416,1495360,1372672,1372800,1372928
.long 1373056,1373184,1373312,1372160,886528,1083136,1279744,1476352,1672960,1869568,100096
.long 28016640,28033024,28049408,28065792,28000256,13744,1055488,25171968,1073741824,1073741824,1053376
.long 1073741824,10336,660216,16780300,2621440,25602048,2290649224,2290649224,9443328,10665984,10665984
.long 15124480,15120384,73500,79744,17514496,91324,92416,1495360,2028032,2028160,2028288
.long 2028416,2028544,2028672,2027520,935680,1132288,1328896,1525504,1722112,1918720,149248
.long 28020736,28037120,28053504,28069888,28004352,30080,1270528,25411584,1073741824,1073741824,1061568
.long 3158720,26624,3448,50465804,2981888,24127488,2290649224,2290649224,9444736,12763136,12771328
.long 18071552,18067456,81176,81408,18153472,93360,92928,1536320,226432,225280,225408
.long 225536,225664,225792,225920,1771264,1792,198400,395008,591616,788224,984832
.long 28049408,28065792,28000256,28016640,28033024,30096,1280768,25413632,1073741824,1073741824,1061568
.long 3158720,26656,660856,50465804,2981888,24619008,2290649224,2290649224,9444736,12763136,12771328
.long 18073600,18069504,81180,81536,18202624,93364,92928,1536320,881792,880640,880768
.long 880896,881024,881152,881280,1820416,50944,247552,444160,640768,837376,1033984
.long 28053504,28069888,28004352,28020736,28037120,30112,1291008,25415680,1073741824,1073741824,1061568
.long 3158720,26688,3448,50465804,2981888,25110528,2290649224,2290649224,9444736,12763136,12771328
.long 18268160,18264064,81688,81664,18251776,93368,92928,1536320,1537152,1536000,1536128
.long 1536256,1536384,1536512,1536640,1869568,100096,296704,493312,689920,886528,1083136
.long 28057600,28073984,28008448,28024832,28041216,30128,1301248,25417728,1073741824,1073741824,1061568
.long 1073741824,26720,660856,50465804,2981888,25602048,2290649224,2290649224,9444736,12763136,12763136
.long 18270208,18266112,81692,81792,18300928,93372,92928,1536320,2192512,2191360,2191488
.long 2191616,2191744,2191872,2192000,1918720,149248,345856,542464,739072,935680,1132288
.long 28061696,28078080,28012544,28028928,28045312,17792,1516288,25657344,1073741824,1073741824,1055424
.long 3152576,10240,4092,16780300,3342336,24127488,2290649224,2290649224,9446144,11190272,11198464
.long 14974976,14970880,73112,83456,18939904,91824,93440,1577280,61952,62080,62208
.long 62336,62464,62592,61440,788992,985600,1182208,1378816,1575424,1772032,2560
.long 28336128,28352512,28368896,28385280,28401664,17808,1526528,25659392,1073741824,1073741824,1055424
.long 3152576,10272,661500,16780300,3342336,24619008,2290649224,2290649224,9446144,11190272,11198464
.long 14977024,14972928,73116,83584,18989056,91828,93440,1577280,717312,717440,717568
.long 717696,717824,717952,716800,838144,1034752,1231360,1427968,1624576,1821184,51712
.long 28340224,28356608,28372992,28389376,28405760,17824,1536768,25661440,1073741824,1073741824,1055424
.long 3152576,10304,4092,16780300,3342336,25110528,2290649224,2290649224,9446144,11190272,11198464
.long 15171584,15167488,73624,83712,19038208,91832,93440,1577280,1372672,1372800,1372928
.long 1373056,1373184,1373312,1372160,887296,1083904,1280512,1477120,1673728,1870336,100864
.long 28344320,28360704,28377088,28393472,28327936,17840,1547008,25663488,1073741824,1073741824,1055424
.long 1073741824,10336,661500,16780300,3342336,25602048,2290649224,2290649224,9446144,11190272,11190272
.long 15173632,15169536,73628,83840,19087360,91836,93440,1577280,2028032,2028160,2028288
.long 2028416,2028544,2028672,2027520,936448,1133056,1329664,1526272,1722880,1919488,150016
.long 28348416,28364800,28381184,28397568,28332032,34176,1762048,25903104,1073741824,1073741824,1063616
.long 3160768,26624,4732,50465804,3702784,24127488,2290649224,2290649224,9447552,13287424,13295616
.long 18120704,18116608,81304,85504,19726336,93872,93952,1618240,226432,225280,225408
.long 225536,225664,225792,225920,1772032,2560,199168,395776,592384,788992,985600
.long 28377088,28393472,28327936,28344320,28360704,34192,1772288,25905152,1073741824,1073741824,1063616
.long 3160768,26656,662140,50465804,3702784,24619008,2290649224,2290649224,9447552,13287424,13295616
.long 18122752,18118656,81308,85632,19775488,93876,93952,1618240,881792,880640,880768
.long 880896,881024,881152,881280,1821184,51712,248320,444928,641536,838144,1034752
.long 28381184,28397568,28332032,28348416,28364800,34208,1782528,25907200,1073741824,1073741824,1063616
.long 3160768,26688,4732,50465804,3702784,25110528,2290649224,2290649224,9447552,13287424,13295616
.long 18317312,18313216,81816,85760,19824640,93880,93952,1618240,1537152,1536000,1536128
.long 1536256,1536384,1536512,1536640,1870336,100864,297472,494080,690688,887296,1083904
.long 28385280,28401664,28336128,28352512,28368896,34224,1792768,25909248,1073741824,1073741824,1063616
.long 1073741824,26720,662140,50465804,3702784,25602048,2290649224,2290649224,9447552,13287424,13287424
.long 18319360,18315264,81820,85888,19873792,93884,93952,1618240,2192512,2191360,2191488
.long 2191616,2191744,2191872,2192000,1919488,150016,346624,543232,739840,936448,1133056
.long 28389376,28405760,28340224,28356608,28372992,5632,41984,24190976,1073741824,1073741824,1049344
.long 3146496,12288,268,50465804,1196032,24132608,2290649224,2290649224,9437760,9633792,9641984
.long 15220736,15216640,73752,69632,13631488,90304,90112,480,82560,82688,82816
.long 82944,83072,81920,82048,983296,1179904,1376512,1573120,1769728,256,196864
.long 27361280,27377664,27394048,27410432,27344896,5648,52224,24193024,1073741824,1073741824,1049344
.long 3146496,12320,657676,50465804,1196032,24624128,2290649224,2290649224,9437760,9633792,9641984
.long 15222784,15218688,73756,69760,13680640,90308,90112,480,737920,738048,738176
.long 738304,738432,737280,737408,1032448,1229056,1425664,1622272,1818880,49408,246016
.long 27365376,27381760,27398144,27414528,27348992,5664,62464,24195072,1073741824,1073741824,1049344
.long 3146496,12352,268,50465804,1196032,25115648,2290649224,2290649224,9437760,9633792,9641984
.long 15417344,15413248,74264,69888,13729792,90312,90112,480,1393280,1393408,1393536
.long 1393664,1393792,1392640,1392768,1081600,1278208,1474816,1671424,1868032,98560,295168
.long 27369472,27385856,27402240,27418624,27353088,5680,72704,24197120,1073741824,1073741824,1049344
.long 1073741824,12384,657676,50465804,1196032,25607168,2290649224,2290649224,9437760,9633792,9633792
.long 15419392,15415296,74268,70016,13778944,90316,90112,480,2048640,2048768,2048896
.long 2049024,2049152,2048000,2048128,1130752,1327360,1523968,1720576,1917184,147712,344320
.long 27373568,27389952,27406336,27422720,27357184,22016,287744,24436736,1073741824,1073741824,1057536
.long 3154688,28672,912,16780300,1556480,24132608,2290649224,2290649224,9439168,11730944,11739136
.long 18366464,18362368,81944,71680,14417920,92352,90624,41440,245760,245888,246016
.long 246144,246272,246400,246528,256,196864,393472,590080,786688,983296,1179904
.long 27402240,27418624,27353088,27369472,27385856,22032,297984,24438784,1073741824,1073741824,1057536
.long 3154688,28704,658320,16780300,1556480,24624128,2290649224,2290649224,9439168,11730944,11739136
.long 18368512,18364416,81948,71808,14467072,92356,90624,41440,901120,901248,901376
.long 901504,901632,901760,901888,49408,246016,442624,639232,835840,1032448,1229056
.long 27406336,27422720,27357184,27373568,27389952,22048,308224,24440832,1073741824,1073741824,1057536
.long 3154688,28736,912,16780300,1556480,25115648,2290649224,2290649224,9439168,11730944,11739136
.long 18563072,18558976,82456,71936,14516224,92360,90624,41440,1556480,1556608,1556736
.long 1556864,1556992,1557120,1557248,98560,295168,491776,688384,884992,1081600,1278208
.long 27410432,27344896,27361280,27377664,27394048,22064,318464,24442880,1073741824,1073741824,1057536
.long 1073741824,28768,658320,16780300,1556480,25607168,2290649224,2290649224,9439168,11730944,11730944
.long 18565120,18561024,82460,72064,14565376,92364,90624,41440,2211840,2211968,2212096
.long 2212224,2212352,2212480,2212608,147712,344320,540928,737536,934144,1130752,1327360
.long 27414528,27348992,27365376,27381760,27398144,9728,533504,24682496,1073741824,1073741824,1051392
.long 3148544,12288,1552,50465804,1916928,24132608,2290649224,2290649224,9440576,10158080,10166272
.long 15269888,15265792,73880,73728,15204352,90816,91136,82400,82560,82688,82816
.long 82944,83072,81920,82048,984064,1180672,1377280,1573888,1770496,1024,197632
.long 27688960,27705344,27721728,27738112,27672576,9744,543744,24684544,1073741824,1073741824,1051392
.long 3148544,12320,658960,50465804,1916928,24624128,2290649224,2290649224,9440576,10158080,10166272
.long 15271936,15267840,73884,73856,15253504,90820,91136,82400,737920,738048,738176
.long 738304,738432,737280,737408,1033216,1229824,1426432,1623040,1819648,50176,246784
.long 27693056,27709440,27725824,27742208,27676672,9760,553984,24686592,1073741824,1073741824,1051392
.long 3148544,12352,1552,50465804,1916928,25115648,2290649224,2290649224,9440576,10158080,10166272
.long 15466496,15462400,74392,73984,15302656,90824,91136,82400,1393280,1393408,1393536
.long 1393664,1393792,1392640,1392768,1082368,1278976,1475584,1672192,1868800,99328,295936
.long 27697152,27713536,27729920,27746304,27680768,9776,564224,24688640,1073741824,1073741824,1051392
.long 1073741824,12384,658960,50465804,1916928,25607168,2290649224,2290649224,9440576,10158080,10158080
.long 15468544,15464448,74396,74112,15351808,90828,91136,82400,2048640,2048768,2048896
.long 2049024,2049152,2048000,2048128,1131520,1328128,1524736,1721344,1917952,148480,345088
.long 27701248,27717632,27734016,27750400,27684864,26112,779264,24928256,1073741824,1073741824,1059584
.long 3156736,28672,2196,16780300,2277376,24132608,2290649224,2290649224,9441984,12255232,12263424
.long 18415616,18411520,82072,75776,15990784,92864,91648,123360,245760,245888,246016
.long 246144,246272,246400,246528,1024,197632,394240,590848,787456,984064,1180672
.long 27729920,27746304,27680768,27697152,27713536,26128,789504,24930304,1073741824,1073741824,1059584
.long 3156736,28704,659604,16780300,2277376,24624128,2290649224,2290649224,9441984,12255232,12263424
.long 18417664,18413568,82076,75904,16039936,92868,91648,123360,901120,901248,901376
.long 901504,901632,901760,901888,50176,246784,443392,640000,836608,1033216,1229824
.long 27734016,27750400,27684864,27701248,27717632,26144,799744,24932352,1073741824,1073741824,1059584
.long 3156736,28736,2196,16780300,2277376,25115648,2290649224,2290649224,9441984,12255232,12263424
.long 18612224,18608128,82584,76032,16089088,92872,91648,123360,1556480,1556608,1556736
.long 1556864,1556992,1557120,1557248,99328,295936,492544,689152,885760,1082368,1278976
.long 27738112,27672576,27688960,27705344,27721728,26160,809984,24934400,1073741824,1073741824,1059584
.long 1073741824,28768,659604,16780300,2277376,25607168,2290649224,2290649224,9441984,12255232,12255232
.long 18614272,18610176,82588,76160,16138240,92876,91648,123360,2211840,2211968,2212096
.long 2212224,2212352,2212480,2212608,148480,345088,541696,738304,934912,1131520,1328128
.long 27742208,27676672,27693056,27709440,27725824,13824,1025024,25174016,1073741824,1073741824,1053440
.long 3150592,12288,2836,50465804,2637824,24132608,2290649224,2290649224,9443392,10682368,10690560
.long 15319040,15314944,74008,77824,16777216,91328,92160,164320,82560,82688,82816
.long 82944,83072,81920,82048,984832,1181440,1378048,1574656,1771264,1792,198400
.long 28016640,28033024,28049408,28065792,28000256,13840,1035264,25176064,1073741824,1073741824,1053440
.long 3150592,12320,660244,50465804,2637824,24624128,2290649224,2290649224,9443392,10682368,10690560
.long 15321088,15316992,74012,77952,16826368,91332,92160,164320,737920,738048,738176
.long 738304,738432,737280,737408,1033984,1230592,1427200,1623808,1820416,50944,247552
.long 28020736,28037120,28053504,28069888,28004352,13856,1045504,25178112,1073741824,1073741824,1053440
.long 3150592,12352,2836,50465804,2637824,25115648,2290649224,2290649224,9443392,10682368,10690560
.long 15515648,15511552,74520,78080,16875520,91336,92160,164320,1393280,1393408,1393536
.long 1393664,1393792,1392640,1392768,1083136,1279744,1476352,1672960,1869568,100096,296704
.long 28024832,28041216,28057600,28073984,28008448,13872,1055744,25180160,1073741824,1073741824,1053440
.long 1073741824,12384,660244,50465804,2637824,25607168,2290649224,2290649224,9443392,10682368,10682368
.long 15517696,15513600,74524,78208,16924672,91340,92160,164320,2048640,2048768,2048896
.long 2049024,2049152,2048000,2048128,1132288,1328896,1525504,1722112,1918720,149248,345856
.long 28028928,28045312,28061696,28078080,28012544,30208,1270784,25419776,1073741824,1073741824,1061632
.long 3158784,28672,3480,16780300,2998272,24132608,2290649224,2290649224,9444800,12779520,12787712
.long 18464768,18460672,82200,79872,17563648,93376,92672,205280,245760,245888,246016
.long 246144,246272,246400,246528,1792,198400,395008,591616,788224,984832,1181440
.long 28057600,28073984,28008448,28024832,28041216,30224,1281024,25421824,1073741824,1073741824,1061632
.long 3158784,28704,660888,16780300,2998272,24624128,2290649224,2290649224,9444800,12779520,12787712
.long 18466816,18462720,82204,80000,17612800,93380,92672,205280,901120,901248,901376
.long 901504,901632,901760,901888,50944,247552,444160,640768,837376,1033984,1230592
.long 28061696,28078080,28012544,28028928,28045312,30240,1291264,25423872,1073741824,1073741824,1061632
.long 3158784,28736,3480,16780300,2998272,25115648,2290649224,2290649224,9444800,12779520,12787712
.long 18661376,18657280,82712,80128,17661952,93384,92672,205280,1556480,1556608,1556736
.long 1556864,1556992,1557120,1557248,100096,296704,493312,689920,886528,1083136,1279744
.long 28065792,28000256,28016640,28033024,28049408,30256,1301504,25425920,1073741824,1073741824,1061632
.long 1073741824,28768,660888,16780300,2998272,25607168,2290649224,2290649224,9444800,12779520,12779520
.long 18663424,18659328,82716,80256,17711104,93388,92672,205280,2211840,2211968,2212096
.long 2212224,2212352,2212480,2212608,149248,345856,542464,739072,935680,1132288,1328896
.long 28069888,28004352,28020736,28037120,28053504,17920,1516544,25665536,1073741824,1073741824,1055488
.long 3152640,12288,4120,50465804,3358720,24132608,2290649224,2290649224,9446208,11206656,11214848
.long 15368192,15364096,74136,81920,18350080,91840,93184,246240,82560,82688,82816
.long 82944,83072,81920,82048,985600,1182208,1378816,1575424,1772032,2560,199168
.long 28344320,28360704,28377088,28393472,28327936,17936,1526784,25667584,1073741824,1073741824,1055488
.long 3152640,12320,661528,50465804,3358720,24624128,2290649224,2290649224,9446208,11206656,11214848
.long 15370240,15366144,74140,82048,18399232,91844,93184,246240,737920,738048,738176
.long 738304,738432,737280,737408,1034752,1231360,1427968,1624576,1821184,51712,248320
.long 28348416,28364800,28381184,28397568,28332032,17952,1537024,25669632,1073741824,1073741824,1055488
.long 3152640,12352,4120,50465804,3358720,25115648,2290649224,2290649224,9446208,11206656,11214848
.long 15564800,15560704,74648,82176,18448384,91848,93184,246240,1393280,1393408,1393536
.long 1393664,1393792,1392640,1392768,1083904,1280512,1477120,1673728,1870336,100864,297472
.long 28352512,28368896,28385280,28401664,28336128,17968,1547264,25671680,1073741824,1073741824,1055488
.long 1073741824,12384,661528,50465804,3358720,25607168,2290649224,2290649224,9446208,11206656,11206656
.long 15566848,15562752,74652,82304,18497536,91852,93184,246240,2048640,2048768,2048896
.long 2049024,2049152,2048000,2048128,1133056,1329664,1526272,1722880,1919488,150016,346624
.long 28356608,28372992,28389376,28405760,28340224,34304,1762304,25911296,1073741824,1073741824,1063680
.long 3160832,28672,4764,16780300,3719168,24132608,2290649224,2290649224,9447616,13303808,13312000
.long 18513920,18509824,82328,83968,19136512,93888,93696,287200,245760,245888,246016
.long 246144,246272,246400,246528,2560,199168,395776,592384,788992,985600,1182208
.long 28385280,28401664,28336128,28352512,28368896,34320,1772544,25913344,1073741824,1073741824,1063680
.long 3160832,28704,662172,16780300,3719168,24624128,2290649224,2290649224,9447616,13303808,13312000
.long 18515968,18511872,82332,84096,19185664,93892,93696,287200,901120,901248,901376
.long 901504,901632,901760,901888,51712,248320,444928,641536,838144,1034752,1231360
.long 28389376,28405760,28340224,28356608,28372992,34336,1782784,25915392,1073741824,1073741824,1063680
.long 3160832,28736,4764,16780300,3719168,25115648,2290649224,2290649224,9447616,13303808,13312000
.long 18710528,18706432,82840,84224,19234816,93896,93696,287200,1556480,1556608,1556736
.long 1556864,1556992,1557120,1557248,100864,297472,494080,690688,887296,1083904,1280512
.long 28393472,28327936,28344320,28360704,28377088,34352,1793024,25917440,1073741824,1073741824,1063680
.long 1073741824,28768,662172,16780300,3719168,25607168,2290649224,2290649224,9447616,13303808,13303808
.long 18712576,18708480,82844,84352,19283968,93900,93696,287200,2211840,2211968,2212096
.long 2212224,2212352,2212480,2212608,150016,346624,543232,739840,936448,1133056,1329664
.long 28397568,28332032,28348416,28364800,28381184,5760,164096,24289280,1572992,27328512,1049408
.long 3146560,14336,1073741824,50465804,1073741824,24132608,0,0,1073741824,9650176,9658368
.long 15613952,15609856,74776,70144,13828096,90320,90112,1311200,103168,103296,103424
.long 103552,102400,102528,102656,1179904,1376512,1573120,1769728,256,196864,393472
.long 27369472,27385856,27402240,27418624,27353088,5776,174336,24291328,1622144,27330560,1049408
.long 3146560,14368,1073741824,50465804,1073741824,24624128,0,0,1073741824,9650176,9658368
.long 15616000,15611904,74780,70272,13877248,90324,90112,1311200,758528,758656,758784
.long 758912,757760,757888,758016,1229056,1425664,1622272,1818880,49408,246016,442624
.long 27373568,27389952,27406336,27422720,27357184,5792,184576,24293376,1671296,27332608,1049408
.long 3146560,14400,1073741824,50465804,1073741824,25115648,0,0,1073741824,9650176,9658368
.long 15810560,15806464,75288,70400,13926400,90328,90112,1311200,1413888,1414016,1414144
.long 1414272,1413120,1413248,1413376,1278208,1474816,1671424,1868032,98560,295168,491776
.long 27377664,27394048,27410432,27344896,27361280,5808,194816,24295424,1720448,27334656,1049408
.long 1073741824,14432,1073741824,50465804,1073741824,25607168,0,0,1073741824,9650176,9650176
.long 15812608,15808512,75292,70528,13975552,90332,90112,1311200,2069248,2069376,2069504
.long 2069632,2068480,2068608,2068736,1327360,1523968,1720576,1917184,147712,344320,540928
.long 27381760,27398144,27414528,27348992,27365376,22144,409856,24535040,1573376,27492352,1057600
.long 3154752,30720,1073741824,16780300,1073741824,24132608,0,0,1073741824,11747328,11755520
.long 18759680,18755584,82968,72192,14614528,92368,90624,1352160,266368,266496,266624
.long 266752,266880,267008,267136,196864,393472,590080,786688,983296,1179904,1376512
.long 27410432,27344896,27361280,27377664,27394048,22160,420096,24537088,1622528,27494400,1057600
.long 3154752,30752,1073741824,16780300,1073741824,24624128,0,0,1073741824,11747328,11755520
.long 18761728,18757632,82972,72320,14663680,92372,90624,1352160,921728,921856,921984
.long 922112,922240,922368,922496,246016,442624,639232,835840,1032448,1229056,1425664
.long 27414528,27348992,27365376,27381760,27398144,22176,430336,24539136,1671680,27496448,1057600
.long 3154752,30784,1073741824,16780300,1073741824,25115648,0,0,1073741824,11747328,11755520
.long 18956288,18952192,83480,72448,14712832,92376,90624,1352160,1577088,1577216,1577344
.long 1577472,1577600,1577728,1577856,295168,491776,688384,884992,1081600,1278208,1474816
.long 27418624,27353088,27369472,27385856,27402240,22192,440576,24541184,1720832,27498496,1057600
.long 1073741824,30816,1073741824,16780300,1073741824,25607168,0,0,1073741824,11747328,11747328
.long 18958336,18954240,83484,72576,14761984,92380,90624,1352160,2232448,2232576,2232704
.long 2232832,2232960,2233088,2233216,344320,540928,737536,934144,1130752,1327360,1523968
.long 27422720,27357184,27373568,27389952,27406336,9856,655616,24780800,1573760,27656192,1051456
.long 3148608,14336,1073741824,50465804,1073741824,24132608,0,0,1073741824,10174464,10182656
.long 15663104,15659008,74904,74240,15400960,90832,91136,1393120,103168,103296,103424
.long 103552,102400,102528,102656,1180672,1377280,1573888,1770496,1024,197632,394240
.long 27697152,27713536,27729920,27746304,27680768,9872,665856,24782848,1622912,27658240,1051456
.long 3148608,14368,1073741824,50465804,1073741824,24624128,0,0,1073741824,10174464,10182656
.long 15665152,15661056,74908,74368,15450112,90836,91136,1393120,758528,758656,758784
.long 758912,757760,757888,758016,1229824,1426432,1623040,1819648,50176,246784,443392
.long 27701248,27717632,27734016,27750400,27684864,9888,676096,24784896,1672064,27660288,1051456
.long 3148608,14400,1073741824,50465804,1073741824,25115648,0,0,1073741824,10174464,10182656
.long 15859712,15855616,75416,74496,15499264,90840,91136,1393120,1413888,1414016,1414144
.long 1414272,1413120,1413248,1413376,1278976,1475584,1672192,1868800,99328,295936,492544
.long 27705344,27721728,27738112,27672576,27688960,9904,686336,24786944,1721216,27662336,1051456
.long 1073741824,14432,1073741824,50465804,1073741824,25607168,0,0,1073741824,10174464,10174464
.long 15861760,15857664,75420,74624,15548416,90844,91136,1393120,2069248,2069376,2069504
.long 2069632,2068480,2068608,2068736,1328128,1524736,1721344,1917952,148480,345088,541696
.long 27709440,27725824,27742208,27676672,27693056,26240,901376,25026560,1574144,27820032,1059648
.long 3156800,30720,1073741824,16780300,1073741824,24132608,0,0,1073741824,12271616,12279808
.long 18808832,18804736,83096,76288,16187392,92880,91648,1434080,266368,266496,266624
.long 266752,266880,267008,267136,197632,394240,590848,787456,984064,1180672,1377280
.long 27738112,27672576,27688960,27705344,27721728,26256,911616,25028608,1623296,27822080,1059648
.long 3156800,30752,1073741824,16780300,1073741824,24624128,0,0,1073741824,12271616,12279808
.long 18810880,18806784,83100,76416,16236544,92884,91648,1434080,921728,921856,921984
.long 922112,922240,922368,922496,246784,443392,640000,836608,1033216,1229824,1426432
.long 27742208,27676672,27693056,27709440,27725824,26272,921856,25030656,1672448,27824128,1059648
.long 3156800,30784,1073741824,16780300,1073741824,25115648,0,0,1073741824,12271616,12279808
.long 19005440,19001344,83608,76544,16285696,92888,91648,1434080,1577088,1577216,1577344
.long 1577472,1577600,1577728,1577856,295936,492544,689152,885760,1082368,1278976,1475584
.long 27746304,27680768,27697152,27713536,27729920,26288,932096,25032704,1721600,27826176,1059648
.long 1073741824,30816,1073741824,16780300,1073741824,25607168,0,0,1073741824,12271616,12271616
.long 19007488,19003392,83612,76672,16334848,92892,91648,1434080,2232448,2232576,2232704
.long 2232832,2232960,2233088,2233216,345088,541696,738304,934912,1131520,1328128,1524736
.long 27750400,27684864,27701248,27717632,27734016,13952,1147136,25272320,1574528,27983872,1053504
.long 3150656,14336,1073741824,50465804,1073741824,24132608,0,0,1073741824,10698752,10706944
.long 15712256,15708160,75032,78336,16973824,91344,92160,1475040,103168,103296,103424
.long 103552,102400,102528,102656,1181440,1378048,1574656,1771264,1792,198400,395008
.long 28024832,28041216,28057600,28073984,28008448,13968,1157376,25274368,1623680,27985920,1053504
.long 3150656,14368,1073741824,50465804,1073741824,24624128,0,0,1073741824,10698752,10706944
.long 15714304,15710208,75036,78464,17022976,91348,92160,1475040,758528,758656,758784
.long 758912,757760,757888,758016,1230592,1427200,1623808,1820416,50944,247552,444160
.long 28028928,28045312,28061696,28078080,28012544,13984,1167616,25276416,1672832,27987968,1053504
.long 3150656,14400,1073741824,50465804,1073741824,25115648,0,0,1073741824,10698752,10706944
.long 15908864,15904768,75544,78592,17072128,91352,92160,1475040,1413888,1414016,1414144
.long 1414272,1413120,1413248,1413376,1279744,1476352,1672960,1869568,100096,296704,493312
.long 28033024,28049408,28065792,28000256,28016640,14000,1177856,25278464,1721984,27990016,1053504
.long 1073741824,14432,1073741824,50465804,1073741824,25607168,0,0,1073741824,10698752,10698752
.long 15910912,15906816,75548,78720,17121280,91356,92160,1475040,2069248,2069376,2069504
.long 2069632,2068480,2068608,2068736,1328896,1525504,1722112,1918720,149248,345856,542464
.long 28037120,28053504,28069888,28004352,28020736,30336,1392896,25518080,1574912,28147712,1061696
.long 3158848,30720,1073741824,16780300,1073741824,24132608,0,0,1073741824,12795904,12804096
.long 18857984,18853888,83224,80384,17760256,93392,92672,1516000,266368,266496,266624
.long 266752,266880,267008,267136,198400,395008,591616,788224,984832,1181440,1378048
.long 28065792,28000256,28016640,28033024,28049408,30352,1403136,25520128,1624064,28149760,1061696
.long 3158848,30752,1073741824,16780300,1073741824,24624128,0,0,1073741824,12795904,12804096
.long 18860032,18855936,83228,80512,17809408,93396,92672,1516000,921728,921856,921984
.long 922112,922240,922368,922496,247552,444160,640768,837376,1033984,1230592,1427200
.long 28069888,28004352,28020736,28037120,28053504,30368,1413376,25522176,1673216,28151808,1061696
.long 3158848,30784,1073741824,16780300,1073741824,25115648,0,0,1073741824,12795904,12804096
.long 19054592,19050496,83736,80640,17858560,93400,92672,1516000,1577088,1577216,1577344
.long 1577472,1577600,1577728,1577856,296704,493312,689920,886528,1083136,1279744,1476352
.long 28073984,28008448,28024832,28041216,28057600,30384,1423616,25524224,1722368,28153856,1061696
.long 1073741824,30816,1073741824,16780300,1073741824,25607168,0,0,1073741824,12795904,12795904
.long 19056640,19052544,83740,80768,17907712,93404,92672,1516000,2232448,2232576,2232704
.long 2232832,2232960,2233088,2233216,345856,542464,739072,935680,1132288,1328896,1525504
.long 28078080,28012544,28028928,28045312,28061696,18048,1638656,25763840,1575296,28311552,1055552
.long 3152704,14336,1073741824,50465804,1073741824,24132608,0,0,1073741824,11223040,11231232
.long 15761408,15757312,75160,82432,18546688,91856,93184,1556960,103168,103296,103424
.long 103552,102400,102528,102656,1182208,1378816,1575424,1772032,2560,199168,395776
.long 28352512,28368896,28385280,28401664,28336128,18064,1648896,25765888,1624448,28313600,1055552
.long 3152704,14368,1073741824,50465804,1073741824,24624128,0,0,1073741824,11223040,11231232
.long 15763456,15759360,75164,82560,18595840,91860,93184,1556960,758528,758656,758784
.long 758912,757760,757888,758016,1231360,1427968,1624576,1821184,51712,248320,444928
.long 28356608,28372992,28389376,28405760,28340224,18080,1659136,25767936,1673600,28315648,1055552
.long 3152704,14400,1073741824,50465804,1073741824,25115648,0,0,1073741824,11223040,11231232
.long 15958016,15953920,75672,82688,18644992,91864,93184,1556960,1413888,1414016,1414144
.long 1414272,1413120,1413248,1413376,1280512,1477120,1673728,1870336,100864,297472,494080
.long 28360704,28377088,28393472,28327936,28344320,18096,1669376,25769984,1722752,28317696,1055552
.long 1073741824,14432,1073741824,50465804,1073741824,25607168,0,0,1073741824,11223040,11223040
.long 15960064,15955968,75676,82816,18694144,91868,93184,1556960,2069248,2069376,2069504
.long 2069632,2068480,2068608,2068736,1329664,1526272,1722880,1919488,150016,346624,543232
.long 28364800,28381184,28397568,28332032,28348416,34432,1884416,26009600,1575680,28475392,1063744
.long 3160896,30720,1073741824,16780300,1073741824,24132608,0,0,1073741824,13320192,13328384
.long 18907136,18903040,83352,84480,19333120,93904,93696,1597920,266368,266496,266624
.long 266752,266880,267008,267136,199168,395776,592384,788992,985600,1182208,1378816
.long 28393472,28327936,28344320,28360704,28377088,34448,1894656,26011648,1624832,28477440,1063744
.long 3160896,30752,1073741824,16780300,1073741824,24624128,0,0,1073741824,13320192,13328384
.long 18909184,18905088,83356,84608,19382272,93908,93696,1597920,921728,921856,921984
.long 922112,922240,922368,922496,248320,444928,641536,838144,1034752,1231360,1427968
.long 28397568,28332032,28348416,28364800,28381184,34464,1904896,26013696,1673984,28479488,1063744
.long 3160896,30784,1073741824,16780300,1073741824,25115648,0,0,1073741824,13320192,13328384
.long 19103744,19099648,83864,84736,19431424,93912,93696,1597920,1577088,1577216,1577344
.long 1577472,1577600,1577728,1577856,297472,494080,690688,887296,1083904,1280512,1477120
.long 28401664,28336128,28352512,28368896,28385280,34480,1915136,26015744,1723136,28481536,1063744
.long 1073741824,30816,1073741824,16780300,1073741824,25607168,0,0,1073741824,13320192,13320192
.long 19105792,19101696,83868,84864,19480576,93916,93696,1597920,2232448,2232576,2232704
.long 2232832,2232960,2233088,2233216,346624,543232,739840,936448,1133056,1329664,1526272
.long 28405760,28340224,28356608,28372992,28389376,5888,164352,24297472,1376384,27320320,1049472
.long 3146624,16384,1073741824,16780300,1073741824,24132608,0,0,1073741824,9666560,9674752
.long 16007168,16003072,75800,70656,14024704,90336,90368,20960,123648,123776,123904
.long 124032,122880,123008,123136,1179904,1376512,1573120,1769728,256,196864,393472
.long 27369472,27385856,27402240,27418624,27353088,5904,174592,24299520,1425536,27322368,1049472
.long 3146624,16416,1073741824,16780300,1073741824,24624128,0,0,1073741824,9666560,9674752
.long 16009216,16005120,75804,70784,14073856,90340,90368,20960,779008,779136,779264
.long 779392,778240,778368,778496,1229056,1425664,1622272,1818880,49408,246016,442624
.long 27373568,27389952,27406336,27422720,27357184,5920,184832,24301568,1474688,27324416,1049472
.long 3146624,16448,1073741824,16780300,1073741824,25115648,0,0,1073741824,9666560,9674752
.long 16203776,16199680,76312,70912,14123008,90344,90368,20960,1434368,1434496,1434624
.long 1434752,1433600,1433728,1433856,1278208,1474816,1671424,1868032,98560,295168,491776
.long 27377664,27394048,27410432,27344896,27361280,5936,195072,24303616,1523840,27326464,1049472
.long 1073741824,16480,1073741824,16780300,1073741824,25607168,0,0,1073741824,9666560,9666560
.long 16205824,16201728,76316,71040,14172160,90348,90368,20960,2089728,2089856,2089984
.long 2090112,2088960,2089088,2089216,1327360,1523968,1720576,1917184,147712,344320,540928
.long 27381760,27398144,27414528,27348992,27365376,22272,410112,24543232,1376768,27484160,1057664
.long 3154816,32768,1073741824,50465804,1073741824,24132608,0,0,1073741824,11763712,11771904
.long 19152896,19148800,83992,72704,14811136,92384,90880,61920,286848,286976,287104
.long 287232,287360,287488,287616,196864,393472,590080,786688,983296,1179904,1376512
.long 27410432,27344896,27361280,27377664,27394048,22288,420352,24545280,1425920,27486208,1057664
.long 3154816,32800,1073741824,50465804,1073741824,24624128,0,0,1073741824,11763712,11771904
.long 19154944,19150848,83996,72832,14860288,92388,90880,61920,942208,942336,942464
.long 942592,942720,942848,942976,246016,442624,639232,835840,1032448,1229056,1425664
.long 27414528,27348992,27365376,27381760,27398144,22304,430592,24547328,1475072,27488256,1057664
.long 3154816,32832,1073741824,50465804,1073741824,25115648,0,0,1073741824,11763712,11771904
.long 19349504,19345408,84504,72960,14909440,92392,90880,61920,1597568,1597696,1597824
.long 1597952,1598080,1598208,1598336,295168,491776,688384,884992,1081600,1278208,1474816
.long 27418624,27353088,27369472,27385856,27402240,22320,440832,24549376,1524224,27490304,1057664
.long 1073741824,32864,1073741824,50465804,1073741824,25607168,0,0,1073741824,11763712,11763712
.long 19351552,19347456,84508,73088,14958592,92396,90880,61920,2252928,2253056,2253184
.long 2253312,2253440,2253568,2253696,344320,540928,737536,934144,1130752,1327360,1523968
.long 27422720,27357184,27373568,27389952,27406336,9984,655872,24788992,1377152,27648000,1051520
.long 3148672,16384,1073741824,16780300,1073741824,24132608,0,0,1073741824,10190848,10199040
.long 16056320,16052224,75928,74752,15597568,90848,91392,102880,123648,123776,123904
.long 124032,122880,123008,123136,1180672,1377280,1573888,1770496,1024,197632,394240
.long 27697152,27713536,27729920,27746304,27680768,10000,666112,24791040,1426304,27650048,1051520
.long 3148672,16416,1073741824,16780300,1073741824,24624128,0,0,1073741824,10190848,10199040
.long 16058368,16054272,75932,74880,15646720,90852,91392,102880,779008,779136,779264
.long 779392,778240,778368,778496,1229824,1426432,1623040,1819648,50176,246784,443392
.long 27701248,27717632,27734016,27750400,27684864,10016,676352,24793088,1475456,27652096,1051520
.long 3148672,16448,1073741824,16780300,1073741824,25115648,0,0,1073741824,10190848,10199040
.long 16252928,16248832,76440,75008,15695872,90856,91392,102880,1434368,1434496,1434624
.long 1434752,1433600,1433728,1433856,1278976,1475584,1672192,1868800,99328,295936,492544
.long 27705344,27721728,27738112,27672576,27688960,10032,686592,24795136,1524608,27654144,1051520
.long 1073741824,16480,1073741824,16780300,1073741824,25607168,0,0,1073741824,10190848,10190848
.long 16254976,16250880,76444,75136,15745024,90860,91392,102880,2089728,2089856,2089984
.long 2090112,2088960,2089088,2089216,1328128,1524736,1721344,1917952,148480,345088,541696
.long 27709440,27725824,27742208,27676672,27693056,26368,901632,25034752,1377536,27811840,1059712
.long 3156864,32768,1073741824,50465804,1073741824,24132608,0,0,1073741824,12288000,12296192
.long 19202048,19197952,84120,76800,16384000,92896,91904,143840,286848,286976,287104
.long 287232,287360,287488,287616,197632,394240,590848,787456,984064,1180672,1377280
.long 27738112,27672576,27688960,27705344,27721728,26384,911872,25036800,1426688,27813888,1059712
.long 3156864,32800,1073741824,50465804,1073741824,24624128,0,0,1073741824,12288000,12296192
.long 19204096,19200000,84124,76928,16433152,92900,91904,143840,942208,942336,942464
.long 942592,942720,942848,942976,246784,443392,640000,836608,1033216,1229824,1426432
.long 27742208,27676672,27693056,27709440,27725824,26400,922112,25038848,1475840,27815936,1059712
.long 3156864,32832,1073741824,50465804,1073741824,25115648,0,0,1073741824,12288000,12296192
.long 19398656,19394560,84632,77056,16482304,92904,91904,143840,1597568,1597696,1597824
.long 1597952,1598080,1598208,1598336,295936,492544,689152,885760,1082368,1278976,1475584
.long 27746304,27680768,27697152,27713536,27729920,26416,932352,25040896,1524992,27817984,1059712
.long 1073741824,32864,1073741824,50465804,1073741824,25607168,0,0,1073741824,12288000,12288000
.long 19400704,19396608,84636,77184,16531456,92908,91904,143840,2252928,2253056,2253184
.long 2253312,2253440,2253568,2253696,345088,541696,738304,934912,1131520,1328128,1524736
.long 27750400,27684864,27701248,27717632,27734016,14080,1147392,25280512,1377920,27975680,1053568
.long 3150720,16384,1073741824,16780300,1073741824,24132608,0,0,1073741824,10715136,10723328
.long 16105472,16101376,76056,78848,17170432,91360,92416,184800,123648,123776,123904
.long 124032,122880,123008,123136,1181440,1378048,1574656,1771264,1792,198400,395008
.long 28024832,28041216,28057600,28073984,28008448,14096,1157632,25282560,1427072,27977728,1053568
.long 3150720,16416,1073741824,16780300,1073741824,24624128,0,0,1073741824,10715136,10723328
.long 16107520,16103424,76060,78976,17219584,91364,92416,184800,779008,779136,779264
.long 779392,778240,778368,778496,1230592,1427200,1623808,1820416,50944,247552,444160
.long 28028928,28045312,28061696,28078080,28012544,14112,1167872,25284608,1476224,27979776,1053568
.long 3150720,16448,1073741824,16780300,1073741824,25115648,0,0,1073741824,10715136,10723328
.long 16302080,16297984,76568,79104,17268736,91368,92416,184800,1434368,1434496,1434624
.long 1434752,1433600,1433728,1433856,1279744,1476352,1672960,1869568,100096,296704,493312
.long 28033024,28049408,28065792,28000256,28016640,14128,1178112,25286656,1525376,27981824,1053568
.long 1073741824,16480,1073741824,16780300,1073741824,25607168,0,0,1073741824,10715136,10715136
.long 16304128,16300032,76572,79232,17317888,91372,92416,184800,2089728,2089856,2089984
.long 2090112,2088960,2089088,2089216,1328896,1525504,1722112,1918720,149248,345856,542464
.long 28037120,28053504,28069888,28004352,28020736,30464,1393152,25526272,1378304,28139520,1061760
.long 3158912,32768,1073741824,50465804,1073741824,24132608,0,0,1073741824,12812288,12820480
.long 19251200,19247104,84248,80896,17956864,93408,92928,225760,286848,286976,287104
.long 287232,287360,287488,287616,198400,395008,591616,788224,984832,1181440,1378048
.long 28065792,28000256,28016640,28033024,28049408,30480,1403392,25528320,1427456,28141568,1061760
.long 3158912,32800,1073741824,50465804,1073741824,24624128,0,0,1073741824,12812288,12820480
.long 19253248,19249152,84252,81024,18006016,93412,92928,225760,942208,942336,942464
.long 942592,942720,942848,942976,247552,444160,640768,837376,1033984,1230592,1427200
.long 28069888,28004352,28020736,28037120,28053504,30496,1413632,25530368,1476608,28143616,1061760
.long 3158912,32832,1073741824,50465804,1073741824,25115648,0,0,1073741824,12812288,12820480
.long 19447808,19443712,84760,81152,18055168,93416,92928,225760,1597568,1597696,1597824
.long 1597952,1598080,1598208,1598336,296704,493312,689920,886528,1083136,1279744,1476352
.long 28073984,28008448,28024832,28041216,28057600,30512,1423872,25532416,1525760,28145664,1061760
.long 1073741824,32864,1073741824,50465804,1073741824,25607168,0,0,1073741824,12812288,12812288
.long 19449856,19445760,84764,81280,18104320,93420,92928,225760,2252928,2253056,2253184
.long 2253312,2253440,2253568,2253696,345856,542464,739072,935680,1132288,1328896,1525504
.long 28078080,28012544,28028928,28045312,28061696,18176,1638912,25772032,1378688,28303360,1055616
.long 3152768,16384,1073741824,16780300,1073741824,24132608,0,0,1073741824,11239424,11247616
.long 16154624,16150528,76184,82944,18743296,91872,93440,266720,123648,123776,123904
.long 124032,122880,123008,123136,1182208,1378816,1575424,1772032,2560,199168,395776
.long 28352512,28368896,28385280,28401664,28336128,18192,1649152,25774080,1427840,28305408,1055616
.long 3152768,16416,1073741824,16780300,1073741824,24624128,0,0,1073741824,11239424,11247616
.long 16156672,16152576,76188,83072,18792448,91876,93440,266720,779008,779136,779264
.long 779392,778240,778368,778496,1231360,1427968,1624576,1821184,51712,248320,444928
.long 28356608,28372992,28389376,28405760,28340224,18208,1659392,25776128,1476992,28307456,1055616
.long 3152768,16448,1073741824,16780300,1073741824,25115648,0,0,1073741824,11239424,11247616
.long 16351232,16347136,76696,83200,18841600,91880,93440,266720,1434368,1434496,1434624
.long 1434752,1433600,1433728,1433856,1280512,1477120,1673728,1870336,100864,297472,494080
.long 28360704,28377088,28393472,28327936,28344320,18224,1669632,25778176,1526144,28309504,1055616
.long 1073741824,16480,1073741824,16780300,1073741824,25607168,0,0,1073741824,11239424,11239424
.long 16353280,16349184,76700,83328,18890752,91884,93440,266720,2089728,2089856,2089984
.long 2090112,2088960,2089088,2089216,1329664,1526272,1722880,1919488,150016,346624,543232
.long 28364800,28381184,28397568,28332032,28348416,34560,1884672,26017792,1379072,28467200,1063808
.long 3160960,32768,1073741824,50465804,1073741824,24132608,0,0,1073741824,13336576,13344768
.long 19300352,19296256,84376,84992,19529728,93920,93952,307680,286848,286976,287104
.long 287232,287360,287488,287616,199168,395776,592384,788992,985600,1182208,1378816
.long 28393472,28327936,28344320,28360704,28377088,34576,1894912,26019840,1428224,28469248,1063808
.long 3160960,32800,1073741824,50465804,1073741824,24624128,0,0,1073741824,13336576,13344768
.long 19302400,19298304,84380,85120,19578880,93924,93952,307680,942208,942336,942464
.long 942592,942720,942848,942976,248320,444928,641536,838144,1034752,1231360,1427968
.long 28397568,28332032,28348416,28364800,28381184,34592,1905152,26021888,1477376,28471296,1063808
.long 3160960,32832,1073741824,50465804,1073741824,25115648,0,0,1073741824,13336576,13344768
.long 19496960,19492864,84888,85248,19628032,93928,93952,307680,1597568,1597696,1597824
.long 1597952,1598080,1598208,1598336,297472,494080,690688,887296,1083904,1280512,1477120
.long 28401664,28336128,28352512,28368896,28385280,34608,1915392,26023936,1526528,28473344,1063808
.long 1073741824,32864,1073741824,50465804,1073741824,25607168,0,0,1073741824,13336576,13336576
.long 19499008,19494912,84892,85376,19677184,93932,93952,307680,2252928,2253056,2253184
.long 2253312,2253440,2253568,2253696,346624,543232,739840,936448,1133056,1329664,1526272
.long 28405760,28340224,28356608,28372992,28389376,6016,164608,24305664,1179776,27312128,1049536
.long 3146688,18432,1073741824,50465804,1073741824,24132608,0,0,1073741824,9682944,9691136
.long 16400384,16396288,76824,71168,14221312,90352,90368,1331680,144256,144384,144512
.long 143360,143488,143616,143744,1376512,1573120,1769728,256,196864,393472,590080
.long 27377664,27394048,27410432,27344896,27361280,6032,174848,24307712,1228928,27314176,1049536
.long 3146688,18464,1073741824,50465804,1073741824,24624128,0,0,1073741824,9682944,9691136
.long 16402432,16398336,76828,71296,14270464,90356,90368,1331680,799616,799744,799872
.long 798720,798848,798976,799104,1425664,1622272,1818880,49408,246016,442624,639232
.long 27381760,27398144,27414528,27348992,27365376,6048,185088,24309760,1278080,27316224,1049536
.long 3146688,18496,1073741824,50465804,1073741824,25115648,0,0,1073741824,9682944,9691136
.long 16596992,16592896,77336,71424,14319616,90360,90368,1331680,1454976,1455104,1455232
.long 1454080,1454208,1454336,1454464,1474816,1671424,1868032,98560,295168,491776,688384
.long 27385856,27402240,27418624,27353088,27369472,6064,195328,24311808,1327232,27318272,1049536
.long 1073741824,18528,1073741824,50465804,1073741824,25607168,0,0,1073741824,9682944,9682944
.long 16599040,16594944,77340,71552,14368768,90364,90368,1331680,2110336,2110464,2110592
.long 2109440,2109568,2109696,2109824,1523968,1720576,1917184,147712,344320,540928,737536
.long 27389952,27406336,27422720,27357184,27373568,22400,410368,24551424,1180160,27475968,1057728
.long 3154880,34816,1073741824,16780300,1073741824,24132608,0,0,1073741824,11780096,11788288
.long 19546112,19542016,85016,73216,15007744,92400,90880,1372640,307456,307584,307712
.long 307840,307968,308096,308224,393472,590080,786688,983296,1179904,1376512,1573120
.long 27418624,27353088,27369472,27385856,27402240,22416,420608,24553472,1229312,27478016,1057728
.long 3154880,34848,1073741824,16780300,1073741824,24624128,0,0,1073741824,11780096,11788288
.long 19548160,19544064,85020,73344,15056896,92404,90880,1372640,962816,962944,963072
.long 963200,963328,963456,963584,442624,639232,835840,1032448,1229056,1425664,1622272
.long 27422720,27357184,27373568,27389952,27406336,22432,430848,24555520,1278464,27480064,1057728
.long 3154880,34880,1073741824,16780300,1073741824,25115648,0,0,1073741824,11780096,11788288
.long 19742720,19738624,85528,73472,15106048,92408,90880,1372640,1618176,1618304,1618432
.long 1618560,1618688,1618816,1618944,491776,688384,884992,1081600,1278208,1474816,1671424
.long 27344896,27361280,27377664,27394048,27410432,22448,441088,24557568,1327616,27482112,1057728
.long 1073741824,34912,1073741824,16780300,1073741824,25607168,0,0,1073741824,11780096,11780096
.long 19744768,19740672,85532,73600,15155200,92412,90880,1372640,2273536,2273664,2273792
.long 2273920,2274048,2274176,2274304,540928,737536,934144,1130752,1327360,1523968,1720576
.long 27348992,27365376,27381760,27398144,27414528,10112,656128,24797184,1180544,27639808,1051584
.long 3148736,18432,1073741824,50465804,1073741824,24132608,0,0,1073741824,10207232,10215424
.long 16449536,16445440,76952,75264,15794176,90864,91392,1413600,144256,144384,144512
.long 143360,143488,143616,143744,1377280,1573888,1770496,1024,197632,394240,590848
.long 27705344,27721728,27738112,27672576,27688960,10128,666368,24799232,1229696,27641856,1051584
.long 3148736,18464,1073741824,50465804,1073741824,24624128,0,0,1073741824,10207232,10215424
.long 16451584,16447488,76956,75392,15843328,90868,91392,1413600,799616,799744,799872
.long 798720,798848,798976,799104,1426432,1623040,1819648,50176,246784,443392,640000
.long 27709440,27725824,27742208,27676672,27693056,10144,676608,24801280,1278848,27643904,1051584
.long 3148736,18496,1073741824,50465804,1073741824,25115648,0,0,1073741824,10207232,10215424
.long 16646144,16642048,77464,75520,15892480,90872,91392,1413600,1454976,1455104,1455232
.long 1454080,1454208,1454336,1454464,1475584,1672192,1868800,99328,295936,492544,689152
.long 27713536,27729920,27746304,27680768,27697152,10160,686848,24803328,1328000,27645952,1051584
.long 1073741824,18528,1073741824,50465804,1073741824,25607168,0,0,1073741824,10207232,10207232
.long 16648192,16644096,77468,75648,15941632,90876,91392,1413600,2110336,2110464,2110592
.long 2109440,2109568,2109696,2109824,1524736,1721344,1917952,148480,345088,541696,738304
.long 27717632,27734016,27750400,27684864,27701248,26496,901888,25042944,1180928,27803648,1059776
.long 3156928,34816,1073741824,16780300,1073741824,24132608,0,0,1073741824,12304384,12312576
.long 19595264,19591168,85144,77312,16580608,92912,91904,1454560,307456,307584,307712
.long 307840,307968,308096,308224,394240,590848,787456,984064,1180672,1377280,1573888
.long 27746304,27680768,27697152,27713536,27729920,26512,912128,25044992,1230080,27805696,1059776
.long 3156928,34848,1073741824,16780300,1073741824,24624128,0,0,1073741824,12304384,12312576
.long 19597312,19593216,85148,77440,16629760,92916,91904,1454560,962816,962944,963072
.long 963200,963328,963456,963584,443392,640000,836608,1033216,1229824,1426432,1623040
.long 27750400,27684864,27701248,27717632,27734016,26528,922368,25047040,1279232,27807744,1059776
.long 3156928,34880,1073741824,16780300,1073741824,25115648,0,0,1073741824,12304384,12312576
.long 19791872,19787776,85656,77568,16678912,92920,91904,1454560,1618176,1618304,1618432
.long 1618560,1618688,1618816,1618944,492544,689152,885760,1082368,1278976,1475584,1672192
.long 27672576,27688960,27705344,27721728,27738112,26544,932608,25049088,1328384,27809792,1059776
.long 1073741824,34912,1073741824,16780300,1073741824,25607168,0,0,1073741824,12304384,12304384
.long 19793920,19789824,85660,77696,16728064,92924,91904,1454560,2273536,2273664,2273792
.long 2273920,2274048,2274176,2274304,541696,738304,934912,1131520,1328128,1524736,1721344
.long 27676672,27693056,27709440,27725824,27742208,14208,1147648,25288704,1181312,27967488,1053632
.long 3150784,18432,1073741824,50465804,1073741824,24132608,0,0,1073741824,10731520,10739712
.long 16498688,16494592,77080,79360,17367040,91376,92416,1495520,144256,144384,144512
.long 143360,143488,143616,143744,1378048,1574656,1771264,1792,198400,395008,591616
.long 28033024,28049408,28065792,28000256,28016640,14224,1157888,25290752,1230464,27969536,1053632
.long 3150784,18464,1073741824,50465804,1073741824,24624128,0,0,1073741824,10731520,10739712
.long 16500736,16496640,77084,79488,17416192,91380,92416,1495520,799616,799744,799872
.long 798720,798848,798976,799104,1427200,1623808,1820416,50944,247552,444160,640768
.long 28037120,28053504,28069888,28004352,28020736,14240,1168128,25292800,1279616,27971584,1053632
.long 3150784,18496,1073741824,50465804,1073741824,25115648,0,0,1073741824,10731520,10739712
.long 16695296,16691200,77592,79616,17465344,91384,92416,1495520,1454976,1455104,1455232
.long 1454080,1454208,1454336,1454464,1476352,1672960,1869568,100096,296704,493312,689920
.long 28041216,28057600,28073984,28008448,28024832,14256,1178368,25294848,1328768,27973632,1053632
.long 1073741824,18528,1073741824,50465804,1073741824,25607168,0,0,1073741824,10731520,10731520
.long 16697344,16693248,77596,79744,17514496,91388,92416,1495520,2110336,2110464,2110592
.long 2109440,2109568,2109696,2109824,1525504,1722112,1918720,149248,345856,542464,739072
.long 28045312,28061696,28078080,28012544,28028928,30592,1393408,25534464,1181696,28131328,1061824
.long 3158976,34816,1073741824,16780300,1073741824,24132608,0,0,1073741824,12828672,12836864
.long 19644416,19640320,85272,81408,18153472,93424,92928,1536480,307456,307584,307712
.long 307840,307968,308096,308224,395008,591616,788224,984832,1181440,1378048,1574656
.long 28073984,28008448,28024832,28041216,28057600,30608,1403648,25536512,1230848,28133376,1061824
.long 3158976,34848,1073741824,16780300,1073741824,24624128,0,0,1073741824,12828672,12836864
.long 19646464,19642368,85276,81536,18202624,93428,92928,1536480,962816,962944,963072
.long 963200,963328,963456,963584,444160,640768,837376,1033984,1230592,1427200,1623808
.long 28078080,28012544,28028928,28045312,28061696,30624,1413888,25538560,1280000,28135424,1061824
.long 3158976,34880,1073741824,16780300,1073741824,25115648,0,0,1073741824,12828672,12836864
.long 19841024,19836928,85784,81664,18251776,93432,92928,1536480,1618176,1618304,1618432
.long 1618560,1618688,1618816,1618944,493312,689920,886528,1083136,1279744,1476352,1672960
.long 28000256,28016640,28033024,28049408,28065792,30640,1424128,25540608,1329152,28137472,1061824
.long 1073741824,34912,1073741824,16780300,1073741824,25607168,0,0,1073741824,12828672,12828672
.long 19843072,19838976,85788,81792,18300928,93436,92928,1536480,2273536,2273664,2273792
.long 2273920,2274048,2274176,2274304,542464,739072,935680,1132288,1328896,1525504,1722112
.long 28004352,28020736,28037120,28053504,28069888,18304,1639168,25780224,1182080,28295168,1055680
.long 3152832,18432,1073741824,50465804,1073741824,24132608,0,0,1073741824,11255808,11264000
.long 16547840,16543744,77208,83456,18939904,91888,93440,1577440,144256,144384,144512
.long 143360,143488,143616,143744,1378816,1575424,1772032,2560,199168,395776,592384
.long 28360704,28377088,28393472,28327936,28344320,18320,1649408,25782272,1231232,28297216,1055680
.long 3152832,18464,1073741824,50465804,1073741824,24624128,0,0,1073741824,11255808,11264000
.long 16549888,16545792,77212,83584,18989056,91892,93440,1577440,799616,799744,799872
.long 798720,798848,798976,799104,1427968,1624576,1821184,51712,248320,444928,641536
.long 28364800,28381184,28397568,28332032,28348416,18336,1659648,25784320,1280384,28299264,1055680
.long 3152832,18496,1073741824,50465804,1073741824,25115648,0,0,1073741824,11255808,11264000
.long 16744448,16740352,77720,83712,19038208,91896,93440,1577440,1454976,1455104,1455232
.long 1454080,1454208,1454336,1454464,1477120,1673728,1870336,100864,297472,494080,690688
.long 28368896,28385280,28401664,28336128,28352512,18352,1669888,25786368,1329536,28301312,1055680
.long 1073741824,18528,1073741824,50465804,1073741824,25607168,0,0,1073741824,11255808,11255808
.long 16746496,16742400,77724,83840,19087360,91900,93440,1577440,2110336,2110464,2110592
.long 2109440,2109568,2109696,2109824,1526272,1722880,1919488,150016,346624,543232,739840
.long 28372992,28389376,28405760,28340224,28356608,34688,1884928,26025984,1182464,28459008,1063872
.long 3161024,34816,1073741824,16780300,1073741824,24132608,0,0,1073741824,13352960,13361152
.long 19693568,19689472,85400,85504,19726336,93936,93952,1618400,307456,307584,307712
.long 307840,307968,308096,308224,395776,592384,788992,985600,1182208,1378816,1575424
.long 28401664,28336128,28352512,28368896,28385280,34704,1895168,26028032,1231616,28461056,1063872
.long 3161024,34848,1073741824,16780300,1073741824,24624128,0,0,1073741824,13352960,13361152
.long 19695616,19691520,85404,85632,19775488,93940,93952,1618400,962816,962944,963072
.long 963200,963328,963456,963584,444928,641536,838144,1034752,1231360,1427968,1624576
.long 28405760,28340224,28356608,28372992,28389376,34720,1905408,26030080,1280768,28463104,1063872
.long 3161024,34880,1073741824,16780300,1073741824,25115648,0,0,1073741824,13352960,13361152
.long 19890176,19886080,85912,85760,19824640,93944,93952,1618400,1618176,1618304,1618432
.long 1618560,1618688,1618816,1618944,494080,690688,887296,1083904,1280512,1477120,1673728
.long 28327936,28344320,28360704,28377088,28393472,34736,1915648,26032128,1329920,28465152,1063872
.long 1073741824,34912,1073741824,16780300,1073741824,25607168,0,0,1073741824,13352960,13352960
.long 19892224,19888128,85916,85888,19873792,93948,93952,1618400,2273536,2273664,2273792
.long 2273920,2274048,2274176,2274304,543232,739840,936448,1133056,1329664,1526272,1722880
.long 28332032,28348416,28364800,28381184,28397568,6144,81920,24199168,1073741824,1073741824,1049600
.long 3146752,4096,300,16780300,1212416,24137728,2290649224,2290649224,9437824,9699328,9707520
.long 13656064,13664256,69680,69632,13631488,90368,90112,640,384,512,640
.long 768,896,1024,1152,590208,786816,983424,1180032,1376640,1573248,1769856
.long 27426816,27443200,27459584,27475968,27492352,6160,92160,24201216,1073741824,1073741824,1049600
.long 3146752,4128,657708,16780300,1212416,24629248,2290649224,2290649224,9437824,9699328,9707520
.long 13658112,13666304,69684,69760,13680640,90372,90112,640,655744,655872,656000
.long 656128,656256,656384,656512,639360,835968,1032576,1229184,1425792,1622400,1819008
.long 27430912,27447296,27463680,27480064,27496448,6176,102400,24203264,1073741824,1073741824,1049600
.long 3146752,4160,300,16780300,1212416,25120768,2290649224,2290649224,9437824,9699328,9707520
.long 13852672,13860864,70192,69888,13729792,90376,90112,640,1311104,1311232,1311360
.long 1311488,1311616,1311744,1311872,688512,885120,1081728,1278336,1474944,1671552,1868160
.long 27435008,27451392,27467776,27484160,27500544,6192,112640,24205312,1073741824,1073741824,1049600
.long 1073741824,4192,657708,16780300,1212416,25612288,2290649224,2290649224,9437824,9699328,9699328
.long 13854720,13862912,70196,70016,13778944,90380,90112,640,1966464,1966592,1966720
.long 1966848,1966976,1967104,1967232,737664,934272,1130880,1327488,1524096,1720704,1917312
.long 27439104,27455488,27471872,27488256,27504640,22528,327680,24444928,1073741824,1073741824,1057792
.long 3154944,20480,940,50465804,1572864,24137728,2290649224,2290649224,9439232,11796480,11804672
.long 16801792,16809984,77872,71680,14417920,92416,90624,41600,164864,164992,163840
.long 163968,164096,164224,164352,1573248,1769856,384,196992,393600,590208,786816
.long 27467776,27484160,27500544,27435008,27451392,22544,337920,24446976,1073741824,1073741824,1057792
.long 3154944,20512,658348,50465804,1572864,24629248,2290649224,2290649224,9439232,11796480,11804672
.long 16803840,16812032,77876,71808,14467072,92420,90624,41600,820224,820352,819200
.long 819328,819456,819584,819712,1622400,1819008,49536,246144,442752,639360,835968
.long 27471872,27488256,27504640,27439104,27455488,22560,348160,24449024,1073741824,1073741824,1057792
.long 3154944,20544,940,50465804,1572864,25120768,2290649224,2290649224,9439232,11796480,11804672
.long 16998400,17006592,78384,71936,14516224,92424,90624,41600,1475584,1475712,1474560
.long 1474688,1474816,1474944,1475072,1671552,1868160,98688,295296,491904,688512,885120
.long 27475968,27492352,27426816,27443200,27459584,22576,358400,24451072,1073741824,1073741824,1057792
.long 1073741824,20576,658348,50465804,1572864,25612288,2290649224,2290649224,9439232,11796480,11796480
.long 17000448,17008640,78388,72064,14565376,92428,90624,41600,2130944,2131072,2129920
.long 2130048,2130176,2130304,2130432,1720704,1917312,147840,344448,541056,737664,934272
.long 27480064,27496448,27430912,27447296,27463680,10240,573440,24690688,1073741824,1073741824,1051648
.long 3148800,4096,1584,16780300,1933312,24137728,2290649224,2290649224,9440640,10223616,10231808
.long 13705216,13713408,69808,73728,15204352,90880,91136,82560,384,512,640
.long 768,896,1024,1152,590976,787584,984192,1180800,1377408,1574016,1770624
.long 27754496,27770880,27787264,27803648,27820032,10256,583680,24692736,1073741824,1073741824,1051648
.long 3148800,4128,658992,16780300,1933312,24629248,2290649224,2290649224,9440640,10223616,10231808
.long 13707264,13715456,69812,73856,15253504,90884,91136,82560,655744,655872,656000
.long 656128,656256,656384,656512,640128,836736,1033344,1229952,1426560,1623168,1819776
.long 27758592,27774976,27791360,27807744,27824128,10272,593920,24694784,1073741824,1073741824,1051648
.long 3148800,4160,1584,16780300,1933312,25120768,2290649224,2290649224,9440640,10223616,10231808
.long 13901824,13910016,70320,73984,15302656,90888,91136,82560,1311104,1311232,1311360
.long 1311488,1311616,1311744,1311872,689280,885888,1082496,1279104,1475712,1672320,1868928
.long 27762688,27779072,27795456,27811840,27828224,10288,604160,24696832,1073741824,1073741824,1051648
.long 1073741824,4192,658992,16780300,1933312,25612288,2290649224,2290649224,9440640,10223616,10223616
.long 13903872,13912064,70324,74112,15351808,90892,91136,82560,1966464,1966592,1966720
.long 1966848,1966976,1967104,1967232,738432,935040,1131648,1328256,1524864,1721472,1918080
.long 27766784,27783168,27799552,27815936,27832320,26624,819200,24936448,1073741824,1073741824,1059840
.long 3156992,20480,2224,50465804,2293760,24137728,2290649224,2290649224,9442048,12320768,12328960
.long 16850944,16859136,78000,75776,15990784,92928,91648,123520,164864,164992,163840
.long 163968,164096,164224,164352,1574016,1770624,1152,197760,394368,590976,787584
.long 27795456,27811840,27828224,27762688,27779072,26640,829440,24938496,1073741824,1073741824,1059840
.long 3156992,20512,659632,50465804,2293760,24629248,2290649224,2290649224,9442048,12320768,12328960
.long 16852992,16861184,78004,75904,16039936,92932,91648,123520,820224,820352,819200
.long 819328,819456,819584,819712,1623168,1819776,50304,246912,443520,640128,836736
.long 27799552,27815936,27832320,27766784,27783168,26656,839680,24940544,1073741824,1073741824,1059840
.long 3156992,20544,2224,50465804,2293760,25120768,2290649224,2290649224,9442048,12320768,12328960
.long 17047552,17055744,78512,76032,16089088,92936,91648,123520,1475584,1475712,1474560
.long 1474688,1474816,1474944,1475072,1672320,1868928,99456,296064,492672,689280,885888
.long 27803648,27820032,27754496,27770880,27787264,26672,849920,24942592,1073741824,1073741824,1059840
.long 1073741824,20576,659632,50465804,2293760,25612288,2290649224,2290649224,9442048,12320768,12320768
.long 17049600,17057792,78516,76160,16138240,92940,91648,123520,2130944,2131072,2129920
.long 2130048,2130176,2130304,2130432,1721472,1918080,148608,345216,541824,738432,935040
.long 27807744,27824128,27758592,27774976,27791360,14336,1064960,25182208,1073741824,1073741824,1053696
.long 3150848,4096,2868,16780300,2654208,24137728,2290649224,2290649224,9443456,10747904,10756096
.long 13754368,13762560,69936,77824,16777216,91392,92160,164480,384,512,640
.long 768,896,1024,1152,591744,788352,984960,1181568,1378176,1574784,1771392
.long 28082176,28098560,28114944,28131328,28147712,14352,1075200,25184256,1073741824,1073741824,1053696
.long 3150848,4128,660276,16780300,2654208,24629248,2290649224,2290649224,9443456,10747904,10756096
.long 13756416,13764608,69940,77952,16826368,91396,92160,164480,655744,655872,656000
.long 656128,656256,656384,656512,640896,837504,1034112,1230720,1427328,1623936,1820544
.long 28086272,28102656,28119040,28135424,28151808,14368,1085440,25186304,1073741824,1073741824,1053696
.long 3150848,4160,2868,16780300,2654208,25120768,2290649224,2290649224,9443456,10747904,10756096
.long 13950976,13959168,70448,78080,16875520,91400,92160,164480,1311104,1311232,1311360
.long 1311488,1311616,1311744,1311872,690048,886656,1083264,1279872,1476480,1673088,1869696
.long 28090368,28106752,28123136,28139520,28155904,14384,1095680,25188352,1073741824,1073741824,1053696
.long 1073741824,4192,660276,16780300,2654208,25612288,2290649224,2290649224,9443456,10747904,10747904
.long 13953024,13961216,70452,78208,16924672,91404,92160,164480,1966464,1966592,1966720
.long 1966848,1966976,1967104,1967232,739200,935808,1132416,1329024,1525632,1722240,1918848
.long 28094464,28110848,28127232,28143616,28160000,30720,1310720,25427968,1073741824,1073741824,1061888
.long 3159040,20480,3508,50465804,3014656,24137728,2290649224,2290649224,9444864,12845056,12853248
.long 16900096,16908288,78128,79872,17563648,93440,92672,205440,164864,164992,163840
.long 163968,164096,164224,164352,1574784,1771392,1920,198528,395136,591744,788352
.long 28123136,28139520,28155904,28090368,28106752,30736,1320960,25430016,1073741824,1073741824,1061888
.long 3159040,20512,660916,50465804,3014656,24629248,2290649224,2290649224,9444864,12845056,12853248
.long 16902144,16910336,78132,80000,17612800,93444,92672,205440,820224,820352,819200
.long 819328,819456,819584,819712,1623936,1820544,51072,247680,444288,640896,837504
.long 28127232,28143616,28160000,28094464,28110848,30752,1331200,25432064,1073741824,1073741824,1061888
.long 3159040,20544,3508,50465804,3014656,25120768,2290649224,2290649224,9444864,12845056,12853248
.long 17096704,17104896,78640,80128,17661952,93448,92672,205440,1475584,1475712,1474560
.long 1474688,1474816,1474944,1475072,1673088,1869696,100224,296832,493440,690048,886656
.long 28131328,28147712,28082176,28098560,28114944,30768,1341440,25434112,1073741824,1073741824,1061888
.long 1073741824,20576,660916,50465804,3014656,25612288,2290649224,2290649224,9444864,12845056,12845056
.long 17098752,17106944,78644,80256,17711104,93452,92672,205440,2130944,2131072,2129920
.long 2130048,2130176,2130304,2130432,1722240,1918848,149376,345984,542592,739200,935808
.long 28135424,28151808,28086272,28102656,28119040,18432,1556480,25673728,1073741824,1073741824,1055744
.long 3152896,4096,4152,16780300,3375104,24137728,2290649224,2290649224,9446272,11272192,11280384
.long 13803520,13811712,70064,81920,18350080,91904,93184,246400,384,512,640
.long 768,896,1024,1152,592512,789120,985728,1182336,1378944,1575552,1772160
.long 28409856,28426240,28442624,28459008,28475392,18448,1566720,25675776,1073741824,1073741824,1055744
.long 3152896,4128,661560,16780300,3375104,24629248,2290649224,2290649224,9446272,11272192,11280384
.long 13805568,13813760,70068,82048,18399232,91908,93184,246400,655744,655872,656000
.long 656128,656256,656384,656512,641664,838272,1034880,1231488,1428096,1624704,1821312
.long 28413952,28430336,28446720,28463104,28479488,18464,1576960,25677824,1073741824,1073741824,1055744
.long 3152896,4160,4152,16780300,3375104,25120768,2290649224,2290649224,9446272,11272192,11280384
.long 14000128,14008320,70576,82176,18448384,91912,93184,246400,1311104,1311232,1311360
.long 1311488,1311616,1311744,1311872,690816,887424,1084032,1280640,1477248,1673856,1870464
.long 28418048,28434432,28450816,28467200,28483584,18480,1587200,25679872,1073741824,1073741824,1055744
.long 1073741824,4192,661560,16780300,3375104,25612288,2290649224,2290649224,9446272,11272192,11272192
.long 14002176,14010368,70580,82304,18497536,91916,93184,246400,1966464,1966592,1966720
.long 1966848,1966976,1967104,1967232,739968,936576,1133184,1329792,1526400,1723008,1919616
.long 28422144,28438528,28454912,28471296,28487680,34816,1802240,25919488,1073741824,1073741824,1063936
.long 3161088,20480,4792,50465804,3735552,24137728,2290649224,2290649224,9447680,13369344,13377536
.long 16949248,16957440,78256,83968,19136512,93952,93696,287360,164864,164992,163840
.long 163968,164096,164224,164352,1575552,1772160,2688,199296,395904,592512,789120
.long 28450816,28467200,28483584,28418048,28434432,34832,1812480,25921536,1073741824,1073741824,1063936
.long 3161088,20512,662200,50465804,3735552,24629248,2290649224,2290649224,9447680,13369344,13377536
.long 16951296,16959488,78260,84096,19185664,93956,93696,287360,820224,820352,819200
.long 819328,819456,819584,819712,1624704,1821312,51840,248448,445056,641664,838272
.long 28454912,28471296,28487680,28422144,28438528,34848,1822720,25923584,1073741824,1073741824,1063936
.long 3161088,20544,4792,50465804,3735552,25120768,2290649224,2290649224,9447680,13369344,13377536
.long 17145856,17154048,78768,84224,19234816,93960,93696,287360,1475584,1475712,1474560
.long 1474688,1474816,1474944,1475072,1673856,1870464,100992,297600,494208,690816,887424
.long 28459008,28475392,28409856,28426240,28442624,34864,1832960,25925632,1073741824,1073741824,1063936
.long 1073741824,20576,662200,50465804,3735552,25612288,2290649224,2290649224,9447680,13369344,13369344
.long 17147904,17156096,78772,84352,19283968,93964,93696,287360,2130944,2131072,2129920
.long 2130048,2130176,2130304,2130432,1723008,1919616,150144,346752,543360,739968,936576
.long 28463104,28479488,28413952,28430336,28446720,6272,82176,24207360,1073741824,1073741824,1049664
.long 3146816,6144,328,50465804,1228800,24137728,2290649224,2290649224,9437888,9715712,9723904
.long 14049280,14057472,70704,70144,13828096,90384,90112,1311360,20864,20992,21120
.long 21248,21376,21504,21632,590208,786816,983424,1180032,1376640,1573248,1769856
.long 27426816,27443200,27459584,27475968,27492352,6288,92416,24209408,1073741824,1073741824,1049664
.long 3146816,6176,657736,50465804,1228800,24629248,2290649224,2290649224,9437888,9715712,9723904
.long 14051328,14059520,70708,70272,13877248,90388,90112,1311360,676224,676352,676480
.long 676608,676736,676864,676992,639360,835968,1032576,1229184,1425792,1622400,1819008
.long 27430912,27447296,27463680,27480064,27496448,6304,102656,24211456,1073741824,1073741824,1049664
.long 3146816,6208,328,50465804,1228800,25120768,2290649224,2290649224,9437888,9715712,9723904
.long 14245888,14254080,71216,70400,13926400,90392,90112,1311360,1331584,1331712,1331840
.long 1331968,1332096,1332224,1332352,688512,885120,1081728,1278336,1474944,1671552,1868160
.long 27435008,27451392,27467776,27484160,27500544,6320,112896,24213504,1073741824,1073741824,1049664
.long 1073741824,6240,657736,50465804,1228800,25612288,2290649224,2290649224,9437888,9715712,9715712
.long 14247936,14256128,71220,70528,13975552,90396,90112,1311360,1986944,1987072,1987200
.long 1987328,1987456,1987584,1987712,737664,934272,1130880,1327488,1524096,1720704,1917312
.long 27439104,27455488,27471872,27488256,27504640,22656,327936,24453120,1073741824,1073741824,1057856
.long 3155008,22528,972,16780300,1589248,24137728,2290649224,2290649224,9439296,11812864,11821056
.long 17195008,17203200,78896,72192,14614528,92432,90624,1352320,185344,185472,184320
.long 184448,184576,184704,184832,1573248,1769856,384,196992,393600,590208,786816
.long 27467776,27484160,27500544,27435008,27451392,22672,338176,24455168,1073741824,1073741824,1057856
.long 3155008,22560,658380,16780300,1589248,24629248,2290649224,2290649224,9439296,11812864,11821056
.long 17197056,17205248,78900,72320,14663680,92436,90624,1352320,840704,840832,839680
.long 839808,839936,840064,840192,1622400,1819008,49536,246144,442752,639360,835968
.long 27471872,27488256,27504640,27439104,27455488,22688,348416,24457216,1073741824,1073741824,1057856
.long 3155008,22592,972,16780300,1589248,25120768,2290649224,2290649224,9439296,11812864,11821056
.long 17391616,17399808,79408,72448,14712832,92440,90624,1352320,1496064,1496192,1495040
.long 1495168,1495296,1495424,1495552,1671552,1868160,98688,295296,491904,688512,885120
.long 27475968,27492352,27426816,27443200,27459584,22704,358656,24459264,1073741824,1073741824,1057856
.long 1073741824,22624,658380,16780300,1589248,25612288,2290649224,2290649224,9439296,11812864,11812864
.long 17393664,17401856,79412,72576,14761984,92444,90624,1352320,2151424,2151552,2150400
.long 2150528,2150656,2150784,2150912,1720704,1917312,147840,344448,541056,737664,934272
.long 27480064,27496448,27430912,27447296,27463680,10368,573696,24698880,1073741824,1073741824,1051712
.long 3148864,6144,1612,50465804,1949696,24137728,2290649224,2290649224,9440704,10240000,10248192
.long 14098432,14106624,70832,74240,15400960,90896,91136,1393280,20864,20992,21120
.long 21248,21376,21504,21632,590976,787584,984192,1180800,1377408,1574016,1770624
.long 27754496,27770880,27787264,27803648,27820032,10384,583936,24700928,1073741824,1073741824,1051712
.long 3148864,6176,659020,50465804,1949696,24629248,2290649224,2290649224,9440704,10240000,10248192
.long 14100480,14108672,70836,74368,15450112,90900,91136,1393280,676224,676352,676480
.long 676608,676736,676864,676992,640128,836736,1033344,1229952,1426560,1623168,1819776
.long 27758592,27774976,27791360,27807744,27824128,10400,594176,24702976,1073741824,1073741824,1051712
.long 3148864,6208,1612,50465804,1949696,25120768,2290649224,2290649224,9440704,10240000,10248192
.long 14295040,14303232,71344,74496,15499264,90904,91136,1393280,1331584,1331712,1331840
.long 1331968,1332096,1332224,1332352,689280,885888,1082496,1279104,1475712,1672320,1868928
.long 27762688,27779072,27795456,27811840,27828224,10416,604416,24705024,1073741824,1073741824,1051712
.long 1073741824,6240,659020,50465804,1949696,25612288,2290649224,2290649224,9440704,10240000,10240000
.long 14297088,14305280,71348,74624,15548416,90908,91136,1393280,1986944,1987072,1987200
.long 1987328,1987456,1987584,1987712,738432,935040,1131648,1328256,1524864,1721472,1918080
.long 27766784,27783168,27799552,27815936,27832320,26752,819456,24944640,1073741824,1073741824,1059904
.long 3157056,22528,2256,16780300,2310144,24137728,2290649224,2290649224,9442112,12337152,12345344
.long 17244160,17252352,79024,76288,16187392,92944,91648,1434240,185344,185472,184320
.long 184448,184576,184704,184832,1574016,1770624,1152,197760,394368,590976,787584
.long 27795456,27811840,27828224,27762688,27779072,26768,829696,24946688,1073741824,1073741824,1059904
.long 3157056,22560,659664,16780300,2310144,24629248,2290649224,2290649224,9442112,12337152,12345344
.long 17246208,17254400,79028,76416,16236544,92948,91648,1434240,840704,840832,839680
.long 839808,839936,840064,840192,1623168,1819776,50304,246912,443520,640128,836736
.long 27799552,27815936,27832320,27766784,27783168,26784,839936,24948736,1073741824,1073741824,1059904
.long 3157056,22592,2256,16780300,2310144,25120768,2290649224,2290649224,9442112,12337152,12345344
.long 17440768,17448960,79536,76544,16285696,92952,91648,1434240,1496064,1496192,1495040
.long 1495168,1495296,1495424,1495552,1672320,1868928,99456,296064,492672,689280,885888
.long 27803648,27820032,27754496,27770880,27787264,26800,850176,24950784,1073741824,1073741824,1059904
.long 1073741824,22624,659664,16780300,2310144,25612288,2290649224,2290649224,9442112,12337152,12337152
.long 17442816,17451008,79540,76672,16334848,92956,91648,1434240,2151424,2151552,2150400
.long 2150528,2150656,2150784,2150912,1721472,1918080,148608,345216,541824,738432,935040
.long 27807744,27824128,27758592,27774976,27791360,14464,1065216,25190400,1073741824,1073741824,1053760
.long 3150912,6144,2896,50465804,2670592,24137728,2290649224,2290649224,9443520,10764288,10772480
.long 14147584,14155776,70960,78336,16973824,91408,92160,1475200,20864,20992,21120
.long 21248,21376,21504,21632,591744,788352,984960,1181568,1378176,1574784,1771392
.long 28082176,28098560,28114944,28131328,28147712,14480,1075456,25192448,1073741824,1073741824,1053760
.long 3150912,6176,660304,50465804,2670592,24629248,2290649224,2290649224,9443520,10764288,10772480
.long 14149632,14157824,70964,78464,17022976,91412,92160,1475200,676224,676352,676480
.long 676608,676736,676864,676992,640896,837504,1034112,1230720,1427328,1623936,1820544
.long 28086272,28102656,28119040,28135424,28151808,14496,1085696,25194496,1073741824,1073741824,1053760
.long 3150912,6208,2896,50465804,2670592,25120768,2290649224,2290649224,9443520,10764288,10772480
.long 14344192,14352384,71472,78592,17072128,91416,92160,1475200,1331584,1331712,1331840
.long 1331968,1332096,1332224,1332352,690048,886656,1083264,1279872,1476480,1673088,1869696
.long 28090368,28106752,28123136,28139520,28155904,14512,1095936,25196544,1073741824,1073741824,1053760
.long 1073741824,6240,660304,50465804,2670592,25612288,2290649224,2290649224,9443520,10764288,10764288
.long 14346240,14354432,71476,78720,17121280,91420,92160,1475200,1986944,1987072,1987200
.long 1987328,1987456,1987584,1987712,739200,935808,1132416,1329024,1525632,1722240,1918848
.long 28094464,28110848,28127232,28143616,28160000,30848,1310976,25436160,1073741824,1073741824,1061952
.long 3159104,22528,3540,16780300,3031040,24137728,2290649224,2290649224,9444928,12861440,12869632
.long 17293312,17301504,79152,80384,17760256,93456,92672,1516160,185344,185472,184320
.long 184448,184576,184704,184832,1574784,1771392,1920,198528,395136,591744,788352
.long 28123136,28139520,28155904,28090368,28106752,30864,1321216,25438208,1073741824,1073741824,1061952
.long 3159104,22560,660948,16780300,3031040,24629248,2290649224,2290649224,9444928,12861440,12869632
.long 17295360,17303552,79156,80512,17809408,93460,92672,1516160,840704,840832,839680
.long 839808,839936,840064,840192,1623936,1820544,51072,247680,444288,640896,837504
.long 28127232,28143616,28160000,28094464,28110848,30880,1331456,25440256,1073741824,1073741824,1061952
.long 3159104,22592,3540,16780300,3031040,25120768,2290649224,2290649224,9444928,12861440,12869632
.long 17489920,17498112,79664,80640,17858560,93464,92672,1516160,1496064,1496192,1495040
.long 1495168,1495296,1495424,1495552,1673088,1869696,100224,296832,493440,690048,886656
.long 28131328,28147712,28082176,28098560,28114944,30896,1341696,25442304,1073741824,1073741824,1061952
.long 1073741824,22624,660948,16780300,3031040,25612288,2290649224,2290649224,9444928,12861440,12861440
.long 17491968,17500160,79668,80768,17907712,93468,92672,1516160,2151424,2151552,2150400
.long 2150528,2150656,2150784,2150912,1722240,1918848,149376,345984,542592,739200,935808
.long 28135424,28151808,28086272,28102656,28119040,18560,1556736,25681920,1073741824,1073741824,1055808
.long 3152960,6144,4180,50465804,3391488,24137728,2290649224,2290649224,9446336,11288576,11296768
.long 14196736,14204928,71088,82432,18546688,91920,93184,1557120,20864,20992,21120
.long 21248,21376,21504,21632,592512,789120,985728,1182336,1378944,1575552,1772160
.long 28409856,28426240,28442624,28459008,28475392,18576,1566976,25683968,1073741824,1073741824,1055808
.long 3152960,6176,661588,50465804,3391488,24629248,2290649224,2290649224,9446336,11288576,11296768
.long 14198784,14206976,71092,82560,18595840,91924,93184,1557120,676224,676352,676480
.long 676608,676736,676864,676992,641664,838272,1034880,1231488,1428096,1624704,1821312
.long 28413952,28430336,28446720,28463104,28479488,18592,1577216,25686016,1073741824,1073741824,1055808
.long 3152960,6208,4180,50465804,3391488,25120768,2290649224,2290649224,9446336,11288576,11296768
.long 14393344,14401536,71600,82688,18644992,91928,93184,1557120,1331584,1331712,1331840
.long 1331968,1332096,1332224,1332352,690816,887424,1084032,1280640,1477248,1673856,1870464
.long 28418048,28434432,28450816,28467200,28483584,18608,1587456,25688064,1073741824,1073741824,1055808
.long 1073741824,6240,661588,50465804,3391488,25612288,2290649224,2290649224,9446336,11288576,11288576
.long 14395392,14403584,71604,82816,18694144,91932,93184,1557120,1986944,1987072,1987200
.long 1987328,1987456,1987584,1987712,739968,936576,1133184,1329792,1526400,1723008,1919616
.long 28422144,28438528,28454912,28471296,28487680,34944,1802496,25927680,1073741824,1073741824,1064000
.long 3161152,22528,4824,16780300,3751936,24137728,2290649224,2290649224,9447744,13385728,13393920
.long 17342464,17350656,79280,84480,19333120,93968,93696,1598080,185344,185472,184320
.long 184448,184576,184704,184832,1575552,1772160,2688,199296,395904,592512,789120
.long 28450816,28467200,28483584,28418048,28434432,34960,1812736,25929728,1073741824,1073741824,1064000
.long 3161152,22560,662232,16780300,3751936,24629248,2290649224,2290649224,9447744,13385728,13393920
.long 17344512,17352704,79284,84608,19382272,93972,93696,1598080,840704,840832,839680
.long 839808,839936,840064,840192,1624704,1821312,51840,248448,445056,641664,838272
.long 28454912,28471296,28487680,28422144,28438528,34976,1822976,25931776,1073741824,1073741824,1064000
.long 3161152,22592,4824,16780300,3751936,25120768,2290649224,2290649224,9447744,13385728,13393920
.long 17539072,17547264,79792,84736,19431424,93976,93696,1598080,1496064,1496192,1495040
.long 1495168,1495296,1495424,1495552,1673856,1870464,100992,297600,494208,690816,887424
.long 28459008,28475392,28409856,28426240,28442624,34992,1833216,25933824,1073741824,1073741824,1064000
.long 1073741824,22624,662232,16780300,3751936,25612288,2290649224,2290649224,9447744,13385728,13385728
.long 17541120,17549312,79796,84864,19480576,93980,93696,1598080,2151424,2151552,2150400
.long 2150528,2150656,2150784,2150912,1723008,1919616,150144,346752,543360,739968,936576
.long 28463104,28479488,28413952,28430336,28446720,6400,1073741824,1073741824,1769601,27337728,1049728
.long 3146880,8192,360,16780300,1245184,24137728,2290649224,2290649224,9437952,9732096,9740288
.long 14442496,14450688,71728,70656,14024704,90400,90368,21120,41472,41600,41728
.long 41856,41984,42112,40960,786816,983424,1180032,1376640,1573248,1769856,384
.long 27435008,27451392,27467776,27484160,27500544,6416,1073741824,1073741824,1818753,27339776,1049728
.long 3146880,8224,657768,16780300,1245184,24629248,2290649224,2290649224,9437952,9732096,9740288
.long 14444544,14452736,71732,70784,14073856,90404,90368,21120,696832,696960,697088
.long 697216,697344,697472,696320,835968,1032576,1229184,1425792,1622400,1819008,49536
.long 27439104,27455488,27471872,27488256,27504640,6432,1073741824,1073741824,1867905,27341824,1049728
.long 3146880,8256,360,16780300,1245184,25120768,2290649224,2290649224,9437952,9732096,9740288
.long 14639104,14647296,72240,70912,14123008,90408,90368,21120,1352192,1352320,1352448
.long 1352576,1352704,1352832,1351680,885120,1081728,1278336,1474944,1671552,1868160,98688
.long 27443200,27459584,27475968,27492352,27426816,6448,1073741824,1073741824,1917057,27343872,1049728
.long 1073741824,8288,657768,16780300,1245184,25612288,2290649224,2290649224,9437952,9732096,9732096
.long 14641152,14649344,72244,71040,14172160,90412,90368,21120,2007552,2007680,2007808
.long 2007936,2008064,2008192,2007040,934272,1130880,1327488,1524096,1720704,1917312,147840
.long 27447296,27463680,27480064,27496448,27430912,22784,1073741824,1073741824,1769985,27501568,1057920
.long 3155072,24576,1000,50465804,1605632,24137728,2290649224,2290649224,9439360,11829248,11837440
.long 17588224,17596416,79920,72704,14811136,92448,90880,62080,205952,204800,204928
.long 205056,205184,205312,205440,1769856,384,196992,393600,590208,786816,983424
.long 27475968,27492352,27426816,27443200,27459584,22800,1073741824,1073741824,1819137,27503616,1057920
.long 3155072,24608,658408,50465804,1605632,24629248,2290649224,2290649224,9439360,11829248,11837440
.long 17590272,17598464,79924,72832,14860288,92452,90880,62080,861312,860160,860288
.long 860416,860544,860672,860800,1819008,49536,246144,442752,639360,835968,1032576
.long 27480064,27496448,27430912,27447296,27463680,22816,1073741824,1073741824,1868289,27505664,1057920
.long 3155072,24640,1000,50465804,1605632,25120768,2290649224,2290649224,9439360,11829248,11837440
.long 17784832,17793024,80432,72960,14909440,92456,90880,62080,1516672,1515520,1515648
.long 1515776,1515904,1516032,1516160,1868160,98688,295296,491904,688512,885120,1081728
.long 27484160,27500544,27435008,27451392,27467776,22832,1073741824,1073741824,1917441,27507712,1057920
.long 1073741824,24672,658408,50465804,1605632,25612288,2290649224,2290649224,9439360,11829248,11829248
.long 17786880,17795072,80436,73088,14958592,92460,90880,62080,2172032,2170880,2171008
.long 2171136,2171264,2171392,2171520,1917312,147840,344448,541056,737664,934272,1130880
.long 27488256,27504640,27439104,27455488,27471872,10496,1073741824,1073741824,1770369,27665408,1051776
.long 3148928,8192,1644,16780300,1966080,24137728,2290649224,2290649224,9440768,10256384,10264576
.long 14491648,14499840,71856,74752,15597568,90912,91392,103040,41472,41600,41728
.long 41856,41984,42112,40960,787584,984192,1180800,1377408,1574016,1770624,1152
.long 27762688,27779072,27795456,27811840,27828224,10512,1073741824,1073741824,1819521,27667456,1051776
.long 3148928,8224,659052,16780300,1966080,24629248,2290649224,2290649224,9440768,10256384,10264576
.long 14493696,14501888,71860,74880,15646720,90916,91392,103040,696832,696960,697088
.long 697216,697344,697472,696320,836736,1033344,1229952,1426560,1623168,1819776,50304
.long 27766784,27783168,27799552,27815936,27832320,10528,1073741824,1073741824,1868673,27669504,1051776
.long 3148928,8256,1644,16780300,1966080,25120768,2290649224,2290649224,9440768,10256384,10264576
.long 14688256,14696448,72368,75008,15695872,90920,91392,103040,1352192,1352320,1352448
.long 1352576,1352704,1352832,1351680,885888,1082496,1279104,1475712,1672320,1868928,99456
.long 27770880,27787264,27803648,27820032,27754496,10544,1073741824,1073741824,1917825,27671552,1051776
.long 1073741824,8288,659052,16780300,1966080,25612288,2290649224,2290649224,9440768,10256384,10256384
.long 14690304,14698496,72372,75136,15745024,90924,91392,103040,2007552,2007680,2007808
.long 2007936,2008064,2008192,2007040,935040,1131648,1328256,1524864,1721472,1918080,148608
.long 27774976,27791360,27807744,27824128,27758592,26880,1073741824,1073741824,1770753,27829248,1059968
.long 3157120,24576,2284,50465804,2326528,24137728,2290649224,2290649224,9442176,12353536,12361728
.long 17637376,17645568,80048,76800,16384000,92960,91904,144000,205952,204800,204928
.long 205056,205184,205312,205440,1770624,1152,197760,394368,590976,787584,984192
.long 27803648,27820032,27754496,27770880,27787264,26896,1073741824,1073741824,1819905,27831296,1059968
.long 3157120,24608,659692,50465804,2326528,24629248,2290649224,2290649224,9442176,12353536,12361728
.long 17639424,17647616,80052,76928,16433152,92964,91904,144000,861312,860160,860288
.long 860416,860544,860672,860800,1819776,50304,246912,443520,640128,836736,1033344
.long 27807744,27824128,27758592,27774976,27791360,26912,1073741824,1073741824,1869057,27833344,1059968
.long 3157120,24640,2284,50465804,2326528,25120768,2290649224,2290649224,9442176,12353536,12361728
.long 17833984,17842176,80560,77056,16482304,92968,91904,144000,1516672,1515520,1515648
.long 1515776,1515904,1516032,1516160,1868928,99456,296064,492672,689280,885888,1082496
.long 27811840,27828224,27762688,27779072,27795456,26928,1073741824,1073741824,1918209,27835392,1059968
.long 1073741824,24672,659692,50465804,2326528,25612288,2290649224,2290649224,9442176,12353536,12353536
.long 17836032,17844224,80564,77184,16531456,92972,91904,144000,2172032,2170880,2171008
.long 2171136,2171264,2171392,2171520,1918080,148608,345216,541824,738432,935040,1131648
.long 27815936,27832320,27766784,27783168,27799552,14592,1073741824,1073741824,1771137,27993088,1053824
.long 3150976,8192,2928,16780300,2686976,24137728,2290649224,2290649224,9443584,10780672,10788864
.long 14540800,14548992,71984,78848,17170432,91424,92416,184960,41472,41600,41728
.long 41856,41984,42112,40960,788352,984960,1181568,1378176,1574784,1771392,1920
.long 28090368,28106752,28123136,28139520,28155904,14608,1073741824,1073741824,1820289,27995136,1053824
.long 3150976,8224,660336,16780300,2686976,24629248,2290649224,2290649224,9443584,10780672,10788864
.long 14542848,14551040,71988,78976,17219584,91428,92416,184960,696832,696960,697088
.long 697216,697344,697472,696320,837504,1034112,1230720,1427328,1623936,1820544,51072
.long 28094464,28110848,28127232,28143616,28160000,14624,1073741824,1073741824,1869441,27997184,1053824
.long 3150976,8256,2928,16780300,2686976,25120768,2290649224,2290649224,9443584,10780672,10788864
.long 14737408,14745600,72496,79104,17268736,91432,92416,184960,1352192,1352320,1352448
.long 1352576,1352704,1352832,1351680,886656,1083264,1279872,1476480,1673088,1869696,100224
.long 28098560,28114944,28131328,28147712,28082176,14640,1073741824,1073741824,1918593,27999232,1053824
.long 1073741824,8288,660336,16780300,2686976,25612288,2290649224,2290649224,9443584,10780672,10780672
.long 14739456,14747648,72500,79232,17317888,91436,92416,184960,2007552,2007680,2007808
.long 2007936,2008064,2008192,2007040,935808,1132416,1329024,1525632,1722240,1918848,149376
.long 28102656,28119040,28135424,28151808,28086272,30976,1073741824,1073741824,1771521,28156928,1062016
.long 3159168,24576,3568,50465804,3047424,24137728,2290649224,2290649224,9444992,12877824,12886016
.long 17686528,17694720,80176,80896,17956864,93472,92928,225920,205952,204800,204928
.long 205056,205184,205312,205440,1771392,1920,198528,395136,591744,788352,984960
.long 28131328,28147712,28082176,28098560,28114944,30992,1073741824,1073741824,1820673,28158976,1062016
.long 3159168,24608,660976,50465804,3047424,24629248,2290649224,2290649224,9444992,12877824,12886016
.long 17688576,17696768,80180,81024,18006016,93476,92928,225920,861312,860160,860288
.long 860416,860544,860672,860800,1820544,51072,247680,444288,640896,837504,1034112
.long 28135424,28151808,28086272,28102656,28119040,31008,1073741824,1073741824,1869825,28161024,1062016
.long 3159168,24640,3568,50465804,3047424,25120768,2290649224,2290649224,9444992,12877824,12886016
.long 17883136,17891328,80688,81152,18055168,93480,92928,225920,1516672,1515520,1515648
.long 1515776,1515904,1516032,1516160,1869696,100224,296832,493440,690048,886656,1083264
.long 28139520,28155904,28090368,28106752,28123136,31024,1073741824,1073741824,1918977,28163072,1062016
.long 1073741824,24672,660976,50465804,3047424,25612288,2290649224,2290649224,9444992,12877824,12877824
.long 17885184,17893376,80692,81280,18104320,93484,92928,225920,2172032,2170880,2171008
.long 2171136,2171264,2171392,2171520,1918848,149376,345984,542592,739200,935808,1132416
.long 28143616,28160000,28094464,28110848,28127232,18688,1073741824,1073741824,1771905,28320768,1055872
.long 3153024,8192,4212,16780300,3407872,24137728,2290649224,2290649224,9446400,11304960,11313152
.long 14589952,14598144,72112,82944,18743296,91936,93440,266880,41472,41600,41728
.long 41856,41984,42112,40960,789120,985728,1182336,1378944,1575552,1772160,2688
.long 28418048,28434432,28450816,28467200,28483584,18704,1073741824,1073741824,1821057,28322816,1055872
.long 3153024,8224,661620,16780300,3407872,24629248,2290649224,2290649224,9446400,11304960,11313152
.long 14592000,14600192,72116,83072,18792448,91940,93440,266880,696832,696960,697088
.long 697216,697344,697472,696320,838272,1034880,1231488,1428096,1624704,1821312,51840
.long 28422144,28438528,28454912,28471296,28487680,18720,1073741824,1073741824,1870209,28324864,1055872
.long 3153024,8256,4212,16780300,3407872,25120768,2290649224,2290649224,9446400,11304960,11313152
.long 14786560,14794752,72624,83200,18841600,91944,93440,266880,1352192,1352320,1352448
.long 1352576,1352704,1352832,1351680,887424,1084032,1280640,1477248,1673856,1870464,100992
.long 28426240,28442624,28459008,28475392,28409856,18736,1073741824,1073741824,1919361,28326912,1055872
.long 1073741824,8288,661620,16780300,3407872,25612288,2290649224,2290649224,9446400,11304960,11304960
.long 14788608,14796800,72628,83328,18890752,91948,93440,266880,2007552,2007680,2007808
.long 2007936,2008064,2008192,2007040,936576,1133184,1329792,1526400,1723008,1919616,150144
.long 28430336,28446720,28463104,28479488,28413952,35072,1073741824,1073741824,1772289,28484608,1064064
.long 3161216,24576,4852,50465804,3768320,24137728,2290649224,2290649224,9447808,13402112,13410304
.long 17735680,17743872,80304,84992,19529728,93984,93952,307840,205952,204800,204928
.long 205056,205184,205312,205440,1772160,2688,199296,395904,592512,789120,985728
.long 28459008,28475392,28409856,28426240,28442624,35088,1073741824,1073741824,1821441,28486656,1064064
.long 3161216,24608,662260,50465804,3768320,24629248,2290649224,2290649224,9447808,13402112,13410304
.long 17737728,17745920,80308,85120,19578880,93988,93952,307840,861312,860160,860288
.long 860416,860544,860672,860800,1821312,51840,248448,445056,641664,838272,1034880
.long 28463104,28479488,28413952,28430336,28446720,35104,1073741824,1073741824,1870593,28488704,1064064
.long 3161216,24640,4852,50465804,3768320,25120768,2290649224,2290649224,9447808,13402112,13410304
.long 17932288,17940480,80816,85248,19628032,93992,93952,307840,1516672,1515520,1515648
.long 1515776,1515904,1516032,1516160,1870464,100992,297600,494208,690816,887424,1084032
.long 28467200,28483584,28418048,28434432,28450816,35120,1073741824,1073741824,1919745,28490752,1064064
.long 1073741824,24672,662260,50465804,3768320,25612288,2290649224,2290649224,9447808,13402112,13402112
.long 17934336,17942528,80820,85376,19677184,93996,93952,307840,2172032,2170880,2171008
.long 2171136,2171264,2171392,2171520,1919616,150144,346752,543360,739968,936576,1133184
.long 28471296,28487680,28422144,28438528,28454912,6528,1073741824,1073741824,1572993,27329536,1049792
.long 3146944,10240,388,50465804,1261568,24137728,2290649224,2290649224,9438016,9748480,9756672
.long 14835712,14843904,72752,71168,14221312,90416,90368,1331840,61952,62080,62208
.long 62336,62464,62592,61440,786816,983424,1180032,1376640,1573248,1769856,384
.long 27435008,27451392,27467776,27484160,27500544,6544,1073741824,1073741824,1622145,27331584,1049792
.long 3146944,10272,657796,50465804,1261568,24629248,2290649224,2290649224,9438016,9748480,9756672
.long 14837760,14845952,72756,71296,14270464,90420,90368,1331840,717312,717440,717568
.long 717696,717824,717952,716800,835968,1032576,1229184,1425792,1622400,1819008,49536
.long 27439104,27455488,27471872,27488256,27504640,6560,1073741824,1073741824,1671297,27333632,1049792
.long 3146944,10304,388,50465804,1261568,25120768,2290649224,2290649224,9438016,9748480,9756672
.long 15032320,15040512,73264,71424,14319616,90424,90368,1331840,1372672,1372800,1372928
.long 1373056,1373184,1373312,1372160,885120,1081728,1278336,1474944,1671552,1868160,98688
.long 27443200,27459584,27475968,27492352,27426816,6576,1073741824,1073741824,1720449,27335680,1049792
.long 1073741824,10336,657796,50465804,1261568,25612288,2290649224,2290649224,9438016,9748480,9748480
.long 15034368,15042560,73268,71552,14368768,90428,90368,1331840,2028032,2028160,2028288
.long 2028416,2028544,2028672,2027520,934272,1130880,1327488,1524096,1720704,1917312,147840
.long 27447296,27463680,27480064,27496448,27430912,22912,1073741824,1073741824,1573377,27493376,1057984
.long 3155136,26624,1032,16780300,1622016,24137728,2290649224,2290649224,9439424,11845632,11853824
.long 17981440,17989632,80944,73216,15007744,92464,90880,1372800,226432,225280,225408
.long 225536,225664,225792,225920,1769856,384,196992,393600,590208,786816,983424
.long 27475968,27492352,27426816,27443200,27459584,22928,1073741824,1073741824,1622529,27495424,1057984
.long 3155136,26656,658440,16780300,1622016,24629248,2290649224,2290649224,9439424,11845632,11853824
.long 17983488,17991680,80948,73344,15056896,92468,90880,1372800,881792,880640,880768
.long 880896,881024,881152,881280,1819008,49536,246144,442752,639360,835968,1032576
.long 27480064,27496448,27430912,27447296,27463680,22944,1073741824,1073741824,1671681,27497472,1057984
.long 3155136,26688,1032,16780300,1622016,25120768,2290649224,2290649224,9439424,11845632,11853824
.long 18178048,18186240,81456,73472,15106048,92472,90880,1372800,1537152,1536000,1536128
.long 1536256,1536384,1536512,1536640,1868160,98688,295296,491904,688512,885120,1081728
.long 27484160,27500544,27435008,27451392,27467776,22960,1073741824,1073741824,1720833,27499520,1057984
.long 1073741824,26720,658440,16780300,1622016,25612288,2290649224,2290649224,9439424,11845632,11845632
.long 18180096,18188288,81460,73600,15155200,92476,90880,1372800,2192512,2191360,2191488
.long 2191616,2191744,2191872,2192000,1917312,147840,344448,541056,737664,934272,1130880
.long 27488256,27504640,27439104,27455488,27471872,10624,1073741824,1073741824,1573761,27657216,1051840
.long 3148992,10240,1672,50465804,1982464,24137728,2290649224,2290649224,9440832,10272768,10280960
.long 14884864,14893056,72880,75264,15794176,90928,91392,1413760,61952,62080,62208
.long 62336,62464,62592,61440,787584,984192,1180800,1377408,1574016,1770624,1152
.long 27762688,27779072,27795456,27811840,27828224,10640,1073741824,1073741824,1622913,27659264,1051840
.long 3148992,10272,659080,50465804,1982464,24629248,2290649224,2290649224,9440832,10272768,10280960
.long 14886912,14895104,72884,75392,15843328,90932,91392,1413760,717312,717440,717568
.long 717696,717824,717952,716800,836736,1033344,1229952,1426560,1623168,1819776,50304
.long 27766784,27783168,27799552,27815936,27832320,10656,1073741824,1073741824,1672065,27661312,1051840
.long 3148992,10304,1672,50465804,1982464,25120768,2290649224,2290649224,9440832,10272768,10280960
.long 15081472,15089664,73392,75520,15892480,90936,91392,1413760,1372672,1372800,1372928
.long 1373056,1373184,1373312,1372160,885888,1082496,1279104,1475712,1672320,1868928,99456
.long 27770880,27787264,27803648,27820032,27754496,10672,1073741824,1073741824,1721217,27663360,1051840
.long 1073741824,10336,659080,50465804,1982464,25612288,2290649224,2290649224,9440832,10272768,10272768
.long 15083520,15091712,73396,75648,15941632,90940,91392,1413760,2028032,2028160,2028288
.long 2028416,2028544,2028672,2027520,935040,1131648,1328256,1524864,1721472,1918080,148608
.long 27774976,27791360,27807744,27824128,27758592,27008,1073741824,1073741824,1574145,27821056,1060032
.long 3157184,26624,2316,16780300,2342912,24137728,2290649224,2290649224,9442240,12369920,12378112
.long 18030592,18038784,81072,77312,16580608,92976,91904,1454720,226432,225280,225408
.long 225536,225664,225792,225920,1770624,1152,197760,394368,590976,787584,984192
.long 27803648,27820032,27754496,27770880,27787264,27024,1073741824,1073741824,1623297,27823104,1060032
.long 3157184,26656,659724,16780300,2342912,24629248,2290649224,2290649224,9442240,12369920,12378112
.long 18032640,18040832,81076,77440,16629760,92980,91904,1454720,881792,880640,880768
.long 880896,881024,881152,881280,1819776,50304,246912,443520,640128,836736,1033344
.long 27807744,27824128,27758592,27774976,27791360,27040,1073741824,1073741824,1672449,27825152,1060032
.long 3157184,26688,2316,16780300,2342912,25120768,2290649224,2290649224,9442240,12369920,12378112
.long 18227200,18235392,81584,77568,16678912,92984,91904,1454720,1537152,1536000,1536128
.long 1536256,1536384,1536512,1536640,1868928,99456,296064,492672,689280,885888,1082496
.long 27811840,27828224,27762688,27779072,27795456,27056,1073741824,1073741824,1721601,27827200,1060032
.long 1073741824,26720,659724,16780300,2342912,25612288,2290649224,2290649224,9442240,12369920,12369920
.long 18229248,18237440,81588,77696,16728064,92988,91904,1454720,2192512,2191360,2191488
.long 2191616,2191744,2191872,2192000,1918080,148608,345216,541824,738432,935040,1131648
.long 27815936,27832320,27766784,27783168,27799552,14720,1073741824,1073741824,1574529,27984896,1053888
.long 3151040,10240,2956,50465804,2703360,24137728,2290649224,2290649224,9443648,10797056,10805248
.long 14934016,14942208,73008,79360,17367040,91440,92416,1495680,61952,62080,62208
.long 62336,62464,62592,61440,788352,984960,1181568,1378176,1574784,1771392,1920
.long 28090368,28106752,28123136,28139520,28155904,14736,1073741824,1073741824,1623681,27986944,1053888
.long 3151040,10272,660364,50465804,2703360,24629248,2290649224,2290649224,9443648,10797056,10805248
.long 14936064,14944256,73012,79488,17416192,91444,92416,1495680,717312,717440,717568
.long 717696,717824,717952,716800,837504,1034112,1230720,1427328,1623936,1820544,51072
.long 28094464,28110848,28127232,28143616,28160000,14752,1073741824,1073741824,1672833,27988992,1053888
.long 3151040,10304,2956,50465804,2703360,25120768,2290649224,2290649224,9443648,10797056,10805248
.long 15130624,15138816,73520,79616,17465344,91448,92416,1495680,1372672,1372800,1372928
.long 1373056,1373184,1373312,1372160,886656,1083264,1279872,1476480,1673088,1869696,100224
.long 28098560,28114944,28131328,28147712,28082176,14768,1073741824,1073741824,1721985,27991040,1053888
.long 1073741824,10336,660364,50465804,2703360,25612288,2290649224,2290649224,9443648,10797056,10797056
.long 15132672,15140864,73524,79744,17514496,91452,92416,1495680,2028032,2028160,2028288
.long 2028416,2028544,2028672,2027520,935808,1132416,1329024,1525632,1722240,1918848,149376
.long 28102656,28119040,28135424,28151808,28086272,31104,1073741824,1073741824,1574913,28148736,1062080
.long 3159232,26624,3600,16780300,3063808,24137728,2290649224,2290649224,9445056,12894208,12902400
.long 18079744,18087936,81200,81408,18153472,93488,92928,1536640,226432,225280,225408
.long 225536,225664,225792,225920,1771392,1920,198528,395136,591744,788352,984960
.long 28131328,28147712,28082176,28098560,28114944,31120,1073741824,1073741824,1624065,28150784,1062080
.long 3159232,26656,661008,16780300,3063808,24629248,2290649224,2290649224,9445056,12894208,12902400
.long 18081792,18089984,81204,81536,18202624,93492,92928,1536640,881792,880640,880768
.long 880896,881024,881152,881280,1820544,51072,247680,444288,640896,837504,1034112
.long 28135424,28151808,28086272,28102656,28119040,31136,1073741824,1073741824,1673217,28152832,1062080
.long 3159232,26688,3600,16780300,3063808,25120768,2290649224,2290649224,9445056,12894208,12902400
.long 18276352,18284544,81712,81664,18251776,93496,92928,1536640,1537152,1536000,1536128
.long 1536256,1536384,1536512,1536640,1869696,100224,296832,493440,690048,886656,1083264
.long 28139520,28155904,28090368,28106752,28123136,31152,1073741824,1073741824,1722369,28154880,1062080
.long 1073741824,26720,661008,16780300,3063808,25612288,2290649224,2290649224,9445056,12894208,12894208
.long 18278400,18286592,81716,81792,18300928,93500,92928,1536640,2192512,2191360,2191488
.long 2191616,2191744,2191872,2192000,1918848,149376,345984,542592,739200,935808,1132416
.long 28143616,28160000,28094464,28110848,28127232,18816,1073741824,1073741824,1575297,28312576,1055936
.long 3153088,10240,4240,50465804,3424256,24137728,2290649224,2290649224,9446464,11321344,11329536
.long 14983168,14991360,73136,83456,18939904,91952,93440,1577600,61952,62080,62208
.long 62336,62464,62592,61440,789120,985728,1182336,1378944,1575552,1772160,2688
.long 28418048,28434432,28450816,28467200,28483584,18832,1073741824,1073741824,1624449,28314624,1055936
.long 3153088,10272,661648,50465804,3424256,24629248,2290649224,2290649224,9446464,11321344,11329536
.long 14985216,14993408,73140,83584,18989056,91956,93440,1577600,717312,717440,717568
.long 717696,717824,717952,716800,838272,1034880,1231488,1428096,1624704,1821312,51840
.long 28422144,28438528,28454912,28471296,28487680,18848,1073741824,1073741824,1673601,28316672,1055936
.long 3153088,10304,4240,50465804,3424256,25120768,2290649224,2290649224,9446464,11321344,11329536
.long 15179776,15187968,73648,83712,19038208,91960,93440,1577600,1372672,1372800,1372928
.long 1373056,1373184,1373312,1372160,887424,1084032,1280640,1477248,1673856,1870464,100992
.long 28426240,28442624,28459008,28475392,28409856,18864,1073741824,1073741824,1722753,28318720,1055936
.long 1073741824,10336,661648,50465804,3424256,25612288,2290649224,2290649224,9446464,11321344,11321344
.long 15181824,15190016,73652,83840,19087360,91964,93440,1577600,2028032,2028160,2028288
.long 2028416,2028544,2028672,2027520,936576,1133184,1329792,1526400,1723008,1919616,150144
.long 28430336,28446720,28463104,28479488,28413952,35200,1073741824,1073741824,1575681,28476416,1064128
.long 3161280,26624,4884,16780300,3784704,24137728,2290649224,2290649224,9447872,13418496,13426688
.long 18128896,18137088,81328,85504,19726336,94000,93952,1618560,226432,225280,225408
.long 225536,225664,225792,225920,1772160,2688,199296,395904,592512,789120,985728
.long 28459008,28475392,28409856,28426240,28442624,35216,1073741824,1073741824,1624833,28478464,1064128
.long 3161280,26656,662292,16780300,3784704,24629248,2290649224,2290649224,9447872,13418496,13426688
.long 18130944,18139136,81332,85632,19775488,94004,93952,1618560,881792,880640,880768
.long 880896,881024,881152,881280,1821312,51840,248448,445056,641664,838272,1034880
.long 28463104,28479488,28413952,28430336,28446720,35232,1073741824,1073741824,1673985,28480512,1064128
.long 3161280,26688,4884,16780300,3784704,25120768,2290649224,2290649224,9447872,13418496,13426688
.long 18325504,18333696,81840,85760,19824640,94008,93952,1618560,1537152,1536000,1536128
.long 1536256,1536384,1536512,1536640,1870464,100992,297600,494208,690816,887424,1084032
.long 28467200,28483584,28418048,28434432,28450816,35248,1073741824,1073741824,1723137,28482560,1064128
.long 1073741824,26720,662292,16780300,3784704,25612288,2290649224,2290649224,9447872,13418496,13418496
.long 18327552,18335744,81844,85888,19873792,94012,93952,1618560,2192512,2191360,2191488
.long 2191616,2191744,2191872,2192000,1919616,150144,346752,543360,739968,936576,1133184
.long 28471296,28487680,28422144,28438528,28454912,6656,82432,24215552,1376385,27321344,1049856
.long 3147008,12288,420,16780300,1277952,24142848,2290649224,2290649224,9438080,9764864,9773056
.long 15228928,15237120,73776,69632,13631488,90432,90112,800,82560,82688,82816
.long 82944,83072,81920,82048,983424,1180032,1376640,1573248,1769856,384,196992
.long 27443200,27459584,27475968,27492352,27426816,6672,92672,24217600,1425537,27323392,1049856
.long 3147008,12320,657828,16780300,1277952,24634368,2290649224,2290649224,9438080,9764864,9773056
.long 15230976,15239168,73780,69760,13680640,90436,90112,800,737920,738048,738176
.long 738304,738432,737280,737408,1032576,1229184,1425792,1622400,1819008,49536,246144
.long 27447296,27463680,27480064,27496448,27430912,6688,102912,24219648,1474689,27325440,1049856
.long 3147008,12352,420,16780300,1277952,25125888,2290649224,2290649224,9438080,9764864,9773056
.long 15425536,15433728,74288,69888,13729792,90440,90112,800,1393280,1393408,1393536
.long 1393664,1393792,1392640,1392768,1081728,1278336,1474944,1671552,1868160,98688,295296
.long 27451392,27467776,27484160,27500544,27435008,6704,113152,24221696,1523841,27327488,1049856
.long 1073741824,12384,657828,16780300,1277952,25617408,2290649224,2290649224,9438080,9764864,9764864
.long 15427584,15435776,74292,70016,13778944,90444,90112,800,2048640,2048768,2048896
.long 2049024,2049152,2048000,2048128,1130880,1327488,1524096,1720704,1917312,147840,344448
.long 27455488,27471872,27488256,27504640,27439104,23040,328192,24461312,1376769,27485184,1058048
.long 3155200,28672,1060,50465804,1638400,24142848,2290649224,2290649224,9439488,11862016,11870208
.long 18374656,18382848,81968,71680,14417920,92480,90624,41760,245760,245888,246016
.long 246144,246272,246400,246528,384,196992,393600,590208,786816,983424,1180032
.long 27484160,27500544,27435008,27451392,27467776,23056,338432,24463360,1425921,27487232,1058048
.long 3155200,28704,658468,50465804,1638400,24634368,2290649224,2290649224,9439488,11862016,11870208
.long 18376704,18384896,81972,71808,14467072,92484,90624,41760,901120,901248,901376
.long 901504,901632,901760,901888,49536,246144,442752,639360,835968,1032576,1229184
.long 27488256,27504640,27439104,27455488,27471872,23072,348672,24465408,1475073,27489280,1058048
.long 3155200,28736,1060,50465804,1638400,25125888,2290649224,2290649224,9439488,11862016,11870208
.long 18571264,18579456,82480,71936,14516224,92488,90624,41760,1556480,1556608,1556736
.long 1556864,1556992,1557120,1557248,98688,295296,491904,688512,885120,1081728,1278336
.long 27492352,27426816,27443200,27459584,27475968,23088,358912,24467456,1524225,27491328,1058048
.long 1073741824,28768,658468,50465804,1638400,25617408,2290649224,2290649224,9439488,11862016,11862016
.long 18573312,18581504,82484,72064,14565376,92492,90624,41760,2211840,2211968,2212096
.long 2212224,2212352,2212480,2212608,147840,344448,541056,737664,934272,1130880,1327488
.long 27496448,27430912,27447296,27463680,27480064,10752,573952,24707072,1377153,27649024,1051904
.long 3149056,12288,1704,16780300,1998848,24142848,2290649224,2290649224,9440896,10289152,10297344
.long 15278080,15286272,73904,73728,15204352,90944,91136,82720,82560,82688,82816
.long 82944,83072,81920,82048,984192,1180800,1377408,1574016,1770624,1152,197760
.long 27770880,27787264,27803648,27820032,27754496,10768,584192,24709120,1426305,27651072,1051904
.long 3149056,12320,659112,16780300,1998848,24634368,2290649224,2290649224,9440896,10289152,10297344
.long 15280128,15288320,73908,73856,15253504,90948,91136,82720,737920,738048,738176
.long 738304,738432,737280,737408,1033344,1229952,1426560,1623168,1819776,50304,246912
.long 27774976,27791360,27807744,27824128,27758592,10784,594432,24711168,1475457,27653120,1051904
.long 3149056,12352,1704,16780300,1998848,25125888,2290649224,2290649224,9440896,10289152,10297344
.long 15474688,15482880,74416,73984,15302656,90952,91136,82720,1393280,1393408,1393536
.long 1393664,1393792,1392640,1392768,1082496,1279104,1475712,1672320,1868928,99456,296064
.long 27779072,27795456,27811840,27828224,27762688,10800,604672,24713216,1524609,27655168,1051904
.long 1073741824,12384,659112,16780300,1998848,25617408,2290649224,2290649224,9440896,10289152,10289152
.long 15476736,15484928,74420,74112,15351808,90956,91136,82720,2048640,2048768,2048896
.long 2049024,2049152,2048000,2048128,1131648,1328256,1524864,1721472,1918080,148608,345216
.long 27783168,27799552,27815936,27832320,27766784,27136,819712,24952832,1377537,27812864,1060096
.long 3157248,28672,2344,50465804,2359296,24142848,2290649224,2290649224,9442304,12386304,12394496
.long 18423808,18432000,82096,75776,15990784,92992,91648,123680,245760,245888,246016
.long 246144,246272,246400,246528,1152,197760,394368,590976,787584,984192,1180800
.long 27811840,27828224,27762688,27779072,27795456,27152,829952,24954880,1426689,27814912,1060096
.long 3157248,28704,659752,50465804,2359296,24634368,2290649224,2290649224,9442304,12386304,12394496
.long 18425856,18434048,82100,75904,16039936,92996,91648,123680,901120,901248,901376
.long 901504,901632,901760,901888,50304,246912,443520,640128,836736,1033344,1229952
.long 27815936,27832320,27766784,27783168,27799552,27168,840192,24956928,1475841,27816960,1060096
.long 3157248,28736,2344,50465804,2359296,25125888,2290649224,2290649224,9442304,12386304,12394496
.long 18620416,18628608,82608,76032,16089088,93000,91648,123680,1556480,1556608,1556736
.long 1556864,1556992,1557120,1557248,99456,296064,492672,689280,885888,1082496,1279104
.long 27820032,27754496,27770880,27787264,27803648,27184,850432,24958976,1524993,27819008,1060096
.long 1073741824,28768,659752,50465804,2359296,25617408,2290649224,2290649224,9442304,12386304,12386304
.long 18622464,18630656,82612,76160,16138240,93004,91648,123680,2211840,2211968,2212096
.long 2212224,2212352,2212480,2212608,148608,345216,541824,738432,935040,1131648,1328256
.long 27824128,27758592,27774976,27791360,27807744,14848,1065472,25198592,1377921,27976704,1053952
.long 3151104,12288,2988,16780300,2719744,24142848,2290649224,2290649224,9443712,10813440,10821632
.long 15327232,15335424,74032,77824,16777216,91456,92160,164640,82560,82688,82816
.long 82944,83072,81920,82048,984960,1181568,1378176,1574784,1771392,1920,198528
.long 28098560,28114944,28131328,28147712,28082176,14864,1075712,25200640,1427073,27978752,1053952
.long 3151104,12320,660396,16780300,2719744,24634368,2290649224,2290649224,9443712,10813440,10821632
.long 15329280,15337472,74036,77952,16826368,91460,92160,164640,737920,738048,738176
.long 738304,738432,737280,737408,1034112,1230720,1427328,1623936,1820544,51072,247680
.long 28102656,28119040,28135424,28151808,28086272,14880,1085952,25202688,1476225,27980800,1053952
.long 3151104,12352,2988,16780300,2719744,25125888,2290649224,2290649224,9443712,10813440,10821632
.long 15523840,15532032,74544,78080,16875520,91464,92160,164640,1393280,1393408,1393536
.long 1393664,1393792,1392640,1392768,1083264,1279872,1476480,1673088,1869696,100224,296832
.long 28106752,28123136,28139520,28155904,28090368,14896,1096192,25204736,1525377,27982848,1053952
.long 1073741824,12384,660396,16780300,2719744,25617408,2290649224,2290649224,9443712,10813440,10813440
.long 15525888,15534080,74548,78208,16924672,91468,92160,164640,2048640,2048768,2048896
.long 2049024,2049152,2048000,2048128,1132416,1329024,1525632,1722240,1918848,149376,345984
.long 28110848,28127232,28143616,28160000,28094464,31232,1311232,25444352,1378305,28140544,1062144
.long 3159296,28672,3628,50465804,3080192,24142848,2290649224,2290649224,9445120,12910592,12918784
.long 18472960,18481152,82224,79872,17563648,93504,92672,205600,245760,245888,246016
.long 246144,246272,246400,246528,1920,198528,395136,591744,788352,984960,1181568
.long 28139520,28155904,28090368,28106752,28123136,31248,1321472,25446400,1427457,28142592,1062144
.long 3159296,28704,661036,50465804,3080192,24634368,2290649224,2290649224,9445120,12910592,12918784
.long 18475008,18483200,82228,80000,17612800,93508,92672,205600,901120,901248,901376
.long 901504,901632,901760,901888,51072,247680,444288,640896,837504,1034112,1230720
.long 28143616,28160000,28094464,28110848,28127232,31264,1331712,25448448,1476609,28144640,1062144
.long 3159296,28736,3628,50465804,3080192,25125888,2290649224,2290649224,9445120,12910592,12918784
.long 18669568,18677760,82736,80128,17661952,93512,92672,205600,1556480,1556608,1556736
.long 1556864,1556992,1557120,1557248,100224,296832,493440,690048,886656,1083264,1279872
.long 28147712,28082176,28098560,28114944,28131328,31280,1341952,25450496,1525761,28146688,1062144
.long 1073741824,28768,661036,50465804,3080192,25617408,2290649224,2290649224,9445120,12910592,12910592
.long 18671616,18679808,82740,80256,17711104,93516,92672,205600,2211840,2211968,2212096
.long 2212224,2212352,2212480,2212608,149376,345984,542592,739200,935808,1132416,1329024
.long 28151808,28086272,28102656,28119040,28135424,18944,1556992,25690112,1378689,28304384,1056000
.long 3153152,12288,4272,16780300,3440640,24142848,2290649224,2290649224,9446528,11337728,11345920
.long 15376384,15384576,74160,81920,18350080,91968,93184,246560,82560,82688,82816
.long 82944,83072,81920,82048,985728,1182336,1378944,1575552,1772160,2688,199296
.long 28426240,28442624,28459008,28475392,28409856,18960,1567232,25692160,1427841,28306432,1056000
.long 3153152,12320,661680,16780300,3440640,24634368,2290649224,2290649224,9446528,11337728,11345920
.long 15378432,15386624,74164,82048,18399232,91972,93184,246560,737920,738048,738176
.long 738304,738432,737280,737408,1034880,1231488,1428096,1624704,1821312,51840,248448
.long 28430336,28446720,28463104,28479488,28413952,18976,1577472,25694208,1476993,28308480,1056000
.long 3153152,12352,4272,16780300,3440640,25125888,2290649224,2290649224,9446528,11337728,11345920
.long 15572992,15581184,74672,82176,18448384,91976,93184,246560,1393280,1393408,1393536
.long 1393664,1393792,1392640,1392768,1084032,1280640,1477248,1673856,1870464,100992,297600
.long 28434432,28450816,28467200,28483584,28418048,18992,1587712,25696256,1526145,28310528,1056000
.long 1073741824,12384,661680,16780300,3440640,25617408,2290649224,2290649224,9446528,11337728,11337728
.long 15575040,15583232,74676,82304,18497536,91980,93184,246560,2048640,2048768,2048896
.long 2049024,2049152,2048000,2048128,1133184,1329792,1526400,1723008,1919616,150144,346752
.long 28438528,28454912,28471296,28487680,28422144,35328,1802752,25935872,1379073,28468224,1064192
.long 3161344,28672,4912,50465804,3801088,24142848,2290649224,2290649224,9447936,13434880,13443072
.long 18522112,18530304,82352,83968,19136512,94016,93696,287520,245760,245888,246016
.long 246144,246272,246400,246528,2688,199296,395904,592512,789120,985728,1182336
.long 28467200,28483584,28418048,28434432,28450816,35344,1812992,25937920,1428225,28470272,1064192
.long 3161344,28704,662320,50465804,3801088,24634368,2290649224,2290649224,9447936,13434880,13443072
.long 18524160,18532352,82356,84096,19185664,94020,93696,287520,901120,901248,901376
.long 901504,901632,901760,901888,51840,248448,445056,641664,838272,1034880,1231488
.long 28471296,28487680,28422144,28438528,28454912,35360,1823232,25939968,1477377,28472320,1064192
.long 3161344,28736,4912,50465804,3801088,25125888,2290649224,2290649224,9447936,13434880,13443072
.long 18718720,18726912,82864,84224,19234816,94024,93696,287520,1556480,1556608,1556736
.long 1556864,1556992,1557120,1557248,100992,297600,494208,690816,887424,1084032,1280640
.long 28475392,28409856,28426240,28442624,28459008,35376,1833472,25942016,1526529,28474368,1064192
.long 1073741824,28768,662320,50465804,3801088,25617408,2290649224,2290649224,9447936,13434880,13434880
.long 18720768,18728960,82868,84352,19283968,94028,93696,287520,2211840,2211968,2212096
.long 2212224,2212352,2212480,2212608,150144,346752,543360,739968,936576,1133184,1329792
.long 28479488,28413952,28430336,28446720,28463104,6784,164864,24313856,983168,27303936,1049920
.long 3147072,14336,1073741824,16780300,1073741824,24142848,0,0,1073741824,9781248,9789440
.long 15622144,15630336,74800,70144,13828096,90448,90112,1311520,103168,103296,103424
.long 103552,102400,102528,102656,1180032,1376640,1573248,1769856,384,196992,393600
.long 27451392,27467776,27484160,27500544,27435008,6800,175104,24315904,1032320,27305984,1049920
.long 3147072,14368,1073741824,16780300,1073741824,24634368,0,0,1073741824,9781248,9789440
.long 15624192,15632384,74804,70272,13877248,90452,90112,1311520,758528,758656,758784
.long 758912,757760,757888,758016,1229184,1425792,1622400,1819008,49536,246144,442752
.long 27455488,27471872,27488256,27504640,27439104,6816,185344,24317952,1081472,27308032,1049920
.long 3147072,14400,1073741824,16780300,1073741824,25125888,0,0,1073741824,9781248,9789440
.long 15818752,15826944,75312,70400,13926400,90456,90112,1311520,1413888,1414016,1414144
.long 1414272,1413120,1413248,1413376,1278336,1474944,1671552,1868160,98688,295296,491904
.long 27459584,27475968,27492352,27426816,27443200,6832,195584,24320000,1130624,27310080,1049920
.long 1073741824,14432,1073741824,16780300,1073741824,25617408,0,0,1073741824,9781248,9781248
.long 15820800,15828992,75316,70528,13975552,90460,90112,1311520,2069248,2069376,2069504
.long 2069632,2068480,2068608,2068736,1327488,1524096,1720704,1917312,147840,344448,541056
.long 27463680,27480064,27496448,27430912,27447296,23168,410624,24559616,983552,27467776,1058112
.long 3155264,30720,1073741824,50465804,1073741824,24142848,0,0,1073741824,11878400,11886592
.long 18767872,18776064,82992,72192,14614528,92496,90624,1352480,266368,266496,266624
.long 266752,266880,267008,267136,196992,393600,590208,786816,983424,1180032,1376640
.long 27492352,27426816,27443200,27459584,27475968,23184,420864,24561664,1032704,27469824,1058112
.long 3155264,30752,1073741824,50465804,1073741824,24634368,0,0,1073741824,11878400,11886592
.long 18769920,18778112,82996,72320,14663680,92500,90624,1352480,921728,921856,921984
.long 922112,922240,922368,922496,246144,442752,639360,835968,1032576,1229184,1425792
.long 27496448,27430912,27447296,27463680,27480064,23200,431104,24563712,1081856,27471872,1058112
.long 3155264,30784,1073741824,50465804,1073741824,25125888,0,0,1073741824,11878400,11886592
.long 18964480,18972672,83504,72448,14712832,92504,90624,1352480,1577088,1577216,1577344
.long 1577472,1577600,1577728,1577856,295296,491904,688512,885120,1081728,1278336,1474944
.long 27500544,27435008,27451392,27467776,27484160,23216,441344,24565760,1131008,27473920,1058112
.long 1073741824,30816,1073741824,50465804,1073741824,25617408,0,0,1073741824,11878400,11878400
.long 18966528,18974720,83508,72576,14761984,92508,90624,1352480,2232448,2232576,2232704
.long 2232832,2232960,2233088,2233216,344448,541056,737664,934272,1130880,1327488,1524096
.long 27504640,27439104,27455488,27471872,27488256,10880,656384,24805376,983936,27631616,1051968
.long 3149120,14336,1073741824,16780300,1073741824,24142848,0,0,1073741824,10305536,10313728
.long 15671296,15679488,74928,74240,15400960,90960,91136,1393440,103168,103296,103424
.long 103552,102400,102528,102656,1180800,1377408,1574016,1770624,1152,197760,394368
.long 27779072,27795456,27811840,27828224,27762688,10896,666624,24807424,1033088,27633664,1051968
.long 3149120,14368,1073741824,16780300,1073741824,24634368,0,0,1073741824,10305536,10313728
.long 15673344,15681536,74932,74368,15450112,90964,91136,1393440,758528,758656,758784
.long 758912,757760,757888,758016,1229952,1426560,1623168,1819776,50304,246912,443520
.long 27783168,27799552,27815936,27832320,27766784,10912,676864,24809472,1082240,27635712,1051968
.long 3149120,14400,1073741824,16780300,1073741824,25125888,0,0,1073741824,10305536,10313728
.long 15867904,15876096,75440,74496,15499264,90968,91136,1393440,1413888,1414016,1414144
.long 1414272,1413120,1413248,1413376,1279104,1475712,1672320,1868928,99456,296064,492672
.long 27787264,27803648,27820032,27754496,27770880,10928,687104,24811520,1131392,27637760,1051968
.long 1073741824,14432,1073741824,16780300,1073741824,25617408,0,0,1073741824,10305536,10305536
.long 15869952,15878144,75444,74624,15548416,90972,91136,1393440,2069248,2069376,2069504
.long 2069632,2068480,2068608,2068736,1328256,1524864,1721472,1918080,148608,345216,541824
.long 27791360,27807744,27824128,27758592,27774976,27264,902144,25051136,984320,27795456,1060160
.long 3157312,30720,1073741824,50465804,1073741824,24142848,0,0,1073741824,12402688,12410880
.long 18817024,18825216,83120,76288,16187392,93008,91648,1434400,266368,266496,266624
.long 266752,266880,267008,267136,197760,394368,590976,787584,984192,1180800,1377408
.long 27820032,27754496,27770880,27787264,27803648,27280,912384,25053184,1033472,27797504,1060160
.long 3157312,30752,1073741824,50465804,1073741824,24634368,0,0,1073741824,12402688,12410880
.long 18819072,18827264,83124,76416,16236544,93012,91648,1434400,921728,921856,921984
.long 922112,922240,922368,922496,246912,443520,640128,836736,1033344,1229952,1426560
.long 27824128,27758592,27774976,27791360,27807744,27296,922624,25055232,1082624,27799552,1060160
.long 3157312,30784,1073741824,50465804,1073741824,25125888,0,0,1073741824,12402688,12410880
.long 19013632,19021824,83632,76544,16285696,93016,91648,1434400,1577088,1577216,1577344
.long 1577472,1577600,1577728,1577856,296064,492672,689280,885888,1082496,1279104,1475712
.long 27828224,27762688,27779072,27795456,27811840,27312,932864,25057280,1131776,27801600,1060160
.long 1073741824,30816,1073741824,50465804,1073741824,25617408,0,0,1073741824,12402688,12402688
.long 19015680,19023872,83636,76672,16334848,93020,91648,1434400,2232448,2232576,2232704
.long 2232832,2232960,2233088,2233216,345216,541824,738432,935040,1131648,1328256,1524864
.long 27832320,27766784,27783168,27799552,27815936,14976,1147904,25296896,984704,27959296,1054016
.long 3151168,14336,1073741824,16780300,1073741824,24142848,0,0,1073741824,10829824,10838016
.long 15720448,15728640,75056,78336,16973824,91472,92160,1475360,103168,103296,103424
.long 103552,102400,102528,102656,1181568,1378176,1574784,1771392,1920,198528,395136
.long 28106752,28123136,28139520,28155904,28090368,14992,1158144,25298944,1033856,27961344,1054016
.long 3151168,14368,1073741824,16780300,1073741824,24634368,0,0,1073741824,10829824,10838016
.long 15722496,15730688,75060,78464,17022976,91476,92160,1475360,758528,758656,758784
.long 758912,757760,757888,758016,1230720,1427328,1623936,1820544,51072,247680,444288
.long 28110848,28127232,28143616,28160000,28094464,15008,1168384,25300992,1083008,27963392,1054016
.long 3151168,14400,1073741824,16780300,1073741824,25125888,0,0,1073741824,10829824,10838016
.long 15917056,15925248,75568,78592,17072128,91480,92160,1475360,1413888,1414016,1414144
.long 1414272,1413120,1413248,1413376,1279872,1476480,1673088,1869696,100224,296832,493440
.long 28114944,28131328,28147712,28082176,28098560,15024,1178624,25303040,1132160,27965440,1054016
.long 1073741824,14432,1073741824,16780300,1073741824,25617408,0,0,1073741824,10829824,10829824
.long 15919104,15927296,75572,78720,17121280,91484,92160,1475360,2069248,2069376,2069504
.long 2069632,2068480,2068608,2068736,1329024,1525632,1722240,1918848,149376,345984,542592
.long 28119040,28135424,28151808,28086272,28102656,31360,1393664,25542656,985088,28123136,1062208
.long 3159360,30720,1073741824,50465804,1073741824,24142848,0,0,1073741824,12926976,12935168
.long 18866176,18874368,83248,80384,17760256,93520,92672,1516320,266368,266496,266624
.long 266752,266880,267008,267136,198528,395136,591744,788352,984960,1181568,1378176
.long 28147712,28082176,28098560,28114944,28131328,31376,1403904,25544704,1034240,28125184,1062208
.long 3159360,30752,1073741824,50465804,1073741824,24634368,0,0,1073741824,12926976,12935168
.long 18868224,18876416,83252,80512,17809408,93524,92672,1516320,921728,921856,921984
.long 922112,922240,922368,922496,247680,444288,640896,837504,1034112,1230720,1427328
.long 28151808,28086272,28102656,28119040,28135424,31392,1414144,25546752,1083392,28127232,1062208
.long 3159360,30784,1073741824,50465804,1073741824,25125888,0,0,1073741824,12926976,12935168
.long 19062784,19070976,83760,80640,17858560,93528,92672,1516320,1577088,1577216,1577344
.long 1577472,1577600,1577728,1577856,296832,493440,690048,886656,1083264,1279872,1476480
.long 28155904,28090368,28106752,28123136,28139520,31408,1424384,25548800,1132544,28129280,1062208
.long 1073741824,30816,1073741824,50465804,1073741824,25617408,0,0,1073741824,12926976,12926976
.long 19064832,19073024,83764,80768,17907712,93532,92672,1516320,2232448,2232576,2232704
.long 2232832,2232960,2233088,2233216,345984,542592,739200,935808,1132416,1329024,1525632
.long 28160000,28094464,28110848,28127232,28143616,19072,1639424,25788416,985472,28286976,1056064
.long 3153216,14336,1073741824,16780300,1073741824,24142848,0,0,1073741824,11354112,11362304
.long 15769600,15777792,75184,82432,18546688,91984,93184,1557280,103168,103296,103424
.long 103552,102400,102528,102656,1182336,1378944,1575552,1772160,2688,199296,395904
.long 28434432,28450816,28467200,28483584,28418048,19088,1649664,25790464,1034624,28289024,1056064
.long 3153216,14368,1073741824,16780300,1073741824,24634368,0,0,1073741824,11354112,11362304
.long 15771648,15779840,75188,82560,18595840,91988,93184,1557280,758528,758656,758784
.long 758912,757760,757888,758016,1231488,1428096,1624704,1821312,51840,248448,445056
.long 28438528,28454912,28471296,28487680,28422144,19104,1659904,25792512,1083776,28291072,1056064
.long 3153216,14400,1073741824,16780300,1073741824,25125888,0,0,1073741824,11354112,11362304
.long 15966208,15974400,75696,82688,18644992,91992,93184,1557280,1413888,1414016,1414144
.long 1414272,1413120,1413248,1413376,1280640,1477248,1673856,1870464,100992,297600,494208
.long 28442624,28459008,28475392,28409856,28426240,19120,1670144,25794560,1132928,28293120,1056064
.long 1073741824,14432,1073741824,16780300,1073741824,25617408,0,0,1073741824,11354112,11354112
.long 15968256,15976448,75700,82816,18694144,91996,93184,1557280,2069248,2069376,2069504
.long 2069632,2068480,2068608,2068736,1329792,1526400,1723008,1919616,150144,346752,543360
.long 28446720,28463104,28479488,28413952,28430336,35456,1885184,26034176,985856,28450816,1064256
.long 3161408,30720,1073741824,50465804,1073741824,24142848,0,0,1073741824,13451264,13459456
.long 18915328,18923520,83376,84480,19333120,94032,93696,1598240,266368,266496,266624
.long 266752,266880,267008,267136,199296,395904,592512,789120,985728,1182336,1378944
.long 28475392,28409856,28426240,28442624,28459008,35472,1895424,26036224,1035008,28452864,1064256
.long 3161408,30752,1073741824,50465804,1073741824,24634368,0,0,1073741824,13451264,13459456
.long 18917376,18925568,83380,84608,19382272,94036,93696,1598240,921728,921856,921984
.long 922112,922240,922368,922496,248448,445056,641664,838272,1034880,1231488,1428096
.long 28479488,28413952,28430336,28446720,28463104,35488,1905664,26038272,1084160,28454912,1064256
.long 3161408,30784,1073741824,50465804,1073741824,25125888,0,0,1073741824,13451264,13459456
.long 19111936,19120128,83888,84736,19431424,94040,93696,1598240,1577088,1577216,1577344
.long 1577472,1577600,1577728,1577856,297600,494208,690816,887424,1084032,1280640,1477248
.long 28483584,28418048,28434432,28450816,28467200,35504,1915904,26040320,1133312,28456960,1064256
.long 1073741824,30816,1073741824,50465804,1073741824,25617408,0,0,1073741824,13451264,13451264
.long 19113984,19122176,83892,84864,19480576,94044,93696,1598240,2232448,2232576,2232704
.long 2232832,2232960,2233088,2233216,346752,543360,739968,936576,1133184,1329792,1526400
.long 28487680,28422144,28438528,28454912,28471296,6912,204800,24322048,786560,27295744,1049984
.long 3147136,16384,1073741824,50465804,1073741824,24142848,0,0,1073741824,9797632,9805824
.long 16015360,16023552,75824,70656,14024704,90464,90368,21280,123648,123776,123904
.long 124032,122880,123008,123136,1180032,1376640,1573248,1769856,384,196992,393600
.long 27451392,27467776,27484160,27500544,27435008,6928,215040,24324096,835712,27297792,1049984
.long 3147136,16416,1073741824,50465804,1073741824,24634368,0,0,1073741824,9797632,9805824
.long 16017408,16025600,75828,70784,14073856,90468,90368,21280,779008,779136,779264
.long 779392,778240,778368,778496,1229184,1425792,1622400,1819008,49536,246144,442752
.long 27455488,27471872,27488256,27504640,27439104,6944,225280,24326144,884864,27299840,1049984
.long 3147136,16448,1073741824,50465804,1073741824,25125888,0,0,1073741824,9797632,9805824
.long 16211968,16220160,76336,70912,14123008,90472,90368,21280,1434368,1434496,1434624
.long 1434752,1433600,1433728,1433856,1278336,1474944,1671552,1868160,98688,295296,491904
.long 27459584,27475968,27492352,27426816,27443200,6960,235520,24328192,934016,27301888,1049984
.long 1073741824,16480,1073741824,50465804,1073741824,25617408,0,0,1073741824,9797632,9797632
.long 16214016,16222208,76340,71040,14172160,90476,90368,21280,2089728,2089856,2089984
.long 2090112,2088960,2089088,2089216,1327488,1524096,1720704,1917312,147840,344448,541056
.long 27463680,27480064,27496448,27430912,27447296,23296,450560,24567808,786944,27459584,1058176
.long 3155328,32768,1073741824,16780300,1073741824,24142848,0,0,1073741824,11894784,11902976
.long 19161088,19169280,84016,72704,14811136,92512,90880,62240,286848,286976,287104
.long 287232,287360,287488,287616,196992,393600,590208,786816,983424,1180032,1376640
.long 27492352,27426816,27443200,27459584,27475968,23312,460800,24569856,836096,27461632,1058176
.long 3155328,32800,1073741824,16780300,1073741824,24634368,0,0,1073741824,11894784,11902976
.long 19163136,19171328,84020,72832,14860288,92516,90880,62240,942208,942336,942464
.long 942592,942720,942848,942976,246144,442752,639360,835968,1032576,1229184,1425792
.long 27496448,27430912,27447296,27463680,27480064,23328,471040,24571904,885248,27463680,1058176
.long 3155328,32832,1073741824,16780300,1073741824,25125888,0,0,1073741824,11894784,11902976
.long 19357696,19365888,84528,72960,14909440,92520,90880,62240,1597568,1597696,1597824
.long 1597952,1598080,1598208,1598336,295296,491904,688512,885120,1081728,1278336,1474944
.long 27500544,27435008,27451392,27467776,27484160,23344,481280,24573952,934400,27465728,1058176
.long 1073741824,32864,1073741824,16780300,1073741824,25617408,0,0,1073741824,11894784,11894784
.long 19359744,19367936,84532,73088,14958592,92524,90880,62240,2252928,2253056,2253184
.long 2253312,2253440,2253568,2253696,344448,541056,737664,934272,1130880,1327488,1524096
.long 27504640,27439104,27455488,27471872,27488256,11008,696320,24813568,787328,27623424,1052032
.long 3149184,16384,1073741824,50465804,1073741824,24142848,0,0,1073741824,10321920,10330112
.long 16064512,16072704,75952,74752,15597568,90976,91392,103200,123648,123776,123904
.long 124032,122880,123008,123136,1180800,1377408,1574016,1770624,1152,197760,394368
.long 27779072,27795456,27811840,27828224,27762688,11024,706560,24815616,836480,27625472,1052032
.long 3149184,16416,1073741824,50465804,1073741824,24634368,0,0,1073741824,10321920,10330112
.long 16066560,16074752,75956,74880,15646720,90980,91392,103200,779008,779136,779264
.long 779392,778240,778368,778496,1229952,1426560,1623168,1819776,50304,246912,443520
.long 27783168,27799552,27815936,27832320,27766784,11040,716800,24817664,885632,27627520,1052032
.long 3149184,16448,1073741824,50465804,1073741824,25125888,0,0,1073741824,10321920,10330112
.long 16261120,16269312,76464,75008,15695872,90984,91392,103200,1434368,1434496,1434624
.long 1434752,1433600,1433728,1433856,1279104,1475712,1672320,1868928,99456,296064,492672
.long 27787264,27803648,27820032,27754496,27770880,11056,727040,24819712,934784,27629568,1052032
.long 1073741824,16480,1073741824,50465804,1073741824,25617408,0,0,1073741824,10321920,10321920
.long 16263168,16271360,76468,75136,15745024,90988,91392,103200,2089728,2089856,2089984
.long 2090112,2088960,2089088,2089216,1328256,1524864,1721472,1918080,148608,345216,541824
.long 27791360,27807744,27824128,27758592,27774976,27392,942080,25059328,787712,27787264,1060224
.long 3157376,32768,1073741824,16780300,1073741824,24142848,0,0,1073741824,12419072,12427264
.long 19210240,19218432,84144,76800,16384000,93024,91904,144160,286848,286976,287104
.long 287232,287360,287488,287616,197760,394368,590976,787584,984192,1180800,1377408
.long 27820032,27754496,27770880,27787264,27803648,27408,952320,25061376,836864,27789312,1060224
.long 3157376,32800,1073741824,16780300,1073741824,24634368,0,0,1073741824,12419072,12427264
.long 19212288,19220480,84148,76928,16433152,93028,91904,144160,942208,942336,942464
.long 942592,942720,942848,942976,246912,443520,640128,836736,1033344,1229952,1426560
.long 27824128,27758592,27774976,27791360,27807744,27424,962560,25063424,886016,27791360,1060224
.long 3157376,32832,1073741824,16780300,1073741824,25125888,0,0,1073741824,12419072,12427264
.long 19406848,19415040,84656,77056,16482304,93032,91904,144160,1597568,1597696,1597824
.long 1597952,1598080,1598208,1598336,296064,492672,689280,885888,1082496,1279104,1475712
.long 27828224,27762688,27779072,27795456,27811840,27440,972800,25065472,935168,27793408,1060224
.long 1073741824,32864,1073741824,16780300,1073741824,25617408,0,0,1073741824,12419072,12419072
.long 19408896,19417088,84660,77184,16531456,93036,91904,144160,2252928,2253056,2253184
.long 2253312,2253440,2253568,2253696,345216,541824,738432,935040,1131648,1328256,1524864
.long 27832320,27766784,27783168,27799552,27815936,15104,1187840,25305088,788096,27951104,1054080
.long 3151232,16384,1073741824,50465804,1073741824,24142848,0,0,1073741824,10846208,10854400
.long 16113664,16121856,76080,78848,17170432,91488,92416,185120,123648,123776,123904
.long 124032,122880,123008,123136,1181568,1378176,1574784,1771392,1920,198528,395136
.long 28106752,28123136,28139520,28155904,28090368,15120,1198080,25307136,837248,27953152,1054080
.long 3151232,16416,1073741824,50465804,1073741824,24634368,0,0,1073741824,10846208,10854400
.long 16115712,16123904,76084,78976,17219584,91492,92416,185120,779008,779136,779264
.long 779392,778240,778368,778496,1230720,1427328,1623936,1820544,51072,247680,444288
.long 28110848,28127232,28143616,28160000,28094464,15136,1208320,25309184,886400,27955200,1054080
.long 3151232,16448,1073741824,50465804,1073741824,25125888,0,0,1073741824,10846208,10854400
.long 16310272,16318464,76592,79104,17268736,91496,92416,185120,1434368,1434496,1434624
.long 1434752,1433600,1433728,1433856,1279872,1476480,1673088,1869696,100224,296832,493440
.long 28114944,28131328,28147712,28082176,28098560,15152,1218560,25311232,935552,27957248,1054080
.long 1073741824,16480,1073741824,50465804,1073741824,25617408,0,0,1073741824,10846208,10846208
.long 16312320,16320512,76596,79232,17317888,91500,92416,185120,2089728,2089856,2089984
.long 2090112,2088960,2089088,2089216,1329024,1525632,1722240,1918848,149376,345984,542592
.long 28119040,28135424,28151808,28086272,28102656,31488,1433600,25550848,788480,28114944,1062272
.long 3159424,32768,1073741824,16780300,1073741824,24142848,0,0,1073741824,12943360,12951552
.long 19259392,19267584,84272,80896,17956864,93536,92928,226080,286848,286976,287104
.long 287232,287360,287488,287616,198528,395136,591744,788352,984960,1181568,1378176
.long 28147712,28082176,28098560,28114944,28131328,31504,1443840,25552896,837632,28116992,1062272
.long 3159424,32800,1073741824,16780300,1073741824,24634368,0,0,1073741824,12943360,12951552
.long 19261440,19269632,84276,81024,18006016,93540,92928,226080,942208,942336,942464
.long 942592,942720,942848,942976,247680,444288,640896,837504,1034112,1230720,1427328
.long 28151808,28086272,28102656,28119040,28135424,31520,1454080,25554944,886784,28119040,1062272
.long 3159424,32832,1073741824,16780300,1073741824,25125888,0,0,1073741824,12943360,12951552
.long 19456000,19464192,84784,81152,18055168,93544,92928,226080,1597568,1597696,1597824
.long 1597952,1598080,1598208,1598336,296832,493440,690048,886656,1083264,1279872,1476480
.long 28155904,28090368,28106752,28123136,28139520,31536,1464320,25556992,935936,28121088,1062272
.long 1073741824,32864,1073741824,16780300,1073741824,25617408,0,0,1073741824,12943360,12943360
.long 19458048,19466240,84788,81280,18104320,93548,92928,226080,2252928,2253056,2253184
.long 2253312,2253440,2253568,2253696,345984,542592,739200,935808,1132416,1329024,1525632
.long 28160000,28094464,28110848,28127232,28143616,19200,1679360,25796608,788864,28278784,1056128
.long 3153280,16384,1073741824,50465804,1073741824,24142848,0,0,1073741824,11370496,11378688
.long 16162816,16171008,76208,82944,18743296,92000,93440,267040,123648,123776,123904
.long 124032,122880,123008,123136,1182336,1378944,1575552,1772160,2688,199296,395904
.long 28434432,28450816,28467200,28483584,28418048,19216,1689600,25798656,838016,28280832,1056128
.long 3153280,16416,1073741824,50465804,1073741824,24634368,0,0,1073741824,11370496,11378688
.long 16164864,16173056,76212,83072,18792448,92004,93440,267040,779008,779136,779264
.long 779392,778240,778368,778496,1231488,1428096,1624704,1821312,51840,248448,445056
.long 28438528,28454912,28471296,28487680,28422144,19232,1699840,25800704,887168,28282880,1056128
.long 3153280,16448,1073741824,50465804,1073741824,25125888,0,0,1073741824,11370496,11378688
.long 16359424,16367616,76720,83200,18841600,92008,93440,267040,1434368,1434496,1434624
.long 1434752,1433600,1433728,1433856,1280640,1477248,1673856,1870464,100992,297600,494208
.long 28442624,28459008,28475392,28409856,28426240,19248,1710080,25802752,936320,28284928,1056128
.long 1073741824,16480,1073741824,50465804,1073741824,25617408,0,0,1073741824,11370496,11370496
.long 16361472,16369664,76724,83328,18890752,92012,93440,267040,2089728,2089856,2089984
.long 2090112,2088960,2089088,2089216,1329792,1526400,1723008,1919616,150144,346752,543360
.long 28446720,28463104,28479488,28413952,28430336,35584,1925120,26042368,789248,28442624,1064320
.long 3161472,32768,1073741824,16780300,1073741824,24142848,0,0,1073741824,13467648,13475840
.long 19308544,19316736,84400,84992,19529728,94048,93952,308000,286848,286976,287104
.long 287232,287360,287488,287616,199296,395904,592512,789120,985728,1182336,1378944
.long 28475392,28409856,28426240,28442624,28459008,35600,1935360,26044416,838400,28444672,1064320
.long 3161472,32800,1073741824,16780300,1073741824,24634368,0,0,1073741824,13467648,13475840
.long 19310592,19318784,84404,85120,19578880,94052,93952,308000,942208,942336,942464
.long 942592,942720,942848,942976,248448,445056,641664,838272,1034880,1231488,1428096
.long 28479488,28413952,28430336,28446720,28463104,35616,1945600,26046464,887552,28446720,1064320
.long 3161472,32832,1073741824,16780300,1073741824,25125888,0,0,1073741824,13467648,13475840
.long 19505152,19513344,84912,85248,19628032,94056,93952,308000,1597568,1597696,1597824
.long 1597952,1598080,1598208,1598336,297600,494208,690816,887424,1084032,1280640,1477248
.long 28483584,28418048,28434432,28450816,28467200,35632,1955840,26048512,936704,28448768,1064320
.long 1073741824,32864,1073741824,16780300,1073741824,25617408,0,0,1073741824,13467648,13467648
.long 19507200,19515392,84916,85376,19677184,94060,93952,308000,2252928,2253056,2253184
.long 2253312,2253440,2253568,2253696,346752,543360,739968,936576,1133184,1329792,1526400
.long 28487680,28422144,28438528,28454912,28471296,7040,205056,24330240,589952,27287552,1050048
.long 3147200,18432,1073741824,16780300,1073741824,24142848,0,0,1073741824,9814016,9822208
.long 16408576,16416768,76848,71168,14221312,90480,90368,1332000,144256,144384,144512
.long 143360,143488,143616,143744,1376640,1573248,1769856,384,196992,393600,590208
.long 27459584,27475968,27492352,27426816,27443200,7056,215296,24332288,639104,27289600,1050048
.long 3147200,18464,1073741824,16780300,1073741824,24634368,0,0,1073741824,9814016,9822208
.long 16410624,16418816,76852,71296,14270464,90484,90368,1332000,799616,799744,799872
.long 798720,798848,798976,799104,1425792,1622400,1819008,49536,246144,442752,639360
.long 27463680,27480064,27496448,27430912,27447296,7072,225536,24334336,688256,27291648,1050048
.long 3147200,18496,1073741824,16780300,1073741824,25125888,0,0,1073741824,9814016,9822208
.long 16605184,16613376,77360,71424,14319616,90488,90368,1332000,1454976,1455104,1455232
.long 1454080,1454208,1454336,1454464,1474944,1671552,1868160,98688,295296,491904,688512
.long 27467776,27484160,27500544,27435008,27451392,7088,235776,24336384,737408,27293696,1050048
.long 1073741824,18528,1073741824,16780300,1073741824,25617408,0,0,1073741824,9814016,9814016
.long 16607232,16615424,77364,71552,14368768,90492,90368,1332000,2110336,2110464,2110592
.long 2109440,2109568,2109696,2109824,1524096,1720704,1917312,147840,344448,541056,737664
.long 27471872,27488256,27504640,27439104,27455488,23424,450816,24576000,590336,27451392,1058240
.long 3155392,34816,1073741824,50465804,1073741824,24142848,0,0,1073741824,11911168,11919360
.long 19554304,19562496,85040,73216,15007744,92528,90880,1372960,307456,307584,307712
.long 307840,307968,308096,308224,393600,590208,786816,983424,1180032,1376640,1573248
.long 27500544,27435008,27451392,27467776,27484160,23440,461056,24578048,639488,27453440,1058240
.long 3155392,34848,1073741824,50465804,1073741824,24634368,0,0,1073741824,11911168,11919360
.long 19556352,19564544,85044,73344,15056896,92532,90880,1372960,962816,962944,963072
.long 963200,963328,963456,963584,442752,639360,835968,1032576,1229184,1425792,1622400
.long 27504640,27439104,27455488,27471872,27488256,23456,471296,24580096,688640,27455488,1058240
.long 3155392,34880,1073741824,50465804,1073741824,25125888,0,0,1073741824,11911168,11919360
.long 19750912,19759104,85552,73472,15106048,92536,90880,1372960,1618176,1618304,1618432
.long 1618560,1618688,1618816,1618944,491904,688512,885120,1081728,1278336,1474944,1671552
.long 27426816,27443200,27459584,27475968,27492352,23472,481536,24582144,737792,27457536,1058240
.long 1073741824,34912,1073741824,50465804,1073741824,25617408,0,0,1073741824,11911168,11911168
.long 19752960,19761152,85556,73600,15155200,92540,90880,1372960,2273536,2273664,2273792
.long 2273920,2274048,2274176,2274304,541056,737664,934272,1130880,1327488,1524096,1720704
.long 27430912,27447296,27463680,27480064,27496448,11136,696576,24821760,590720,27615232,1052096
.long 3149248,18432,1073741824,16780300,1073741824,24142848,0,0,1073741824,10338304,10346496
.long 16457728,16465920,76976,75264,15794176,90992,91392,1413920,144256,144384,144512
.long 143360,143488,143616,143744,1377408,1574016,1770624,1152,197760,394368,590976
.long 27787264,27803648,27820032,27754496,27770880,11152,706816,24823808,639872,27617280,1052096
.long 3149248,18464,1073741824,16780300,1073741824,24634368,0,0,1073741824,10338304,10346496
.long 16459776,16467968,76980,75392,15843328,90996,91392,1413920,799616,799744,799872
.long 798720,798848,798976,799104,1426560,1623168,1819776,50304,246912,443520,640128
.long 27791360,27807744,27824128,27758592,27774976,11168,717056,24825856,689024,27619328,1052096
.long 3149248,18496,1073741824,16780300,1073741824,25125888,0,0,1073741824,10338304,10346496
.long 16654336,16662528,77488,75520,15892480,91000,91392,1413920,1454976,1455104,1455232
.long 1454080,1454208,1454336,1454464,1475712,1672320,1868928,99456,296064,492672,689280
.long 27795456,27811840,27828224,27762688,27779072,11184,727296,24827904,738176,27621376,1052096
.long 1073741824,18528,1073741824,16780300,1073741824,25617408,0,0,1073741824,10338304,10338304
.long 16656384,16664576,77492,75648,15941632,91004,91392,1413920,2110336,2110464,2110592
.long 2109440,2109568,2109696,2109824,1524864,1721472,1918080,148608,345216,541824,738432
.long 27799552,27815936,27832320,27766784,27783168,27520,942336,25067520,591104,27779072,1060288
.long 3157440,34816,1073741824,50465804,1073741824,24142848,0,0,1073741824,12435456,12443648
.long 19603456,19611648,85168,77312,16580608,93040,91904,1454880,307456,307584,307712
.long 307840,307968,308096,308224,394368,590976,787584,984192,1180800,1377408,1574016
.long 27828224,27762688,27779072,27795456,27811840,27536,952576,25069568,640256,27781120,1060288
.long 3157440,34848,1073741824,50465804,1073741824,24634368,0,0,1073741824,12435456,12443648
.long 19605504,19613696,85172,77440,16629760,93044,91904,1454880,962816,962944,963072
.long 963200,963328,963456,963584,443520,640128,836736,1033344,1229952,1426560,1623168
.long 27832320,27766784,27783168,27799552,27815936,27552,962816,25071616,689408,27783168,1060288
.long 3157440,34880,1073741824,50465804,1073741824,25125888,0,0,1073741824,12435456,12443648
.long 19800064,19808256,85680,77568,16678912,93048,91904,1454880,1618176,1618304,1618432
.long 1618560,1618688,1618816,1618944,492672,689280,885888,1082496,1279104,1475712,1672320
.long 27754496,27770880,27787264,27803648,27820032,27568,973056,25073664,738560,27785216,1060288
.long 1073741824,34912,1073741824,50465804,1073741824,25617408,0,0,1073741824,12435456,12435456
.long 19802112,19810304,85684,77696,16728064,93052,91904,1454880,2273536,2273664,2273792
.long 2273920,2274048,2274176,2274304,541824,738432,935040,1131648,1328256,1524864,1721472
.long 27758592,27774976,27791360,27807744,27824128,15232,1188096,25313280,591488,27942912,1054144
.long 3151296,18432,1073741824,16780300,1073741824,24142848,0,0,1073741824,10862592,10870784
.long 16506880,16515072,77104,79360,17367040,91504,92416,1495840,144256,144384,144512
.long 143360,143488,143616,143744,1378176,1574784,1771392,1920,198528,395136,591744
.long 28114944,28131328,28147712,28082176,28098560,15248,1198336,25315328,640640,27944960,1054144
.long 3151296,18464,1073741824,16780300,1073741824,24634368,0,0,1073741824,10862592,10870784
.long 16508928,16517120,77108,79488,17416192,91508,92416,1495840,799616,799744,799872
.long 798720,798848,798976,799104,1427328,1623936,1820544,51072,247680,444288,640896
.long 28119040,28135424,28151808,28086272,28102656,15264,1208576,25317376,689792,27947008,1054144
.long 3151296,18496,1073741824,16780300,1073741824,25125888,0,0,1073741824,10862592,10870784
.long 16703488,16711680,77616,79616,17465344,91512,92416,1495840,1454976,1455104,1455232
.long 1454080,1454208,1454336,1454464,1476480,1673088,1869696,100224,296832,493440,690048
.long 28123136,28139520,28155904,28090368,28106752,15280,1218816,25319424,738944,27949056,1054144
.long 1073741824,18528,1073741824,16780300,1073741824,25617408,0,0,1073741824,10862592,10862592
.long 16705536,16713728,77620,79744,17514496,91516,92416,1495840,2110336,2110464,2110592
.long 2109440,2109568,2109696,2109824,1525632,1722240,1918848,149376,345984,542592,739200
.long 28127232,28143616,28160000,28094464,28110848,31616,1433856,25559040,591872,28106752,1062336
.long 3159488,34816,1073741824,50465804,1073741824,24142848,0,0,1073741824,12959744,12967936
.long 19652608,19660800,85296,81408,18153472,93552,92928,1536800,307456,307584,307712
.long 307840,307968,308096,308224,395136,591744,788352,984960,1181568,1378176,1574784
.long 28155904,28090368,28106752,28123136,28139520,31632,1444096,25561088,641024,28108800,1062336
.long 3159488,34848,1073741824,50465804,1073741824,24634368,0,0,1073741824,12959744,12967936
.long 19654656,19662848,85300,81536,18202624,93556,92928,1536800,962816,962944,963072
.long 963200,963328,963456,963584,444288,640896,837504,1034112,1230720,1427328,1623936
.long 28160000,28094464,28110848,28127232,28143616,31648,1454336,25563136,690176,28110848,1062336
.long 3159488,34880,1073741824,50465804,1073741824,25125888,0,0,1073741824,12959744,12967936
.long 19849216,19857408,85808,81664,18251776,93560,92928,1536800,1618176,1618304,1618432
.long 1618560,1618688,1618816,1618944,493440,690048,886656,1083264,1279872,1476480,1673088
.long 28082176,28098560,28114944,28131328,28147712,31664,1464576,25565184,739328,28112896,1062336
.long 1073741824,34912,1073741824,50465804,1073741824,25617408,0,0,1073741824,12959744,12959744
.long 19851264,19859456,85812,81792,18300928,93564,92928,1536800,2273536,2273664,2273792
.long 2273920,2274048,2274176,2274304,542592,739200,935808,1132416,1329024,1525632,1722240
.long 28086272,28102656,28119040,28135424,28151808,19328,1679616,25804800,592256,28270592,1056192
.long 3153344,18432,1073741824,16780300,1073741824,24142848,0,0,1073741824,11386880,11395072
.long 16556032,16564224,77232,83456,18939904,92016,93440,1577760,144256,144384,144512
.long 143360,143488,143616,143744,1378944,1575552,1772160,2688,199296,395904,592512
.long 28442624,28459008,28475392,28409856,28426240,19344,1689856,25806848,641408,28272640,1056192
.long 3153344,18464,1073741824,16780300,1073741824,24634368,0,0,1073741824,11386880,11395072
.long 16558080,16566272,77236,83584,18989056,92020,93440,1577760,799616,799744,799872
.long 798720,798848,798976,799104,1428096,1624704,1821312,51840,248448,445056,641664
.long 28446720,28463104,28479488,28413952,28430336,19360,1700096,25808896,690560,28274688,1056192
.long 3153344,18496,1073741824,16780300,1073741824,25125888,0,0,1073741824,11386880,11395072
.long 16752640,16760832,77744,83712,19038208,92024,93440,1577760,1454976,1455104,1455232
.long 1454080,1454208,1454336,1454464,1477248,1673856,1870464,100992,297600,494208,690816
.long 28450816,28467200,28483584,28418048,28434432,19376,1710336,25810944,739712,28276736,1056192
.long 1073741824,18528,1073741824,16780300,1073741824,25617408,0,0,1073741824,11386880,11386880
.long 16754688,16762880,77748,83840,19087360,92028,93440,1577760,2110336,2110464,2110592
.long 2109440,2109568,2109696,2109824,1526400,1723008,1919616,150144,346752,543360,739968
.long 28454912,28471296,28487680,28422144,28438528,35712,1925376,26050560,592640,28434432,1064384
.long 3161536,34816,1073741824,50465804,1073741824,24142848,0,0,1073741824,13484032,13492224
.long 19701760,19709952,85424,85504,19726336,94064,93952,1618720,307456,307584,307712
.long 307840,307968,308096,308224,395904,592512,789120,985728,1182336,1378944,1575552
.long 28483584,28418048,28434432,28450816,28467200,35728,1935616,26052608,641792,28436480,1064384
.long 3161536,34848,1073741824,50465804,1073741824,24634368,0,0,1073741824,13484032,13492224
.long 19703808,19712000,85428,85632,19775488,94068,93952,1618720,962816,962944,963072
.long 963200,963328,963456,963584,445056,641664,838272,1034880,1231488,1428096,1624704
.long 28487680,28422144,28438528,28454912,28471296,35744,1945856,26054656,690944,28438528,1064384
.long 3161536,34880,1073741824,50465804,1073741824,25125888,0,0,1073741824,13484032,13492224
.long 19898368,19906560,85936,85760,19824640,94072,93952,1618720,1618176,1618304,1618432
.long 1618560,1618688,1618816,1618944,494208,690816,887424,1084032,1280640,1477248,1673856
.long 28409856,28426240,28442624,28459008,28475392,35760,1956096,26056704,740096,28440576,1064384
.long 1073741824,34912,1073741824,50465804,1073741824,25617408,0,0,1073741824,13484032,13484032
.long 19900416,19908608,85940,85888,19873792,94076,93952,1618720,2273536,2273664,2273792
.long 2273920,2274048,2274176,2274304,543360,739968,936576,1133184,1329792,1526400,1723008
.long 28413952,28430336,28446720,28463104,28479488,7168,82688,24223744,1179777,27313152,1050112
.long 3147264,4096,448,50465804,1294336,24147968,2290649224,2290649224,9438144,9830400,9838592
.long 13672448,13668352,69704,69632,13631488,90496,90112,960,384,512,640
.long 768,896,1024,1152,590464,787072,983680,1180288,1376896,1573504,1770112
.long 27508736,27525120,27541504,27557888,27574272,7184,92928,24225792,1228929,27315200,1050112
.long 3147264,4128,657856,50465804,1294336,24639488,2290649224,2290649224,9438144,9830400,9838592
.long 13674496,13670400,69708,69760,13680640,90500,90112,960,655744,655872,656000
.long 656128,656256,656384,656512,639616,836224,1032832,1229440,1426048,1622656,1819264
.long 27512832,27529216,27545600,27561984,27578368,7200,103168,24227840,1278081,27317248,1050112
.long 3147264,4160,448,50465804,1294336,25131008,2290649224,2290649224,9438144,9830400,9838592
.long 13869056,13864960,70216,69888,13729792,90504,90112,960,1311104,1311232,1311360
.long 1311488,1311616,1311744,1311872,688768,885376,1081984,1278592,1475200,1671808,1868416
.long 27516928,27533312,27549696,27566080,27582464,7216,113408,24229888,1327233,27319296,1050112
.long 1073741824,4192,657856,50465804,1294336,25622528,2290649224,2290649224,9438144,9830400,9830400
.long 13871104,13867008,70220,70016,13778944,90508,90112,960,1966464,1966592,1966720
.long 1966848,1966976,1967104,1967232,737920,934528,1131136,1327744,1524352,1720960,1917568
.long 27521024,27537408,27553792,27570176,27586560,23552,328448,24469504,1180161,27476992,1058304
.long 3155456,20480,1092,16780300,1654784,24147968,2290649224,2290649224,9439552,11927552,11935744
.long 16818176,16814080,77896,71680,14417920,92544,90624,41920,164864,164992,163840
.long 163968,164096,164224,164352,1573504,1770112,640,197248,393856,590464,787072
.long 27549696,27566080,27582464,27516928,27533312,23568,338688,24471552,1229313,27479040,1058304
.long 3155456,20512,658500,16780300,1654784,24639488,2290649224,2290649224,9439552,11927552,11935744
.long 16820224,16816128,77900,71808,14467072,92548,90624,41920,820224,820352,819200
.long 819328,819456,819584,819712,1622656,1819264,49792,246400,443008,639616,836224
.long 27553792,27570176,27586560,27521024,27537408,23584,348928,24473600,1278465,27481088,1058304
.long 3155456,20544,1092,16780300,1654784,25131008,2290649224,2290649224,9439552,11927552,11935744
.long 17014784,17010688,78408,71936,14516224,92552,90624,41920,1475584,1475712,1474560
.long 1474688,1474816,1474944,1475072,1671808,1868416,98944,295552,492160,688768,885376
.long 27557888,27574272,27508736,27525120,27541504,23600,359168,24475648,1327617,27483136,1058304
.long 1073741824,20576,658500,16780300,1654784,25622528,2290649224,2290649224,9439552,11927552,11927552
.long 17016832,17012736,78412,72064,14565376,92556,90624,41920,2130944,2131072,2129920
.long 2130048,2130176,2130304,2130432,1720960,1917568,148096,344704,541312,737920,934528
.long 27561984,27578368,27512832,27529216,27545600,11264,574208,24715264,1180545,27640832,1052160
.long 3149312,4096,1732,50465804,2015232,24147968,2290649224,2290649224,9440960,10354688,10362880
.long 13721600,13717504,69832,73728,15204352,91008,91136,82880,384,512,640
.long 768,896,1024,1152,591232,787840,984448,1181056,1377664,1574272,1770880
.long 27836416,27852800,27869184,27885568,27901952,11280,584448,24717312,1229697,27642880,1052160
.long 3149312,4128,659140,50465804,2015232,24639488,2290649224,2290649224,9440960,10354688,10362880
.long 13723648,13719552,69836,73856,15253504,91012,91136,82880,655744,655872,656000
.long 656128,656256,656384,656512,640384,836992,1033600,1230208,1426816,1623424,1820032
.long 27840512,27856896,27873280,27889664,27906048,11296,594688,24719360,1278849,27644928,1052160
.long 3149312,4160,1732,50465804,2015232,25131008,2290649224,2290649224,9440960,10354688,10362880
.long 13918208,13914112,70344,73984,15302656,91016,91136,82880,1311104,1311232,1311360
.long 1311488,1311616,1311744,1311872,689536,886144,1082752,1279360,1475968,1672576,1869184
.long 27844608,27860992,27877376,27893760,27910144,11312,604928,24721408,1328001,27646976,1052160
.long 1073741824,4192,659140,50465804,2015232,25622528,2290649224,2290649224,9440960,10354688,10354688
.long 13920256,13916160,70348,74112,15351808,91020,91136,82880,1966464,1966592,1966720
.long 1966848,1966976,1967104,1967232,738688,935296,1131904,1328512,1525120,1721728,1918336
.long 27848704,27865088,27881472,27897856,27914240,27648,819968,24961024,1180929,27804672,1060352
.long 3157504,20480,2376,16780300,2375680,24147968,2290649224,2290649224,9442368,12451840,12460032
.long 16867328,16863232,78024,75776,15990784,93056,91648,123840,164864,164992,163840
.long 163968,164096,164224,164352,1574272,1770880,1408,198016,394624,591232,787840
.long 27877376,27893760,27910144,27844608,27860992,27664,830208,24963072,1230081,27806720,1060352
.long 3157504,20512,659784,16780300,2375680,24639488,2290649224,2290649224,9442368,12451840,12460032
.long 16869376,16865280,78028,75904,16039936,93060,91648,123840,820224,820352,819200
.long 819328,819456,819584,819712,1623424,1820032,50560,247168,443776,640384,836992
.long 27881472,27897856,27914240,27848704,27865088,27680,840448,24965120,1279233,27808768,1060352
.long 3157504,20544,2376,16780300,2375680,25131008,2290649224,2290649224,9442368,12451840,12460032
.long 17063936,17059840,78536,76032,16089088,93064,91648,123840,1475584,1475712,1474560
.long 1474688,1474816,1474944,1475072,1672576,1869184,99712,296320,492928,689536,886144
.long 27885568,27901952,27836416,27852800,27869184,27696,850688,24967168,1328385,27810816,1060352
.long 1073741824,20576,659784,16780300,2375680,25622528,2290649224,2290649224,9442368,12451840,12451840
.long 17065984,17061888,78540,76160,16138240,93068,91648,123840,2130944,2131072,2129920
.long 2130048,2130176,2130304,2130432,1721728,1918336,148864,345472,542080,738688,935296
.long 27889664,27906048,27840512,27856896,27873280,15360,1065728,25206784,1181313,27968512,1054208
.long 3151360,4096,3016,50465804,2736128,24147968,2290649224,2290649224,9443776,10878976,10887168
.long 13770752,13766656,69960,77824,16777216,91520,92160,164800,384,512,640
.long 768,896,1024,1152,592000,788608,985216,1181824,1378432,1575040,1771648
.long 28164096,28180480,28196864,28213248,28229632,15376,1075968,25208832,1230465,27970560,1054208
.long 3151360,4128,660424,50465804,2736128,24639488,2290649224,2290649224,9443776,10878976,10887168
.long 13772800,13768704,69964,77952,16826368,91524,92160,164800,655744,655872,656000
.long 656128,656256,656384,656512,641152,837760,1034368,1230976,1427584,1624192,1820800
.long 28168192,28184576,28200960,28217344,28233728,15392,1086208,25210880,1279617,27972608,1054208
.long 3151360,4160,3016,50465804,2736128,25131008,2290649224,2290649224,9443776,10878976,10887168
.long 13967360,13963264,70472,78080,16875520,91528,92160,164800,1311104,1311232,1311360
.long 1311488,1311616,1311744,1311872,690304,886912,1083520,1280128,1476736,1673344,1869952
.long 28172288,28188672,28205056,28221440,28237824,15408,1096448,25212928,1328769,27974656,1054208
.long 1073741824,4192,660424,50465804,2736128,25622528,2290649224,2290649224,9443776,10878976,10878976
.long 13969408,13965312,70476,78208,16924672,91532,92160,164800,1966464,1966592,1966720
.long 1966848,1966976,1967104,1967232,739456,936064,1132672,1329280,1525888,1722496,1919104
.long 28176384,28192768,28209152,28225536,28241920,31744,1311488,25452544,1181697,28132352,1062400
.long 3159552,20480,3660,16780300,3096576,24147968,2290649224,2290649224,9445184,12976128,12984320
.long 16916480,16912384,78152,79872,17563648,93568,92672,205760,164864,164992,163840
.long 163968,164096,164224,164352,1575040,1771648,2176,198784,395392,592000,788608
.long 28205056,28221440,28237824,28172288,28188672,31760,1321728,25454592,1230849,28134400,1062400
.long 3159552,20512,661068,16780300,3096576,24639488,2290649224,2290649224,9445184,12976128,12984320
.long 16918528,16914432,78156,80000,17612800,93572,92672,205760,820224,820352,819200
.long 819328,819456,819584,819712,1624192,1820800,51328,247936,444544,641152,837760
.long 28209152,28225536,28241920,28176384,28192768,31776,1331968,25456640,1280001,28136448,1062400
.long 3159552,20544,3660,16780300,3096576,25131008,2290649224,2290649224,9445184,12976128,12984320
.long 17113088,17108992,78664,80128,17661952,93576,92672,205760,1475584,1475712,1474560
.long 1474688,1474816,1474944,1475072,1673344,1869952,100480,297088,493696,690304,886912
.long 28213248,28229632,28164096,28180480,28196864,31792,1342208,25458688,1329153,28138496,1062400
.long 1073741824,20576,661068,16780300,3096576,25622528,2290649224,2290649224,9445184,12976128,12976128
.long 17115136,17111040,78668,80256,17711104,93580,92672,205760,2130944,2131072,2129920
.long 2130048,2130176,2130304,2130432,1722496,1919104,149632,346240,542848,739456,936064
.long 28217344,28233728,28168192,28184576,28200960,19456,1557248,25698304,1182081,28296192,1056256
.long 3153408,4096,4300,50465804,3457024,24147968,2290649224,2290649224,9446592,11403264,11411456
.long 13819904,13815808,70088,81920,18350080,92032,93184,246720,384,512,640
.long 768,896,1024,1152,592768,789376,985984,1182592,1379200,1575808,1772416
.long 28491776,28508160,28524544,28540928,28557312,19472,1567488,25700352,1231233,28298240,1056256
.long 3153408,4128,661708,50465804,3457024,24639488,2290649224,2290649224,9446592,11403264,11411456
.long 13821952,13817856,70092,82048,18399232,92036,93184,246720,655744,655872,656000
.long 656128,656256,656384,656512,641920,838528,1035136,1231744,1428352,1624960,1821568
.long 28495872,28512256,28528640,28545024,28561408,19488,1577728,25702400,1280385,28300288,1056256
.long 3153408,4160,4300,50465804,3457024,25131008,2290649224,2290649224,9446592,11403264,11411456
.long 14016512,14012416,70600,82176,18448384,92040,93184,246720,1311104,1311232,1311360
.long 1311488,1311616,1311744,1311872,691072,887680,1084288,1280896,1477504,1674112,1870720
.long 28499968,28516352,28532736,28549120,28565504,19504,1587968,25704448,1329537,28302336,1056256
.long 1073741824,4192,661708,50465804,3457024,25622528,2290649224,2290649224,9446592,11403264,11403264
.long 14018560,14014464,70604,82304,18497536,92044,93184,246720,1966464,1966592,1966720
.long 1966848,1966976,1967104,1967232,740224,936832,1133440,1330048,1526656,1723264,1919872
.long 28504064,28520448,28536832,28553216,28569600,35840,1803008,25944064,1182465,28460032,1064448
.long 3161600,20480,4944,16780300,3817472,24147968,2290649224,2290649224,9448000,13500416,13508608
.long 16965632,16961536,78280,83968,19136512,94080,93696,287680,164864,164992,163840
.long 163968,164096,164224,164352,1575808,1772416,2944,199552,396160,592768,789376
.long 28532736,28549120,28565504,28499968,28516352,35856,1813248,25946112,1231617,28462080,1064448
.long 3161600,20512,662352,16780300,3817472,24639488,2290649224,2290649224,9448000,13500416,13508608
.long 16967680,16963584,78284,84096,19185664,94084,93696,287680,820224,820352,819200
.long 819328,819456,819584,819712,1624960,1821568,52096,248704,445312,641920,838528
.long 28536832,28553216,28569600,28504064,28520448,35872,1823488,25948160,1280769,28464128,1064448
.long 3161600,20544,4944,16780300,3817472,25131008,2290649224,2290649224,9448000,13500416,13508608
.long 17162240,17158144,78792,84224,19234816,94088,93696,287680,1475584,1475712,1474560
.long 1474688,1474816,1474944,1475072,1674112,1870720,101248,297856,494464,691072,887680
.long 28540928,28557312,28491776,28508160,28524544,35888,1833728,25950208,1329921,28466176,1064448
.long 1073741824,20576,662352,16780300,3817472,25622528,2290649224,2290649224,9448000,13500416,13500416
.long 17164288,17160192,78796,84352,19283968,94092,93696,287680,2130944,2131072,2129920
.long 2130048,2130176,2130304,2130432,1723264,1919872,150400,347008,543616,740224,936832
.long 28545024,28561408,28495872,28512256,28528640,7296,82944,24231936,983169,27304960,1050176
.long 3147328,6144,480,16780300,1310720,24147968,2290649224,2290649224,9438208,9846784,9854976
.long 14065664,14061568,70728,70144,13828096,90512,90112,1311680,20864,20992,21120
.long 21248,21376,21504,21632,590464,787072,983680,1180288,1376896,1573504,1770112
.long 27508736,27525120,27541504,27557888,27574272,7312,93184,24233984,1032321,27307008,1050176
.long 3147328,6176,657888,16780300,1310720,24639488,2290649224,2290649224,9438208,9846784,9854976
.long 14067712,14063616,70732,70272,13877248,90516,90112,1311680,676224,676352,676480
.long 676608,676736,676864,676992,639616,836224,1032832,1229440,1426048,1622656,1819264
.long 27512832,27529216,27545600,27561984,27578368,7328,103424,24236032,1081473,27309056,1050176
.long 3147328,6208,480,16780300,1310720,25131008,2290649224,2290649224,9438208,9846784,9854976
.long 14262272,14258176,71240,70400,13926400,90520,90112,1311680,1331584,1331712,1331840
.long 1331968,1332096,1332224,1332352,688768,885376,1081984,1278592,1475200,1671808,1868416
.long 27516928,27533312,27549696,27566080,27582464,7344,113664,24238080,1130625,27311104,1050176
.long 1073741824,6240,657888,16780300,1310720,25622528,2290649224,2290649224,9438208,9846784,9846784
.long 14264320,14260224,71244,70528,13975552,90524,90112,1311680,1986944,1987072,1987200
.long 1987328,1987456,1987584,1987712,737920,934528,1131136,1327744,1524352,1720960,1917568
.long 27521024,27537408,27553792,27570176,27586560,23680,328704,24477696,983553,27468800,1058368
.long 3155520,22528,1120,50465804,1671168,24147968,2290649224,2290649224,9439616,11943936,11952128
.long 17211392,17207296,78920,72192,14614528,92560,90624,1352640,185344,185472,184320
.long 184448,184576,184704,184832,1573504,1770112,640,197248,393856,590464,787072
.long 27549696,27566080,27582464,27516928,27533312,23696,338944,24479744,1032705,27470848,1058368
.long 3155520,22560,658528,50465804,1671168,24639488,2290649224,2290649224,9439616,11943936,11952128
.long 17213440,17209344,78924,72320,14663680,92564,90624,1352640,840704,840832,839680
.long 839808,839936,840064,840192,1622656,1819264,49792,246400,443008,639616,836224
.long 27553792,27570176,27586560,27521024,27537408,23712,349184,24481792,1081857,27472896,1058368
.long 3155520,22592,1120,50465804,1671168,25131008,2290649224,2290649224,9439616,11943936,11952128
.long 17408000,17403904,79432,72448,14712832,92568,90624,1352640,1496064,1496192,1495040
.long 1495168,1495296,1495424,1495552,1671808,1868416,98944,295552,492160,688768,885376
.long 27557888,27574272,27508736,27525120,27541504,23728,359424,24483840,1131009,27474944,1058368
.long 1073741824,22624,658528,50465804,1671168,25622528,2290649224,2290649224,9439616,11943936,11943936
.long 17410048,17405952,79436,72576,14761984,92572,90624,1352640,2151424,2151552,2150400
.long 2150528,2150656,2150784,2150912,1720960,1917568,148096,344704,541312,737920,934528
.long 27561984,27578368,27512832,27529216,27545600,11392,574464,24723456,983937,27632640,1052224
.long 3149376,6144,1764,16780300,2031616,24147968,2290649224,2290649224,9441024,10371072,10379264
.long 14114816,14110720,70856,74240,15400960,91024,91136,1393600,20864,20992,21120
.long 21248,21376,21504,21632,591232,787840,984448,1181056,1377664,1574272,1770880
.long 27836416,27852800,27869184,27885568,27901952,11408,584704,24725504,1033089,27634688,1052224
.long 3149376,6176,659172,16780300,2031616,24639488,2290649224,2290649224,9441024,10371072,10379264
.long 14116864,14112768,70860,74368,15450112,91028,91136,1393600,676224,676352,676480
.long 676608,676736,676864,676992,640384,836992,1033600,1230208,1426816,1623424,1820032
.long 27840512,27856896,27873280,27889664,27906048,11424,594944,24727552,1082241,27636736,1052224
.long 3149376,6208,1764,16780300,2031616,25131008,2290649224,2290649224,9441024,10371072,10379264
.long 14311424,14307328,71368,74496,15499264,91032,91136,1393600,1331584,1331712,1331840
.long 1331968,1332096,1332224,1332352,689536,886144,1082752,1279360,1475968,1672576,1869184
.long 27844608,27860992,27877376,27893760,27910144,11440,605184,24729600,1131393,27638784,1052224
.long 1073741824,6240,659172,16780300,2031616,25622528,2290649224,2290649224,9441024,10371072,10371072
.long 14313472,14309376,71372,74624,15548416,91036,91136,1393600,1986944,1987072,1987200
.long 1987328,1987456,1987584,1987712,738688,935296,1131904,1328512,1525120,1721728,1918336
.long 27848704,27865088,27881472,27897856,27914240,27776,820224,24969216,984321,27796480,1060416
.long 3157568,22528,2404,50465804,2392064,24147968,2290649224,2290649224,9442432,12468224,12476416
.long 17260544,17256448,79048,76288,16187392,93072,91648,1434560,185344,185472,184320
.long 184448,184576,184704,184832,1574272,1770880,1408,198016,394624,591232,787840
.long 27877376,27893760,27910144,27844608,27860992,27792,830464,24971264,1033473,27798528,1060416
.long 3157568,22560,659812,50465804,2392064,24639488,2290649224,2290649224,9442432,12468224,12476416
.long 17262592,17258496,79052,76416,16236544,93076,91648,1434560,840704,840832,839680
.long 839808,839936,840064,840192,1623424,1820032,50560,247168,443776,640384,836992
.long 27881472,27897856,27914240,27848704,27865088,27808,840704,24973312,1082625,27800576,1060416
.long 3157568,22592,2404,50465804,2392064,25131008,2290649224,2290649224,9442432,12468224,12476416
.long 17457152,17453056,79560,76544,16285696,93080,91648,1434560,1496064,1496192,1495040
.long 1495168,1495296,1495424,1495552,1672576,1869184,99712,296320,492928,689536,886144
.long 27885568,27901952,27836416,27852800,27869184,27824,850944,24975360,1131777,27802624,1060416
.long 1073741824,22624,659812,50465804,2392064,25622528,2290649224,2290649224,9442432,12468224,12468224
.long 17459200,17455104,79564,76672,16334848,93084,91648,1434560,2151424,2151552,2150400
.long 2150528,2150656,2150784,2150912,1721728,1918336,148864,345472,542080,738688,935296
.long 27889664,27906048,27840512,27856896,27873280,15488,1065984,25214976,984705,27960320,1054272
.long 3151424,6144,3048,16780300,2752512,24147968,2290649224,2290649224,9443840,10895360,10903552
.long 14163968,14159872,70984,78336,16973824,91536,92160,1475520,20864,20992,21120
.long 21248,21376,21504,21632,592000,788608,985216,1181824,1378432,1575040,1771648
.long 28164096,28180480,28196864,28213248,28229632,15504,1076224,25217024,1033857,27962368,1054272
.long 3151424,6176,660456,16780300,2752512,24639488,2290649224,2290649224,9443840,10895360,10903552
.long 14166016,14161920,70988,78464,17022976,91540,92160,1475520,676224,676352,676480
.long 676608,676736,676864,676992,641152,837760,1034368,1230976,1427584,1624192,1820800
.long 28168192,28184576,28200960,28217344,28233728,15520,1086464,25219072,1083009,27964416,1054272
.long 3151424,6208,3048,16780300,2752512,25131008,2290649224,2290649224,9443840,10895360,10903552
.long 14360576,14356480,71496,78592,17072128,91544,92160,1475520,1331584,1331712,1331840
.long 1331968,1332096,1332224,1332352,690304,886912,1083520,1280128,1476736,1673344,1869952
.long 28172288,28188672,28205056,28221440,28237824,15536,1096704,25221120,1132161,27966464,1054272
.long 1073741824,6240,660456,16780300,2752512,25622528,2290649224,2290649224,9443840,10895360,10895360
.long 14362624,14358528,71500,78720,17121280,91548,92160,1475520,1986944,1987072,1987200
.long 1987328,1987456,1987584,1987712,739456,936064,1132672,1329280,1525888,1722496,1919104
.long 28176384,28192768,28209152,28225536,28241920,31872,1311744,25460736,985089,28124160,1062464
.long 3159616,22528,3688,50465804,3112960,24147968,2290649224,2290649224,9445248,12992512,13000704
.long 17309696,17305600,79176,80384,17760256,93584,92672,1516480,185344,185472,184320
.long 184448,184576,184704,184832,1575040,1771648,2176,198784,395392,592000,788608
.long 28205056,28221440,28237824,28172288,28188672,31888,1321984,25462784,1034241,28126208,1062464
.long 3159616,22560,661096,50465804,3112960,24639488,2290649224,2290649224,9445248,12992512,13000704
.long 17311744,17307648,79180,80512,17809408,93588,92672,1516480,840704,840832,839680
.long 839808,839936,840064,840192,1624192,1820800,51328,247936,444544,641152,837760
.long 28209152,28225536,28241920,28176384,28192768,31904,1332224,25464832,1083393,28128256,1062464
.long 3159616,22592,3688,50465804,3112960,25131008,2290649224,2290649224,9445248,12992512,13000704
.long 17506304,17502208,79688,80640,17858560,93592,92672,1516480,1496064,1496192,1495040
.long 1495168,1495296,1495424,1495552,1673344,1869952,100480,297088,493696,690304,886912
.long 28213248,28229632,28164096,28180480,28196864,31920,1342464,25466880,1132545,28130304,1062464
.long 1073741824,22624,661096,50465804,3112960,25622528,2290649224,2290649224,9445248,12992512,12992512
.long 17508352,17504256,79692,80768,17907712,93596,92672,1516480,2151424,2151552,2150400
.long 2150528,2150656,2150784,2150912,1722496,1919104,149632,346240,542848,739456,936064
.long 28217344,28233728,28168192,28184576,28200960,19584,1557504,25706496,985473,28288000,1056320
.long 3153472,6144,4332,16780300,3473408,24147968,2290649224,2290649224,9446656,11419648,11427840
.long 14213120,14209024,71112,82432,18546688,92048,93184,1557440,20864,20992,21120
.long 21248,21376,21504,21632,592768,789376,985984,1182592,1379200,1575808,1772416
.long 28491776,28508160,28524544,28540928,28557312,19600,1567744,25708544,1034625,28290048,1056320
.long 3153472,6176,661740,16780300,3473408,24639488,2290649224,2290649224,9446656,11419648,11427840
.long 14215168,14211072,71116,82560,18595840,92052,93184,1557440,676224,676352,676480
.long 676608,676736,676864,676992,641920,838528,1035136,1231744,1428352,1624960,1821568
.long 28495872,28512256,28528640,28545024,28561408,19616,1577984,25710592,1083777,28292096,1056320
.long 3153472,6208,4332,16780300,3473408,25131008,2290649224,2290649224,9446656,11419648,11427840
.long 14409728,14405632,71624,82688,18644992,92056,93184,1557440,1331584,1331712,1331840
.long 1331968,1332096,1332224,1332352,691072,887680,1084288,1280896,1477504,1674112,1870720
.long 28499968,28516352,28532736,28549120,28565504,19632,1588224,25712640,1132929,28294144,1056320
.long 1073741824,6240,661740,16780300,3473408,25622528,2290649224,2290649224,9446656,11419648,11419648
.long 14411776,14407680,71628,82816,18694144,92060,93184,1557440,1986944,1987072,1987200
.long 1987328,1987456,1987584,1987712,740224,936832,1133440,1330048,1526656,1723264,1919872
.long 28504064,28520448,28536832,28553216,28569600,35968,1803264,25952256,985857,28451840,1064512
.long 3161664,22528,4972,50465804,3833856,24147968,2290649224,2290649224,9448064,13516800,13524992
.long 17358848,17354752,79304,84480,19333120,94096,93696,1598400,185344,185472,184320
.long 184448,184576,184704,184832,1575808,1772416,2944,199552,396160,592768,789376
.long 28532736,28549120,28565504,28499968,28516352,35984,1813504,25954304,1035009,28453888,1064512
.long 3161664,22560,662380,50465804,3833856,24639488,2290649224,2290649224,9448064,13516800,13524992
.long 17360896,17356800,79308,84608,19382272,94100,93696,1598400,840704,840832,839680
.long 839808,839936,840064,840192,1624960,1821568,52096,248704,445312,641920,838528
.long 28536832,28553216,28569600,28504064,28520448,36000,1823744,25956352,1084161,28455936,1064512
.long 3161664,22592,4972,50465804,3833856,25131008,2290649224,2290649224,9448064,13516800,13524992
.long 17555456,17551360,79816,84736,19431424,94104,93696,1598400,1496064,1496192,1495040
.long 1495168,1495296,1495424,1495552,1674112,1870720,101248,297856,494464,691072,887680
.long 28540928,28557312,28491776,28508160,28524544,36016,1833984,25958400,1133313,28457984,1064512
.long 1073741824,22624,662380,50465804,3833856,25622528,2290649224,2290649224,9448064,13516800,13516800
.long 17557504,17553408,79820,84864,19480576,94108,93696,1598400,2151424,2151552,2150400
.long 2150528,2150656,2150784,2150912,1723264,1919872,150400,347008,543616,740224,936832
.long 28545024,28561408,28495872,28512256,28528640,7424,122880,24240128,786561,27296768,1050240
.long 3147392,8192,508,50465804,1327104,24147968,2290649224,2290649224,9438272,9863168,9871360
.long 14458880,14454784,71752,70656,14024704,90528,90368,21440,41472,41600,41728
.long 41856,41984,42112,40960,787072,983680,1180288,1376896,1573504,1770112,640
.long 27516928,27533312,27549696,27566080,27582464,7440,133120,24242176,835713,27298816,1050240
.long 3147392,8224,657916,50465804,1327104,24639488,2290649224,2290649224,9438272,9863168,9871360
.long 14460928,14456832,71756,70784,14073856,90532,90368,21440,696832,696960,697088
.long 697216,697344,697472,696320,836224,1032832,1229440,1426048,1622656,1819264,49792
.long 27521024,27537408,27553792,27570176,27586560,7456,143360,24244224,884865,27300864,1050240
.long 3147392,8256,508,50465804,1327104,25131008,2290649224,2290649224,9438272,9863168,9871360
.long 14655488,14651392,72264,70912,14123008,90536,90368,21440,1352192,1352320,1352448
.long 1352576,1352704,1352832,1351680,885376,1081984,1278592,1475200,1671808,1868416,98944
.long 27525120,27541504,27557888,27574272,27508736,7472,153600,24246272,934017,27302912,1050240
.long 1073741824,8288,657916,50465804,1327104,25622528,2290649224,2290649224,9438272,9863168,9863168
.long 14657536,14653440,72268,71040,14172160,90540,90368,21440,2007552,2007680,2007808
.long 2007936,2008064,2008192,2007040,934528,1131136,1327744,1524352,1720960,1917568,148096
.long 27529216,27545600,27561984,27578368,27512832,23808,368640,24485888,786945,27460608,1058432
.long 3155584,24576,1152,16780300,1687552,24147968,2290649224,2290649224,9439680,11960320,11968512
.long 17604608,17600512,79944,72704,14811136,92576,90880,62400,205952,204800,204928
.long 205056,205184,205312,205440,1770112,640,197248,393856,590464,787072,983680
.long 27557888,27574272,27508736,27525120,27541504,23824,378880,24487936,836097,27462656,1058432
.long 3155584,24608,658560,16780300,1687552,24639488,2290649224,2290649224,9439680,11960320,11968512
.long 17606656,17602560,79948,72832,14860288,92580,90880,62400,861312,860160,860288
.long 860416,860544,860672,860800,1819264,49792,246400,443008,639616,836224,1032832
.long 27561984,27578368,27512832,27529216,27545600,23840,389120,24489984,885249,27464704,1058432
.long 3155584,24640,1152,16780300,1687552,25131008,2290649224,2290649224,9439680,11960320,11968512
.long 17801216,17797120,80456,72960,14909440,92584,90880,62400,1516672,1515520,1515648
.long 1515776,1515904,1516032,1516160,1868416,98944,295552,492160,688768,885376,1081984
.long 27566080,27582464,27516928,27533312,27549696,23856,399360,24492032,934401,27466752,1058432
.long 1073741824,24672,658560,16780300,1687552,25622528,2290649224,2290649224,9439680,11960320,11960320
.long 17803264,17799168,80460,73088,14958592,92588,90880,62400,2172032,2170880,2171008
.long 2171136,2171264,2171392,2171520,1917568,148096,344704,541312,737920,934528,1131136
.long 27570176,27586560,27521024,27537408,27553792,11520,614400,24731648,787329,27624448,1052288
.long 3149440,8192,1792,50465804,2048000,24147968,2290649224,2290649224,9441088,10387456,10395648
.long 14508032,14503936,71880,74752,15597568,91040,91392,103360,41472,41600,41728
.long 41856,41984,42112,40960,787840,984448,1181056,1377664,1574272,1770880,1408
.long 27844608,27860992,27877376,27893760,27910144,11536,624640,24733696,836481,27626496,1052288
.long 3149440,8224,659200,50465804,2048000,24639488,2290649224,2290649224,9441088,10387456,10395648
.long 14510080,14505984,71884,74880,15646720,91044,91392,103360,696832,696960,697088
.long 697216,697344,697472,696320,836992,1033600,1230208,1426816,1623424,1820032,50560
.long 27848704,27865088,27881472,27897856,27914240,11552,634880,24735744,885633,27628544,1052288
.long 3149440,8256,1792,50465804,2048000,25131008,2290649224,2290649224,9441088,10387456,10395648
.long 14704640,14700544,72392,75008,15695872,91048,91392,103360,1352192,1352320,1352448
.long 1352576,1352704,1352832,1351680,886144,1082752,1279360,1475968,1672576,1869184,99712
.long 27852800,27869184,27885568,27901952,27836416,11568,645120,24737792,934785,27630592,1052288
.long 1073741824,8288,659200,50465804,2048000,25622528,2290649224,2290649224,9441088,10387456,10387456
.long 14706688,14702592,72396,75136,15745024,91052,91392,103360,2007552,2007680,2007808
.long 2007936,2008064,2008192,2007040,935296,1131904,1328512,1525120,1721728,1918336,148864
.long 27856896,27873280,27889664,27906048,27840512,27904,860160,24977408,787713,27788288,1060480
.long 3157632,24576,2436,16780300,2408448,24147968,2290649224,2290649224,9442496,12484608,12492800
.long 17653760,17649664,80072,76800,16384000,93088,91904,144320,205952,204800,204928
.long 205056,205184,205312,205440,1770880,1408,198016,394624,591232,787840,984448
.long 27885568,27901952,27836416,27852800,27869184,27920,870400,24979456,836865,27790336,1060480
.long 3157632,24608,659844,16780300,2408448,24639488,2290649224,2290649224,9442496,12484608,12492800
.long 17655808,17651712,80076,76928,16433152,93092,91904,144320,861312,860160,860288
.long 860416,860544,860672,860800,1820032,50560,247168,443776,640384,836992,1033600
.long 27889664,27906048,27840512,27856896,27873280,27936,880640,24981504,886017,27792384,1060480
.long 3157632,24640,2436,16780300,2408448,25131008,2290649224,2290649224,9442496,12484608,12492800
.long 17850368,17846272,80584,77056,16482304,93096,91904,144320,1516672,1515520,1515648
.long 1515776,1515904,1516032,1516160,1869184,99712,296320,492928,689536,886144,1082752
.long 27893760,27910144,27844608,27860992,27877376,27952,890880,24983552,935169,27794432,1060480
.long 1073741824,24672,659844,16780300,2408448,25622528,2290649224,2290649224,9442496,12484608,12484608
.long 17852416,17848320,80588,77184,16531456,93100,91904,144320,2172032,2170880,2171008
.long 2171136,2171264,2171392,2171520,1918336,148864,345472,542080,738688,935296,1131904
.long 27897856,27914240,27848704,27865088,27881472,15616,1105920,25223168,788097,27952128,1054336
.long 3151488,8192,3076,50465804,2768896,24147968,2290649224,2290649224,9443904,10911744,10919936
.long 14557184,14553088,72008,78848,17170432,91552,92416,185280,41472,41600,41728
.long 41856,41984,42112,40960,788608,985216,1181824,1378432,1575040,1771648,2176
.long 28172288,28188672,28205056,28221440,28237824,15632,1116160,25225216,837249,27954176,1054336
.long 3151488,8224,660484,50465804,2768896,24639488,2290649224,2290649224,9443904,10911744,10919936
.long 14559232,14555136,72012,78976,17219584,91556,92416,185280,696832,696960,697088
.long 697216,697344,697472,696320,837760,1034368,1230976,1427584,1624192,1820800,51328
.long 28176384,28192768,28209152,28225536,28241920,15648,1126400,25227264,886401,27956224,1054336
.long 3151488,8256,3076,50465804,2768896,25131008,2290649224,2290649224,9443904,10911744,10919936
.long 14753792,14749696,72520,79104,17268736,91560,92416,185280,1352192,1352320,1352448
.long 1352576,1352704,1352832,1351680,886912,1083520,1280128,1476736,1673344,1869952,100480
.long 28180480,28196864,28213248,28229632,28164096,15664,1136640,25229312,935553,27958272,1054336
.long 1073741824,8288,660484,50465804,2768896,25622528,2290649224,2290649224,9443904,10911744,10911744
.long 14755840,14751744,72524,79232,17317888,91564,92416,185280,2007552,2007680,2007808
.long 2007936,2008064,2008192,2007040,936064,1132672,1329280,1525888,1722496,1919104,149632
.long 28184576,28200960,28217344,28233728,28168192,32000,1351680,25468928,788481,28115968,1062528
.long 3159680,24576,3720,16780300,3129344,24147968,2290649224,2290649224,9445312,13008896,13017088
.long 17702912,17698816,80200,80896,17956864,93600,92928,226240,205952,204800,204928
.long 205056,205184,205312,205440,1771648,2176,198784,395392,592000,788608,985216
.long 28213248,28229632,28164096,28180480,28196864,32016,1361920,25470976,837633,28118016,1062528
.long 3159680,24608,661128,16780300,3129344,24639488,2290649224,2290649224,9445312,13008896,13017088
.long 17704960,17700864,80204,81024,18006016,93604,92928,226240,861312,860160,860288
.long 860416,860544,860672,860800,1820800,51328,247936,444544,641152,837760,1034368
.long 28217344,28233728,28168192,28184576,28200960,32032,1372160,25473024,886785,28120064,1062528
.long 3159680,24640,3720,16780300,3129344,25131008,2290649224,2290649224,9445312,13008896,13017088
.long 17899520,17895424,80712,81152,18055168,93608,92928,226240,1516672,1515520,1515648
.long 1515776,1515904,1516032,1516160,1869952,100480,297088,493696,690304,886912,1083520
.long 28221440,28237824,28172288,28188672,28205056,32048,1382400,25475072,935937,28122112,1062528
.long 1073741824,24672,661128,16780300,3129344,25622528,2290649224,2290649224,9445312,13008896,13008896
.long 17901568,17897472,80716,81280,18104320,93612,92928,226240,2172032,2170880,2171008
.long 2171136,2171264,2171392,2171520,1919104,149632,346240,542848,739456,936064,1132672
.long 28225536,28241920,28176384,28192768,28209152,19712,1597440,25714688,788865,28279808,1056384
.long 3153536,8192,4360,50465804,3489792,24147968,2290649224,2290649224,9446720,11436032,11444224
.long 14606336,14602240,72136,82944,18743296,92064,93440,267200,41472,41600,41728
.long 41856,41984,42112,40960,789376,985984,1182592,1379200,1575808,1772416,2944
.long 28499968,28516352,28532736,28549120,28565504,19728,1607680,25716736,838017,28281856,1056384
.long 3153536,8224,661768,50465804,3489792,24639488,2290649224,2290649224,9446720,11436032,11444224
.long 14608384,14604288,72140,83072,18792448,92068,93440,267200,696832,696960,697088
.long 697216,697344,697472,696320,838528,1035136,1231744,1428352,1624960,1821568,52096
.long 28504064,28520448,28536832,28553216,28569600,19744,1617920,25718784,887169,28283904,1056384
.long 3153536,8256,4360,50465804,3489792,25131008,2290649224,2290649224,9446720,11436032,11444224
.long 14802944,14798848,72648,83200,18841600,92072,93440,267200,1352192,1352320,1352448
.long 1352576,1352704,1352832,1351680,887680,1084288,1280896,1477504,1674112,1870720,101248
.long 28508160,28524544,28540928,28557312,28491776,19760,1628160,25720832,936321,28285952,1056384
.long 1073741824,8288,661768,50465804,3489792,25622528,2290649224,2290649224,9446720,11436032,11436032
.long 14804992,14800896,72652,83328,18890752,92076,93440,267200,2007552,2007680,2007808
.long 2007936,2008064,2008192,2007040,936832,1133440,1330048,1526656,1723264,1919872,150400
.long 28512256,28528640,28545024,28561408,28495872,36096,1843200,25960448,789249,28443648,1064576
.long 3161728,24576,5004,16780300,3850240,24147968,2290649224,2290649224,9448128,13533184,13541376
.long 17752064,17747968,80328,84992,19529728,94112,93952,308160,205952,204800,204928
.long 205056,205184,205312,205440,1772416,2944,199552,396160,592768,789376,985984
.long 28540928,28557312,28491776,28508160,28524544,36112,1853440,25962496,838401,28445696,1064576
.long 3161728,24608,662412,16780300,3850240,24639488,2290649224,2290649224,9448128,13533184,13541376
.long 17754112,17750016,80332,85120,19578880,94116,93952,308160,861312,860160,860288
.long 860416,860544,860672,860800,1821568,52096,248704,445312,641920,838528,1035136
.long 28545024,28561408,28495872,28512256,28528640,36128,1863680,25964544,887553,28447744,1064576
.long 3161728,24640,5004,16780300,3850240,25131008,2290649224,2290649224,9448128,13533184,13541376
.long 17948672,17944576,80840,85248,19628032,94120,93952,308160,1516672,1515520,1515648
.long 1515776,1515904,1516032,1516160,1870720,101248,297856,494464,691072,887680,1084288
.long 28549120,28565504,28499968,28516352,28532736,36144,1873920,25966592,936705,28449792,1064576
.long 1073741824,24672,662412,16780300,3850240,25622528,2290649224,2290649224,9448128,13533184,13533184
.long 17950720,17946624,80844,85376,19677184,94124,93952,308160,2172032,2170880,2171008
.long 2171136,2171264,2171392,2171520,1919872,150400,347008,543616,740224,936832,1133440
.long 28553216,28569600,28504064,28520448,28536832,7552,123136,24248320,589953,27288576,1050304
.long 3147456,10240,540,16780300,1343488,24147968,2290649224,2290649224,9438336,9879552,9887744
.long 14852096,14848000,72776,71168,14221312,90544,90368,1332160,61952,62080,62208
.long 62336,62464,62592,61440,787072,983680,1180288,1376896,1573504,1770112,640
.long 27516928,27533312,27549696,27566080,27582464,7568,133376,24250368,639105,27290624,1050304
.long 3147456,10272,657948,16780300,1343488,24639488,2290649224,2290649224,9438336,9879552,9887744
.long 14854144,14850048,72780,71296,14270464,90548,90368,1332160,717312,717440,717568
.long 717696,717824,717952,716800,836224,1032832,1229440,1426048,1622656,1819264,49792
.long 27521024,27537408,27553792,27570176,27586560,7584,143616,24252416,688257,27292672,1050304
.long 3147456,10304,540,16780300,1343488,25131008,2290649224,2290649224,9438336,9879552,9887744
.long 15048704,15044608,73288,71424,14319616,90552,90368,1332160,1372672,1372800,1372928
.long 1373056,1373184,1373312,1372160,885376,1081984,1278592,1475200,1671808,1868416,98944
.long 27525120,27541504,27557888,27574272,27508736,7600,153856,24254464,737409,27294720,1050304
.long 1073741824,10336,657948,16780300,1343488,25622528,2290649224,2290649224,9438336,9879552,9879552
.long 15050752,15046656,73292,71552,14368768,90556,90368,1332160,2028032,2028160,2028288
.long 2028416,2028544,2028672,2027520,934528,1131136,1327744,1524352,1720960,1917568,148096
.long 27529216,27545600,27561984,27578368,27512832,23936,368896,24494080,590337,27452416,1058496
.long 3155648,26624,1180,50465804,1703936,24147968,2290649224,2290649224,9439744,11976704,11984896
.long 17997824,17993728,80968,73216,15007744,92592,90880,1373120,226432,225280,225408
.long 225536,225664,225792,225920,1770112,640,197248,393856,590464,787072,983680
.long 27557888,27574272,27508736,27525120,27541504,23952,379136,24496128,639489,27454464,1058496
.long 3155648,26656,658588,50465804,1703936,24639488,2290649224,2290649224,9439744,11976704,11984896
.long 17999872,17995776,80972,73344,15056896,92596,90880,1373120,881792,880640,880768
.long 880896,881024,881152,881280,1819264,49792,246400,443008,639616,836224,1032832
.long 27561984,27578368,27512832,27529216,27545600,23968,389376,24498176,688641,27456512,1058496
.long 3155648,26688,1180,50465804,1703936,25131008,2290649224,2290649224,9439744,11976704,11984896
.long 18194432,18190336,81480,73472,15106048,92600,90880,1373120,1537152,1536000,1536128
.long 1536256,1536384,1536512,1536640,1868416,98944,295552,492160,688768,885376,1081984
.long 27566080,27582464,27516928,27533312,27549696,23984,399616,24500224,737793,27458560,1058496
.long 1073741824,26720,658588,50465804,1703936,25622528,2290649224,2290649224,9439744,11976704,11976704
.long 18196480,18192384,81484,73600,15155200,92604,90880,1373120,2192512,2191360,2191488
.long 2191616,2191744,2191872,2192000,1917568,148096,344704,541312,737920,934528,1131136
.long 27570176,27586560,27521024,27537408,27553792,11648,614656,24739840,590721,27616256,1052352
.long 3149504,10240,1824,16780300,2064384,24147968,2290649224,2290649224,9441152,10403840,10412032
.long 14901248,14897152,72904,75264,15794176,91056,91392,1414080,61952,62080,62208
.long 62336,62464,62592,61440,787840,984448,1181056,1377664,1574272,1770880,1408
.long 27844608,27860992,27877376,27893760,27910144,11664,624896,24741888,639873,27618304,1052352
.long 3149504,10272,659232,16780300,2064384,24639488,2290649224,2290649224,9441152,10403840,10412032
.long 14903296,14899200,72908,75392,15843328,91060,91392,1414080,717312,717440,717568
.long 717696,717824,717952,716800,836992,1033600,1230208,1426816,1623424,1820032,50560
.long 27848704,27865088,27881472,27897856,27914240,11680,635136,24743936,689025,27620352,1052352
.long 3149504,10304,1824,16780300,2064384,25131008,2290649224,2290649224,9441152,10403840,10412032
.long 15097856,15093760,73416,75520,15892480,91064,91392,1414080,1372672,1372800,1372928
.long 1373056,1373184,1373312,1372160,886144,1082752,1279360,1475968,1672576,1869184,99712
.long 27852800,27869184,27885568,27901952,27836416,11696,645376,24745984,738177,27622400,1052352
.long 1073741824,10336,659232,16780300,2064384,25622528,2290649224,2290649224,9441152,10403840,10403840
.long 15099904,15095808,73420,75648,15941632,91068,91392,1414080,2028032,2028160,2028288
.long 2028416,2028544,2028672,2027520,935296,1131904,1328512,1525120,1721728,1918336,148864
.long 27856896,27873280,27889664,27906048,27840512,28032,860416,24985600,591105,27780096,1060544
.long 3157696,26624,2464,50465804,2424832,24147968,2290649224,2290649224,9442560,12500992,12509184
.long 18046976,18042880,81096,77312,16580608,93104,91904,1455040,226432,225280,225408
.long 225536,225664,225792,225920,1770880,1408,198016,394624,591232,787840,984448
.long 27885568,27901952,27836416,27852800,27869184,28048,870656,24987648,640257,27782144,1060544
.long 3157696,26656,659872,50465804,2424832,24639488,2290649224,2290649224,9442560,12500992,12509184
.long 18049024,18044928,81100,77440,16629760,93108,91904,1455040,881792,880640,880768
.long 880896,881024,881152,881280,1820032,50560,247168,443776,640384,836992,1033600
.long 27889664,27906048,27840512,27856896,27873280,28064,880896,24989696,689409,27784192,1060544
.long 3157696,26688,2464,50465804,2424832,25131008,2290649224,2290649224,9442560,12500992,12509184
.long 18243584,18239488,81608,77568,16678912,93112,91904,1455040,1537152,1536000,1536128
.long 1536256,1536384,1536512,1536640,1869184,99712,296320,492928,689536,886144,1082752
.long 27893760,27910144,27844608,27860992,27877376,28080,891136,24991744,738561,27786240,1060544
.long 1073741824,26720,659872,50465804,2424832,25622528,2290649224,2290649224,9442560,12500992,12500992
.long 18245632,18241536,81612,77696,16728064,93116,91904,1455040,2192512,2191360,2191488
.long 2191616,2191744,2191872,2192000,1918336,148864,345472,542080,738688,935296,1131904
.long 27897856,27914240,27848704,27865088,27881472,15744,1106176,25231360,591489,27943936,1054400
.long 3151552,10240,3108,16780300,2785280,24147968,2290649224,2290649224,9443968,10928128,10936320
.long 14950400,14946304,73032,79360,17367040,91568,92416,1496000,61952,62080,62208
.long 62336,62464,62592,61440,788608,985216,1181824,1378432,1575040,1771648,2176
.long 28172288,28188672,28205056,28221440,28237824,15760,1116416,25233408,640641,27945984,1054400
.long 3151552,10272,660516,16780300,2785280,24639488,2290649224,2290649224,9443968,10928128,10936320
.long 14952448,14948352,73036,79488,17416192,91572,92416,1496000,717312,717440,717568
.long 717696,717824,717952,716800,837760,1034368,1230976,1427584,1624192,1820800,51328
.long 28176384,28192768,28209152,28225536,28241920,15776,1126656,25235456,689793,27948032,1054400
.long 3151552,10304,3108,16780300,2785280,25131008,2290649224,2290649224,9443968,10928128,10936320
.long 15147008,15142912,73544,79616,17465344,91576,92416,1496000,1372672,1372800,1372928
.long 1373056,1373184,1373312,1372160,886912,1083520,1280128,1476736,1673344,1869952,100480
.long 28180480,28196864,28213248,28229632,28164096,15792,1136896,25237504,738945,27950080,1054400
.long 1073741824,10336,660516,16780300,2785280,25622528,2290649224,2290649224,9443968,10928128,10928128
.long 15149056,15144960,73548,79744,17514496,91580,92416,1496000,2028032,2028160,2028288
.long 2028416,2028544,2028672,2027520,936064,1132672,1329280,1525888,1722496,1919104,149632
.long 28184576,28200960,28217344,28233728,28168192,32128,1351936,25477120,591873,28107776,1062592
.long 3159744,26624,3748,50465804,3145728,24147968,2290649224,2290649224,9445376,13025280,13033472
.long 18096128,18092032,81224,81408,18153472,93616,92928,1536960,226432,225280,225408
.long 225536,225664,225792,225920,1771648,2176,198784,395392,592000,788608,985216
.long 28213248,28229632,28164096,28180480,28196864,32144,1362176,25479168,641025,28109824,1062592
.long 3159744,26656,661156,50465804,3145728,24639488,2290649224,2290649224,9445376,13025280,13033472
.long 18098176,18094080,81228,81536,18202624,93620,92928,1536960,881792,880640,880768
.long 880896,881024,881152,881280,1820800,51328,247936,444544,641152,837760,1034368
.long 28217344,28233728,28168192,28184576,28200960,32160,1372416,25481216,690177,28111872,1062592
.long 3159744,26688,3748,50465804,3145728,25131008,2290649224,2290649224,9445376,13025280,13033472
.long 18292736,18288640,81736,81664,18251776,93624,92928,1536960,1537152,1536000,1536128
.long 1536256,1536384,1536512,1536640,1869952,100480,297088,493696,690304,886912,1083520
.long 28221440,28237824,28172288,28188672,28205056,32176,1382656,25483264,739329,28113920,1062592
.long 1073741824,26720,661156,50465804,3145728,25622528,2290649224,2290649224,9445376,13025280,13025280
.long 18294784,18290688,81740,81792,18300928,93628,92928,1536960,2192512,2191360,2191488
.long 2191616,2191744,2191872,2192000,1919104,149632,346240,542848,739456,936064,1132672
.long 28225536,28241920,28176384,28192768,28209152,19840,1597696,25722880,592257,28271616,1056448
.long 3153600,10240,4392,16780300,3506176,24147968,2290649224,2290649224,9446784,11452416,11460608
.long 14999552,14995456,73160,83456,18939904,92080,93440,1577920,61952,62080,62208
.long 62336,62464,62592,61440,789376,985984,1182592,1379200,1575808,1772416,2944
.long 28499968,28516352,28532736,28549120,28565504,19856,1607936,25724928,641409,28273664,1056448
.long 3153600,10272,661800,16780300,3506176,24639488,2290649224,2290649224,9446784,11452416,11460608
.long 15001600,14997504,73164,83584,18989056,92084,93440,1577920,717312,717440,717568
.long 717696,717824,717952,716800,838528,1035136,1231744,1428352,1624960,1821568,52096
.long 28504064,28520448,28536832,28553216,28569600,19872,1618176,25726976,690561,28275712,1056448
.long 3153600,10304,4392,16780300,3506176,25131008,2290649224,2290649224,9446784,11452416,11460608
.long 15196160,15192064,73672,83712,19038208,92088,93440,1577920,1372672,1372800,1372928
.long 1373056,1373184,1373312,1372160,887680,1084288,1280896,1477504,1674112,1870720,101248
.long 28508160,28524544,28540928,28557312,28491776,19888,1628416,25729024,739713,28277760,1056448
.long 1073741824,10336,661800,16780300,3506176,25622528,2290649224,2290649224,9446784,11452416,11452416
.long 15198208,15194112,73676,83840,19087360,92092,93440,1577920,2028032,2028160,2028288
.long 2028416,2028544,2028672,2027520,936832,1133440,1330048,1526656,1723264,1919872,150400
.long 28512256,28528640,28545024,28561408,28495872,36224,1843456,25968640,592641,28435456,1064640
.long 3161792,26624,5032,50465804,3866624,24147968,2290649224,2290649224,9448192,13549568,13557760
.long 18145280,18141184,81352,85504,19726336,94128,93952,1618880,226432,225280,225408
.long 225536,225664,225792,225920,1772416,2944,199552,396160,592768,789376,985984
.long 28540928,28557312,28491776,28508160,28524544,36240,1853696,25970688,641793,28437504,1064640
.long 3161792,26656,662440,50465804,3866624,24639488,2290649224,2290649224,9448192,13549568,13557760
.long 18147328,18143232,81356,85632,19775488,94132,93952,1618880,881792,880640,880768
.long 880896,881024,881152,881280,1821568,52096,248704,445312,641920,838528,1035136
.long 28545024,28561408,28495872,28512256,28528640,36256,1863936,25972736,690945,28439552,1064640
.long 3161792,26688,5032,50465804,3866624,25131008,2290649224,2290649224,9448192,13549568,13557760
.long 18341888,18337792,81864,85760,19824640,94136,93952,1618880,1537152,1536000,1536128
.long 1536256,1536384,1536512,1536640,1870720,101248,297856,494464,691072,887680,1084288
.long 28549120,28565504,28499968,28516352,28532736,36272,1874176,25974784,740097,28441600,1064640
.long 1073741824,26720,662440,50465804,3866624,25622528,2290649224,2290649224,9448192,13549568,13549568
.long 18343936,18339840,81868,85888,19873792,94140,93952,1618880,2192512,2191360,2191488
.long 2191616,2191744,2191872,2192000,1919872,150400,347008,543616,740224,936832,1133440
.long 28553216,28569600,28504064,28520448,28536832,7680,123392,24256512,393345,27280384,1050368
.long 3147520,12288,568,50465804,1359872,24153088,2290649224,2290649224,9438400,9895936,9904128
.long 15245312,15241216,73800,69632,13631488,90560,90112,1120,82560,82688,82816
.long 82944,83072,81920,82048,983680,1180288,1376896,1573504,1770112,640,197248
.long 27525120,27541504,27557888,27574272,27508736,7696,133632,24258560,442497,27282432,1050368
.long 3147520,12320,657976,50465804,1359872,24644608,2290649224,2290649224,9438400,9895936,9904128
.long 15247360,15243264,73804,69760,13680640,90564,90112,1120,737920,738048,738176
.long 738304,738432,737280,737408,1032832,1229440,1426048,1622656,1819264,49792,246400
.long 27529216,27545600,27561984,27578368,27512832,7712,143872,24260608,491649,27284480,1050368
.long 3147520,12352,568,50465804,1359872,25136128,2290649224,2290649224,9438400,9895936,9904128
.long 15441920,15437824,74312,69888,13729792,90568,90112,1120,1393280,1393408,1393536
.long 1393664,1393792,1392640,1392768,1081984,1278592,1475200,1671808,1868416,98944,295552
.long 27533312,27549696,27566080,27582464,27516928,7728,154112,24262656,540801,27286528,1050368
.long 1073741824,12384,657976,50465804,1359872,25627648,2290649224,2290649224,9438400,9895936,9895936
.long 15443968,15439872,74316,70016,13778944,90572,90112,1120,2048640,2048768,2048896
.long 2049024,2049152,2048000,2048128,1131136,1327744,1524352,1720960,1917568,148096,344704
.long 27537408,27553792,27570176,27586560,27521024,24064,369152,24502272,393729,27444224,1058560
.long 3155712,28672,1212,16780300,1720320,24153088,2290649224,2290649224,9439808,11993088,12001280
.long 18391040,18386944,81992,71680,14417920,92608,90624,42080,245760,245888,246016
.long 246144,246272,246400,246528,640,197248,393856,590464,787072,983680,1180288
.long 27566080,27582464,27516928,27533312,27549696,24080,379392,24504320,442881,27446272,1058560
.long 3155712,28704,658620,16780300,1720320,24644608,2290649224,2290649224,9439808,11993088,12001280
.long 18393088,18388992,81996,71808,14467072,92612,90624,42080,901120,901248,901376
.long 901504,901632,901760,901888,49792,246400,443008,639616,836224,1032832,1229440
.long 27570176,27586560,27521024,27537408,27553792,24096,389632,24506368,492033,27448320,1058560
.long 3155712,28736,1212,16780300,1720320,25136128,2290649224,2290649224,9439808,11993088,12001280
.long 18587648,18583552,82504,71936,14516224,92616,90624,42080,1556480,1556608,1556736
.long 1556864,1556992,1557120,1557248,98944,295552,492160,688768,885376,1081984,1278592
.long 27574272,27508736,27525120,27541504,27557888,24112,399872,24508416,541185,27450368,1058560
.long 1073741824,28768,658620,16780300,1720320,25627648,2290649224,2290649224,9439808,11993088,11993088
.long 18589696,18585600,82508,72064,14565376,92620,90624,42080,2211840,2211968,2212096
.long 2212224,2212352,2212480,2212608,148096,344704,541312,737920,934528,1131136,1327744
.long 27578368,27512832,27529216,27545600,27561984,11776,614912,24748032,394113,27608064,1052416
.long 3149568,12288,1852,50465804,2080768,24153088,2290649224,2290649224,9441216,10420224,10428416
.long 15294464,15290368,73928,73728,15204352,91072,91136,83040,82560,82688,82816
.long 82944,83072,81920,82048,984448,1181056,1377664,1574272,1770880,1408,198016
.long 27852800,27869184,27885568,27901952,27836416,11792,625152,24750080,443265,27610112,1052416
.long 3149568,12320,659260,50465804,2080768,24644608,2290649224,2290649224,9441216,10420224,10428416
.long 15296512,15292416,73932,73856,15253504,91076,91136,83040,737920,738048,738176
.long 738304,738432,737280,737408,1033600,1230208,1426816,1623424,1820032,50560,247168
.long 27856896,27873280,27889664,27906048,27840512,11808,635392,24752128,492417,27612160,1052416
.long 3149568,12352,1852,50465804,2080768,25136128,2290649224,2290649224,9441216,10420224,10428416
.long 15491072,15486976,74440,73984,15302656,91080,91136,83040,1393280,1393408,1393536
.long 1393664,1393792,1392640,1392768,1082752,1279360,1475968,1672576,1869184,99712,296320
.long 27860992,27877376,27893760,27910144,27844608,11824,645632,24754176,541569,27614208,1052416
.long 1073741824,12384,659260,50465804,2080768,25627648,2290649224,2290649224,9441216,10420224,10420224
.long 15493120,15489024,74444,74112,15351808,91084,91136,83040,2048640,2048768,2048896
.long 2049024,2049152,2048000,2048128,1131904,1328512,1525120,1721728,1918336,148864,345472
.long 27865088,27881472,27897856,27914240,27848704,28160,860672,24993792,394497,27771904,1060608
.long 3157760,28672,2496,16780300,2441216,24153088,2290649224,2290649224,9442624,12517376,12525568
.long 18440192,18436096,82120,75776,15990784,93120,91648,124000,245760,245888,246016
.long 246144,246272,246400,246528,1408,198016,394624,591232,787840,984448,1181056
.long 27893760,27910144,27844608,27860992,27877376,28176,870912,24995840,443649,27773952,1060608
.long 3157760,28704,659904,16780300,2441216,24644608,2290649224,2290649224,9442624,12517376,12525568
.long 18442240,18438144,82124,75904,16039936,93124,91648,124000,901120,901248,901376
.long 901504,901632,901760,901888,50560,247168,443776,640384,836992,1033600,1230208
.long 27897856,27914240,27848704,27865088,27881472,28192,881152,24997888,492801,27776000,1060608
.long 3157760,28736,2496,16780300,2441216,25136128,2290649224,2290649224,9442624,12517376,12525568
.long 18636800,18632704,82632,76032,16089088,93128,91648,124000,1556480,1556608,1556736
.long 1556864,1556992,1557120,1557248,99712,296320,492928,689536,886144,1082752,1279360
.long 27901952,27836416,27852800,27869184,27885568,28208,891392,24999936,541953,27778048,1060608
.long 1073741824,28768,659904,16780300,2441216,25627648,2290649224,2290649224,9442624,12517376,12517376
.long 18638848,18634752,82636,76160,16138240,93132,91648,124000,2211840,2211968,2212096
.long 2212224,2212352,2212480,2212608,148864,345472,542080,738688,935296,1131904,1328512
.long 27906048,27840512,27856896,27873280,27889664,15872,1106432,25239552,394881,27935744,1054464
.long 3151616,12288,3136,50465804,2801664,24153088,2290649224,2290649224,9444032,10944512,10952704
.long 15343616,15339520,74056,77824,16777216,91584,92160,164960,82560,82688,82816
.long 82944,83072,81920,82048,985216,1181824,1378432,1575040,1771648,2176,198784
.long 28180480,28196864,28213248,28229632,28164096,15888,1116672,25241600,444033,27937792,1054464
.long 3151616,12320,660544,50465804,2801664,24644608,2290649224,2290649224,9444032,10944512,10952704
.long 15345664,15341568,74060,77952,16826368,91588,92160,164960,737920,738048,738176
.long 738304,738432,737280,737408,1034368,1230976,1427584,1624192,1820800,51328,247936
.long 28184576,28200960,28217344,28233728,28168192,15904,1126912,25243648,493185,27939840,1054464
.long 3151616,12352,3136,50465804,2801664,25136128,2290649224,2290649224,9444032,10944512,10952704
.long 15540224,15536128,74568,78080,16875520,91592,92160,164960,1393280,1393408,1393536
.long 1393664,1393792,1392640,1392768,1083520,1280128,1476736,1673344,1869952,100480,297088
.long 28188672,28205056,28221440,28237824,28172288,15920,1137152,25245696,542337,27941888,1054464
.long 1073741824,12384,660544,50465804,2801664,25627648,2290649224,2290649224,9444032,10944512,10944512
.long 15542272,15538176,74572,78208,16924672,91596,92160,164960,2048640,2048768,2048896
.long 2049024,2049152,2048000,2048128,1132672,1329280,1525888,1722496,1919104,149632,346240
.long 28192768,28209152,28225536,28241920,28176384,32256,1352192,25485312,395265,28099584,1062656
.long 3159808,28672,3780,16780300,3162112,24153088,2290649224,2290649224,9445440,13041664,13049856
.long 18489344,18485248,82248,79872,17563648,93632,92672,205920,245760,245888,246016
.long 246144,246272,246400,246528,2176,198784,395392,592000,788608,985216,1181824
.long 28221440,28237824,28172288,28188672,28205056,32272,1362432,25487360,444417,28101632,1062656
.long 3159808,28704,661188,16780300,3162112,24644608,2290649224,2290649224,9445440,13041664,13049856
.long 18491392,18487296,82252,80000,17612800,93636,92672,205920,901120,901248,901376
.long 901504,901632,901760,901888,51328,247936,444544,641152,837760,1034368,1230976
.long 28225536,28241920,28176384,28192768,28209152,32288,1372672,25489408,493569,28103680,1062656
.long 3159808,28736,3780,16780300,3162112,25136128,2290649224,2290649224,9445440,13041664,13049856
.long 18685952,18681856,82760,80128,17661952,93640,92672,205920,1556480,1556608,1556736
.long 1556864,1556992,1557120,1557248,100480,297088,493696,690304,886912,1083520,1280128
.long 28229632,28164096,28180480,28196864,28213248,32304,1382912,25491456,542721,28105728,1062656
.long 1073741824,28768,661188,16780300,3162112,25627648,2290649224,2290649224,9445440,13041664,13041664
.long 18688000,18683904,82764,80256,17711104,93644,92672,205920,2211840,2211968,2212096
.long 2212224,2212352,2212480,2212608,149632,346240,542848,739456,936064,1132672,1329280
.long 28233728,28168192,28184576,28200960,28217344,19968,1597952,25731072,395649,28263424,1056512
.long 3153664,12288,4420,50465804,3522560,24153088,2290649224,2290649224,9446848,11468800,11476992
.long 15392768,15388672,74184,81920,18350080,92096,93184,246880,82560,82688,82816
.long 82944,83072,81920,82048,985984,1182592,1379200,1575808,1772416,2944,199552
.long 28508160,28524544,28540928,28557312,28491776,19984,1608192,25733120,444801,28265472,1056512
.long 3153664,12320,661828,50465804,3522560,24644608,2290649224,2290649224,9446848,11468800,11476992
.long 15394816,15390720,74188,82048,18399232,92100,93184,246880,737920,738048,738176
.long 738304,738432,737280,737408,1035136,1231744,1428352,1624960,1821568,52096,248704
.long 28512256,28528640,28545024,28561408,28495872,20000,1618432,25735168,493953,28267520,1056512
.long 3153664,12352,4420,50465804,3522560,25136128,2290649224,2290649224,9446848,11468800,11476992
.long 15589376,15585280,74696,82176,18448384,92104,93184,246880,1393280,1393408,1393536
.long 1393664,1393792,1392640,1392768,1084288,1280896,1477504,1674112,1870720,101248,297856
.long 28516352,28532736,28549120,28565504,28499968,20016,1628672,25737216,543105,28269568,1056512
.long 1073741824,12384,661828,50465804,3522560,25627648,2290649224,2290649224,9446848,11468800,11468800
.long 15591424,15587328,74700,82304,18497536,92108,93184,246880,2048640,2048768,2048896
.long 2049024,2049152,2048000,2048128,1133440,1330048,1526656,1723264,1919872,150400,347008
.long 28520448,28536832,28553216,28569600,28504064,36352,1843712,25976832,396033,28427264,1064704
.long 3161856,28672,5064,16780300,3883008,24153088,2290649224,2290649224,9448256,13565952,13574144
.long 18538496,18534400,82376,83968,19136512,94144,93696,287840,245760,245888,246016
.long 246144,246272,246400,246528,2944,199552,396160,592768,789376,985984,1182592
.long 28549120,28565504,28499968,28516352,28532736,36368,1853952,25978880,445185,28429312,1064704
.long 3161856,28704,662472,16780300,3883008,24644608,2290649224,2290649224,9448256,13565952,13574144
.long 18540544,18536448,82380,84096,19185664,94148,93696,287840,901120,901248,901376
.long 901504,901632,901760,901888,52096,248704,445312,641920,838528,1035136,1231744
.long 28553216,28569600,28504064,28520448,28536832,36384,1864192,25980928,494337,28431360,1064704
.long 3161856,28736,5064,16780300,3883008,25136128,2290649224,2290649224,9448256,13565952,13574144
.long 18735104,18731008,82888,84224,19234816,94152,93696,287840,1556480,1556608,1556736
.long 1556864,1556992,1557120,1557248,101248,297856,494464,691072,887680,1084288,1280896
.long 28557312,28491776,28508160,28524544,28540928,36400,1874432,25982976,543489,28433408,1064704
.long 1073741824,28768,662472,16780300,3883008,25627648,2290649224,2290649224,9448256,13565952,13565952
.long 18737152,18733056,82892,84352,19283968,94156,93696,287840,2211840,2211968,2212096
.long 2212224,2212352,2212480,2212608,150400,347008,543616,740224,936832,1133440,1330048
.long 28561408,28495872,28512256,28528640,28545024,7808,205312,24338432,393344,27279360,1050432
.long 3147584,14336,1073741824,50465804,1073741824,24153088,0,0,1073741824,9912320,9920512
.long 15638528,15634432,74824,70144,13828096,90576,90112,1311840,103168,103296,103424
.long 103552,102400,102528,102656,1180288,1376896,1573504,1770112,640,197248,393856
.long 27533312,27549696,27566080,27582464,27516928,7824,215552,24340480,442496,27281408,1050432
.long 3147584,14368,1073741824,50465804,1073741824,24644608,0,0,1073741824,9912320,9920512
.long 15640576,15636480,74828,70272,13877248,90580,90112,1311840,758528,758656,758784
.long 758912,757760,757888,758016,1229440,1426048,1622656,1819264,49792,246400,443008
.long 27537408,27553792,27570176,27586560,27521024,7840,225792,24342528,491648,27283456,1050432
.long 3147584,14400,1073741824,50465804,1073741824,25136128,0,0,1073741824,9912320,9920512
.long 15835136,15831040,75336,70400,13926400,90584,90112,1311840,1413888,1414016,1414144
.long 1414272,1413120,1413248,1413376,1278592,1475200,1671808,1868416,98944,295552,492160
.long 27541504,27557888,27574272,27508736,27525120,7856,236032,24344576,540800,27285504,1050432
.long 1073741824,14432,1073741824,50465804,1073741824,25627648,0,0,1073741824,9912320,9912320
.long 15837184,15833088,75340,70528,13975552,90588,90112,1311840,2069248,2069376,2069504
.long 2069632,2068480,2068608,2068736,1327744,1524352,1720960,1917568,148096,344704,541312
.long 27545600,27561984,27578368,27512832,27529216,24192,451072,24584192,393728,27443200,1058624
.long 3155776,30720,1073741824,16780300,1073741824,24153088,0,0,1073741824,12009472,12017664
.long 18784256,18780160,83016,72192,14614528,92624,90624,1352800,266368,266496,266624
.long 266752,266880,267008,267136,197248,393856,590464,787072,983680,1180288,1376896
.long 27574272,27508736,27525120,27541504,27557888,24208,461312,24586240,442880,27445248,1058624
.long 3155776,30752,1073741824,16780300,1073741824,24644608,0,0,1073741824,12009472,12017664
.long 18786304,18782208,83020,72320,14663680,92628,90624,1352800,921728,921856,921984
.long 922112,922240,922368,922496,246400,443008,639616,836224,1032832,1229440,1426048
.long 27578368,27512832,27529216,27545600,27561984,24224,471552,24588288,492032,27447296,1058624
.long 3155776,30784,1073741824,16780300,1073741824,25136128,0,0,1073741824,12009472,12017664
.long 18980864,18976768,83528,72448,14712832,92632,90624,1352800,1577088,1577216,1577344
.long 1577472,1577600,1577728,1577856,295552,492160,688768,885376,1081984,1278592,1475200
.long 27582464,27516928,27533312,27549696,27566080,24240,481792,24590336,541184,27449344,1058624
.long 1073741824,30816,1073741824,16780300,1073741824,25627648,0,0,1073741824,12009472,12009472
.long 18982912,18978816,83532,72576,14761984,92636,90624,1352800,2232448,2232576,2232704
.long 2232832,2232960,2233088,2233216,344704,541312,737920,934528,1131136,1327744,1524352
.long 27586560,27521024,27537408,27553792,27570176,11904,696832,24829952,394112,27607040,1052480
.long 3149632,14336,1073741824,50465804,1073741824,24153088,0,0,1073741824,10436608,10444800
.long 15687680,15683584,74952,74240,15400960,91088,91136,1393760,103168,103296,103424
.long 103552,102400,102528,102656,1181056,1377664,1574272,1770880,1408,198016,394624
.long 27860992,27877376,27893760,27910144,27844608,11920,707072,24832000,443264,27609088,1052480
.long 3149632,14368,1073741824,50465804,1073741824,24644608,0,0,1073741824,10436608,10444800
.long 15689728,15685632,74956,74368,15450112,91092,91136,1393760,758528,758656,758784
.long 758912,757760,757888,758016,1230208,1426816,1623424,1820032,50560,247168,443776
.long 27865088,27881472,27897856,27914240,27848704,11936,717312,24834048,492416,27611136,1052480
.long 3149632,14400,1073741824,50465804,1073741824,25136128,0,0,1073741824,10436608,10444800
.long 15884288,15880192,75464,74496,15499264,91096,91136,1393760,1413888,1414016,1414144
.long 1414272,1413120,1413248,1413376,1279360,1475968,1672576,1869184,99712,296320,492928
.long 27869184,27885568,27901952,27836416,27852800,11952,727552,24836096,541568,27613184,1052480
.long 1073741824,14432,1073741824,50465804,1073741824,25627648,0,0,1073741824,10436608,10436608
.long 15886336,15882240,75468,74624,15548416,91100,91136,1393760,2069248,2069376,2069504
.long 2069632,2068480,2068608,2068736,1328512,1525120,1721728,1918336,148864,345472,542080
.long 27873280,27889664,27906048,27840512,27856896,28288,942592,25075712,394496,27770880,1060672
.long 3157824,30720,1073741824,16780300,1073741824,24153088,0,0,1073741824,12533760,12541952
.long 18833408,18829312,83144,76288,16187392,93136,91648,1434720,266368,266496,266624
.long 266752,266880,267008,267136,198016,394624,591232,787840,984448,1181056,1377664
.long 27901952,27836416,27852800,27869184,27885568,28304,952832,25077760,443648,27772928,1060672
.long 3157824,30752,1073741824,16780300,1073741824,24644608,0,0,1073741824,12533760,12541952
.long 18835456,18831360,83148,76416,16236544,93140,91648,1434720,921728,921856,921984
.long 922112,922240,922368,922496,247168,443776,640384,836992,1033600,1230208,1426816
.long 27906048,27840512,27856896,27873280,27889664,28320,963072,25079808,492800,27774976,1060672
.long 3157824,30784,1073741824,16780300,1073741824,25136128,0,0,1073741824,12533760,12541952
.long 19030016,19025920,83656,76544,16285696,93144,91648,1434720,1577088,1577216,1577344
.long 1577472,1577600,1577728,1577856,296320,492928,689536,886144,1082752,1279360,1475968
.long 27910144,27844608,27860992,27877376,27893760,28336,973312,25081856,541952,27777024,1060672
.long 1073741824,30816,1073741824,16780300,1073741824,25627648,0,0,1073741824,12533760,12533760
.long 19032064,19027968,83660,76672,16334848,93148,91648,1434720,2232448,2232576,2232704
.long 2232832,2232960,2233088,2233216,345472,542080,738688,935296,1131904,1328512,1525120
.long 27914240,27848704,27865088,27881472,27897856,16000,1188352,25321472,394880,27934720,1054528
.long 3151680,14336,1073741824,50465804,1073741824,24153088,0,0,1073741824,10960896,10969088
.long 15736832,15732736,75080,78336,16973824,91600,92160,1475680,103168,103296,103424
.long 103552,102400,102528,102656,1181824,1378432,1575040,1771648,2176,198784,395392
.long 28188672,28205056,28221440,28237824,28172288,16016,1198592,25323520,444032,27936768,1054528
.long 3151680,14368,1073741824,50465804,1073741824,24644608,0,0,1073741824,10960896,10969088
.long 15738880,15734784,75084,78464,17022976,91604,92160,1475680,758528,758656,758784
.long 758912,757760,757888,758016,1230976,1427584,1624192,1820800,51328,247936,444544
.long 28192768,28209152,28225536,28241920,28176384,16032,1208832,25325568,493184,27938816,1054528
.long 3151680,14400,1073741824,50465804,1073741824,25136128,0,0,1073741824,10960896,10969088
.long 15933440,15929344,75592,78592,17072128,91608,92160,1475680,1413888,1414016,1414144
.long 1414272,1413120,1413248,1413376,1280128,1476736,1673344,1869952,100480,297088,493696
.long 28196864,28213248,28229632,28164096,28180480,16048,1219072,25327616,542336,27940864,1054528
.long 1073741824,14432,1073741824,50465804,1073741824,25627648,0,0,1073741824,10960896,10960896
.long 15935488,15931392,75596,78720,17121280,91612,92160,1475680,2069248,2069376,2069504
.long 2069632,2068480,2068608,2068736,1329280,1525888,1722496,1919104,149632,346240,542848
.long 28200960,28217344,28233728,28168192,28184576,32384,1434112,25567232,395264,28098560,1062720
.long 3159872,30720,1073741824,16780300,1073741824,24153088,0,0,1073741824,13058048,13066240
.long 18882560,18878464,83272,80384,17760256,93648,92672,1516640,266368,266496,266624
.long 266752,266880,267008,267136,198784,395392,592000,788608,985216,1181824,1378432
.long 28229632,28164096,28180480,28196864,28213248,32400,1444352,25569280,444416,28100608,1062720
.long 3159872,30752,1073741824,16780300,1073741824,24644608,0,0,1073741824,13058048,13066240
.long 18884608,18880512,83276,80512,17809408,93652,92672,1516640,921728,921856,921984
.long 922112,922240,922368,922496,247936,444544,641152,837760,1034368,1230976,1427584
.long 28233728,28168192,28184576,28200960,28217344,32416,1454592,25571328,493568,28102656,1062720
.long 3159872,30784,1073741824,16780300,1073741824,25136128,0,0,1073741824,13058048,13066240
.long 19079168,19075072,83784,80640,17858560,93656,92672,1516640,1577088,1577216,1577344
.long 1577472,1577600,1577728,1577856,297088,493696,690304,886912,1083520,1280128,1476736
.long 28237824,28172288,28188672,28205056,28221440,32432,1464832,25573376,542720,28104704,1062720
.long 1073741824,30816,1073741824,16780300,1073741824,25627648,0,0,1073741824,13058048,13058048
.long 19081216,19077120,83788,80768,17907712,93660,92672,1516640,2232448,2232576,2232704
.long 2232832,2232960,2233088,2233216,346240,542848,739456,936064,1132672,1329280,1525888
.long 28241920,28176384,28192768,28209152,28225536,20096,1679872,25812992,395648,28262400,1056576
.long 3153728,14336,1073741824,50465804,1073741824,24153088,0,0,1073741824,11485184,11493376
.long 15785984,15781888,75208,82432,18546688,92112,93184,1557600,103168,103296,103424
.long 103552,102400,102528,102656,1182592,1379200,1575808,1772416,2944,199552,396160
.long 28516352,28532736,28549120,28565504,28499968,20112,1690112,25815040,444800,28264448,1056576
.long 3153728,14368,1073741824,50465804,1073741824,24644608,0,0,1073741824,11485184,11493376
.long 15788032,15783936,75212,82560,18595840,92116,93184,1557600,758528,758656,758784
.long 758912,757760,757888,758016,1231744,1428352,1624960,1821568,52096,248704,445312
.long 28520448,28536832,28553216,28569600,28504064,20128,1700352,25817088,493952,28266496,1056576
.long 3153728,14400,1073741824,50465804,1073741824,25136128,0,0,1073741824,11485184,11493376
.long 15982592,15978496,75720,82688,18644992,92120,93184,1557600,1413888,1414016,1414144
.long 1414272,1413120,1413248,1413376,1280896,1477504,1674112,1870720,101248,297856,494464
.long 28524544,28540928,28557312,28491776,28508160,20144,1710592,25819136,543104,28268544,1056576
.long 1073741824,14432,1073741824,50465804,1073741824,25627648,0,0,1073741824,11485184,11485184
.long 15984640,15980544,75724,82816,18694144,92124,93184,1557600,2069248,2069376,2069504
.long 2069632,2068480,2068608,2068736,1330048,1526656,1723264,1919872,150400,347008,543616
.long 28528640,28545024,28561408,28495872,28512256,36480,1925632,26058752,396032,28426240,1064768
.long 3161920,30720,1073741824,16780300,1073741824,24153088,0,0,1073741824,13582336,13590528
.long 18931712,18927616,83400,84480,19333120,94160,93696,1598560,266368,266496,266624
.long 266752,266880,267008,267136,199552,396160,592768,789376,985984,1182592,1379200
.long 28557312,28491776,28508160,28524544,28540928,36496,1935872,26060800,445184,28428288,1064768
.long 3161920,30752,1073741824,16780300,1073741824,24644608,0,0,1073741824,13582336,13590528
.long 18933760,18929664,83404,84608,19382272,94164,93696,1598560,921728,921856,921984
.long 922112,922240,922368,922496,248704,445312,641920,838528,1035136,1231744,1428352
.long 28561408,28495872,28512256,28528640,28545024,36512,1946112,26062848,494336,28430336,1064768
.long 3161920,30784,1073741824,16780300,1073741824,25136128,0,0,1073741824,13582336,13590528
.long 19128320,19124224,83912,84736,19431424,94168,93696,1598560,1577088,1577216,1577344
.long 1577472,1577600,1577728,1577856,297856,494464,691072,887680,1084288,1280896,1477504
.long 28565504,28499968,28516352,28532736,28549120,36528,1956352,26064896,543488,28432384,1064768
.long 1073741824,30816,1073741824,16780300,1073741824,25627648,0,0,1073741824,13582336,13582336
.long 19130368,19126272,83916,84864,19480576,94172,93696,1598560,2232448,2232576,2232704
.long 2232832,2232960,2233088,2233216,347008,543616,740224,936832,1133440,1330048,1526656
.long 28569600,28504064,28520448,28536832,28553216,7936,205568,24346624,196736,27271168,1050496
.long 3147648,16384,1073741824,16780300,1073741824,24153088,0,0,1073741824,9928704,9936896
.long 16031744,16027648,75848,70656,14024704,90592,90368,21600,123648,123776,123904
.long 124032,122880,123008,123136,1180288,1376896,1573504,1770112,640,197248,393856
.long 27533312,27549696,27566080,27582464,27516928,7952,215808,24348672,245888,27273216,1050496
.long 3147648,16416,1073741824,16780300,1073741824,24644608,0,0,1073741824,9928704,9936896
.long 16033792,16029696,75852,70784,14073856,90596,90368,21600,779008,779136,779264
.long 779392,778240,778368,778496,1229440,1426048,1622656,1819264,49792,246400,443008
.long 27537408,27553792,27570176,27586560,27521024,7968,226048,24350720,295040,27275264,1050496
.long 3147648,16448,1073741824,16780300,1073741824,25136128,0,0,1073741824,9928704,9936896
.long 16228352,16224256,76360,70912,14123008,90600,90368,21600,1434368,1434496,1434624
.long 1434752,1433600,1433728,1433856,1278592,1475200,1671808,1868416,98944,295552,492160
.long 27541504,27557888,27574272,27508736,27525120,7984,236288,24352768,344192,27277312,1050496
.long 1073741824,16480,1073741824,16780300,1073741824,25627648,0,0,1073741824,9928704,9928704
.long 16230400,16226304,76364,71040,14172160,90604,90368,21600,2089728,2089856,2089984
.long 2090112,2088960,2089088,2089216,1327744,1524352,1720960,1917568,148096,344704,541312
.long 27545600,27561984,27578368,27512832,27529216,24320,451328,24592384,197120,27435008,1058688
.long 3155840,32768,1073741824,50465804,1073741824,24153088,0,0,1073741824,12025856,12034048
.long 19177472,19173376,84040,72704,14811136,92640,90880,62560,286848,286976,287104
.long 287232,287360,287488,287616,197248,393856,590464,787072,983680,1180288,1376896
.long 27574272,27508736,27525120,27541504,27557888,24336,461568,24594432,246272,27437056,1058688
.long 3155840,32800,1073741824,50465804,1073741824,24644608,0,0,1073741824,12025856,12034048
.long 19179520,19175424,84044,72832,14860288,92644,90880,62560,942208,942336,942464
.long 942592,942720,942848,942976,246400,443008,639616,836224,1032832,1229440,1426048
.long 27578368,27512832,27529216,27545600,27561984,24352,471808,24596480,295424,27439104,1058688
.long 3155840,32832,1073741824,50465804,1073741824,25136128,0,0,1073741824,12025856,12034048
.long 19374080,19369984,84552,72960,14909440,92648,90880,62560,1597568,1597696,1597824
.long 1597952,1598080,1598208,1598336,295552,492160,688768,885376,1081984,1278592,1475200
.long 27582464,27516928,27533312,27549696,27566080,24368,482048,24598528,344576,27441152,1058688
.long 1073741824,32864,1073741824,50465804,1073741824,25627648,0,0,1073741824,12025856,12025856
.long 19376128,19372032,84556,73088,14958592,92652,90880,62560,2252928,2253056,2253184
.long 2253312,2253440,2253568,2253696,344704,541312,737920,934528,1131136,1327744,1524352
.long 27586560,27521024,27537408,27553792,27570176,12032,697088,24838144,197504,27598848,1052544
.long 3149696,16384,1073741824,16780300,1073741824,24153088,0,0,1073741824,10452992,10461184
.long 16080896,16076800,75976,74752,15597568,91104,91392,103520,123648,123776,123904
.long 124032,122880,123008,123136,1181056,1377664,1574272,1770880,1408,198016,394624
.long 27860992,27877376,27893760,27910144,27844608,12048,707328,24840192,246656,27600896,1052544
.long 3149696,16416,1073741824,16780300,1073741824,24644608,0,0,1073741824,10452992,10461184
.long 16082944,16078848,75980,74880,15646720,91108,91392,103520,779008,779136,779264
.long 779392,778240,778368,778496,1230208,1426816,1623424,1820032,50560,247168,443776
.long 27865088,27881472,27897856,27914240,27848704,12064,717568,24842240,295808,27602944,1052544
.long 3149696,16448,1073741824,16780300,1073741824,25136128,0,0,1073741824,10452992,10461184
.long 16277504,16273408,76488,75008,15695872,91112,91392,103520,1434368,1434496,1434624
.long 1434752,1433600,1433728,1433856,1279360,1475968,1672576,1869184,99712,296320,492928
.long 27869184,27885568,27901952,27836416,27852800,12080,727808,24844288,344960,27604992,1052544
.long 1073741824,16480,1073741824,16780300,1073741824,25627648,0,0,1073741824,10452992,10452992
.long 16279552,16275456,76492,75136,15745024,91116,91392,103520,2089728,2089856,2089984
.long 2090112,2088960,2089088,2089216,1328512,1525120,1721728,1918336,148864,345472,542080
.long 27873280,27889664,27906048,27840512,27856896,28416,942848,25083904,197888,27762688,1060736
.long 3157888,32768,1073741824,50465804,1073741824,24153088,0,0,1073741824,12550144,12558336
.long 19226624,19222528,84168,76800,16384000,93152,91904,144480,286848,286976,287104
.long 287232,287360,287488,287616,198016,394624,591232,787840,984448,1181056,1377664
.long 27901952,27836416,27852800,27869184,27885568,28432,953088,25085952,247040,27764736,1060736
.long 3157888,32800,1073741824,50465804,1073741824,24644608,0,0,1073741824,12550144,12558336
.long 19228672,19224576,84172,76928,16433152,93156,91904,144480,942208,942336,942464
.long 942592,942720,942848,942976,247168,443776,640384,836992,1033600,1230208,1426816
.long 27906048,27840512,27856896,27873280,27889664,28448,963328,25088000,296192,27766784,1060736
.long 3157888,32832,1073741824,50465804,1073741824,25136128,0,0,1073741824,12550144,12558336
.long 19423232,19419136,84680,77056,16482304,93160,91904,144480,1597568,1597696,1597824
.long 1597952,1598080,1598208,1598336,296320,492928,689536,886144,1082752,1279360,1475968
.long 27910144,27844608,27860992,27877376,27893760,28464,973568,25090048,345344,27768832,1060736
.long 1073741824,32864,1073741824,50465804,1073741824,25627648,0,0,1073741824,12550144,12550144
.long 19425280,19421184,84684,77184,16531456,93164,91904,144480,2252928,2253056,2253184
.long 2253312,2253440,2253568,2253696,345472,542080,738688,935296,1131904,1328512,1525120
.long 27914240,27848704,27865088,27881472,27897856,16128,1188608,25329664,198272,27926528,1054592
.long 3151744,16384,1073741824,16780300,1073741824,24153088,0,0,1073741824,10977280,10985472
.long 16130048,16125952,76104,78848,17170432,91616,92416,185440,123648,123776,123904
.long 124032,122880,123008,123136,1181824,1378432,1575040,1771648,2176,198784,395392
.long 28188672,28205056,28221440,28237824,28172288,16144,1198848,25331712,247424,27928576,1054592
.long 3151744,16416,1073741824,16780300,1073741824,24644608,0,0,1073741824,10977280,10985472
.long 16132096,16128000,76108,78976,17219584,91620,92416,185440,779008,779136,779264
.long 779392,778240,778368,778496,1230976,1427584,1624192,1820800,51328,247936,444544
.long 28192768,28209152,28225536,28241920,28176384,16160,1209088,25333760,296576,27930624,1054592
.long 3151744,16448,1073741824,16780300,1073741824,25136128,0,0,1073741824,10977280,10985472
.long 16326656,16322560,76616,79104,17268736,91624,92416,185440,1434368,1434496,1434624
.long 1434752,1433600,1433728,1433856,1280128,1476736,1673344,1869952,100480,297088,493696
.long 28196864,28213248,28229632,28164096,28180480,16176,1219328,25335808,345728,27932672,1054592
.long 1073741824,16480,1073741824,16780300,1073741824,25627648,0,0,1073741824,10977280,10977280
.long 16328704,16324608,76620,79232,17317888,91628,92416,185440,2089728,2089856,2089984
.long 2090112,2088960,2089088,2089216,1329280,1525888,1722496,1919104,149632,346240,542848
.long 28200960,28217344,28233728,28168192,28184576,32512,1434368,25575424,198656,28090368,1062784
.long 3159936,32768,1073741824,50465804,1073741824,24153088,0,0,1073741824,13074432,13082624
.long 19275776,19271680,84296,80896,17956864,93664,92928,226400,286848,286976,287104
.long 287232,287360,287488,287616,198784,395392,592000,788608,985216,1181824,1378432
.long 28229632,28164096,28180480,28196864,28213248,32528,1444608,25577472,247808,28092416,1062784
.long 3159936,32800,1073741824,50465804,1073741824,24644608,0,0,1073741824,13074432,13082624
.long 19277824,19273728,84300,81024,18006016,93668,92928,226400,942208,942336,942464
.long 942592,942720,942848,942976,247936,444544,641152,837760,1034368,1230976,1427584
.long 28233728,28168192,28184576,28200960,28217344,32544,1454848,25579520,296960,28094464,1062784
.long 3159936,32832,1073741824,50465804,1073741824,25136128,0,0,1073741824,13074432,13082624
.long 19472384,19468288,84808,81152,18055168,93672,92928,226400,1597568,1597696,1597824
.long 1597952,1598080,1598208,1598336,297088,493696,690304,886912,1083520,1280128,1476736
.long 28237824,28172288,28188672,28205056,28221440,32560,1465088,25581568,346112,28096512,1062784
.long 1073741824,32864,1073741824,50465804,1073741824,25627648,0,0,1073741824,13074432,13074432
.long 19474432,19470336,84812,81280,18104320,93676,92928,226400,2252928,2253056,2253184
.long 2253312,2253440,2253568,2253696,346240,542848,739456,936064,1132672,1329280,1525888
.long 28241920,28176384,28192768,28209152,28225536,20224,1680128,25821184,199040,28254208,1056640
.long 3153792,16384,1073741824,16780300,1073741824,24153088,0,0,1073741824,11501568,11509760
.long 16179200,16175104,76232,82944,18743296,92128,93440,267360,123648,123776,123904
.long 124032,122880,123008,123136,1182592,1379200,1575808,1772416,2944,199552,396160
.long 28516352,28532736,28549120,28565504,28499968,20240,1690368,25823232,248192,28256256,1056640
.long 3153792,16416,1073741824,16780300,1073741824,24644608,0,0,1073741824,11501568,11509760
.long 16181248,16177152,76236,83072,18792448,92132,93440,267360,779008,779136,779264
.long 779392,778240,778368,778496,1231744,1428352,1624960,1821568,52096,248704,445312
.long 28520448,28536832,28553216,28569600,28504064,20256,1700608,25825280,297344,28258304,1056640
.long 3153792,16448,1073741824,16780300,1073741824,25136128,0,0,1073741824,11501568,11509760
.long 16375808,16371712,76744,83200,18841600,92136,93440,267360,1434368,1434496,1434624
.long 1434752,1433600,1433728,1433856,1280896,1477504,1674112,1870720,101248,297856,494464
.long 28524544,28540928,28557312,28491776,28508160,20272,1710848,25827328,346496,28260352,1056640
.long 1073741824,16480,1073741824,16780300,1073741824,25627648,0,0,1073741824,11501568,11501568
.long 16377856,16373760,76748,83328,18890752,92140,93440,267360,2089728,2089856,2089984
.long 2090112,2088960,2089088,2089216,1330048,1526656,1723264,1919872,150400,347008,543616
.long 28528640,28545024,28561408,28495872,28512256,36608,1925888,26066944,199424,28418048,1064832
.long 3161984,32768,1073741824,50465804,1073741824,24153088,0,0,1073741824,13598720,13606912
.long 19324928,19320832,84424,84992,19529728,94176,93952,308320,286848,286976,287104
.long 287232,287360,287488,287616,199552,396160,592768,789376,985984,1182592,1379200
.long 28557312,28491776,28508160,28524544,28540928,36624,1936128,26068992,248576,28420096,1064832
.long 3161984,32800,1073741824,50465804,1073741824,24644608,0,0,1073741824,13598720,13606912
.long 19326976,19322880,84428,85120,19578880,94180,93952,308320,942208,942336,942464
.long 942592,942720,942848,942976,248704,445312,641920,838528,1035136,1231744,1428352
.long 28561408,28495872,28512256,28528640,28545024,36640,1946368,26071040,297728,28422144,1064832
.long 3161984,32832,1073741824,50465804,1073741824,25136128,0,0,1073741824,13598720,13606912
.long 19521536,19517440,84936,85248,19628032,94184,93952,308320,1597568,1597696,1597824
.long 1597952,1598080,1598208,1598336,297856,494464,691072,887680,1084288,1280896,1477504
.long 28565504,28499968,28516352,28532736,28549120,36656,1956608,26073088,346880,28424192,1064832
.long 1073741824,32864,1073741824,50465804,1073741824,25627648,0,0,1073741824,13598720,13598720
.long 19523584,19519488,84940,85376,19677184,94188,93952,308320,2252928,2253056,2253184
.long 2253312,2253440,2253568,2253696,347008,543616,740224,936832,1133440,1330048,1526656
.long 28569600,28504064,28520448,28536832,28553216,8064,205824,24354816,128,27262976,1050560
.long 3147712,18432,1073741824,50465804,1073741824,24153088,0,0,1073741824,9945088,9953280
.long 16424960,16420864,76872,71168,14221312,90608,90368,1332320,144256,144384,144512
.long 143360,143488,143616,143744,1376896,1573504,1770112,640,197248,393856,590464
.long 27541504,27557888,27574272,27508736,27525120,8080,216064,24356864,49280,27265024,1050560
.long 3147712,18464,1073741824,50465804,1073741824,24644608,0,0,1073741824,9945088,9953280
.long 16427008,16422912,76876,71296,14270464,90612,90368,1332320,799616,799744,799872
.long 798720,798848,798976,799104,1426048,1622656,1819264,49792,246400,443008,639616
.long 27545600,27561984,27578368,27512832,27529216,8096,226304,24358912,98432,27267072,1050560
.long 3147712,18496,1073741824,50465804,1073741824,25136128,0,0,1073741824,9945088,9953280
.long 16621568,16617472,77384,71424,14319616,90616,90368,1332320,1454976,1455104,1455232
.long 1454080,1454208,1454336,1454464,1475200,1671808,1868416,98944,295552,492160,688768
.long 27549696,27566080,27582464,27516928,27533312,8112,236544,24360960,147584,27269120,1050560
.long 1073741824,18528,1073741824,50465804,1073741824,25627648,0,0,1073741824,9945088,9945088
.long 16623616,16619520,77388,71552,14368768,90620,90368,1332320,2110336,2110464,2110592
.long 2109440,2109568,2109696,2109824,1524352,1720960,1917568,148096,344704,541312,737920
.long 27553792,27570176,27586560,27521024,27537408,24448,451584,24600576,512,27426816,1058752
.long 3155904,34816,1073741824,16780300,1073741824,24153088,0,0,1073741824,12042240,12050432
.long 19570688,19566592,85064,73216,15007744,92656,90880,1373280,307456,307584,307712
.long 307840,307968,308096,308224,393856,590464,787072,983680,1180288,1376896,1573504
.long 27582464,27516928,27533312,27549696,27566080,24464,461824,24602624,49664,27428864,1058752
.long 3155904,34848,1073741824,16780300,1073741824,24644608,0,0,1073741824,12042240,12050432
.long 19572736,19568640,85068,73344,15056896,92660,90880,1373280,962816,962944,963072
.long 963200,963328,963456,963584,443008,639616,836224,1032832,1229440,1426048,1622656
.long 27586560,27521024,27537408,27553792,27570176,24480,472064,24604672,98816,27430912,1058752
.long 3155904,34880,1073741824,16780300,1073741824,25136128,0,0,1073741824,12042240,12050432
.long 19767296,19763200,85576,73472,15106048,92664,90880,1373280,1618176,1618304,1618432
.long 1618560,1618688,1618816,1618944,492160,688768,885376,1081984,1278592,1475200,1671808
.long 27508736,27525120,27541504,27557888,27574272,24496,482304,24606720,147968,27432960,1058752
.long 1073741824,34912,1073741824,16780300,1073741824,25627648,0,0,1073741824,12042240,12042240
.long 19769344,19765248,85580,73600,15155200,92668,90880,1373280,2273536,2273664,2273792
.long 2273920,2274048,2274176,2274304,541312,737920,934528,1131136,1327744,1524352,1720960
.long 27512832,27529216,27545600,27561984,27578368,12160,697344,24846336,896,27590656,1052608
.long 3149760,18432,1073741824,50465804,1073741824,24153088,0,0,1073741824,10469376,10477568
.long 16474112,16470016,77000,75264,15794176,91120,91392,1414240,144256,144384,144512
.long 143360,143488,143616,143744,1377664,1574272,1770880,1408,198016,394624,591232
.long 27869184,27885568,27901952,27836416,27852800,12176,707584,24848384,50048,27592704,1052608
.long 3149760,18464,1073741824,50465804,1073741824,24644608,0,0,1073741824,10469376,10477568
.long 16476160,16472064,77004,75392,15843328,91124,91392,1414240,799616,799744,799872
.long 798720,798848,798976,799104,1426816,1623424,1820032,50560,247168,443776,640384
.long 27873280,27889664,27906048,27840512,27856896,12192,717824,24850432,99200,27594752,1052608
.long 3149760,18496,1073741824,50465804,1073741824,25136128,0,0,1073741824,10469376,10477568
.long 16670720,16666624,77512,75520,15892480,91128,91392,1414240,1454976,1455104,1455232
.long 1454080,1454208,1454336,1454464,1475968,1672576,1869184,99712,296320,492928,689536
.long 27877376,27893760,27910144,27844608,27860992,12208,728064,24852480,148352,27596800,1052608
.long 1073741824,18528,1073741824,50465804,1073741824,25627648,0,0,1073741824,10469376,10469376
.long 16672768,16668672,77516,75648,15941632,91132,91392,1414240,2110336,2110464,2110592
.long 2109440,2109568,2109696,2109824,1525120,1721728,1918336,148864,345472,542080,738688
.long 27881472,27897856,27914240,27848704,27865088,28544,943104,25092096,1280,27754496,1060800
.long 3157952,34816,1073741824,16780300,1073741824,24153088,0,0,1073741824,12566528,12574720
.long 19619840,19615744,85192,77312,16580608,93168,91904,1455200,307456,307584,307712
.long 307840,307968,308096,308224,394624,591232,787840,984448,1181056,1377664,1574272
.long 27910144,27844608,27860992,27877376,27893760,28560,953344,25094144,50432,27756544,1060800
.long 3157952,34848,1073741824,16780300,1073741824,24644608,0,0,1073741824,12566528,12574720
.long 19621888,19617792,85196,77440,16629760,93172,91904,1455200,962816,962944,963072
.long 963200,963328,963456,963584,443776,640384,836992,1033600,1230208,1426816,1623424
.long 27914240,27848704,27865088,27881472,27897856,28576,963584,25096192,99584,27758592,1060800
.long 3157952,34880,1073741824,16780300,1073741824,25136128,0,0,1073741824,12566528,12574720
.long 19816448,19812352,85704,77568,16678912,93176,91904,1455200,1618176,1618304,1618432
.long 1618560,1618688,1618816,1618944,492928,689536,886144,1082752,1279360,1475968,1672576
.long 27836416,27852800,27869184,27885568,27901952,28592,973824,25098240,148736,27760640,1060800
.long 1073741824,34912,1073741824,16780300,1073741824,25627648,0,0,1073741824,12566528,12566528
.long 19818496,19814400,85708,77696,16728064,93180,91904,1455200,2273536,2273664,2273792
.long 2273920,2274048,2274176,2274304,542080,738688,935296,1131904,1328512,1525120,1721728
.long 27840512,27856896,27873280,27889664,27906048,16256,1188864,25337856,1664,27918336,1054656
.long 3151808,18432,1073741824,50465804,1073741824,24153088,0,0,1073741824,10993664,11001856
.long 16523264,16519168,77128,79360,17367040,91632,92416,1496160,144256,144384,144512
.long 143360,143488,143616,143744,1378432,1575040,1771648,2176,198784,395392,592000
.long 28196864,28213248,28229632,28164096,28180480,16272,1199104,25339904,50816,27920384,1054656
.long 3151808,18464,1073741824,50465804,1073741824,24644608,0,0,1073741824,10993664,11001856
.long 16525312,16521216,77132,79488,17416192,91636,92416,1496160,799616,799744,799872
.long 798720,798848,798976,799104,1427584,1624192,1820800,51328,247936,444544,641152
.long 28200960,28217344,28233728,28168192,28184576,16288,1209344,25341952,99968,27922432,1054656
.long 3151808,18496,1073741824,50465804,1073741824,25136128,0,0,1073741824,10993664,11001856
.long 16719872,16715776,77640,79616,17465344,91640,92416,1496160,1454976,1455104,1455232
.long 1454080,1454208,1454336,1454464,1476736,1673344,1869952,100480,297088,493696,690304
.long 28205056,28221440,28237824,28172288,28188672,16304,1219584,25344000,149120,27924480,1054656
.long 1073741824,18528,1073741824,50465804,1073741824,25627648,0,0,1073741824,10993664,10993664
.long 16721920,16717824,77644,79744,17514496,91644,92416,1496160,2110336,2110464,2110592
.long 2109440,2109568,2109696,2109824,1525888,1722496,1919104,149632,346240,542848,739456
.long 28209152,28225536,28241920,28176384,28192768,32640,1434624,25583616,2048,28082176,1062848
.long 3160000,34816,1073741824,16780300,1073741824,24153088,0,0,1073741824,13090816,13099008
.long 19668992,19664896,85320,81408,18153472,93680,92928,1537120,307456,307584,307712
.long 307840,307968,308096,308224,395392,592000,788608,985216,1181824,1378432,1575040
.long 28237824,28172288,28188672,28205056,28221440,32656,1444864,25585664,51200,28084224,1062848
.long 3160000,34848,1073741824,16780300,1073741824,24644608,0,0,1073741824,13090816,13099008
.long 19671040,19666944,85324,81536,18202624,93684,92928,1537120,962816,962944,963072
.long 963200,963328,963456,963584,444544,641152,837760,1034368,1230976,1427584,1624192
.long 28241920,28176384,28192768,28209152,28225536,32672,1455104,25587712,100352,28086272,1062848
.long 3160000,34880,1073741824,16780300,1073741824,25136128,0,0,1073741824,13090816,13099008
.long 19865600,19861504,85832,81664,18251776,93688,92928,1537120,1618176,1618304,1618432
.long 1618560,1618688,1618816,1618944,493696,690304,886912,1083520,1280128,1476736,1673344
.long 28164096,28180480,28196864,28213248,28229632,32688,1465344,25589760,149504,28088320,1062848
.long 1073741824,34912,1073741824,16780300,1073741824,25627648,0,0,1073741824,13090816,13090816
.long 19867648,19863552,85836,81792,18300928,93692,92928,1537120,2273536,2273664,2273792
.long 2273920,2274048,2274176,2274304,542848,739456,936064,1132672,1329280,1525888,1722496
.long 28168192,28184576,28200960,28217344,28233728,20352,1680384,25829376,2432,28246016,1056704
.long 3153856,18432,1073741824,50465804,1073741824,24153088,0,0,1073741824,11517952,11526144
.long 16572416,16568320,77256,83456,18939904,92144,93440,1578080,144256,144384,144512
.long 143360,143488,143616,143744,1379200,1575808,1772416,2944,199552,396160,592768
.long 28524544,28540928,28557312,28491776,28508160,20368,1690624,25831424,51584,28248064,1056704
.long 3153856,18464,1073741824,50465804,1073741824,24644608,0,0,1073741824,11517952,11526144
.long 16574464,16570368,77260,83584,18989056,92148,93440,1578080,799616,799744,799872
.long 798720,798848,798976,799104,1428352,1624960,1821568,52096,248704,445312,641920
.long 28528640,28545024,28561408,28495872,28512256,20384,1700864,25833472,100736,28250112,1056704
.long 3153856,18496,1073741824,50465804,1073741824,25136128,0,0,1073741824,11517952,11526144
.long 16769024,16764928,77768,83712,19038208,92152,93440,1578080,1454976,1455104,1455232
.long 1454080,1454208,1454336,1454464,1477504,1674112,1870720,101248,297856,494464,691072
.long 28532736,28549120,28565504,28499968,28516352,20400,1711104,25835520,149888,28252160,1056704
.long 1073741824,18528,1073741824,50465804,1073741824,25627648,0,0,1073741824,11517952,11517952
.long 16771072,16766976,77772,83840,19087360,92156,93440,1578080,2110336,2110464,2110592
.long 2109440,2109568,2109696,2109824,1526656,1723264,1919872,150400,347008,543616,740224
.long 28536832,28553216,28569600,28504064,28520448,36736,1926144,26075136,2816,28409856,1064896
.long 3162048,34816,1073741824,16780300,1073741824,24153088,0,0,1073741824,13615104,13623296
.long 19718144,19714048,85448,85504,19726336,94192,93952,1619040,307456,307584,307712
.long 307840,307968,308096,308224,396160,592768,789376,985984,1182592,1379200,1575808
.long 28565504,28499968,28516352,28532736,28549120,36752,1936384,26077184,51968,28411904,1064896
.long 3162048,34848,1073741824,16780300,1073741824,24644608,0,0,1073741824,13615104,13623296
.long 19720192,19716096,85452,85632,19775488,94196,93952,1619040,962816,962944,963072
.long 963200,963328,963456,963584,445312,641920,838528,1035136,1231744,1428352,1624960
.long 28569600,28504064,28520448,28536832,28553216,36768,1946624,26079232,101120,28413952,1064896
.long 3162048,34880,1073741824,16780300,1073741824,25136128,0,0,1073741824,13615104,13623296
.long 19914752,19910656,85960,85760,19824640,94200,93952,1619040,1618176,1618304,1618432
.long 1618560,1618688,1618816,1618944,494464,691072,887680,1084288,1280896,1477504,1674112
.long 28491776,28508160,28524544,28540928,28557312,36784,1956864,26081280,150272,28416000,1064896
.long 1073741824,34912,1073741824,16780300,1073741824,25627648,0,0,1073741824,13615104,13615104
.long 19916800,19912704,85964,85888,19873792,94204,93952,1619040,2273536,2273664,2273792
.long 2273920,2274048,2274176,2274304,543616,740224,936832,1133440,1330048,1526656,1723264
.long 28495872,28512256,28528640,28545024,28561408
.size tab_data, 211968
.section .rodata,"a"
.p2align 6
.amdhsa_kernel parallel_sum__spectral_gfnet__glu_gated_swiglu__prompt_kernel
  .amdhsa_next_free_vgpr 512
  .amdhsa_next_free_sgpr 102
  .amdhsa_accum_offset 256
  .amdhsa_group_segment_fixed_size 0
  .amdhsa_kernarg_size 80
  .amdhsa_user_sgpr_count 2
  .amdhsa_user_sgpr_kernarg_segment_ptr 1
  .amdhsa_system_sgpr_workgroup_id_x 1
.end_amdhsa_kernel
```
